```python
import torch

def _softmax(x, axis=-1):
    return torch.softmax(x, dim=axis)

def _gelu(x):
    return torch.nn.functional.gelu(x, approximate='tanh')

def _silu(x):
    return torch.nn.functional.silu(x)

def _sigmoid(x):
    return torch.sigmoid(x)

def _layernorm(x, axis=-1, eps=1e-05):
    m = x.mean(dim=axis, keepdim=True)
    v = x.var(dim=axis, keepdim=True, unbiased=False)
    return (x - m) / torch.sqrt(v + eps)

def _scatter_add(tgt, idx, src, axis=0):
    return tgt.clone().index_add_(axis, idx, src)

def _segment_sum(src, seg, n):
    out = torch.zeros((n,) + src.shape[1:], dtype=src.dtype)
    return out.index_add_(0, seg, src)

def _pad(x, pw):
    flat = tuple((v for pair in reversed(pw) for v in pair))
    return torch.nn.functional.pad(x, flat)
kernel_name = 'adaLN_cond__grouped_kv_mqa__mixer_gmlp__prompt'

def setup_inputs():

    _w = lambda a: (lambda t: t.to(torch.bfloat16) if t.is_floating_point() else t)(torch.as_tensor(a))

    def _A_setup():
        B, S, D, H = (1, 2048, 576, 32)
        Dh = D // H
        return {'x': _w((lambda *s: torch.randn(*s, dtype=torch.bfloat16) * 0.05)(B, S, D)), 'wq': _w((lambda *s: torch.randn(*s, dtype=torch.bfloat16) * 0.05)(D, H * Dh)), 'wk': _w((lambda *s: torch.randn(*s, dtype=torch.bfloat16) * 0.05)(D, Dh)), 'wv': _w((lambda *s: torch.randn(*s, dtype=torch.bfloat16) * 0.05)(D, Dh)), 'wo': _w((lambda *s: torch.randn(*s, dtype=torch.bfloat16) * 0.05)(H * Dh, D))}
    _A_in = _A_setup()

    def _B_setup():
        B, S, D, F = (1, 2048, 576, 4608)
        Fh = F // 2
        return {'x': _w((lambda *s: torch.randn(*s, dtype=torch.bfloat16) * 0.05)(B, S, D)), 'w_in': _w((lambda *s: torch.randn(*s, dtype=torch.bfloat16) * 0.2)(D, 2 * Fh)), 'w_sp': _w(0.01 * (lambda *s: torch.randn(*s, dtype=torch.bfloat16) * 0.2)(S, S)), 'b_sp': _w(1.0 + 0.01 * (lambda *s: torch.randn(*s, dtype=torch.bfloat16) * 0.05)(S)), 'w_out': _w((lambda *s: torch.randn(*s, dtype=torch.bfloat16) * 0.05)(Fh, D))}
    _B_in = _B_setup()
    return {'A_x': _A_in['x'], 'A_wq': _A_in['wq'], 'A_wk': _A_in['wk'], 'A_wv': _A_in['wv'], 'A_wo': _A_in['wo'], 'B_x': _B_in['x'], 'B_w_in': _B_in['w_in'], 'B_w_sp': _B_in['w_sp'], 'B_b_sp': _B_in['b_sp'], 'B_w_out': _B_in['w_out'], 'c': _w((lambda *s: torch.randn(*s, dtype=torch.bfloat16) * 0.1)(1, 576) * 8.0), 'w_mod': _w((lambda *s: torch.randn(*s, dtype=torch.bfloat16) * 0.1)(576, 6 * 576) * 576 ** (-0.5) * 8.0)}

def reference(A_x, A_wq, A_wk, A_wv, A_wo, B_x, B_w_in, B_w_sp, B_b_sp, B_w_out, c, w_mod):

    def _A_ref(x, wq, wk, wv, wo):
        B, S, D = x.shape
        H = 32
        Dh = D // H
        q = (lambda x, *d: x.permute(*d))((x @ wq).reshape(B, S, H, Dh), 0, 2, 1, 3)
        k = x @ wk
        v = x @ wv
        scores = torch.einsum('bhqd,bkd->bhqk', q, k) * Dh ** (-0.5)
        p = _softmax(scores, axis=-1)
        o = torch.einsum('bhqk,bkd->bhqd', p, v)
        return (lambda x, *d: x.permute(*d))(o, 0, 2, 1, 3).reshape(B, S, H * Dh) @ wo

    def _B_ref(x, w_in, w_sp, b_sp, w_out):
        B, S, D = x.shape
        F = w_in.shape[-1]
        Fh = F // 2
        z = _gelu(torch.einsum('bsd,df->bsf', x, w_in))
        z1 = z[..., :Fh].clone()
        z2 = _layernorm(z[..., Fh:], axis=-1)
        g = torch.einsum('ts,bsf->btf', w_sp, z2) + b_sp[None, :, None]
        return torch.einsum('bsf,fd->bsd', z1 * g, w_out)
    x = A_x
    mod = (_silu(c) @ w_mod).reshape(c.shape[0], 6, 1, -1)
    sa, ca, ga, sb, cb, gb = (mod[:, 0].clone(), mod[:, 1].clone(), mod[:, 2].clone(), mod[:, 3].clone(), mod[:, 4].clone(), mod[:, 5].clone())
    h = _layernorm(x, axis=-1) * (1 + ca) + sa
    x = x + ga * _A_ref(h, A_wq, A_wk, A_wv, A_wo)
    h = _layernorm(x, axis=-1) * (1 + cb) + sb
    x = x + gb * _B_ref(h, B_w_in, B_w_sp, B_b_sp, B_w_out)
    return x
```

```asm
; @launch kernel=k0_kernel grid=(454,1,1) block=(256,1,1) lds=22528
; @launch kernel=k1_kernel grid=(256,1,1) block=(512,1,1) lds=97792
; @launch kernel=k2_kernel grid=(256,1,1) block=(512,1,1) lds=163840
; @launch kernel=k3_kernel grid=(256,1,1) block=(256,1,1) lds=160768
.amdgcn_target "amdgcn-amd-amdhsa--gfx950"
.text
.globl k0_kernel
.p2align 8
.type k0_kernel,@function
k0_kernel:
  s_load_dwordx8 s[4:11], s[0:1], 0
  s_load_dwordx4 s[12:15], s[0:1], 80
  s_load_dwordx2 s[16:17], s[0:1], 112
  s_cmp_ge_u32 s2, 454
  s_cbranch_scc1 L_pfs_k0_kernel_2
  s_getpc_b64 s[40:41]
L_pf_k0_kernel_1:
  s_add_u32 s40, s40, k0_kernel-L_pf_k0_kernel_1
  s_addc_u32 s41, s41, -1
  s_and_b32 s41, s41, 0xffff
  s_mov_b32 s42, L_end_k1_kernel-k0_kernel
  s_mov_b32 s43, 0x20000
  v_lshlrev_b32 v60, 7, v0
  buffer_load_dword v61, v60, s[40:43], 0 offen
L_pfs_k0_kernel_2:
  s_cmp_ge_u32 s2, 454
  s_cbranch_scc1 L_k0_end
  v_lshrrev_b32 v1, 6, v0
  s_nop 0
  v_readfirstlane_b32 s3, v1
  v_and_b32 v1, 63, v0
  s_add_u32 s18, s2, 418
  s_add_u32 s19, s2, 126
  s_cmp_lt_u32 s2, 36
  s_cselect_b32 s18, s18, s19
  s_sub_u32 s19, s2, 292
  s_cmp_ge_u32 s2, 292
  s_cselect_b32 s2, s19, s18
  s_waitcnt lgkmcnt(0)
  s_cmp_lt_u32 s2, 162
  s_cbranch_scc1 L_k0_mod
  s_cmp_ge_u32 s2, 418
  s_cbranch_scc1 L_k0_wq
  s_sub_u32 s18, s2, 162
  s_mov_b32 s20, s4
  s_and_b32 s21, s5, 0xffff
  s_mov_b32 s22, 2359296
  s_mov_b32 s23, 0x20000
  s_add_u32 s24, s16, 1048576
  s_addc_u32 s25, s17, 0
  s_and_b32 s25, s25, 0xffff
  s_mov_b32 s26, 2359296
  s_mov_b32 s27, 0x20000
  s_lshl_b32 s19, s18, 3
  s_lshl_b32 s32, s3, 1
  s_add_u32 s19, s19, s32
  v_lshrrev_b32 v2, 5, v1
  v_add_u32 v2, s19, v2
  v_and_b32 v3, 31, v1
  v_mul_u32_u24 v4, 1152, v2
  v_lshl_add_u32 v4, v3, 4, v4
  v_cmp_gt_u32 vcc, 24, v3
  v_mov_b32 v5, 2146435072
  s_nop 0
  v_cndmask_b32 v4, v5, v4, vcc
  buffer_load_dwordx4 v[8:11], v4, s[20:23], 0 offen
  buffer_load_dwordx4 v[12:15], v4, s[20:23], 0 offen offset:384
  buffer_load_dwordx4 v[16:19], v4, s[20:23], 0 offen offset:768
  v_lshrrev_b32 v6, 4, v2
  v_mul_u32_u24 v6, 18, v6
  v_lshrrev_b32 v7, 2, v3
  v_add_u32 v6, v6, v7
  v_lshlrev_b32 v6, 6, v6
  v_and_b32 v7, 3, v3
  v_lshl_add_u32 v6, v7, 4, v6
  v_and_b32 v7, 15, v2
  v_add_u32 v6, v6, v7
  v_lshlrev_b32 v6, 4, v6
  v_cndmask_b32 v6, v5, v6, vcc
  s_waitcnt vmcnt(0)
  v_lshlrev_b32 v32, 16, v8
  v_and_b32 v33, 0xffff0000, v8
  v_lshlrev_b32 v34, 16, v9
  v_and_b32 v35, 0xffff0000, v9
  v_lshlrev_b32 v36, 16, v10
  v_and_b32 v37, 0xffff0000, v10
  v_lshlrev_b32 v38, 16, v11
  v_and_b32 v39, 0xffff0000, v11
  v_lshlrev_b32 v40, 16, v12
  v_and_b32 v41, 0xffff0000, v12
  v_lshlrev_b32 v42, 16, v13
  v_and_b32 v43, 0xffff0000, v13
  v_lshlrev_b32 v44, 16, v14
  v_and_b32 v45, 0xffff0000, v14
  v_lshlrev_b32 v46, 16, v15
  v_and_b32 v47, 0xffff0000, v15
  v_lshlrev_b32 v48, 16, v16
  v_and_b32 v49, 0xffff0000, v16
  v_lshlrev_b32 v50, 16, v17
  v_and_b32 v51, 0xffff0000, v17
  v_lshlrev_b32 v52, 16, v18
  v_and_b32 v53, 0xffff0000, v18
  v_lshlrev_b32 v54, 16, v19
  v_and_b32 v55, 0xffff0000, v19
  v_pk_add_f32 v[20:21], v[32:33], v[34:35]
  v_pk_mul_f32 v[22:23], v[32:33], v[32:33]
  v_pk_fma_f32 v[22:23], v[34:35], v[34:35], v[22:23]
  v_pk_add_f32 v[20:21], v[20:21], v[36:37]
  v_pk_fma_f32 v[22:23], v[36:37], v[36:37], v[22:23]
  v_pk_add_f32 v[20:21], v[20:21], v[38:39]
  v_pk_fma_f32 v[22:23], v[38:39], v[38:39], v[22:23]
  v_pk_add_f32 v[20:21], v[20:21], v[40:41]
  v_pk_fma_f32 v[22:23], v[40:41], v[40:41], v[22:23]
  v_pk_add_f32 v[20:21], v[20:21], v[42:43]
  v_pk_fma_f32 v[22:23], v[42:43], v[42:43], v[22:23]
  v_pk_add_f32 v[20:21], v[20:21], v[44:45]
  v_pk_fma_f32 v[22:23], v[44:45], v[44:45], v[22:23]
  v_pk_add_f32 v[20:21], v[20:21], v[46:47]
  v_pk_fma_f32 v[22:23], v[46:47], v[46:47], v[22:23]
  v_pk_add_f32 v[20:21], v[20:21], v[48:49]
  v_pk_fma_f32 v[22:23], v[48:49], v[48:49], v[22:23]
  v_pk_add_f32 v[20:21], v[20:21], v[50:51]
  v_pk_fma_f32 v[22:23], v[50:51], v[50:51], v[22:23]
  v_pk_add_f32 v[20:21], v[20:21], v[52:53]
  v_pk_fma_f32 v[22:23], v[52:53], v[52:53], v[22:23]
  v_pk_add_f32 v[20:21], v[20:21], v[54:55]
  v_pk_fma_f32 v[22:23], v[54:55], v[54:55], v[22:23]
  v_add_f32 v20, v20, v21
  v_add_f32 v22, v22, v23
  s_nop 0
  v_add_f32_dpp v20, v20, v20 row_ror:8 row_mask:0xf bank_mask:0xf
  v_add_f32_dpp v22, v22, v22 row_ror:8 row_mask:0xf bank_mask:0xf
  s_nop 0
  v_add_f32_dpp v20, v20, v20 row_ror:4 row_mask:0xf bank_mask:0xf
  v_add_f32_dpp v22, v22, v22 row_ror:4 row_mask:0xf bank_mask:0xf
  s_nop 0
  v_add_f32_dpp v20, v20, v20 row_ror:2 row_mask:0xf bank_mask:0xf
  v_add_f32_dpp v22, v22, v22 row_ror:2 row_mask:0xf bank_mask:0xf
  s_nop 0
  v_add_f32_dpp v20, v20, v20 row_ror:1 row_mask:0xf bank_mask:0xf
  v_add_f32_dpp v22, v22, v22 row_ror:1 row_mask:0xf bank_mask:0xf
  v_mov_b32 v21, v20
  s_nop 1
  v_permlane16_swap_b32 v20, v21
  v_add_f32 v20, v20, v21
  v_mov_b32 v23, v22
  s_nop 1
  v_permlane16_swap_b32 v22, v23
  v_add_f32 v22, v22, v23
  v_mul_f32 v20, 0x3ae38e39, v20
  v_mul_f32 v22, 0x3ae38e39, v22
  v_fma_f32 v22, -v20, v20, v22
  v_max_f32 v22, 0, v22
  v_add_f32 v22, 0x3727c5ac, v22
  v_rsq_f32 v22, v22
  s_nop 0
  v_mul_f32 v20, v20, v22
  v_sub_f32 v20, 0, v20
  v_pk_fma_f32 v[32:33], v[32:33], v[22:23], v[20:21] op_sel_hi:[1,0,0]
  v_cvt_pk_f16_f32 v8, v32, v33
  v_pk_fma_f32 v[34:35], v[34:35], v[22:23], v[20:21] op_sel_hi:[1,0,0]
  v_cvt_pk_f16_f32 v9, v34, v35
  v_pk_fma_f32 v[36:37], v[36:37], v[22:23], v[20:21] op_sel_hi:[1,0,0]
  v_cvt_pk_f16_f32 v10, v36, v37
  v_pk_fma_f32 v[38:39], v[38:39], v[22:23], v[20:21] op_sel_hi:[1,0,0]
  v_cvt_pk_f16_f32 v11, v38, v39
  v_pk_fma_f32 v[40:41], v[40:41], v[22:23], v[20:21] op_sel_hi:[1,0,0]
  v_cvt_pk_f16_f32 v12, v40, v41
  v_pk_fma_f32 v[42:43], v[42:43], v[22:23], v[20:21] op_sel_hi:[1,0,0]
  v_cvt_pk_f16_f32 v13, v42, v43
  v_pk_fma_f32 v[44:45], v[44:45], v[22:23], v[20:21] op_sel_hi:[1,0,0]
  v_cvt_pk_f16_f32 v14, v44, v45
  v_pk_fma_f32 v[46:47], v[46:47], v[22:23], v[20:21] op_sel_hi:[1,0,0]
  v_cvt_pk_f16_f32 v15, v46, v47
  v_pk_fma_f32 v[48:49], v[48:49], v[22:23], v[20:21] op_sel_hi:[1,0,0]
  v_cvt_pk_f16_f32 v16, v48, v49
  v_pk_fma_f32 v[50:51], v[50:51], v[22:23], v[20:21] op_sel_hi:[1,0,0]
  v_cvt_pk_f16_f32 v17, v50, v51
  v_pk_fma_f32 v[52:53], v[52:53], v[22:23], v[20:21] op_sel_hi:[1,0,0]
  v_cvt_pk_f16_f32 v18, v52, v53
  v_pk_fma_f32 v[54:55], v[54:55], v[22:23], v[20:21] op_sel_hi:[1,0,0]
  v_cvt_pk_f16_f32 v19, v54, v55
  s_movk_i32 s36, 6144
  s_movk_i32 s37, 12288
  buffer_store_dwordx4 v[8:11], v6, s[24:27], 0 offen
  buffer_store_dwordx4 v[12:15], v6, s[24:27], s36 offen
  buffer_store_dwordx4 v[16:19], v6, s[24:27], s37 offen
  s_add_u32 s28, s16, 786432
  s_addc_u32 s29, s17, 0
  s_and_b32 s29, s29, 0xffff
  s_mov_b32 s30, 262144
  s_mov_b32 s31, 0x20000
  s_add_u32 s32, s16, 131072
  s_addc_u32 s33, s17, 0
  s_and_b32 s33, s33, 0xffff
  s_mov_b32 s34, 153600
  s_mov_b32 s35, 0x20000
  s_cmp_lg_u32 s3, 0
  s_cbranch_scc1 L_k0_nos
  v_mov_b32 v20, -1
  v_mov_b32 v21, -1
  v_mov_b32 v22, -1
  v_mov_b32 v23, -1
  v_lshlrev_b32 v7, 4, v1
  s_lshl_b32 s36, s18, 10
  buffer_store_dwordx4 v[20:23], v7, s[28:31], s36 offen
L_k0_nos:
  s_cmp_lg_u32 s3, 1
  s_cbranch_scc1 L_k0_noo
  v_mov_b32 v24, 0x3f803f80
  v_mov_b32 v25, 0x3f803f80
  v_mov_b32 v26, 0x3f803f80
  v_mov_b32 v27, 0x3f803f80
  s_lshr_b32 s36, s18, 4
  s_mul_i32 s36, s36, 9600
  s_bfe_u32 s37, s18, 0x20002
  s_mul_i32 s37, s37, 2272
  s_add_u32 s36, s36, s37
  s_bfe_u32 s37, s18, 0x10001
  s_mul_i32 s37, s37, 624
  s_add_u32 s36, s36, s37
  s_and_b32 s37, s18, 1
  s_mul_i32 s38, s37, 304
  s_add_u32 s36, s36, s38
  s_add_u32 s36, s36, 1312
  v_cmp_eq_u32 vcc, 0, v1
  s_nop 1
  v_cndmask_b32 v24, 0, v24, vcc
  v_cndmask_b32 v25, 0, v25, vcc
  v_cndmask_b32 v26, 0, v26, vcc
  v_cndmask_b32 v27, 0, v27, vcc
  v_lshlrev_b32 v7, 4, v1
  v_cmp_ge_u32 vcc, s37, v1
  s_nop 1
  v_cndmask_b32 v7, v5, v7, vcc
  buffer_store_dwordx4 v[24:27], v7, s[32:35], s36 offen
L_k0_noo:
  s_cmp_lg_u32 s3, 2
  s_cbranch_scc1 L_k0_noc
  s_cmp_ge_u32 s18, 16
  s_cbranch_scc1 L_k0_noc
  s_add_u32 s28, s16, 106496
  s_addc_u32 s29, s17, 0
  s_and_b32 s29, s29, 0xffff
  s_mov_b32 s30, 16384
  s_mov_b32 s31, 0x20000
  v_mov_b32 v20, 0
  v_mov_b32 v21, 0
  v_mov_b32 v22, 0
  v_mov_b32 v23, 0
  v_lshlrev_b32 v7, 4, v1
  s_lshl_b32 s36, s18, 10
  buffer_store_dwordx4 v[20:23], v7, s[28:31], s36 offen
L_k0_noc:
  s_cmp_lg_u32 s3, 3
  s_cbranch_scc1 L_k0_nod
  s_cmp_ge_u32 s18, 128
  s_cbranch_scc1 L_k0_nod
  s_add_u32 s28, s16, 524288
  s_addc_u32 s29, s17, 0
  s_and_b32 s29, s29, 0xffff
  s_mov_b32 s30, 131072
  s_mov_b32 s31, 0x20000
  v_mov_b32 v20, -1
  v_mov_b32 v21, -1
  v_mov_b32 v22, -1
  v_mov_b32 v23, -1
  v_lshlrev_b32 v7, 4, v1
  s_lshl_b32 s36, s18, 10
  buffer_store_dwordx4 v[20:23], v7, s[28:31], s36 offen
L_k0_nod:
  s_endpgm
L_k0_wq:
  s_sub_u32 s18, s2, 418
  s_lshl_b32 s18, s18, 2
  s_add_u32 s18, s18, s3
  s_mul_i32 s19, s18, 57
  s_lshr_b32 s19, s19, 10
  s_mul_i32 s36, s19, 18
  s_sub_u32 s36, s18, s36
  s_mul_i32 s37, s3, 5632
  s_mov_b32 s20, s6
  s_and_b32 s21, s7, 0xffff
  s_mov_b32 s22, 663552
  s_mov_b32 s23, 0x20000
  s_mov_b32 s24, s8
  s_and_b32 s25, s9, 0xffff
  s_mov_b32 s26, 20736
  s_mov_b32 s27, 0x20000
  s_mov_b32 s28, s10
  s_and_b32 s29, s11, 0xffff
  s_mov_b32 s30, 20736
  s_mov_b32 s31, 0x20000
  s_add_u32 s32, s16, 16777216
  s_addc_u32 s33, s17, 0
  s_and_b32 s33, s33, 0xffff
  s_mov_b32 s34, 737280
  s_mov_b32 s35, 0x20000
  v_lshrrev_b32 v4, 3, v1
  v_and_b32 v5, 7, v1
  v_mul_u32_u24 v2, 1152, v4
  v_lshl_add_u32 v2, v5, 4, v2
  v_lshrrev_b32 v3, 1, v5
  v_lshl_add_u32 v2, v3, 2, v2
  v_mul_u32_u24 v3, 1152, v1
  v_cmp_gt_u32 vcc, 32, v1
  v_mov_b32 v7, 2146435072
  s_mul_i32 s38, s36, 36864
  s_mul_i32 s39, s19, 144
  s_add_u32 s38, s38, s39
  v_cndmask_b32 v3, v7, v3, vcc
  buffer_load_dwordx4 v[20:23], v2, s[20:23], s38 offen
  buffer_load_dword v36, v3, s[20:23], s38 offen offset:32
  buffer_load_dword v37, v3, s[20:23], s38 offen offset:68
  buffer_load_dword v38, v3, s[20:23], s38 offen offset:104
  buffer_load_dword v39, v3, s[20:23], s38 offen offset:140
  s_add_u32 s38, s38, 9216
  buffer_load_dwordx4 v[24:27], v2, s[20:23], s38 offen
  s_add_u32 s38, s38, 9216
  buffer_load_dwordx4 v[28:31], v2, s[20:23], s38 offen
  s_add_u32 s38, s38, 9216
  buffer_load_dwordx4 v[32:35], v2, s[20:23], s38 offen
  s_add_u32 s38, s38, 9216
  v_mul_u32_u24 v8, 176, v4
  v_lshl_add_u32 v8, v5, 4, v8
  v_add_u32 v8, s37, v8
  v_mul_u32_u24 v14, 36, v1
  v_mov_b32 v15, 2146435072
  v_cmp_gt_u32 vcc, 32, v1
  s_nop 1
  v_cndmask_b32 v14, v15, v14, vcc
  v_and_b32 v15, 31, v1
  v_mul_u32_u24 v15, 176, v15
  v_lshrrev_b32 v16, 5, v1
  v_lshl_add_u32 v15, v16, 4, v15
  v_add_u32 v15, s37, v15
  s_mul_i32 s38, s36, 1152
  v_mov_b32 v40, 0
  v_mov_b32 v41, 0
  v_mov_b32 v42, 0
  v_mov_b32 v43, 0
  s_cmp_eq_u32 s19, 0
  s_cbranch_scc0 L_k0_kv1
  buffer_load_dwordx4 v[40:43], v14, s[24:27], s38 offen
L_k0_kv1:
  s_cmp_eq_u32 s19, 1
  s_cbranch_scc0 L_k0_kv2
  buffer_load_dwordx4 v[40:43], v14, s[24:27], s38 offen offset:16
L_k0_kv2:
  s_cmp_eq_u32 s19, 2
  s_cbranch_scc0 L_k0_kv3
  buffer_load_dword v40, v14, s[24:27], s38 offen offset:32
  buffer_load_dword v42, v14, s[28:31], s38 offen offset:32
L_k0_kv3:
  s_cmp_eq_u32 s19, 3
  s_cbranch_scc0 L_k0_kv4
  buffer_load_dwordx4 v[40:43], v14, s[28:31], s38 offen
L_k0_kv4:
  s_cmp_eq_u32 s19, 4
  s_cbranch_scc0 L_k0_kv5
  buffer_load_dwordx4 v[40:43], v14, s[28:31], s38 offen offset:16
L_k0_kv5:
  v_lshrrev_b32 v18, 4, v1
  v_lshlrev_b32 v18, 3, v18
  v_bfe_u32 v19, v1, 2, 2
  v_add_u32 v18, v18, v19
  v_mul_u32_u24 v18, 176, v18
  v_add_u32 v18, s37, v18
  v_and_b32 v19, 3, v1
  v_lshl_add_u32 v16, v19, 4, v18
  v_lshl_add_u32 v17, v19, 3, v18
  s_waitcnt vmcnt(0)
  ds_write_b128 v8, v[20:23] offset:0
  ds_write_b128 v8, v[24:27] offset:1408
  ds_write_b128 v8, v[28:31] offset:2816
  ds_write_b128 v8, v[32:35] offset:4224
  s_mov_b32 exec_hi, 0
  ds_write_b128 v15, v[36:39] offset:128
  s_mov_b64 exec, -1
  ds_write_b128 v15, v[40:43] offset:144
  s_waitcnt lgkmcnt(0)
  ds_read_b64_tr_b16 v[44:45], v16 offset:0
  ds_read_b64_tr_b16 v[46:47], v16 offset:704
  ds_read_b64_tr_b16 v[48:49], v16 offset:8
  ds_read_b64_tr_b16 v[50:51], v16 offset:712
  ds_read_b64_tr_b16 v[52:53], v16 offset:64
  ds_read_b64_tr_b16 v[54:55], v16 offset:768
  ds_read_b64_tr_b16 v[56:57], v16 offset:72
  ds_read_b64_tr_b16 v[58:59], v16 offset:776
  ds_read_b64_tr_b16 v[60:61], v17 offset:128
  ds_read_b64_tr_b16 v[62:63], v17 offset:832
  v_lshlrev_b32 v2, 4, v1
  s_mul_i32 s38, s18, 5120
  s_add_u32 s39, s38, 4096
  s_waitcnt lgkmcnt(0)
  buffer_store_dwordx4 v[44:47], v2, s[32:35], s38 offen offset:0
  buffer_store_dwordx4 v[48:51], v2, s[32:35], s38 offen offset:1024
  buffer_store_dwordx4 v[52:55], v2, s[32:35], s38 offen offset:2048
  buffer_store_dwordx4 v[56:59], v2, s[32:35], s38 offen offset:3072
  buffer_store_dwordx4 v[60:63], v2, s[32:35], s39 offen
L_k0_end:
  s_endpgm
L_k0_mod:
  s_mov_b32 s20, s14
  s_and_b32 s21, s15, 0xffff
  s_mov_b32 s22, 3981312
  s_mov_b32 s23, 0x20000
  s_mov_b32 s24, s12
  s_and_b32 s25, s13, 0xffff
  s_mov_b32 s26, 1152
  s_mov_b32 s27, 0x20000
  s_cmp_ge_u32 s2, 54
  s_cselect_b32 s18, 1, 0
  s_cmp_ge_u32 s2, 108
  s_cselect_b32 s18, 2, s18
  s_mul_i32 s19, s18, 54
  s_sub_u32 s19, s2, s19
  s_mul_i32 s32, s18, 192
  v_lshrrev_b32 v3, 1, v1
  v_add_u32 v3, s32, v3
  v_lshlrev_b32 v4, 1, v3
  s_movk_i32 s33, 6912
  v_mul_lo_u32 v3, v3, s33
  v_and_b32 v5, 1, v1
  s_lshl_b32 s33, s19, 7
  s_lshl_b32 s34, s3, 5
  s_add_u32 s33, s33, s34
  v_lshl_add_u32 v5, v5, 4, s33
  v_add_u32 v3, v3, v5
  buffer_load_ushort v8, v4, s[24:27], 0 offen offset:0
  buffer_load_ushort v9, v4, s[24:27], 0 offen offset:64
  buffer_load_ushort v10, v4, s[24:27], 0 offen offset:128
  buffer_load_ushort v11, v4, s[24:27], 0 offen offset:192
  buffer_load_ushort v12, v4, s[24:27], 0 offen offset:256
  buffer_load_ushort v13, v4, s[24:27], 0 offen offset:320
  s_mov_b32 s33, 0
  buffer_load_dwordx4 v[16:19], v3, s[20:23], s33 offen
  s_mov_b32 s33, 221184
  buffer_load_dwordx4 v[20:23], v3, s[20:23], s33 offen
  s_mov_b32 s33, 442368
  buffer_load_dwordx4 v[24:27], v3, s[20:23], s33 offen
  s_mov_b32 s33, 663552
  buffer_load_dwordx4 v[28:31], v3, s[20:23], s33 offen
  s_mov_b32 s33, 884736
  buffer_load_dwordx4 v[32:35], v3, s[20:23], s33 offen
  s_mov_b32 s33, 1105920
  buffer_load_dwordx4 v[36:39], v3, s[20:23], s33 offen
  s_add_u32 s28, s16, 0
  s_addc_u32 s29, s17, 0
  s_and_b32 s29, s29, 0xffff
  s_mov_b32 s30, 41472
  s_mov_b32 s31, 0x20000
  v_mov_b32 v40, 0
  v_mov_b32 v41, 0
  v_mov_b32 v42, 0
  v_mov_b32 v43, 0
  v_mov_b32 v44, 0
  v_mov_b32 v45, 0
  v_mov_b32 v46, 0
  v_mov_b32 v47, 0
  v_and_b32 v6, 1, v1
  v_lshlrev_b32 v6, 5, v6
  v_lshrrev_b32 v7, 4, v1
  v_lshl_add_u32 v6, v7, 2, v6
  v_and_b32 v7, 14, v1
  v_cmp_eq_u32 vcc, 0, v7
  v_mov_b32 v7, 2146435072
  s_nop 0
  v_cndmask_b32 v6, v7, v6, vcc
  s_mul_i32 s33, s18, 13824
  s_lshl_b32 s34, s19, 8
  s_add_u32 s33, s33, s34
  s_lshl_b32 s34, s3, 6
  s_add_u32 s33, s33, s34
  s_waitcnt vmcnt(6)
  v_lshlrev_b32 v8, 16, v8
  v_mul_f32 v48, 0xbfb8aa3b, v8
  v_lshlrev_b32 v9, 16, v9
  v_mul_f32 v49, 0xbfb8aa3b, v9
  v_lshlrev_b32 v10, 16, v10
  v_mul_f32 v50, 0xbfb8aa3b, v10
  v_lshlrev_b32 v11, 16, v11
  v_mul_f32 v51, 0xbfb8aa3b, v11
  v_lshlrev_b32 v12, 16, v12
  v_mul_f32 v52, 0xbfb8aa3b, v12
  v_lshlrev_b32 v13, 16, v13
  v_mul_f32 v53, 0xbfb8aa3b, v13
  v_exp_f32 v48, v48
  v_exp_f32 v49, v49
  v_exp_f32 v50, v50
  v_exp_f32 v51, v51
  v_exp_f32 v52, v52
  v_exp_f32 v53, v53
  v_add_f32 v48, 1.0, v48
  v_add_f32 v49, 1.0, v49
  v_add_f32 v50, 1.0, v50
  v_add_f32 v51, 1.0, v51
  v_add_f32 v52, 1.0, v52
  v_add_f32 v53, 1.0, v53
  v_rcp_f32 v48, v48
  v_rcp_f32 v49, v49
  v_rcp_f32 v50, v50
  v_rcp_f32 v51, v51
  v_rcp_f32 v52, v52
  v_rcp_f32 v53, v53
  v_mul_f32 v48, v48, v8
  v_mul_f32 v49, v49, v9
  v_mul_f32 v50, v50, v10
  v_mul_f32 v51, v51, v11
  v_mul_f32 v52, v52, v12
  v_mul_f32 v53, v53, v13
  v_cvt_pk_bf16_f32 v48, v48, v48
  v_cvt_pk_bf16_f32 v49, v49, v49
  v_cvt_pk_bf16_f32 v50, v50, v50
  v_cvt_pk_bf16_f32 v51, v51, v51
  v_cvt_pk_bf16_f32 v52, v52, v52
  v_cvt_pk_bf16_f32 v53, v53, v53
  v_lshlrev_b32 v8, 16, v48
  v_lshlrev_b32 v9, 16, v49
  v_lshlrev_b32 v10, 16, v50
  v_lshlrev_b32 v11, 16, v51
  v_lshlrev_b32 v12, 16, v52
  v_lshlrev_b32 v13, 16, v53
  s_waitcnt vmcnt(5)
  v_lshlrev_b32 v48, 16, v16
  v_and_b32 v49, 0xffff0000, v16
  v_lshlrev_b32 v50, 16, v17
  v_and_b32 v51, 0xffff0000, v17
  v_lshlrev_b32 v52, 16, v18
  v_and_b32 v53, 0xffff0000, v18
  v_lshlrev_b32 v54, 16, v19
  v_and_b32 v55, 0xffff0000, v19
  v_pk_fma_f32 v[40:41], v[48:49], v[8:9], v[40:41] op_sel:[0,0,0] op_sel_hi:[1,0,1]
  v_pk_fma_f32 v[42:43], v[50:51], v[8:9], v[42:43] op_sel:[0,0,0] op_sel_hi:[1,0,1]
  v_pk_fma_f32 v[44:45], v[52:53], v[8:9], v[44:45] op_sel:[0,0,0] op_sel_hi:[1,0,1]
  v_pk_fma_f32 v[46:47], v[54:55], v[8:9], v[46:47] op_sel:[0,0,0] op_sel_hi:[1,0,1]
  s_waitcnt vmcnt(4)
  v_lshlrev_b32 v48, 16, v20
  v_and_b32 v49, 0xffff0000, v20
  v_lshlrev_b32 v50, 16, v21
  v_and_b32 v51, 0xffff0000, v21
  v_lshlrev_b32 v52, 16, v22
  v_and_b32 v53, 0xffff0000, v22
  v_lshlrev_b32 v54, 16, v23
  v_and_b32 v55, 0xffff0000, v23
  v_pk_fma_f32 v[40:41], v[48:49], v[8:9], v[40:41] op_sel:[0,1,0] op_sel_hi:[1,1,1]
  v_pk_fma_f32 v[42:43], v[50:51], v[8:9], v[42:43] op_sel:[0,1,0] op_sel_hi:[1,1,1]
  v_pk_fma_f32 v[44:45], v[52:53], v[8:9], v[44:45] op_sel:[0,1,0] op_sel_hi:[1,1,1]
  v_pk_fma_f32 v[46:47], v[54:55], v[8:9], v[46:47] op_sel:[0,1,0] op_sel_hi:[1,1,1]
  s_waitcnt vmcnt(3)
  v_lshlrev_b32 v48, 16, v24
  v_and_b32 v49, 0xffff0000, v24
  v_lshlrev_b32 v50, 16, v25
  v_and_b32 v51, 0xffff0000, v25
  v_lshlrev_b32 v52, 16, v26
  v_and_b32 v53, 0xffff0000, v26
  v_lshlrev_b32 v54, 16, v27
  v_and_b32 v55, 0xffff0000, v27
  v_pk_fma_f32 v[40:41], v[48:49], v[10:11], v[40:41] op_sel:[0,0,0] op_sel_hi:[1,0,1]
  v_pk_fma_f32 v[42:43], v[50:51], v[10:11], v[42:43] op_sel:[0,0,0] op_sel_hi:[1,0,1]
  v_pk_fma_f32 v[44:45], v[52:53], v[10:11], v[44:45] op_sel:[0,0,0] op_sel_hi:[1,0,1]
  v_pk_fma_f32 v[46:47], v[54:55], v[10:11], v[46:47] op_sel:[0,0,0] op_sel_hi:[1,0,1]
  s_waitcnt vmcnt(2)
  v_lshlrev_b32 v48, 16, v28
  v_and_b32 v49, 0xffff0000, v28
  v_lshlrev_b32 v50, 16, v29
  v_and_b32 v51, 0xffff0000, v29
  v_lshlrev_b32 v52, 16, v30
  v_and_b32 v53, 0xffff0000, v30
  v_lshlrev_b32 v54, 16, v31
  v_and_b32 v55, 0xffff0000, v31
  v_pk_fma_f32 v[40:41], v[48:49], v[10:11], v[40:41] op_sel:[0,1,0] op_sel_hi:[1,1,1]
  v_pk_fma_f32 v[42:43], v[50:51], v[10:11], v[42:43] op_sel:[0,1,0] op_sel_hi:[1,1,1]
  v_pk_fma_f32 v[44:45], v[52:53], v[10:11], v[44:45] op_sel:[0,1,0] op_sel_hi:[1,1,1]
  v_pk_fma_f32 v[46:47], v[54:55], v[10:11], v[46:47] op_sel:[0,1,0] op_sel_hi:[1,1,1]
  s_waitcnt vmcnt(1)
  v_lshlrev_b32 v48, 16, v32
  v_and_b32 v49, 0xffff0000, v32
  v_lshlrev_b32 v50, 16, v33
  v_and_b32 v51, 0xffff0000, v33
  v_lshlrev_b32 v52, 16, v34
  v_and_b32 v53, 0xffff0000, v34
  v_lshlrev_b32 v54, 16, v35
  v_and_b32 v55, 0xffff0000, v35
  v_pk_fma_f32 v[40:41], v[48:49], v[12:13], v[40:41] op_sel:[0,0,0] op_sel_hi:[1,0,1]
  v_pk_fma_f32 v[42:43], v[50:51], v[12:13], v[42:43] op_sel:[0,0,0] op_sel_hi:[1,0,1]
  v_pk_fma_f32 v[44:45], v[52:53], v[12:13], v[44:45] op_sel:[0,0,0] op_sel_hi:[1,0,1]
  v_pk_fma_f32 v[46:47], v[54:55], v[12:13], v[46:47] op_sel:[0,0,0] op_sel_hi:[1,0,1]
  s_waitcnt vmcnt(0)
  v_lshlrev_b32 v48, 16, v36
  v_and_b32 v49, 0xffff0000, v36
  v_lshlrev_b32 v50, 16, v37
  v_and_b32 v51, 0xffff0000, v37
  v_lshlrev_b32 v52, 16, v38
  v_and_b32 v53, 0xffff0000, v38
  v_lshlrev_b32 v54, 16, v39
  v_and_b32 v55, 0xffff0000, v39
  v_pk_fma_f32 v[40:41], v[48:49], v[12:13], v[40:41] op_sel:[0,1,0] op_sel_hi:[1,1,1]
  v_pk_fma_f32 v[42:43], v[50:51], v[12:13], v[42:43] op_sel:[0,1,0] op_sel_hi:[1,1,1]
  v_pk_fma_f32 v[44:45], v[52:53], v[12:13], v[44:45] op_sel:[0,1,0] op_sel_hi:[1,1,1]
  v_pk_fma_f32 v[46:47], v[54:55], v[12:13], v[46:47] op_sel:[0,1,0] op_sel_hi:[1,1,1]
  v_add_f32_dpp v40, v40, v40 quad_perm:[2,3,0,1] row_mask:0xf bank_mask:0xf
  v_add_f32_dpp v41, v41, v41 quad_perm:[2,3,0,1] row_mask:0xf bank_mask:0xf
  v_add_f32_dpp v42, v42, v42 quad_perm:[2,3,0,1] row_mask:0xf bank_mask:0xf
  v_add_f32_dpp v43, v43, v43 quad_perm:[2,3,0,1] row_mask:0xf bank_mask:0xf
  v_add_f32_dpp v44, v44, v44 quad_perm:[2,3,0,1] row_mask:0xf bank_mask:0xf
  v_add_f32_dpp v45, v45, v45 quad_perm:[2,3,0,1] row_mask:0xf bank_mask:0xf
  v_add_f32_dpp v46, v46, v46 quad_perm:[2,3,0,1] row_mask:0xf bank_mask:0xf
  v_add_f32_dpp v47, v47, v47 quad_perm:[2,3,0,1] row_mask:0xf bank_mask:0xf
  v_add_f32_dpp v40, v40, v40 row_ror:4 row_mask:0xf bank_mask:0xf
  v_add_f32_dpp v41, v41, v41 row_ror:4 row_mask:0xf bank_mask:0xf
  v_add_f32_dpp v42, v42, v42 row_ror:4 row_mask:0xf bank_mask:0xf
  v_add_f32_dpp v43, v43, v43 row_ror:4 row_mask:0xf bank_mask:0xf
  v_add_f32_dpp v44, v44, v44 row_ror:4 row_mask:0xf bank_mask:0xf
  v_add_f32_dpp v45, v45, v45 row_ror:4 row_mask:0xf bank_mask:0xf
  v_add_f32_dpp v46, v46, v46 row_ror:4 row_mask:0xf bank_mask:0xf
  v_add_f32_dpp v47, v47, v47 row_ror:4 row_mask:0xf bank_mask:0xf
  v_add_f32_dpp v40, v40, v40 row_ror:8 row_mask:0xf bank_mask:0xf
  v_add_f32_dpp v41, v41, v41 row_ror:8 row_mask:0xf bank_mask:0xf
  v_add_f32_dpp v42, v42, v42 row_ror:8 row_mask:0xf bank_mask:0xf
  v_add_f32_dpp v43, v43, v43 row_ror:8 row_mask:0xf bank_mask:0xf
  v_add_f32_dpp v44, v44, v44 row_ror:8 row_mask:0xf bank_mask:0xf
  v_add_f32_dpp v45, v45, v45 row_ror:8 row_mask:0xf bank_mask:0xf
  v_add_f32_dpp v46, v46, v46 row_ror:8 row_mask:0xf bank_mask:0xf
  v_add_f32_dpp v47, v47, v47 row_ror:8 row_mask:0xf bank_mask:0xf
  v_permlane16_swap_b32 v40, v41
  v_permlane16_swap_b32 v42, v43
  v_permlane16_swap_b32 v44, v45
  v_permlane16_swap_b32 v46, v47
  v_add_f32 v40, v40, v41
  v_add_f32 v42, v42, v43
  v_add_f32 v44, v44, v45
  v_add_f32 v46, v46, v47
  v_permlane32_swap_b32 v40, v42
  s_nop 0
  v_permlane32_swap_b32 v44, v46
  v_add_f32 v40, v40, v42
  v_add_f32 v44, v44, v46
  buffer_store_dword v40, v6, s[28:31], s33 offen
  buffer_store_dword v44, v6, s[28:31], s33 offen offset:16
  s_endpgm
L_end_k0_kernel:
.section .rodata,"a"
.p2align 6
.amdhsa_kernel k0_kernel
  .amdhsa_next_free_vgpr 64
  .amdhsa_next_free_sgpr 48
  .amdhsa_accum_offset 64
  .amdhsa_group_segment_fixed_size 0
  .amdhsa_kernarg_size 120
  .amdhsa_user_sgpr_count 2
  .amdhsa_user_sgpr_kernarg_segment_ptr 1
  .amdhsa_system_sgpr_workgroup_id_x 1
  .amdhsa_float_denorm_mode_32 3
.end_amdhsa_kernel
.text
.globl k1_kernel
.p2align 8
.type k1_kernel,@function
k1_kernel:
  s_cmp_ge_u32 s2, 256
  s_cbranch_scc1 L_k1_end
  s_load_dwordx2 s[16:17], s[0:1], 112
  v_lshrrev_b32 v1, 6, v0
  s_nop 0
  v_readfirstlane_b32 s3, v1
  s_and_b32 s6, s2, 7
  s_lshr_b32 s7, s2, 3
  s_lshr_b32 s4, s6, 1
  s_lshl_b32 s4, s4, 3
  s_and_b32 s5, s7, 7
  s_add_u32 s4, s4, s5
  s_and_b32 s5, s6, 1
  s_lshl_b32 s5, s5, 2
  s_lshr_b32 s7, s7, 3
  s_add_u32 s5, s5, s7
  v_and_b32 v1, 63, v0
  v_lshlrev_b32 v2, 4, v1
  s_cmp_ge_u32 s3, 4
  s_cbranch_scc1 L_k1_ld
  s_movk_i32 s8, 13824
  s_movk_i32 s9, 27648
  s_lshl_b32 s10, s4, 2
  s_add_u32 s10, s10, s3
  s_mul_i32 s11, s10, 18432
  s_mul_i32 s12, s3, 72
  v_add_u32 v3, s12, v1
  v_cmp_gt_u32 vcc, 8, v1
  v_lshlrev_b32 v3, 4, v3
  v_add_u32 v4, 1024, v3
  v_mov_b32 v5, 2146435072
  v_cndmask_b32 v4, v5, v4, vcc
  s_waitcnt lgkmcnt(0)
  s_add_u32 s20, s16, 0
  s_addc_u32 s21, s17, 0
  s_and_b32 s21, s21, 0xffff
  s_mov_b32 s22, 41472
  s_mov_b32 s23, 0x20000
  buffer_load_dwordx4 v[8:11], v3, s[20:23], 0 offen
  buffer_load_dwordx4 v[12:15], v3, s[20:23], s8 offen
  buffer_load_dwordx4 v[16:19], v3, s[20:23], s9 offen
  buffer_load_dwordx4 v[20:23], v4, s[20:23], 0 offen
  buffer_load_dwordx4 v[24:27], v4, s[20:23], s8 offen
  buffer_load_dwordx4 v[28:31], v4, s[20:23], s9 offen
  s_add_u32 s24, s16, 1048576
  s_addc_u32 s25, s17, 0
  s_and_b32 s25, s25, 0xffff
  s_mov_b32 s26, 2359296
  s_mov_b32 s27, 0x20000
  buffer_load_dwordx4 v[64:67], v2, s[24:27], s11 offen offset:0
  buffer_load_dwordx4 v[68:71], v2, s[24:27], s11 offen offset:1024
  buffer_load_dwordx4 v[72:75], v2, s[24:27], s11 offen offset:2048
  buffer_load_dwordx4 v[76:79], v2, s[24:27], s11 offen offset:3072
  s_add_u32 s11, s11, 4096
  buffer_load_dwordx4 v[80:83], v2, s[24:27], s11 offen offset:0
  buffer_load_dwordx4 v[84:87], v2, s[24:27], s11 offen offset:1024
  buffer_load_dwordx4 v[88:91], v2, s[24:27], s11 offen offset:2048
  v_mov_b32 v40, 0
  v_mov_b32 v41, 0
  v_mov_b32 v42, 0
  v_mov_b32 v43, 0
  v_mov_b32 v44, 0
  v_mov_b32 v45, 0
  v_mov_b32 v46, 0
  v_mov_b32 v47, 0
  v_mov_b32 v48, 0
  v_mov_b32 v49, 0
  v_mov_b32 v50, 0
  v_mov_b32 v51, 0
  v_mov_b32 v52, 0
  v_mov_b32 v53, 0
  v_mov_b32 v54, 0
  v_mov_b32 v55, 0
  v_mov_b32 v56, 0
  v_mov_b32 v57, 0
  v_mov_b32 v58, 0
  v_mov_b32 v59, 0
  s_cmp_ge_u32 s3, 2
  s_cselect_b32 s12, 1.0, 0
  s_waitcnt vmcnt(7)
  v_pk_add_f32 v[8:9], v[8:9], v[12:13]
  v_pk_add_f32 v[10:11], v[10:11], v[14:15]
  v_pk_add_f32 v[20:21], v[20:21], v[24:25]
  v_pk_add_f32 v[22:23], v[22:23], v[26:27]
  v_pk_add_f32 v[8:9], v[8:9], v[16:17]
  v_pk_add_f32 v[10:11], v[10:11], v[18:19]
  v_pk_add_f32 v[20:21], v[20:21], v[28:29]
  v_pk_add_f32 v[22:23], v[22:23], v[30:31]
  v_cvt_pk_bf16_f32 v14, v8, v9
  v_lshlrev_b32 v8, 16, v14
  v_and_b32 v9, 0xffff0000, v14
  v_cvt_pk_bf16_f32 v14, v10, v11
  v_lshlrev_b32 v10, 16, v14
  v_and_b32 v11, 0xffff0000, v14
  v_cvt_pk_bf16_f32 v14, v20, v21
  v_lshlrev_b32 v20, 16, v14
  v_and_b32 v21, 0xffff0000, v14
  v_cvt_pk_bf16_f32 v14, v22, v23
  v_lshlrev_b32 v22, 16, v14
  v_and_b32 v23, 0xffff0000, v14
  v_add_f32 v8, s12, v8
  v_add_f32 v9, s12, v9
  v_add_f32 v10, s12, v10
  v_add_f32 v11, s12, v11
  v_add_f32 v20, s12, v20
  v_add_f32 v21, s12, v21
  v_add_f32 v22, s12, v22
  v_add_f32 v23, s12, v23
  v_cvt_pk_bf16_f32 v14, v8, v9
  v_lshlrev_b32 v8, 16, v14
  v_and_b32 v9, 0xffff0000, v14
  v_cvt_pk_bf16_f32 v14, v10, v11
  v_lshlrev_b32 v10, 16, v14
  v_and_b32 v11, 0xffff0000, v14
  v_cvt_pk_bf16_f32 v14, v20, v21
  v_lshlrev_b32 v20, 16, v14
  v_and_b32 v21, 0xffff0000, v14
  v_cvt_pk_bf16_f32 v14, v22, v23
  v_lshlrev_b32 v22, 16, v14
  v_and_b32 v23, 0xffff0000, v14
  v_add_u32 v3, 92160, v3
  ds_write_b128 v3, v[8:11]
  s_mov_b64 exec, 0xff
  ds_write_b128 v3, v[20:23] offset:1024
  s_mov_b64 exec, -1
  v_lshrrev_b32 v4, 4, v1
  v_lshlrev_b32 v4, 5, v4
  v_add_u32 v4, 92160, v4
  v_add_u32 v5, 0x10000, v2
  s_waitcnt lgkmcnt(0)
  s_barrier
  ds_read_b128 v[8:11], v4 offset:2304
  ds_read_b128 v[12:15], v4 offset:2320
  ds_read_b128 v[16:19], v4 offset:0
  ds_read_b128 v[20:23], v4 offset:16
  ds_read_b128 v[24:27], v4 offset:2432
  ds_read_b128 v[28:31], v4 offset:2448
  ds_read_b128 v[32:35], v4 offset:128
  ds_read_b128 v[36:39], v4 offset:144
  ds_read_b128 v[140:143], v2 offset:0
  ds_read_b128 v[144:147], v2 offset:1024
  ds_read_b128 v[148:151], v2 offset:2048
  ds_read_b128 v[152:155], v2 offset:3072
  ds_read_b128 v[156:159], v2 offset:4096
  ds_read_b128 v[160:163], v2 offset:5120
  ds_read_b128 v[164:167], v2 offset:6144
  ds_read_b128 v[168:171], v2 offset:7168
  ds_read_b128 v[172:175], v2 offset:8192
  ds_read_b128 v[176:179], v2 offset:9216
  s_waitcnt vmcnt(6)
  s_waitcnt lgkmcnt(14)
  v_fma_mix_f32 v180, v64, v8, v16 op_sel:[0,0,0] op_sel_hi:[1,0,0]
  v_fma_mix_f32 v181, v64, v9, v17 op_sel:[1,0,0] op_sel_hi:[1,0,0]
  v_fma_mix_f32 v182, v65, v10, v18 op_sel:[0,0,0] op_sel_hi:[1,0,0]
  v_fma_mix_f32 v183, v65, v11, v19 op_sel:[1,0,0] op_sel_hi:[1,0,0]
  v_fma_mix_f32 v184, v66, v12, v20 op_sel:[0,0,0] op_sel_hi:[1,0,0]
  v_fma_mix_f32 v185, v66, v13, v21 op_sel:[1,0,0] op_sel_hi:[1,0,0]
  v_fma_mix_f32 v186, v67, v14, v22 op_sel:[0,0,0] op_sel_hi:[1,0,0]
  v_fma_mix_f32 v187, v67, v15, v23 op_sel:[1,0,0] op_sel_hi:[1,0,0]
  v_cvt_pk_bf16_f32 v64, v180, v181
  v_cvt_pk_bf16_f32 v65, v182, v183
  v_cvt_pk_bf16_f32 v66, v184, v185
  v_cvt_pk_bf16_f32 v67, v186, v187
  s_waitcnt vmcnt(5)
  s_waitcnt lgkmcnt(5)
  v_mfma_f32_16x16x32_bf16 v[40:43], v[140:143], v[64:67], v[40:43]
  ds_read_b128 v[8:11], v4 offset:2560
  ds_read_b128 v[12:15], v4 offset:2576
  v_fma_mix_f32 v180, v68, v24, v32 op_sel:[0,0,0] op_sel_hi:[1,0,0]
  v_fma_mix_f32 v181, v68, v25, v33 op_sel:[1,0,0] op_sel_hi:[1,0,0]
  v_mfma_f32_16x16x32_bf16 v[44:47], v[144:147], v[64:67], v[44:47]
  ds_read_b128 v[16:19], v4 offset:256
  ds_read_b128 v[20:23], v4 offset:272
  v_fma_mix_f32 v182, v69, v26, v34 op_sel:[0,0,0] op_sel_hi:[1,0,0]
  v_fma_mix_f32 v183, v69, v27, v35 op_sel:[1,0,0] op_sel_hi:[1,0,0]
  v_mfma_f32_16x16x32_bf16 v[48:51], v[148:151], v[64:67], v[48:51]
  ds_read_b128 v[188:191], v2 offset:10240
  ds_read_b128 v[192:195], v2 offset:11264
  v_fma_mix_f32 v184, v70, v28, v36 op_sel:[0,0,0] op_sel_hi:[1,0,0]
  v_fma_mix_f32 v185, v70, v29, v37 op_sel:[1,0,0] op_sel_hi:[1,0,0]
  v_fma_mix_f32 v186, v71, v30, v38 op_sel:[0,0,0] op_sel_hi:[1,0,0]
  v_mfma_f32_16x16x32_bf16 v[52:55], v[152:155], v[64:67], v[52:55]
  ds_read_b128 v[196:199], v2 offset:12288
  ds_read_b128 v[200:203], v2 offset:13312
  buffer_load_dwordx4 v[92:95], v2, s[24:27], s11 offen offset:3072
  v_fma_mix_f32 v187, v71, v31, v39 op_sel:[1,0,0] op_sel_hi:[1,0,0]
  v_cvt_pk_bf16_f32 v68, v180, v181
  v_mfma_f32_16x16x32_bf16 v[56:59], v[156:159], v[64:67], v[56:59]
  ds_read_b128 v[204:207], v2 offset:14336
  v_cvt_pk_bf16_f32 v69, v182, v183
  v_cvt_pk_bf16_f32 v70, v184, v185
  v_cvt_pk_bf16_f32 v71, v186, v187
  s_waitcnt vmcnt(5)
  s_waitcnt lgkmcnt(5)
  v_mfma_f32_16x16x32_bf16 v[40:43], v[160:163], v[68:71], v[40:43]
  ds_read_b128 v[24:27], v4 offset:2688
  ds_read_b128 v[28:31], v4 offset:2704
  v_fma_mix_f32 v180, v72, v8, v16 op_sel:[0,0,0] op_sel_hi:[1,0,0]
  v_fma_mix_f32 v181, v72, v9, v17 op_sel:[1,0,0] op_sel_hi:[1,0,0]
  v_mfma_f32_16x16x32_bf16 v[44:47], v[164:167], v[68:71], v[44:47]
  ds_read_b128 v[32:35], v4 offset:384
  ds_read_b128 v[36:39], v4 offset:400
  v_fma_mix_f32 v182, v73, v10, v18 op_sel:[0,0,0] op_sel_hi:[1,0,0]
  v_fma_mix_f32 v183, v73, v11, v19 op_sel:[1,0,0] op_sel_hi:[1,0,0]
  v_mfma_f32_16x16x32_bf16 v[48:51], v[168:171], v[68:71], v[48:51]
  ds_read_b128 v[140:143], v2 offset:15360
  ds_read_b128 v[144:147], v2 offset:16384
  v_fma_mix_f32 v184, v74, v12, v20 op_sel:[0,0,0] op_sel_hi:[1,0,0]
  v_fma_mix_f32 v185, v74, v13, v21 op_sel:[1,0,0] op_sel_hi:[1,0,0]
  v_fma_mix_f32 v186, v75, v14, v22 op_sel:[0,0,0] op_sel_hi:[1,0,0]
  v_mfma_f32_16x16x32_bf16 v[52:55], v[172:175], v[68:71], v[52:55]
  ds_read_b128 v[148:151], v2 offset:17408
  ds_read_b128 v[152:155], v2 offset:18432
  s_add_u32 s11, s11, 4096
  buffer_load_dwordx4 v[96:99], v2, s[24:27], s11 offen offset:0
  v_fma_mix_f32 v187, v75, v15, v23 op_sel:[1,0,0] op_sel_hi:[1,0,0]
  v_cvt_pk_bf16_f32 v72, v180, v181
  v_mfma_f32_16x16x32_bf16 v[56:59], v[176:179], v[68:71], v[56:59]
  ds_read_b128 v[156:159], v2 offset:19456
  v_cvt_pk_bf16_f32 v73, v182, v183
  v_cvt_pk_bf16_f32 v74, v184, v185
  v_cvt_pk_bf16_f32 v75, v186, v187
  s_barrier
  s_waitcnt vmcnt(5)
  s_waitcnt lgkmcnt(5)
  v_mfma_f32_16x16x32_bf16 v[40:43], v[188:191], v[72:75], v[40:43]
  ds_read_b128 v[8:11], v4 offset:2816
  ds_read_b128 v[12:15], v4 offset:2832
  v_fma_mix_f32 v180, v76, v24, v32 op_sel:[0,0,0] op_sel_hi:[1,0,0]
  v_fma_mix_f32 v181, v76, v25, v33 op_sel:[1,0,0] op_sel_hi:[1,0,0]
  v_mfma_f32_16x16x32_bf16 v[44:47], v[192:195], v[72:75], v[44:47]
  ds_read_b128 v[16:19], v4 offset:512
  ds_read_b128 v[20:23], v4 offset:528
  v_fma_mix_f32 v182, v77, v26, v34 op_sel:[0,0,0] op_sel_hi:[1,0,0]
  v_fma_mix_f32 v183, v77, v27, v35 op_sel:[1,0,0] op_sel_hi:[1,0,0]
  v_mfma_f32_16x16x32_bf16 v[48:51], v[196:199], v[72:75], v[48:51]
  ds_read_b128 v[160:163], v2 offset:20480
  ds_read_b128 v[164:167], v2 offset:21504
  v_fma_mix_f32 v184, v78, v28, v36 op_sel:[0,0,0] op_sel_hi:[1,0,0]
  v_fma_mix_f32 v185, v78, v29, v37 op_sel:[1,0,0] op_sel_hi:[1,0,0]
  v_fma_mix_f32 v186, v79, v30, v38 op_sel:[0,0,0] op_sel_hi:[1,0,0]
  v_mfma_f32_16x16x32_bf16 v[52:55], v[200:203], v[72:75], v[52:55]
  ds_read_b128 v[168:171], v2 offset:22528
  ds_read_b128 v[172:175], v2 offset:23552
  buffer_load_dwordx4 v[100:103], v2, s[24:27], s11 offen offset:1024
  v_fma_mix_f32 v187, v79, v31, v39 op_sel:[1,0,0] op_sel_hi:[1,0,0]
  v_cvt_pk_bf16_f32 v76, v180, v181
  v_mfma_f32_16x16x32_bf16 v[56:59], v[204:207], v[72:75], v[56:59]
  ds_read_b128 v[176:179], v2 offset:24576
  v_cvt_pk_bf16_f32 v77, v182, v183
  v_cvt_pk_bf16_f32 v78, v184, v185
  v_cvt_pk_bf16_f32 v79, v186, v187
  s_waitcnt vmcnt(5)
  s_waitcnt lgkmcnt(5)
  v_mfma_f32_16x16x32_bf16 v[40:43], v[140:143], v[76:79], v[40:43]
  ds_read_b128 v[24:27], v4 offset:2944
  ds_read_b128 v[28:31], v4 offset:2960
  v_fma_mix_f32 v180, v80, v8, v16 op_sel:[0,0,0] op_sel_hi:[1,0,0]
  v_fma_mix_f32 v181, v80, v9, v17 op_sel:[1,0,0] op_sel_hi:[1,0,0]
  v_mfma_f32_16x16x32_bf16 v[44:47], v[144:147], v[76:79], v[44:47]
  ds_read_b128 v[32:35], v4 offset:640
  ds_read_b128 v[36:39], v4 offset:656
  v_fma_mix_f32 v182, v81, v10, v18 op_sel:[0,0,0] op_sel_hi:[1,0,0]
  v_fma_mix_f32 v183, v81, v11, v19 op_sel:[1,0,0] op_sel_hi:[1,0,0]
  v_mfma_f32_16x16x32_bf16 v[48:51], v[148:151], v[76:79], v[48:51]
  ds_read_b128 v[188:191], v2 offset:25600
  ds_read_b128 v[192:195], v2 offset:26624
  v_fma_mix_f32 v184, v82, v12, v20 op_sel:[0,0,0] op_sel_hi:[1,0,0]
  v_fma_mix_f32 v185, v82, v13, v21 op_sel:[1,0,0] op_sel_hi:[1,0,0]
  v_fma_mix_f32 v186, v83, v14, v22 op_sel:[0,0,0] op_sel_hi:[1,0,0]
  v_mfma_f32_16x16x32_bf16 v[52:55], v[152:155], v[76:79], v[52:55]
  ds_read_b128 v[196:199], v2 offset:27648
  ds_read_b128 v[200:203], v2 offset:28672
  buffer_load_dwordx4 v[104:107], v2, s[24:27], s11 offen offset:2048
  v_fma_mix_f32 v187, v83, v15, v23 op_sel:[1,0,0] op_sel_hi:[1,0,0]
  v_cvt_pk_bf16_f32 v80, v180, v181
  v_mfma_f32_16x16x32_bf16 v[56:59], v[156:159], v[76:79], v[56:59]
  ds_read_b128 v[204:207], v2 offset:29696
  v_cvt_pk_bf16_f32 v81, v182, v183
  v_cvt_pk_bf16_f32 v82, v184, v185
  v_cvt_pk_bf16_f32 v83, v186, v187
  s_waitcnt vmcnt(5)
  s_waitcnt lgkmcnt(5)
  v_mfma_f32_16x16x32_bf16 v[40:43], v[160:163], v[80:83], v[40:43]
  ds_read_b128 v[8:11], v4 offset:3072
  ds_read_b128 v[12:15], v4 offset:3088
  v_fma_mix_f32 v180, v84, v24, v32 op_sel:[0,0,0] op_sel_hi:[1,0,0]
  v_fma_mix_f32 v181, v84, v25, v33 op_sel:[1,0,0] op_sel_hi:[1,0,0]
  v_mfma_f32_16x16x32_bf16 v[44:47], v[164:167], v[80:83], v[44:47]
  ds_read_b128 v[16:19], v4 offset:768
  ds_read_b128 v[20:23], v4 offset:784
  v_fma_mix_f32 v182, v85, v26, v34 op_sel:[0,0,0] op_sel_hi:[1,0,0]
  v_fma_mix_f32 v183, v85, v27, v35 op_sel:[1,0,0] op_sel_hi:[1,0,0]
  v_mfma_f32_16x16x32_bf16 v[48:51], v[168:171], v[80:83], v[48:51]
  ds_read_b128 v[140:143], v2 offset:30720
  ds_read_b128 v[144:147], v2 offset:31744
  v_fma_mix_f32 v184, v86, v28, v36 op_sel:[0,0,0] op_sel_hi:[1,0,0]
  v_fma_mix_f32 v185, v86, v29, v37 op_sel:[1,0,0] op_sel_hi:[1,0,0]
  v_fma_mix_f32 v186, v87, v30, v38 op_sel:[0,0,0] op_sel_hi:[1,0,0]
  v_mfma_f32_16x16x32_bf16 v[52:55], v[172:175], v[80:83], v[52:55]
  ds_read_b128 v[148:151], v2 offset:32768
  ds_read_b128 v[152:155], v2 offset:33792
  buffer_load_dwordx4 v[108:111], v2, s[24:27], s11 offen offset:3072
  v_fma_mix_f32 v187, v87, v31, v39 op_sel:[1,0,0] op_sel_hi:[1,0,0]
  v_cvt_pk_bf16_f32 v84, v180, v181
  v_mfma_f32_16x16x32_bf16 v[56:59], v[176:179], v[80:83], v[56:59]
  ds_read_b128 v[156:159], v2 offset:34816
  v_cvt_pk_bf16_f32 v85, v182, v183
  v_cvt_pk_bf16_f32 v86, v184, v185
  v_cvt_pk_bf16_f32 v87, v186, v187
  s_waitcnt vmcnt(5)
  s_waitcnt lgkmcnt(5)
  v_mfma_f32_16x16x32_bf16 v[40:43], v[188:191], v[84:87], v[40:43]
  ds_read_b128 v[24:27], v4 offset:3200
  ds_read_b128 v[28:31], v4 offset:3216
  v_fma_mix_f32 v180, v88, v8, v16 op_sel:[0,0,0] op_sel_hi:[1,0,0]
  v_fma_mix_f32 v181, v88, v9, v17 op_sel:[1,0,0] op_sel_hi:[1,0,0]
  v_mfma_f32_16x16x32_bf16 v[44:47], v[192:195], v[84:87], v[44:47]
  ds_read_b128 v[32:35], v4 offset:896
  ds_read_b128 v[36:39], v4 offset:912
  v_fma_mix_f32 v182, v89, v10, v18 op_sel:[0,0,0] op_sel_hi:[1,0,0]
  v_fma_mix_f32 v183, v89, v11, v19 op_sel:[1,0,0] op_sel_hi:[1,0,0]
  v_mfma_f32_16x16x32_bf16 v[48:51], v[196:199], v[84:87], v[48:51]
  ds_read_b128 v[160:163], v2 offset:35840
  ds_read_b128 v[164:167], v2 offset:36864
  v_fma_mix_f32 v184, v90, v12, v20 op_sel:[0,0,0] op_sel_hi:[1,0,0]
  v_fma_mix_f32 v185, v90, v13, v21 op_sel:[1,0,0] op_sel_hi:[1,0,0]
  v_fma_mix_f32 v186, v91, v14, v22 op_sel:[0,0,0] op_sel_hi:[1,0,0]
  v_mfma_f32_16x16x32_bf16 v[52:55], v[200:203], v[84:87], v[52:55]
  ds_read_b128 v[168:171], v2 offset:37888
  ds_read_b128 v[172:175], v2 offset:38912
  s_add_u32 s11, s11, 4096
  buffer_load_dwordx4 v[112:115], v2, s[24:27], s11 offen offset:0
  v_fma_mix_f32 v187, v91, v15, v23 op_sel:[1,0,0] op_sel_hi:[1,0,0]
  v_cvt_pk_bf16_f32 v88, v180, v181
  v_mfma_f32_16x16x32_bf16 v[56:59], v[204:207], v[84:87], v[56:59]
  ds_read_b128 v[176:179], v2 offset:39936
  v_cvt_pk_bf16_f32 v89, v182, v183
  v_cvt_pk_bf16_f32 v90, v184, v185
  v_cvt_pk_bf16_f32 v91, v186, v187
  s_barrier
  s_waitcnt vmcnt(5)
  s_waitcnt lgkmcnt(5)
  v_mfma_f32_16x16x32_bf16 v[40:43], v[140:143], v[88:91], v[40:43]
  ds_read_b128 v[8:11], v4 offset:3328
  ds_read_b128 v[12:15], v4 offset:3344
  v_fma_mix_f32 v180, v92, v24, v32 op_sel:[0,0,0] op_sel_hi:[1,0,0]
  v_fma_mix_f32 v181, v92, v25, v33 op_sel:[1,0,0] op_sel_hi:[1,0,0]
  v_mfma_f32_16x16x32_bf16 v[44:47], v[144:147], v[88:91], v[44:47]
  ds_read_b128 v[16:19], v4 offset:1024
  ds_read_b128 v[20:23], v4 offset:1040
  v_fma_mix_f32 v182, v93, v26, v34 op_sel:[0,0,0] op_sel_hi:[1,0,0]
  v_fma_mix_f32 v183, v93, v27, v35 op_sel:[1,0,0] op_sel_hi:[1,0,0]
  v_mfma_f32_16x16x32_bf16 v[48:51], v[148:151], v[88:91], v[48:51]
  ds_read_b128 v[188:191], v2 offset:40960
  ds_read_b128 v[192:195], v2 offset:41984
  v_fma_mix_f32 v184, v94, v28, v36 op_sel:[0,0,0] op_sel_hi:[1,0,0]
  v_fma_mix_f32 v185, v94, v29, v37 op_sel:[1,0,0] op_sel_hi:[1,0,0]
  v_fma_mix_f32 v186, v95, v30, v38 op_sel:[0,0,0] op_sel_hi:[1,0,0]
  v_mfma_f32_16x16x32_bf16 v[52:55], v[152:155], v[88:91], v[52:55]
  ds_read_b128 v[196:199], v2 offset:43008
  ds_read_b128 v[200:203], v2 offset:44032
  buffer_load_dwordx4 v[116:119], v2, s[24:27], s11 offen offset:1024
  v_fma_mix_f32 v187, v95, v31, v39 op_sel:[1,0,0] op_sel_hi:[1,0,0]
  v_cvt_pk_bf16_f32 v92, v180, v181
  v_mfma_f32_16x16x32_bf16 v[56:59], v[156:159], v[88:91], v[56:59]
  ds_read_b128 v[204:207], v2 offset:45056
  v_cvt_pk_bf16_f32 v93, v182, v183
  v_cvt_pk_bf16_f32 v94, v184, v185
  v_cvt_pk_bf16_f32 v95, v186, v187
  s_waitcnt vmcnt(5)
  s_waitcnt lgkmcnt(5)
  v_mfma_f32_16x16x32_bf16 v[40:43], v[160:163], v[92:95], v[40:43]
  ds_read_b128 v[24:27], v4 offset:3456
  ds_read_b128 v[28:31], v4 offset:3472
  v_fma_mix_f32 v180, v96, v8, v16 op_sel:[0,0,0] op_sel_hi:[1,0,0]
  v_fma_mix_f32 v181, v96, v9, v17 op_sel:[1,0,0] op_sel_hi:[1,0,0]
  v_mfma_f32_16x16x32_bf16 v[44:47], v[164:167], v[92:95], v[44:47]
  ds_read_b128 v[32:35], v4 offset:1152
  ds_read_b128 v[36:39], v4 offset:1168
  v_fma_mix_f32 v182, v97, v10, v18 op_sel:[0,0,0] op_sel_hi:[1,0,0]
  v_fma_mix_f32 v183, v97, v11, v19 op_sel:[1,0,0] op_sel_hi:[1,0,0]
  v_mfma_f32_16x16x32_bf16 v[48:51], v[168:171], v[92:95], v[48:51]
  ds_read_b128 v[140:143], v2 offset:46080
  ds_read_b128 v[144:147], v2 offset:47104
  v_fma_mix_f32 v184, v98, v12, v20 op_sel:[0,0,0] op_sel_hi:[1,0,0]
  v_fma_mix_f32 v185, v98, v13, v21 op_sel:[1,0,0] op_sel_hi:[1,0,0]
  v_fma_mix_f32 v186, v99, v14, v22 op_sel:[0,0,0] op_sel_hi:[1,0,0]
  v_mfma_f32_16x16x32_bf16 v[52:55], v[172:175], v[92:95], v[52:55]
  ds_read_b128 v[148:151], v2 offset:48128
  ds_read_b128 v[152:155], v2 offset:49152
  buffer_load_dwordx4 v[120:123], v2, s[24:27], s11 offen offset:2048
  v_fma_mix_f32 v187, v99, v15, v23 op_sel:[1,0,0] op_sel_hi:[1,0,0]
  v_cvt_pk_bf16_f32 v96, v180, v181
  v_mfma_f32_16x16x32_bf16 v[56:59], v[176:179], v[92:95], v[56:59]
  ds_read_b128 v[156:159], v2 offset:50176
  v_cvt_pk_bf16_f32 v97, v182, v183
  v_cvt_pk_bf16_f32 v98, v184, v185
  v_cvt_pk_bf16_f32 v99, v186, v187
  s_waitcnt vmcnt(5)
  s_waitcnt lgkmcnt(5)
  v_mfma_f32_16x16x32_bf16 v[40:43], v[188:191], v[96:99], v[40:43]
  ds_read_b128 v[8:11], v4 offset:3584
  ds_read_b128 v[12:15], v4 offset:3600
  v_fma_mix_f32 v180, v100, v24, v32 op_sel:[0,0,0] op_sel_hi:[1,0,0]
  v_fma_mix_f32 v181, v100, v25, v33 op_sel:[1,0,0] op_sel_hi:[1,0,0]
  v_mfma_f32_16x16x32_bf16 v[44:47], v[192:195], v[96:99], v[44:47]
  ds_read_b128 v[16:19], v4 offset:1280
  ds_read_b128 v[20:23], v4 offset:1296
  v_fma_mix_f32 v182, v101, v26, v34 op_sel:[0,0,0] op_sel_hi:[1,0,0]
  v_fma_mix_f32 v183, v101, v27, v35 op_sel:[1,0,0] op_sel_hi:[1,0,0]
  v_mfma_f32_16x16x32_bf16 v[48:51], v[196:199], v[96:99], v[48:51]
  ds_read_b128 v[160:163], v2 offset:51200
  ds_read_b128 v[164:167], v2 offset:52224
  v_fma_mix_f32 v184, v102, v28, v36 op_sel:[0,0,0] op_sel_hi:[1,0,0]
  v_fma_mix_f32 v185, v102, v29, v37 op_sel:[1,0,0] op_sel_hi:[1,0,0]
  v_fma_mix_f32 v186, v103, v30, v38 op_sel:[0,0,0] op_sel_hi:[1,0,0]
  v_mfma_f32_16x16x32_bf16 v[52:55], v[200:203], v[96:99], v[52:55]
  ds_read_b128 v[168:171], v2 offset:53248
  ds_read_b128 v[172:175], v2 offset:54272
  buffer_load_dwordx4 v[124:127], v2, s[24:27], s11 offen offset:3072
  v_fma_mix_f32 v187, v103, v31, v39 op_sel:[1,0,0] op_sel_hi:[1,0,0]
  v_cvt_pk_bf16_f32 v100, v180, v181
  v_mfma_f32_16x16x32_bf16 v[56:59], v[204:207], v[96:99], v[56:59]
  ds_read_b128 v[176:179], v2 offset:55296
  v_cvt_pk_bf16_f32 v101, v182, v183
  v_cvt_pk_bf16_f32 v102, v184, v185
  v_cvt_pk_bf16_f32 v103, v186, v187
  s_waitcnt vmcnt(5)
  s_waitcnt lgkmcnt(5)
  v_mfma_f32_16x16x32_bf16 v[40:43], v[140:143], v[100:103], v[40:43]
  ds_read_b128 v[24:27], v4 offset:3712
  ds_read_b128 v[28:31], v4 offset:3728
  v_fma_mix_f32 v180, v104, v8, v16 op_sel:[0,0,0] op_sel_hi:[1,0,0]
  v_fma_mix_f32 v181, v104, v9, v17 op_sel:[1,0,0] op_sel_hi:[1,0,0]
  v_mfma_f32_16x16x32_bf16 v[44:47], v[144:147], v[100:103], v[44:47]
  ds_read_b128 v[32:35], v4 offset:1408
  ds_read_b128 v[36:39], v4 offset:1424
  v_fma_mix_f32 v182, v105, v10, v18 op_sel:[0,0,0] op_sel_hi:[1,0,0]
  v_fma_mix_f32 v183, v105, v11, v19 op_sel:[1,0,0] op_sel_hi:[1,0,0]
  v_mfma_f32_16x16x32_bf16 v[48:51], v[148:151], v[100:103], v[48:51]
  ds_read_b128 v[188:191], v2 offset:56320
  ds_read_b128 v[192:195], v2 offset:57344
  v_fma_mix_f32 v184, v106, v12, v20 op_sel:[0,0,0] op_sel_hi:[1,0,0]
  v_fma_mix_f32 v185, v106, v13, v21 op_sel:[1,0,0] op_sel_hi:[1,0,0]
  v_fma_mix_f32 v186, v107, v14, v22 op_sel:[0,0,0] op_sel_hi:[1,0,0]
  v_mfma_f32_16x16x32_bf16 v[52:55], v[152:155], v[100:103], v[52:55]
  ds_read_b128 v[196:199], v2 offset:58368
  ds_read_b128 v[200:203], v2 offset:59392
  s_add_u32 s11, s11, 4096
  buffer_load_dwordx4 v[128:131], v2, s[24:27], s11 offen offset:0
  v_fma_mix_f32 v187, v107, v15, v23 op_sel:[1,0,0] op_sel_hi:[1,0,0]
  v_cvt_pk_bf16_f32 v104, v180, v181
  v_mfma_f32_16x16x32_bf16 v[56:59], v[156:159], v[100:103], v[56:59]
  ds_read_b128 v[204:207], v2 offset:60416
  v_cvt_pk_bf16_f32 v105, v182, v183
  v_cvt_pk_bf16_f32 v106, v184, v185
  v_cvt_pk_bf16_f32 v107, v186, v187
  s_barrier
  s_waitcnt vmcnt(5)
  s_waitcnt lgkmcnt(5)
  v_mfma_f32_16x16x32_bf16 v[40:43], v[160:163], v[104:107], v[40:43]
  ds_read_b128 v[8:11], v4 offset:3840
  ds_read_b128 v[12:15], v4 offset:3856
  v_fma_mix_f32 v180, v108, v24, v32 op_sel:[0,0,0] op_sel_hi:[1,0,0]
  v_fma_mix_f32 v181, v108, v25, v33 op_sel:[1,0,0] op_sel_hi:[1,0,0]
  v_mfma_f32_16x16x32_bf16 v[44:47], v[164:167], v[104:107], v[44:47]
  ds_read_b128 v[16:19], v4 offset:1536
  ds_read_b128 v[20:23], v4 offset:1552
  v_fma_mix_f32 v182, v109, v26, v34 op_sel:[0,0,0] op_sel_hi:[1,0,0]
  v_fma_mix_f32 v183, v109, v27, v35 op_sel:[1,0,0] op_sel_hi:[1,0,0]
  v_mfma_f32_16x16x32_bf16 v[48:51], v[168:171], v[104:107], v[48:51]
  ds_read_b128 v[140:143], v2 offset:61440
  ds_read_b128 v[144:147], v2 offset:62464
  v_fma_mix_f32 v184, v110, v28, v36 op_sel:[0,0,0] op_sel_hi:[1,0,0]
  v_fma_mix_f32 v185, v110, v29, v37 op_sel:[1,0,0] op_sel_hi:[1,0,0]
  v_fma_mix_f32 v186, v111, v30, v38 op_sel:[0,0,0] op_sel_hi:[1,0,0]
  v_mfma_f32_16x16x32_bf16 v[52:55], v[172:175], v[104:107], v[52:55]
  ds_read_b128 v[148:151], v2 offset:63488
  ds_read_b128 v[152:155], v2 offset:64512
  buffer_load_dwordx4 v[132:135], v2, s[24:27], s11 offen offset:1024
  v_fma_mix_f32 v187, v111, v31, v39 op_sel:[1,0,0] op_sel_hi:[1,0,0]
  v_cvt_pk_bf16_f32 v108, v180, v181
  v_mfma_f32_16x16x32_bf16 v[56:59], v[176:179], v[104:107], v[56:59]
  ds_read_b128 v[156:159], v5 offset:0
  v_cvt_pk_bf16_f32 v109, v182, v183
  v_cvt_pk_bf16_f32 v110, v184, v185
  v_cvt_pk_bf16_f32 v111, v186, v187
  s_waitcnt vmcnt(5)
  s_waitcnt lgkmcnt(5)
  v_mfma_f32_16x16x32_bf16 v[40:43], v[188:191], v[108:111], v[40:43]
  ds_read_b128 v[24:27], v4 offset:3968
  ds_read_b128 v[28:31], v4 offset:3984
  v_fma_mix_f32 v180, v112, v8, v16 op_sel:[0,0,0] op_sel_hi:[1,0,0]
  v_fma_mix_f32 v181, v112, v9, v17 op_sel:[1,0,0] op_sel_hi:[1,0,0]
  v_mfma_f32_16x16x32_bf16 v[44:47], v[192:195], v[108:111], v[44:47]
  ds_read_b128 v[32:35], v4 offset:1664
  ds_read_b128 v[36:39], v4 offset:1680
  v_fma_mix_f32 v182, v113, v10, v18 op_sel:[0,0,0] op_sel_hi:[1,0,0]
  v_fma_mix_f32 v183, v113, v11, v19 op_sel:[1,0,0] op_sel_hi:[1,0,0]
  v_mfma_f32_16x16x32_bf16 v[48:51], v[196:199], v[108:111], v[48:51]
  ds_read_b128 v[160:163], v5 offset:1024
  ds_read_b128 v[164:167], v5 offset:2048
  v_fma_mix_f32 v184, v114, v12, v20 op_sel:[0,0,0] op_sel_hi:[1,0,0]
  v_fma_mix_f32 v185, v114, v13, v21 op_sel:[1,0,0] op_sel_hi:[1,0,0]
  v_fma_mix_f32 v186, v115, v14, v22 op_sel:[0,0,0] op_sel_hi:[1,0,0]
  v_mfma_f32_16x16x32_bf16 v[52:55], v[200:203], v[108:111], v[52:55]
  ds_read_b128 v[168:171], v5 offset:3072
  ds_read_b128 v[172:175], v5 offset:4096
  v_fma_mix_f32 v187, v115, v15, v23 op_sel:[1,0,0] op_sel_hi:[1,0,0]
  v_cvt_pk_bf16_f32 v112, v180, v181
  v_mfma_f32_16x16x32_bf16 v[56:59], v[204:207], v[108:111], v[56:59]
  ds_read_b128 v[176:179], v5 offset:5120
  v_cvt_pk_bf16_f32 v113, v182, v183
  v_cvt_pk_bf16_f32 v114, v184, v185
  v_cvt_pk_bf16_f32 v115, v186, v187
  s_waitcnt vmcnt(4)
  s_waitcnt lgkmcnt(5)
  v_mfma_f32_16x16x32_bf16 v[40:43], v[140:143], v[112:115], v[40:43]
  ds_read_b128 v[8:11], v4 offset:4096
  ds_read_b128 v[12:15], v4 offset:4112
  v_fma_mix_f32 v180, v116, v24, v32 op_sel:[0,0,0] op_sel_hi:[1,0,0]
  v_fma_mix_f32 v181, v116, v25, v33 op_sel:[1,0,0] op_sel_hi:[1,0,0]
  v_mfma_f32_16x16x32_bf16 v[44:47], v[144:147], v[112:115], v[44:47]
  ds_read_b128 v[16:19], v4 offset:1792
  ds_read_b128 v[20:23], v4 offset:1808
  v_fma_mix_f32 v182, v117, v26, v34 op_sel:[0,0,0] op_sel_hi:[1,0,0]
  v_fma_mix_f32 v183, v117, v27, v35 op_sel:[1,0,0] op_sel_hi:[1,0,0]
  v_mfma_f32_16x16x32_bf16 v[48:51], v[148:151], v[112:115], v[48:51]
  ds_read_b128 v[188:191], v5 offset:6144
  ds_read_b128 v[192:195], v5 offset:7168
  v_fma_mix_f32 v184, v118, v28, v36 op_sel:[0,0,0] op_sel_hi:[1,0,0]
  v_fma_mix_f32 v185, v118, v29, v37 op_sel:[1,0,0] op_sel_hi:[1,0,0]
  v_fma_mix_f32 v186, v119, v30, v38 op_sel:[0,0,0] op_sel_hi:[1,0,0]
  v_mfma_f32_16x16x32_bf16 v[52:55], v[152:155], v[112:115], v[52:55]
  ds_read_b128 v[196:199], v5 offset:8192
  ds_read_b128 v[200:203], v5 offset:9216
  v_fma_mix_f32 v187, v119, v31, v39 op_sel:[1,0,0] op_sel_hi:[1,0,0]
  v_cvt_pk_bf16_f32 v116, v180, v181
  v_mfma_f32_16x16x32_bf16 v[56:59], v[156:159], v[112:115], v[56:59]
  ds_read_b128 v[204:207], v5 offset:10240
  v_cvt_pk_bf16_f32 v117, v182, v183
  v_cvt_pk_bf16_f32 v118, v184, v185
  v_cvt_pk_bf16_f32 v119, v186, v187
  s_waitcnt vmcnt(3)
  s_waitcnt lgkmcnt(5)
  v_mfma_f32_16x16x32_bf16 v[40:43], v[160:163], v[116:119], v[40:43]
  ds_read_b128 v[24:27], v4 offset:4224
  ds_read_b128 v[28:31], v4 offset:4240
  v_fma_mix_f32 v180, v120, v8, v16 op_sel:[0,0,0] op_sel_hi:[1,0,0]
  v_fma_mix_f32 v181, v120, v9, v17 op_sel:[1,0,0] op_sel_hi:[1,0,0]
  v_mfma_f32_16x16x32_bf16 v[44:47], v[164:167], v[116:119], v[44:47]
  ds_read_b128 v[32:35], v4 offset:1920
  ds_read_b128 v[36:39], v4 offset:1936
  v_fma_mix_f32 v182, v121, v10, v18 op_sel:[0,0,0] op_sel_hi:[1,0,0]
  v_fma_mix_f32 v183, v121, v11, v19 op_sel:[1,0,0] op_sel_hi:[1,0,0]
  v_mfma_f32_16x16x32_bf16 v[48:51], v[168:171], v[116:119], v[48:51]
  ds_read_b128 v[140:143], v5 offset:11264
  ds_read_b128 v[144:147], v5 offset:12288
  v_fma_mix_f32 v184, v122, v12, v20 op_sel:[0,0,0] op_sel_hi:[1,0,0]
  v_fma_mix_f32 v185, v122, v13, v21 op_sel:[1,0,0] op_sel_hi:[1,0,0]
  v_fma_mix_f32 v186, v123, v14, v22 op_sel:[0,0,0] op_sel_hi:[1,0,0]
  v_mfma_f32_16x16x32_bf16 v[52:55], v[172:175], v[116:119], v[52:55]
  ds_read_b128 v[148:151], v5 offset:13312
  ds_read_b128 v[152:155], v5 offset:14336
  v_fma_mix_f32 v187, v123, v15, v23 op_sel:[1,0,0] op_sel_hi:[1,0,0]
  v_cvt_pk_bf16_f32 v120, v180, v181
  v_mfma_f32_16x16x32_bf16 v[56:59], v[176:179], v[116:119], v[56:59]
  ds_read_b128 v[156:159], v5 offset:15360
  v_cvt_pk_bf16_f32 v121, v182, v183
  v_cvt_pk_bf16_f32 v122, v184, v185
  v_cvt_pk_bf16_f32 v123, v186, v187
  s_barrier
  s_waitcnt vmcnt(2)
  s_waitcnt lgkmcnt(5)
  v_mfma_f32_16x16x32_bf16 v[40:43], v[188:191], v[120:123], v[40:43]
  ds_read_b128 v[8:11], v4 offset:4352
  ds_read_b128 v[12:15], v4 offset:4368
  v_fma_mix_f32 v180, v124, v24, v32 op_sel:[0,0,0] op_sel_hi:[1,0,0]
  v_fma_mix_f32 v181, v124, v25, v33 op_sel:[1,0,0] op_sel_hi:[1,0,0]
  v_mfma_f32_16x16x32_bf16 v[44:47], v[192:195], v[120:123], v[44:47]
  ds_read_b128 v[16:19], v4 offset:2048
  ds_read_b128 v[20:23], v4 offset:2064
  v_fma_mix_f32 v182, v125, v26, v34 op_sel:[0,0,0] op_sel_hi:[1,0,0]
  v_fma_mix_f32 v183, v125, v27, v35 op_sel:[1,0,0] op_sel_hi:[1,0,0]
  v_mfma_f32_16x16x32_bf16 v[48:51], v[196:199], v[120:123], v[48:51]
  ds_read_b128 v[160:163], v5 offset:16384
  ds_read_b128 v[164:167], v5 offset:17408
  v_fma_mix_f32 v184, v126, v28, v36 op_sel:[0,0,0] op_sel_hi:[1,0,0]
  v_fma_mix_f32 v185, v126, v29, v37 op_sel:[1,0,0] op_sel_hi:[1,0,0]
  v_fma_mix_f32 v186, v127, v30, v38 op_sel:[0,0,0] op_sel_hi:[1,0,0]
  v_mfma_f32_16x16x32_bf16 v[52:55], v[200:203], v[120:123], v[52:55]
  ds_read_b128 v[168:171], v5 offset:18432
  ds_read_b128 v[172:175], v5 offset:19456
  v_fma_mix_f32 v187, v127, v31, v39 op_sel:[1,0,0] op_sel_hi:[1,0,0]
  v_cvt_pk_bf16_f32 v124, v180, v181
  v_mfma_f32_16x16x32_bf16 v[56:59], v[204:207], v[120:123], v[56:59]
  ds_read_b128 v[176:179], v5 offset:20480
  v_cvt_pk_bf16_f32 v125, v182, v183
  v_cvt_pk_bf16_f32 v126, v184, v185
  v_cvt_pk_bf16_f32 v127, v186, v187
  s_waitcnt vmcnt(1)
  s_waitcnt lgkmcnt(5)
  v_mfma_f32_16x16x32_bf16 v[40:43], v[140:143], v[124:127], v[40:43]
  ds_read_b128 v[24:27], v4 offset:4480
  ds_read_b128 v[28:31], v4 offset:4496
  v_fma_mix_f32 v180, v128, v8, v16 op_sel:[0,0,0] op_sel_hi:[1,0,0]
  v_fma_mix_f32 v181, v128, v9, v17 op_sel:[1,0,0] op_sel_hi:[1,0,0]
  v_mfma_f32_16x16x32_bf16 v[44:47], v[144:147], v[124:127], v[44:47]
  ds_read_b128 v[32:35], v4 offset:2176
  ds_read_b128 v[36:39], v4 offset:2192
  v_fma_mix_f32 v182, v129, v10, v18 op_sel:[0,0,0] op_sel_hi:[1,0,0]
  v_fma_mix_f32 v183, v129, v11, v19 op_sel:[1,0,0] op_sel_hi:[1,0,0]
  v_mfma_f32_16x16x32_bf16 v[48:51], v[148:151], v[124:127], v[48:51]
  ds_read_b128 v[188:191], v5 offset:21504
  ds_read_b128 v[192:195], v5 offset:22528
  v_fma_mix_f32 v184, v130, v12, v20 op_sel:[0,0,0] op_sel_hi:[1,0,0]
  v_fma_mix_f32 v185, v130, v13, v21 op_sel:[1,0,0] op_sel_hi:[1,0,0]
  v_fma_mix_f32 v186, v131, v14, v22 op_sel:[0,0,0] op_sel_hi:[1,0,0]
  v_mfma_f32_16x16x32_bf16 v[52:55], v[152:155], v[124:127], v[52:55]
  ds_read_b128 v[196:199], v5 offset:23552
  ds_read_b128 v[200:203], v5 offset:24576
  v_fma_mix_f32 v187, v131, v15, v23 op_sel:[1,0,0] op_sel_hi:[1,0,0]
  v_cvt_pk_bf16_f32 v128, v180, v181
  v_mfma_f32_16x16x32_bf16 v[56:59], v[156:159], v[124:127], v[56:59]
  ds_read_b128 v[204:207], v5 offset:25600
  v_cvt_pk_bf16_f32 v129, v182, v183
  v_cvt_pk_bf16_f32 v130, v184, v185
  v_cvt_pk_bf16_f32 v131, v186, v187
  s_waitcnt vmcnt(0)
  s_waitcnt lgkmcnt(5)
  v_mfma_f32_16x16x32_bf16 v[40:43], v[160:163], v[128:131], v[40:43]
  v_fma_mix_f32 v180, v132, v24, v32 op_sel:[0,0,0] op_sel_hi:[1,0,0]
  v_fma_mix_f32 v181, v132, v25, v33 op_sel:[1,0,0] op_sel_hi:[1,0,0]
  v_mfma_f32_16x16x32_bf16 v[44:47], v[164:167], v[128:131], v[44:47]
  v_fma_mix_f32 v182, v133, v26, v34 op_sel:[0,0,0] op_sel_hi:[1,0,0]
  v_fma_mix_f32 v183, v133, v27, v35 op_sel:[1,0,0] op_sel_hi:[1,0,0]
  v_mfma_f32_16x16x32_bf16 v[48:51], v[168:171], v[128:131], v[48:51]
  v_fma_mix_f32 v184, v134, v28, v36 op_sel:[0,0,0] op_sel_hi:[1,0,0]
  v_fma_mix_f32 v185, v134, v29, v37 op_sel:[1,0,0] op_sel_hi:[1,0,0]
  v_fma_mix_f32 v186, v135, v30, v38 op_sel:[0,0,0] op_sel_hi:[1,0,0]
  v_mfma_f32_16x16x32_bf16 v[52:55], v[172:175], v[128:131], v[52:55]
  v_fma_mix_f32 v187, v135, v31, v39 op_sel:[1,0,0] op_sel_hi:[1,0,0]
  v_cvt_pk_bf16_f32 v132, v180, v181
  v_mfma_f32_16x16x32_bf16 v[56:59], v[176:179], v[128:131], v[56:59]
  v_cvt_pk_bf16_f32 v133, v182, v183
  v_cvt_pk_bf16_f32 v134, v184, v185
  v_cvt_pk_bf16_f32 v135, v186, v187
  s_waitcnt lgkmcnt(0)
  s_nop 0
  v_mfma_f32_16x16x32_bf16 v[40:43], v[188:191], v[132:135], v[40:43]
  v_mfma_f32_16x16x32_bf16 v[44:47], v[192:195], v[132:135], v[44:47]
  v_mfma_f32_16x16x32_bf16 v[48:51], v[196:199], v[132:135], v[48:51]
  v_mfma_f32_16x16x32_bf16 v[52:55], v[200:203], v[132:135], v[52:55]
  v_mfma_f32_16x16x32_bf16 v[56:59], v[204:207], v[132:135], v[56:59]
  s_cmp_ge_u32 s2, 16
  s_cbranch_scc1 L_pfs_k1_kernel_2
  s_cmp_lg_u32 s3, 0
  s_cbranch_scc1 L_pfs_k1_kernel_2
  s_getpc_b64 s[32:33]
L_pf_k1_kernel_1:
  s_add_u32 s32, s32, k2_kernel-L_pf_k1_kernel_1
  s_addc_u32 s33, s33, 0
  s_and_b32 s33, s33, 0xffff
  s_mov_b32 s34, L_end_k2_kernel-k2_kernel
  s_mov_b32 s35, 0x20000
  v_lshlrev_b32 v60, 7, v1
  buffer_load_dword v61, v60, s[32:35], 0 offen
  v_add_u32 v60, 0x2000, v60
  buffer_load_dword v61, v60, s[32:35], 0 offen
L_pfs_k1_kernel_2:
  s_add_u32 s20, s16, 4194304
  s_addc_u32 s21, s17, 0
  s_and_b32 s21, s21, 0xffff
  s_mov_b32 s22, 2359296
  s_mov_b32 s23, 0x20000
  s_add_u32 s24, s16, 131072
  s_addc_u32 s25, s17, 0
  s_and_b32 s25, s25, 0xffff
  s_mov_b32 s26, 153600
  s_mov_b32 s27, 0x20000
  s_add_u32 s28, s16, 98304
  s_addc_u32 s29, s17, 0
  s_and_b32 s29, s29, 0xffff
  s_mov_b32 s30, 2048
  s_mov_b32 s31, 0x20000
  s_lshl_b32 s11, s10, 3
  s_add_u32 s11, s11, s5
  s_mul_i32 s11, s11, 2304
  v_and_b32 v8, 15, v1
  v_lshrrev_b32 v9, 4, v1
  v_cmp_eq_u32 vcc, 0, v9
  v_mov_b32 v12, 2146435072
  s_nop 0
  v_cndmask_b32 v11, v12, v2, vcc
  s_mov_b32 s12, 0x3eae1a93
  s_mov_b32 s13, s12
  v_pk_mul_f32 v[40:41], v[40:41], s[12:13]
  v_pk_mul_f32 v[42:43], v[42:43], s[12:13]
  v_cvt_pk_bf16_f32 v16, v40, v41
  v_cvt_pk_bf16_f32 v17, v42, v43
  v_pk_mul_f32 v[44:45], v[44:45], s[12:13]
  v_pk_mul_f32 v[46:47], v[46:47], s[12:13]
  v_cvt_pk_bf16_f32 v18, v44, v45
  v_cvt_pk_bf16_f32 v19, v46, v47
  buffer_store_dwordx4 v[16:19], v2, s[20:23], s11 offen offset:0
  v_pk_mul_f32 v[48:49], v[48:49], s[12:13]
  v_pk_mul_f32 v[50:51], v[50:51], s[12:13]
  v_cvt_pk_bf16_f32 v20, v48, v49
  v_cvt_pk_bf16_f32 v21, v50, v51
  v_pk_mul_f32 v[52:53], v[52:53], s[12:13]
  v_pk_mul_f32 v[54:55], v[54:55], s[12:13]
  v_cvt_pk_bf16_f32 v22, v52, v53
  v_cvt_pk_bf16_f32 v23, v54, v55
  buffer_store_dwordx4 v[20:23], v2, s[20:23], s11 offen offset:1024
  v_pk_mul_f32 v[24:25], v[56:57], s[12:13]
  v_pk_mul_f32 v[26:27], v[58:59], s[12:13]
  v_cvt_pk_bf16_f32 v24, v24, v25
  v_cvt_pk_bf16_f32 v25, v26, v27
  v_mov_b32 v34, v24
  v_mov_b32 v35, v25
  s_nop 0
  v_permlane16_swap_b32 v34, v26
  v_permlane16_swap_b32 v35, v27
  buffer_store_dwordx4 v[24:27], v11, s[20:23], s11 offen offset:2048
  s_cmp_ge_u32 s5, 5
  s_cbranch_scc1 L_k1_fin
  v_cvt_pk_bf16_f32 v28, v56, v57
  v_cvt_pk_bf16_f32 v29, v58, v59
  s_lshr_b32 s11, s10, 3
  s_mul_i32 s11, s11, 9600
  s_bfe_u32 s12, s10, 0x20001
  s_mul_i32 s13, s12, 2272
  s_add_u32 s13, s13, s11
  s_and_b32 s14, s10, 1
  s_cmp_ge_u32 s5, 3
  s_cbranch_scc1 L_k1_v
  v_mul_f32 v32, v56, v56
  v_fmac_f32 v32, v57, v57
  v_fmac_f32 v32, v58, v58
  v_fmac_f32 v32, v59, v59
  v_lshlrev_b32 v15, 4, v8
  v_cmp_eq_u32 vcc, 2, v9
  s_nop 1
  v_cndmask_b32 v15, v12, v15, vcc
  s_lshl_b32 s15, s14, 8
  s_cmp_eq_u32 s5, 2
  s_cbranch_scc1 L_k1_k2
  v_mov_b32 v34, v28
  v_mov_b32 v35, v29
  s_lshl_b32 s12, s5, 9
  s_add_u32 s15, s15, s12
  s_add_u32 s15, s15, s13
  v_permlane16_swap_b32 v34, v30
  v_permlane16_swap_b32 v35, v31
  buffer_store_dwordx4 v[28:31], v15, s[24:27], s15 offen
  v_mov_b32 v33, v32
  s_nop 1
  v_permlane16_swap_b32 v32, v33
  v_add_f32 v32, v32, v33
  s_branch L_k1_km
L_k1_k2:
  s_lshl_b32 s12, s12, 2
  s_add_u32 s15, s15, s12
  s_add_u32 s15, s15, s11
  s_add_u32 s15, s15, 9088
  buffer_store_dword v28, v15, s[24:27], s15 offen
L_k1_km:
  s_nop 0
  v_max_f32_dpp v32, v32, v32 row_ror:8 row_mask:0xf bank_mask:0xf
  s_nop 1
  v_max_f32_dpp v32, v32, v32 row_ror:4 row_mask:0xf bank_mask:0xf
  s_nop 1
  v_max_f32_dpp v32, v32, v32 row_ror:2 row_mask:0xf bank_mask:0xf
  s_nop 1
  v_max_f32_dpp v32, v32, v32 row_ror:1 row_mask:0xf bank_mask:0xf
  s_lshl_b32 s12, s10, 4
  s_lshl_b32 s15, s5, 2
  s_add_u32 s12, s12, s15
  v_cmp_eq_u32 vcc, 32, v1
  s_nop 1
  v_cndmask_b32 v15, v12, 0, vcc
  buffer_store_dword v32, v15, s[28:31], s12 offen
  s_cmp_lg_u32 s5, 2
  s_cbranch_scc1 L_k1_fin
L_k1_v:
  s_lshl_b32 s12, s3, 8
  s_add_u32 s12, s12, 96768
  v_and_b32 v13, 3, v8
  v_lshlrev_b32 v13, 1, v13
  v_bfe_u32 v14, v8, 3, 1
  v_lshl_add_u32 v13, v14, 3, v13
  v_bfe_u32 v14, v8, 2, 1
  v_lshl_add_u32 v13, v14, 4, v13
  v_and_b32 v14, 1, v9
  v_lshl_add_u32 v13, v14, 7, v13
  v_add_u32 v13, s12, v13
  v_lshl_add_u32 v14, v1, 4, s12
  s_mov_b32 exec_lo, 0
  ds_write_b16 v13, v28
  ds_write_b16_d16_hi v13, v28 offset:32
  ds_write_b16 v13, v29 offset:64
  ds_write_b16_d16_hi v13, v29 offset:96
  s_mov_b32 exec_lo, -1
  s_mul_i32 s14, s14, 624
  s_add_u32 s13, s13, s14
  v_and_b32 v15, 1, v1
  v_mul_u32_u24 v15, 304, v15
  v_bfe_u32 v13, v1, 1, 2
  v_lshl_add_u32 v15, v13, 4, v15
  v_bfe_u32 v13, v1, 3, 1
  v_lshl_add_u32 v15, v13, 7, v15
  s_waitcnt lgkmcnt(0)
  ds_read_b128 v[28:31], v14
  s_lshl_b32 s12, s5, 6
  s_add_u32 s12, s12, 832
  s_cmp_eq_u32 s5, 2
  s_cselect_b32 s12, 1152, s12
  s_add_u32 s13, s13, s12
  s_cselect_b32 s14, 0, 0
  s_cmp_eq_u32 s5, 2
  s_cselect_b32 s14, 8, 0
  s_cselect_b32 s15, 4, 16
  v_subrev_u32 v13, s14, v1
  v_cmp_gt_u32 vcc, s15, v13
  s_nop 1
  v_cndmask_b32 v15, v12, v15, vcc
  s_waitcnt lgkmcnt(0)
  buffer_store_dwordx4 v[28:31], v15, s[24:27], s13 offen
L_k1_fin:
L_k1_end:
  s_endpgm
L_k1_ld:
  s_sub_u32 s3, s3, 4
  s_lshl_b32 s13, s3, 10
  s_mul_i32 s12, s5, 92160
  s_waitcnt lgkmcnt(0)
  s_add_u32 s28, s16, 16777216
  s_addc_u32 s29, s17, 0
  s_and_b32 s29, s29, 0xffff
  s_mov_b32 s30, 737280
  s_mov_b32 s31, 0x20000
  s_mov_b32 m0, s13
  s_add_u32 s14, s13, s12
  buffer_load_dwordx4 v2, s[28:31], s14 offen lds
  s_add_u32 s13, s13, 4096
  s_mov_b32 m0, s13
  s_add_u32 s14, s13, s12
  buffer_load_dwordx4 v2, s[28:31], s14 offen lds
  s_add_u32 s13, s13, 4096
  s_mov_b32 m0, s13
  s_add_u32 s14, s13, s12
  buffer_load_dwordx4 v2, s[28:31], s14 offen lds
  s_add_u32 s13, s13, 4096
  s_mov_b32 m0, s13
  s_add_u32 s14, s13, s12
  buffer_load_dwordx4 v2, s[28:31], s14 offen lds
  s_add_u32 s13, s13, 4096
  s_mov_b32 m0, s13
  s_add_u32 s14, s13, s12
  buffer_load_dwordx4 v2, s[28:31], s14 offen lds
  s_add_u32 s13, s13, 4096
  s_mov_b32 m0, s13
  s_add_u32 s14, s13, s12
  buffer_load_dwordx4 v2, s[28:31], s14 offen lds
  s_add_u32 s13, s13, 4096
  s_mov_b32 m0, s13
  s_add_u32 s14, s13, s12
  buffer_load_dwordx4 v2, s[28:31], s14 offen lds
  s_add_u32 s13, s13, 4096
  s_mov_b32 m0, s13
  s_add_u32 s14, s13, s12
  buffer_load_dwordx4 v2, s[28:31], s14 offen lds
  s_add_u32 s13, s13, 4096
  s_mov_b32 m0, s13
  s_add_u32 s14, s13, s12
  buffer_load_dwordx4 v2, s[28:31], s14 offen lds
  s_add_u32 s13, s13, 4096
  s_mov_b32 m0, s13
  s_add_u32 s14, s13, s12
  buffer_load_dwordx4 v2, s[28:31], s14 offen lds
  s_add_u32 s13, s13, 4096
  s_mov_b32 m0, s13
  s_add_u32 s14, s13, s12
  buffer_load_dwordx4 v2, s[28:31], s14 offen lds
  s_add_u32 s13, s13, 4096
  s_waitcnt vmcnt(6)
  s_barrier
  s_mov_b32 m0, s13
  s_add_u32 s14, s13, s12
  buffer_load_dwordx4 v2, s[28:31], s14 offen lds
  s_add_u32 s13, s13, 4096
  s_mov_b32 m0, s13
  s_add_u32 s14, s13, s12
  buffer_load_dwordx4 v2, s[28:31], s14 offen lds
  s_add_u32 s13, s13, 4096
  s_mov_b32 m0, s13
  s_add_u32 s14, s13, s12
  buffer_load_dwordx4 v2, s[28:31], s14 offen lds
  s_add_u32 s13, s13, 4096
  s_mov_b32 m0, s13
  s_add_u32 s14, s13, s12
  buffer_load_dwordx4 v2, s[28:31], s14 offen lds
  s_add_u32 s13, s13, 4096
  s_mov_b32 m0, s13
  s_add_u32 s14, s13, s12
  buffer_load_dwordx4 v2, s[28:31], s14 offen lds
  s_add_u32 s13, s13, 4096
  s_mov_b32 m0, s13
  s_add_u32 s14, s13, s12
  buffer_load_dwordx4 v2, s[28:31], s14 offen lds
  s_add_u32 s13, s13, 4096
  s_mov_b32 m0, s13
  s_add_u32 s14, s13, s12
  buffer_load_dwordx4 v2, s[28:31], s14 offen lds
  s_add_u32 s13, s13, 4096
  s_mov_b32 m0, s13
  s_add_u32 s14, s13, s12
  buffer_load_dwordx4 v2, s[28:31], s14 offen lds
  s_add_u32 s13, s13, 4096
  s_mov_b32 m0, s13
  s_add_u32 s14, s13, s12
  buffer_load_dwordx4 v2, s[28:31], s14 offen lds
  s_add_u32 s13, s13, 4096
  s_mov_b32 m0, s13
  s_add_u32 s14, s13, s12
  buffer_load_dwordx4 v2, s[28:31], s14 offen lds
  s_add_u32 s13, s13, 4096
  s_mov_b32 m0, s13
  s_add_u32 s14, s13, s12
  buffer_load_dwordx4 v2, s[28:31], s14 offen lds
  s_add_u32 s13, s13, 4096
  s_min_u32 s13, s13, 91136
  s_mov_b32 m0, s13
  s_add_u32 s14, s13, s12
  buffer_load_dwordx4 v2, s[28:31], s14 offen lds
  s_add_u32 s13, s13, 4096
  s_waitcnt vmcnt(13)
  s_barrier
  s_waitcnt vmcnt(8)
  s_barrier
  s_waitcnt vmcnt(3)
  s_barrier
  s_waitcnt vmcnt(0)
  s_barrier
  s_cmp_ge_u32 s2, 4
  s_cbranch_scc1 L_k1_end
  v_and_b32 v0, 255, v0
  v_mov_b32 v12, 2146435072
  s_movk_i32 s8, 13824
  s_movk_i32 s9, 27648
  s_add_u32 s20, s16, 0
  s_addc_u32 s21, s17, 0
  s_and_b32 s21, s21, 0xffff
  s_mov_b32 s22, 41472
  s_mov_b32 s23, 0x20000
  s_add_u32 s24, s16, 65536
  s_addc_u32 s25, s17, 0
  s_and_b32 s25, s25, 0xffff
  s_mov_b32 s26, 13824
  s_mov_b32 s27, 0x20000
  s_add_u32 s28, s16, 81920
  s_addc_u32 s29, s17, 0
  s_and_b32 s29, s29, 0xffff
  s_mov_b32 s30, 2304
  s_mov_b32 s31, 0x20000
  s_mul_i32 s12, s2, 216
  v_add_u32 v4, s12, v0
  v_lshlrev_b32 v5, 4, v4
  v_cmp_gt_u32 vcc, 216, v0
  s_nop 1
  v_cndmask_b32 v5, v12, v5, vcc
  buffer_load_dwordx4 v[32:35], v5, s[20:23], 0 offen
  buffer_load_dwordx4 v[36:39], v5, s[20:23], s8 offen
  buffer_load_dwordx4 v[40:43], v5, s[20:23], s9 offen
  v_subrev_u32 v6, 144, v4
  v_subrev_u32 v7, 576, v4
  v_min_u32 v6, v6, v7
  v_cmp_gt_u32 vcc, 144, v6
  s_nop 1
  v_cndmask_b32 v44, 0, 1.0, vcc
  s_waitcnt vmcnt(0)
  v_pk_add_f32 v[32:33], v[32:33], v[36:37]
  v_pk_add_f32 v[34:35], v[34:35], v[38:39]
  v_pk_add_f32 v[32:33], v[32:33], v[40:41]
  v_pk_add_f32 v[34:35], v[34:35], v[42:43]
  v_cvt_pk_bf16_f32 v36, v32, v33
  v_lshlrev_b32 v32, 16, v36
  v_and_b32 v33, 0xffff0000, v36
  v_cvt_pk_bf16_f32 v37, v34, v35
  v_lshlrev_b32 v34, 16, v37
  v_and_b32 v35, 0xffff0000, v37
  v_pk_add_f32 v[32:33], v[32:33], v[44:45] op_sel_hi:[1,0]
  v_pk_add_f32 v[34:35], v[34:35], v[44:45] op_sel_hi:[1,0]
  v_cvt_pk_bf16_f32 v36, v32, v33
  v_lshlrev_b32 v32, 16, v36
  v_and_b32 v33, 0xffff0000, v36
  v_cvt_pk_bf16_f32 v37, v34, v35
  v_lshlrev_b32 v34, 16, v37
  v_and_b32 v35, 0xffff0000, v37
  buffer_store_dwordx4 v[32:35], v5, s[24:27], 0 offen
  v_lshlrev_b32 v6, 3, v7
  v_subrev_u32 v13, 432, v4
  v_lshlrev_b32 v14, 3, v13
  v_add_u32 v14, 1152, v14
  v_cmp_gt_u32 vcc, 144, v13
  s_nop 1
  v_cndmask_b32 v6, v6, v14, vcc
  v_cmp_gt_u32 vcc, 288, v13
  s_nop 1
  v_cndmask_b32 v6, v12, v6, vcc
  v_cmp_gt_u32 vcc, 216, v0
  s_nop 1
  v_cndmask_b32 v6, v12, v6, vcc
  buffer_store_dwordx2 v[36:37], v6, s[28:31], 0 offen
  s_endpgm
L_end_k1_kernel:
.section .rodata,"a"
.p2align 6
.amdhsa_kernel k1_kernel
  .amdhsa_next_free_vgpr 208
  .amdhsa_next_free_sgpr 64
  .amdhsa_accum_offset 208
  .amdhsa_group_segment_fixed_size 0
  .amdhsa_kernarg_size 120
  .amdhsa_user_sgpr_count 2
  .amdhsa_user_sgpr_kernarg_segment_ptr 1
  .amdhsa_system_sgpr_workgroup_id_x 1
  .amdhsa_float_denorm_mode_32 3
.end_amdhsa_kernel
.text
.globl k2_kernel
.p2align 8
.type k2_kernel,@function
k2_kernel:
  s_cmp_ge_u32 s2, 256
  s_cbranch_scc1 L_k2_end
  s_load_dwordx2 s[16:17], s[0:1], 112
  v_lshrrev_b32 v1, 6, v0
  s_nop 0
  v_readfirstlane_b32 s3, v1
  v_and_b32 v1, 63, v0
  v_lshlrev_b32 v2, 4, v1
  s_cmp_ge_u32 s3, 4
  s_cbranch_scc1 L_k2_loader
  s_lshr_b32 s4, s2, 2
  s_and_b32 s5, s2, 3
  s_lshl_b32 s5, s5, 2
  s_add_u32 s5, s5, s3
  s_lshl_b32 s5, s5, 1
  v_and_b32 v5, 31, v1
  v_lshrrev_b32 v6, 5, v1
  v_bfe_u32 v7, v1, 4, 1
  v_mul_u32_u24 v7, 18432, v7
  v_and_b32 v3, 15, v1
  v_lshl_add_u32 v7, v3, 4, v7
  s_lshl_b32 s6, s4, 4
  s_lshr_b32 s7, s5, 2
  s_add_u32 s6, s6, s7
  s_mul_i32 s6, s6, 2304
  s_and_b32 s7, s5, 2
  s_lshl_b32 s8, s7, 2
  s_add_u32 s8, s8, s6
  s_lshl_b32 s7, s7, 9
  s_add_u32 s6, s6, s7
  v_lshl_add_u32 v3, v6, 8, v7
  v_cmp_eq_u32 vcc, 0, v6
  v_mov_b32 v4, 2146435072
  s_nop 0
  v_cndmask_b32 v7, v4, v7, vcc
  v_lshlrev_b32 v4, 5, v1
  s_waitcnt lgkmcnt(0)
  s_add_u32 s20, s16, 4194304
  s_addc_u32 s21, s17, 0
  s_and_b32 s21, s21, 0xffff
  s_mov_b32 s22, 2359296
  s_mov_b32 s23, 0x20000
  buffer_load_dwordx4 v[8:11], v3, s[20:23], s6 offen
  buffer_load_dwordx4 v[12:15], v3, s[20:23], s6 offen offset:512
  buffer_load_dword v18, v7, s[20:23], s8 offen offset:2048
  buffer_load_dword v30, v7, s[20:23], s8 offen offset:2052
  s_add_u32 s24, s16, 98304
  s_addc_u32 s25, s17, 0
  s_and_b32 s25, s25, 0xffff
  s_mov_b32 s26, 2048
  s_mov_b32 s27, 0x20000
  buffer_load_dwordx4 v[72:75], v4, s[24:27], 0 offen
  buffer_load_dwordx4 v[76:79], v4, s[24:27], 0 offen offset:16
  v_mul_u32_u24 v3, 304, v6
  v_lshl_add_u32 v3, v5, 4, v3
  v_cmp_lt_u32 vcc, 18, v5
  v_mov_b32 v4, 608
  s_nop 0
  v_cndmask_b32 v3, v3, v4, vcc
  v_add_u32 v3, 1024, v3
  v_lshlrev_b32 v4, 4, v5
  v_add_u32 v4, 9088, v4
  s_mov_b32 s12, 0x7ffff
  s_mov_b32 s13, 0x7ffff
  s_add_u32 s28, s16, 7340032
  s_addc_u32 s29, s17, 0
  s_and_b32 s29, s29, 0xffff
  s_mov_b32 s30, 2359296
  s_mov_b32 s31, 0x20000
  v_mov_b32 v16, 0
  v_mov_b32 v17, 0
  v_mov_b32 v19, 0
  v_mov_b32 v20, 0
  v_mov_b32 v21, 0
  v_mov_b32 v22, 0
  v_mov_b32 v23, 0
  v_mov_b32 v24, 0
  v_mov_b32 v26, 0
  v_mov_b32 v27, 0
  v_mov_b32 v40, 0
  v_mov_b32 v41, 0
  v_mov_b32 v42, 0
  v_mov_b32 v43, 0
  v_mov_b32 v44, 0
  v_mov_b32 v45, 0
  v_mov_b32 v46, 0
  v_mov_b32 v47, 0
  v_mov_b32 v48, 0
  v_mov_b32 v49, 0
  v_mov_b32 v50, 0
  v_mov_b32 v51, 0
  v_mov_b32 v52, 0
  v_mov_b32 v53, 0
  v_mov_b32 v54, 0
  v_mov_b32 v55, 0
  v_mov_b32 v28, 0
  v_mov_b32 v29, 0
  v_mov_b32 v31, 0
  v_mov_b32 v32, 0
  v_mov_b32 v33, 0
  v_mov_b32 v34, 0
  v_mov_b32 v35, 0
  v_mov_b32 v36, 0
  v_mov_b32 v38, 0
  v_mov_b32 v39, 0
  v_mov_b32 v56, 0
  v_mov_b32 v57, 0
  v_mov_b32 v58, 0
  v_mov_b32 v59, 0
  v_mov_b32 v60, 0
  v_mov_b32 v61, 0
  v_mov_b32 v62, 0
  v_mov_b32 v63, 0
  v_mov_b32 v64, 0
  v_mov_b32 v65, 0
  v_mov_b32 v66, 0
  v_mov_b32 v67, 0
  v_mov_b32 v68, 0
  v_mov_b32 v69, 0
  v_mov_b32 v70, 0
  v_mov_b32 v71, 0
  v_mov_b32 v148, 0
  v_mov_b32 v149, 0
  v_mov_b32 v150, 0
  v_mov_b32 v151, 0
  v_mov_b32 v183, 0
  v_mov_b32 v182, 0
  v_mov_b32 v181, 0
  v_mov_b32 v180, 0
  s_waitcnt vmcnt(0)
  v_mov_b32 v25, v18
  v_mov_b32 v37, v30
  v_add_f32 v72, v72, v73
  v_add_f32 v76, v76, v77
  v_add_f32 v72, v72, v74
  v_add_f32 v76, v76, v78
  v_max_f32 v72, v72, v76
  v_lshlrev_b32 v80, 16, v8
  v_and_b32 v81, 0xffff0000, v8
  v_lshlrev_b32 v82, 16, v9
  v_and_b32 v83, 0xffff0000, v9
  v_lshlrev_b32 v84, 16, v10
  v_max_f32_dpp v72, v72, v72 row_ror:8 row_mask:0xf bank_mask:0xf
  v_and_b32 v85, 0xffff0000, v10
  v_lshlrev_b32 v86, 16, v11
  v_and_b32 v87, 0xffff0000, v11
  v_lshlrev_b32 v88, 16, v18
  v_and_b32 v89, 0xffff0000, v18
  v_max_f32_dpp v72, v72, v72 row_ror:4 row_mask:0xf bank_mask:0xf
  v_lshlrev_b32 v90, 16, v12
  v_and_b32 v91, 0xffff0000, v12
  v_lshlrev_b32 v92, 16, v13
  v_and_b32 v93, 0xffff0000, v13
  v_lshlrev_b32 v94, 16, v14
  v_max_f32_dpp v72, v72, v72 row_ror:2 row_mask:0xf bank_mask:0xf
  v_and_b32 v95, 0xffff0000, v14
  v_lshlrev_b32 v96, 16, v15
  v_and_b32 v97, 0xffff0000, v15
  v_lshlrev_b32 v98, 16, v30
  v_and_b32 v99, 0xffff0000, v30
  v_max_f32_dpp v72, v72, v72 row_ror:1 row_mask:0xf bank_mask:0xf
  v_pk_mul_f32 v[100:101], v[80:81], v[80:81]
  v_pk_mul_f32 v[102:103], v[90:91], v[90:91]
  v_mov_b32 v76, v72
  v_pk_fma_f32 v[100:101], v[82:83], v[82:83], v[100:101]
  v_pk_fma_f32 v[102:103], v[92:93], v[92:93], v[102:103]
  v_permlane16_swap_b32 v72, v76
  v_max_f32 v72, v72, v76
  v_mov_b32 v76, v72
  v_pk_fma_f32 v[100:101], v[84:85], v[84:85], v[100:101]
  v_pk_fma_f32 v[102:103], v[94:95], v[94:95], v[102:103]
  v_pk_fma_f32 v[100:101], v[86:87], v[86:87], v[100:101]
  v_pk_fma_f32 v[102:103], v[96:97], v[96:97], v[102:103]
  v_pk_fma_f32 v[100:101], v[88:89], v[88:89], v[100:101]
  v_pk_fma_f32 v[102:103], v[98:99], v[98:99], v[102:103]
  v_add_f32 v75, v100, v101
  v_add_f32 v79, v102, v103
  v_permlane32_swap_b32 v72, v76
  v_max_f32 v72, v72, v76
  v_permlane32_swap_b32 v75, v79
  v_add_f32 v75, v75, v79
  v_mul_f32 v72, v72, v75
  s_mov_b32 s6, 0x45788b2f
  v_cmp_nge_f32 vcc, s6, v72
  s_barrier
  s_nop 0
  s_cbranch_vccnz L_k2_slow
  v_mov_b32 v184, v18
  v_mov_b32 v187, v30
  v_mov_b32 v185, 0
  v_mov_b32 v186, 0
  ds_read_b128 v[160:163], v4
  ds_read_b128 v[152:155], v2 offset:0
  v_permlane32_swap_b32 v184, v187
  ds_read_b128 v[156:159], v2 offset:2272
  v_mov_b32 v187, v184
  ds_read_b128 v[168:171], v3 offset:0
  ds_read_b128 v[172:175], v3 offset:624
  s_waitcnt lgkmcnt(3)
  v_mfma_f32_32x32x4_2b_bf16 v[72:103], v[160:161], v[184:185], 0
  s_nop 15
  s_nop 1
  v_mfma_f32_32x32x16_bf16 v[72:87], v[152:155], v[8:11], v[72:87]
  v_mfma_f32_32x32x16_bf16 v[88:103], v[152:155], v[12:15], v[88:103]
  s_mov_b32 s7, 0
  s_waitcnt lgkmcnt(0)
  s_nop 9
  .p2align 6
L_k2_loop:
  v_mfma_f32_32x32x4_2b_bf16 v[104:135], v[160:161], v[186:187], 0
  ds_read_b128 v[152:155], v2 offset:4544
  v_exp_f32 v72, v72
  v_exp_f32 v73, v73
  v_exp_f32 v74, v74
  v_exp_f32 v75, v75
  v_exp_f32 v76, v76
  v_exp_f32 v77, v77
  v_exp_f32 v78, v78
  v_exp_f32 v79, v79
  v_mfma_f32_32x32x16_bf16 v[56:71], v[180:183], v[148:151], v[56:71]
  ds_read_b128 v[176:179], v3 offset:2272
  v_cvt_pk_bf16_f32 v136, v72, v73
  v_cvt_pk_bf16_f32 v137, v74, v75
  v_cvt_pk_bf16_f32 v138, v76, v77
  v_cvt_pk_bf16_f32 v139, v78, v79
  v_exp_f32 v80, v80
  v_exp_f32 v81, v81
  v_exp_f32 v82, v82
  v_mfma_f32_32x32x16_bf16 v[40:55], v[168:171], v[136:139], v[40:55]
  ds_read_b128 v[180:183], v3 offset:2896
  v_exp_f32 v83, v83
  v_exp_f32 v84, v84
  v_exp_f32 v85, v85
  v_exp_f32 v86, v86
  v_exp_f32 v87, v87
  v_mfma_f32_32x32x16_bf16 v[104:119], v[156:159], v[8:11], v[104:119]
  ds_read_b128 v[164:167], v4 offset:9600
  v_cvt_pk_bf16_f32 v140, v80, v81
  v_cvt_pk_bf16_f32 v141, v82, v83
  v_cvt_pk_bf16_f32 v142, v84, v85
  v_cvt_pk_bf16_f32 v143, v86, v87
  v_exp_f32 v88, v88
  v_exp_f32 v89, v89
  v_exp_f32 v90, v90
  v_mfma_f32_32x32x16_bf16 v[120:135], v[156:159], v[12:15], v[120:135]
  v_exp_f32 v91, v91
  v_exp_f32 v92, v92
  v_exp_f32 v93, v93
  v_exp_f32 v94, v94
  v_exp_f32 v95, v95
  v_mfma_f32_32x32x16_bf16 v[40:55], v[172:175], v[140:143], v[40:55]
  v_cvt_pk_bf16_f32 v144, v88, v89
  v_cvt_pk_bf16_f32 v145, v90, v91
  v_cvt_pk_bf16_f32 v146, v92, v93
  v_cvt_pk_bf16_f32 v147, v94, v95
  v_exp_f32 v96, v96
  v_exp_f32 v97, v97
  v_exp_f32 v98, v98
  v_mfma_f32_32x32x16_bf16 v[56:71], v[168:171], v[144:147], v[56:71]
  s_waitcnt lgkmcnt(0)
  v_exp_f32 v99, v99
  v_exp_f32 v100, v100
  v_exp_f32 v101, v101
  v_exp_f32 v102, v102
  v_exp_f32 v103, v103
  v_cvt_pk_bf16_f32 v148, v96, v97
  v_cvt_pk_bf16_f32 v149, v98, v99
  v_cvt_pk_bf16_f32 v150, v100, v101
  v_cvt_pk_bf16_f32 v151, v102, v103
  v_mfma_f32_32x32x4_2b_bf16 v[72:103], v[162:163], v[184:185], 0
  ds_read_b128 v[156:159], v2 offset:6816
  v_exp_f32 v104, v104
  v_exp_f32 v105, v105
  v_exp_f32 v106, v106
  v_exp_f32 v107, v107
  v_exp_f32 v108, v108
  v_exp_f32 v109, v109
  v_exp_f32 v110, v110
  v_exp_f32 v111, v111
  v_mfma_f32_32x32x16_bf16 v[56:71], v[172:175], v[148:151], v[56:71]
  ds_read_b128 v[168:171], v3 offset:4544
  v_cvt_pk_bf16_f32 v136, v104, v105
  v_cvt_pk_bf16_f32 v137, v106, v107
  v_cvt_pk_bf16_f32 v138, v108, v109
  v_cvt_pk_bf16_f32 v139, v110, v111
  v_exp_f32 v112, v112
  v_exp_f32 v113, v113
  v_exp_f32 v114, v114
  v_mfma_f32_32x32x16_bf16 v[40:55], v[176:179], v[136:139], v[40:55]
  ds_read_b128 v[172:175], v3 offset:5168
  v_exp_f32 v115, v115
  v_exp_f32 v116, v116
  v_exp_f32 v117, v117
  v_exp_f32 v118, v118
  v_exp_f32 v119, v119
  v_mfma_f32_32x32x16_bf16 v[72:87], v[152:155], v[8:11], v[72:87]
  v_cvt_pk_bf16_f32 v140, v112, v113
  v_cvt_pk_bf16_f32 v141, v114, v115
  v_cvt_pk_bf16_f32 v142, v116, v117
  v_cvt_pk_bf16_f32 v143, v118, v119
  v_exp_f32 v120, v120
  v_exp_f32 v121, v121
  v_exp_f32 v122, v122
  v_mfma_f32_32x32x16_bf16 v[88:103], v[152:155], v[12:15], v[88:103]
  v_exp_f32 v123, v123
  v_exp_f32 v124, v124
  v_exp_f32 v125, v125
  v_exp_f32 v126, v126
  v_exp_f32 v127, v127
  v_mfma_f32_32x32x16_bf16 v[40:55], v[180:183], v[140:143], v[40:55]
  v_cvt_pk_bf16_f32 v144, v120, v121
  v_cvt_pk_bf16_f32 v145, v122, v123
  v_cvt_pk_bf16_f32 v146, v124, v125
  v_cvt_pk_bf16_f32 v147, v126, v127
  v_exp_f32 v128, v128
  v_exp_f32 v129, v129
  v_exp_f32 v130, v130
  v_mfma_f32_32x32x16_bf16 v[56:71], v[176:179], v[144:147], v[56:71]
  s_waitcnt lgkmcnt(0)
  v_exp_f32 v131, v131
  v_exp_f32 v132, v132
  v_exp_f32 v133, v133
  v_exp_f32 v134, v134
  v_exp_f32 v135, v135
  v_cvt_pk_bf16_f32 v148, v128, v129
  v_cvt_pk_bf16_f32 v149, v130, v131
  v_cvt_pk_bf16_f32 v150, v132, v133
  v_cvt_pk_bf16_f32 v151, v134, v135
  v_mfma_f32_32x32x4_2b_bf16 v[104:135], v[162:163], v[186:187], 0
  ds_read_b128 v[152:155], v2 offset:9600
  v_exp_f32 v72, v72
  v_exp_f32 v73, v73
  v_exp_f32 v74, v74
  v_exp_f32 v75, v75
  v_exp_f32 v76, v76
  v_exp_f32 v77, v77
  v_exp_f32 v78, v78
  v_exp_f32 v79, v79
  v_mfma_f32_32x32x16_bf16 v[56:71], v[180:183], v[148:151], v[56:71]
  ds_read_b128 v[176:179], v3 offset:6816
  v_cvt_pk_bf16_f32 v136, v72, v73
  v_cvt_pk_bf16_f32 v137, v74, v75
  v_cvt_pk_bf16_f32 v138, v76, v77
  v_cvt_pk_bf16_f32 v139, v78, v79
  v_exp_f32 v80, v80
  v_exp_f32 v81, v81
  v_exp_f32 v82, v82
  v_mfma_f32_32x32x16_bf16 v[40:55], v[168:171], v[136:139], v[40:55]
  ds_read_b128 v[180:183], v3 offset:7440
  v_exp_f32 v83, v83
  v_exp_f32 v84, v84
  v_exp_f32 v85, v85
  v_exp_f32 v86, v86
  v_exp_f32 v87, v87
  v_mfma_f32_32x32x16_bf16 v[104:119], v[156:159], v[8:11], v[104:119]
  v_cvt_pk_bf16_f32 v140, v80, v81
  v_cvt_pk_bf16_f32 v141, v82, v83
  v_cvt_pk_bf16_f32 v142, v84, v85
  v_cvt_pk_bf16_f32 v143, v86, v87
  v_exp_f32 v88, v88
  v_exp_f32 v89, v89
  v_exp_f32 v90, v90
  v_mfma_f32_32x32x16_bf16 v[120:135], v[156:159], v[12:15], v[120:135]
  v_exp_f32 v91, v91
  v_exp_f32 v92, v92
  v_exp_f32 v93, v93
  v_exp_f32 v94, v94
  v_exp_f32 v95, v95
  v_mfma_f32_32x32x16_bf16 v[40:55], v[172:175], v[140:143], v[40:55]
  v_cvt_pk_bf16_f32 v144, v88, v89
  v_cvt_pk_bf16_f32 v145, v90, v91
  v_cvt_pk_bf16_f32 v146, v92, v93
  v_cvt_pk_bf16_f32 v147, v94, v95
  v_exp_f32 v96, v96
  v_exp_f32 v97, v97
  v_exp_f32 v98, v98
  v_mfma_f32_32x32x16_bf16 v[56:71], v[168:171], v[144:147], v[56:71]
  s_waitcnt lgkmcnt(0)
  v_exp_f32 v99, v99
  v_exp_f32 v100, v100
  v_exp_f32 v101, v101
  v_exp_f32 v102, v102
  v_exp_f32 v103, v103
  v_cvt_pk_bf16_f32 v148, v96, v97
  v_cvt_pk_bf16_f32 v149, v98, v99
  v_cvt_pk_bf16_f32 v150, v100, v101
  v_cvt_pk_bf16_f32 v151, v102, v103
  v_mfma_f32_32x32x4_2b_bf16 v[72:103], v[164:165], v[184:185], 0
  ds_read_b128 v[156:159], v2 offset:11872
  v_exp_f32 v104, v104
  v_exp_f32 v105, v105
  v_exp_f32 v106, v106
  v_exp_f32 v107, v107
  v_exp_f32 v108, v108
  v_exp_f32 v109, v109
  v_exp_f32 v110, v110
  v_exp_f32 v111, v111
  v_mfma_f32_32x32x16_bf16 v[56:71], v[172:175], v[148:151], v[56:71]
  ds_read_b128 v[168:171], v3 offset:9600
  v_cvt_pk_bf16_f32 v136, v104, v105
  v_cvt_pk_bf16_f32 v137, v106, v107
  v_cvt_pk_bf16_f32 v138, v108, v109
  v_cvt_pk_bf16_f32 v139, v110, v111
  v_exp_f32 v112, v112
  v_exp_f32 v113, v113
  v_exp_f32 v114, v114
  v_mfma_f32_32x32x16_bf16 v[40:55], v[176:179], v[136:139], v[40:55]
  ds_read_b128 v[172:175], v3 offset:10224
  v_exp_f32 v115, v115
  v_exp_f32 v116, v116
  v_exp_f32 v117, v117
  v_exp_f32 v118, v118
  v_exp_f32 v119, v119
  v_mfma_f32_32x32x16_bf16 v[72:87], v[152:155], v[8:11], v[72:87]
  v_cvt_pk_bf16_f32 v140, v112, v113
  v_cvt_pk_bf16_f32 v141, v114, v115
  v_cvt_pk_bf16_f32 v142, v116, v117
  v_cvt_pk_bf16_f32 v143, v118, v119
  v_exp_f32 v120, v120
  v_exp_f32 v121, v121
  v_exp_f32 v122, v122
  v_mfma_f32_32x32x16_bf16 v[88:103], v[152:155], v[12:15], v[88:103]
  v_exp_f32 v123, v123
  v_exp_f32 v124, v124
  v_exp_f32 v125, v125
  v_exp_f32 v126, v126
  v_exp_f32 v127, v127
  v_mfma_f32_32x32x16_bf16 v[40:55], v[180:183], v[140:143], v[40:55]
  v_cvt_pk_bf16_f32 v144, v120, v121
  v_cvt_pk_bf16_f32 v145, v122, v123
  v_cvt_pk_bf16_f32 v146, v124, v125
  v_cvt_pk_bf16_f32 v147, v126, v127
  v_exp_f32 v128, v128
  v_exp_f32 v129, v129
  v_exp_f32 v130, v130
  v_mfma_f32_32x32x16_bf16 v[56:71], v[176:179], v[144:147], v[56:71]
  s_waitcnt lgkmcnt(0)
  v_exp_f32 v131, v131
  v_exp_f32 v132, v132
  v_exp_f32 v133, v133
  v_exp_f32 v134, v134
  v_exp_f32 v135, v135
  v_cvt_pk_bf16_f32 v148, v128, v129
  v_cvt_pk_bf16_f32 v149, v130, v131
  v_cvt_pk_bf16_f32 v150, v132, v133
  v_cvt_pk_bf16_f32 v151, v134, v135
  v_mfma_f32_32x32x4_2b_bf16 v[104:135], v[164:165], v[186:187], 0
  ds_read_b128 v[152:155], v2 offset:14144
  v_exp_f32 v72, v72
  v_exp_f32 v73, v73
  v_exp_f32 v74, v74
  v_exp_f32 v75, v75
  v_exp_f32 v76, v76
  v_exp_f32 v77, v77
  v_exp_f32 v78, v78
  v_exp_f32 v79, v79
  v_mfma_f32_32x32x16_bf16 v[56:71], v[180:183], v[148:151], v[56:71]
  ds_read_b128 v[176:179], v3 offset:11872
  v_cvt_pk_bf16_f32 v136, v72, v73
  v_cvt_pk_bf16_f32 v137, v74, v75
  v_cvt_pk_bf16_f32 v138, v76, v77
  v_cvt_pk_bf16_f32 v139, v78, v79
  v_exp_f32 v80, v80
  v_exp_f32 v81, v81
  v_exp_f32 v82, v82
  v_mfma_f32_32x32x16_bf16 v[40:55], v[168:171], v[136:139], v[40:55]
  ds_read_b128 v[180:183], v3 offset:12496
  v_exp_f32 v83, v83
  v_exp_f32 v84, v84
  v_exp_f32 v85, v85
  v_exp_f32 v86, v86
  v_exp_f32 v87, v87
  v_mfma_f32_32x32x16_bf16 v[104:119], v[156:159], v[8:11], v[104:119]
  ds_read_b128 v[160:163], v4 offset:19200
  v_cvt_pk_bf16_f32 v140, v80, v81
  v_cvt_pk_bf16_f32 v141, v82, v83
  v_cvt_pk_bf16_f32 v142, v84, v85
  v_cvt_pk_bf16_f32 v143, v86, v87
  v_exp_f32 v88, v88
  v_exp_f32 v89, v89
  v_exp_f32 v90, v90
  v_mfma_f32_32x32x16_bf16 v[120:135], v[156:159], v[12:15], v[120:135]
  v_exp_f32 v91, v91
  v_exp_f32 v92, v92
  v_exp_f32 v93, v93
  v_exp_f32 v94, v94
  v_exp_f32 v95, v95
  v_mfma_f32_32x32x16_bf16 v[40:55], v[172:175], v[140:143], v[40:55]
  v_cvt_pk_bf16_f32 v144, v88, v89
  v_cvt_pk_bf16_f32 v145, v90, v91
  v_cvt_pk_bf16_f32 v146, v92, v93
  v_cvt_pk_bf16_f32 v147, v94, v95
  v_exp_f32 v96, v96
  v_exp_f32 v97, v97
  v_exp_f32 v98, v98
  v_mfma_f32_32x32x16_bf16 v[56:71], v[168:171], v[144:147], v[56:71]
  s_waitcnt lgkmcnt(0)
  v_exp_f32 v99, v99
  v_exp_f32 v100, v100
  v_exp_f32 v101, v101
  v_exp_f32 v102, v102
  v_exp_f32 v103, v103
  v_cvt_pk_bf16_f32 v148, v96, v97
  v_cvt_pk_bf16_f32 v149, v98, v99
  v_cvt_pk_bf16_f32 v150, v100, v101
  v_cvt_pk_bf16_f32 v151, v102, v103
  v_mfma_f32_32x32x4_2b_bf16 v[72:103], v[166:167], v[184:185], 0
  ds_read_b128 v[156:159], v2 offset:16416
  v_exp_f32 v104, v104
  v_exp_f32 v105, v105
  v_exp_f32 v106, v106
  v_exp_f32 v107, v107
  v_exp_f32 v108, v108
  v_exp_f32 v109, v109
  v_exp_f32 v110, v110
  v_exp_f32 v111, v111
  v_mfma_f32_32x32x16_bf16 v[56:71], v[172:175], v[148:151], v[56:71]
  ds_read_b128 v[168:171], v3 offset:14144
  v_cvt_pk_bf16_f32 v136, v104, v105
  v_cvt_pk_bf16_f32 v137, v106, v107
  v_cvt_pk_bf16_f32 v138, v108, v109
  v_cvt_pk_bf16_f32 v139, v110, v111
  v_exp_f32 v112, v112
  v_exp_f32 v113, v113
  v_exp_f32 v114, v114
  v_mfma_f32_32x32x16_bf16 v[40:55], v[176:179], v[136:139], v[40:55]
  ds_read_b128 v[172:175], v3 offset:14768
  v_exp_f32 v115, v115
  v_exp_f32 v116, v116
  v_exp_f32 v117, v117
  v_exp_f32 v118, v118
  v_exp_f32 v119, v119
  v_mfma_f32_32x32x16_bf16 v[72:87], v[152:155], v[8:11], v[72:87]
  v_cvt_pk_bf16_f32 v140, v112, v113
  v_cvt_pk_bf16_f32 v141, v114, v115
  v_cvt_pk_bf16_f32 v142, v116, v117
  v_cvt_pk_bf16_f32 v143, v118, v119
  v_exp_f32 v120, v120
  v_exp_f32 v121, v121
  v_exp_f32 v122, v122
  v_mfma_f32_32x32x16_bf16 v[88:103], v[152:155], v[12:15], v[88:103]
  v_exp_f32 v123, v123
  v_exp_f32 v124, v124
  v_exp_f32 v125, v125
  v_exp_f32 v126, v126
  v_exp_f32 v127, v127
  v_mfma_f32_32x32x16_bf16 v[40:55], v[180:183], v[140:143], v[40:55]
  v_cvt_pk_bf16_f32 v144, v120, v121
  v_cvt_pk_bf16_f32 v145, v122, v123
  v_cvt_pk_bf16_f32 v146, v124, v125
  v_cvt_pk_bf16_f32 v147, v126, v127
  v_exp_f32 v128, v128
  v_exp_f32 v129, v129
  v_exp_f32 v130, v130
  v_mfma_f32_32x32x16_bf16 v[56:71], v[176:179], v[144:147], v[56:71]
  s_waitcnt lgkmcnt(0)
  v_exp_f32 v131, v131
  v_exp_f32 v132, v132
  v_exp_f32 v133, v133
  v_exp_f32 v134, v134
  v_exp_f32 v135, v135
  v_cvt_pk_bf16_f32 v148, v128, v129
  v_cvt_pk_bf16_f32 v149, v130, v131
  v_cvt_pk_bf16_f32 v150, v132, v133
  v_cvt_pk_bf16_f32 v151, v134, v135
  v_mfma_f32_32x32x4_2b_bf16 v[104:135], v[166:167], v[186:187], 0
  ds_read_b128 v[152:155], v2 offset:19200
  v_exp_f32 v72, v72
  v_exp_f32 v73, v73
  v_exp_f32 v74, v74
  v_exp_f32 v75, v75
  v_exp_f32 v76, v76
  v_exp_f32 v77, v77
  v_exp_f32 v78, v78
  v_exp_f32 v79, v79
  v_mfma_f32_32x32x16_bf16 v[56:71], v[180:183], v[148:151], v[56:71]
  ds_read_b128 v[176:179], v3 offset:16416
  v_cvt_pk_bf16_f32 v136, v72, v73
  v_cvt_pk_bf16_f32 v137, v74, v75
  v_cvt_pk_bf16_f32 v138, v76, v77
  v_cvt_pk_bf16_f32 v139, v78, v79
  v_exp_f32 v80, v80
  v_exp_f32 v81, v81
  v_exp_f32 v82, v82
  v_mfma_f32_32x32x16_bf16 v[40:55], v[168:171], v[136:139], v[40:55]
  ds_read_b128 v[180:183], v3 offset:17040
  v_exp_f32 v83, v83
  v_exp_f32 v84, v84
  v_exp_f32 v85, v85
  v_exp_f32 v86, v86
  v_exp_f32 v87, v87
  v_mfma_f32_32x32x16_bf16 v[104:119], v[156:159], v[8:11], v[104:119]
  v_cvt_pk_bf16_f32 v140, v80, v81
  v_cvt_pk_bf16_f32 v141, v82, v83
  v_cvt_pk_bf16_f32 v142, v84, v85
  v_cvt_pk_bf16_f32 v143, v86, v87
  v_exp_f32 v88, v88
  v_exp_f32 v89, v89
  v_exp_f32 v90, v90
  v_mfma_f32_32x32x16_bf16 v[120:135], v[156:159], v[12:15], v[120:135]
  v_exp_f32 v91, v91
  v_exp_f32 v92, v92
  v_exp_f32 v93, v93
  v_exp_f32 v94, v94
  v_exp_f32 v95, v95
  v_mfma_f32_32x32x16_bf16 v[40:55], v[172:175], v[140:143], v[40:55]
  v_cvt_pk_bf16_f32 v144, v88, v89
  v_cvt_pk_bf16_f32 v145, v90, v91
  v_cvt_pk_bf16_f32 v146, v92, v93
  v_cvt_pk_bf16_f32 v147, v94, v95
  v_exp_f32 v96, v96
  v_exp_f32 v97, v97
  v_exp_f32 v98, v98
  v_mfma_f32_32x32x16_bf16 v[56:71], v[168:171], v[144:147], v[56:71]
  s_waitcnt lgkmcnt(0)
  v_exp_f32 v99, v99
  v_exp_f32 v100, v100
  v_exp_f32 v101, v101
  v_exp_f32 v102, v102
  v_exp_f32 v103, v103
  v_cvt_pk_bf16_f32 v148, v96, v97
  v_cvt_pk_bf16_f32 v149, v98, v99
  v_cvt_pk_bf16_f32 v150, v100, v101
  v_cvt_pk_bf16_f32 v151, v102, v103
  v_mfma_f32_32x32x4_2b_bf16 v[72:103], v[160:161], v[184:185], 0
  ds_read_b128 v[156:159], v2 offset:21472
  v_exp_f32 v104, v104
  v_exp_f32 v105, v105
  v_exp_f32 v106, v106
  v_exp_f32 v107, v107
  v_exp_f32 v108, v108
  v_exp_f32 v109, v109
  v_exp_f32 v110, v110
  v_exp_f32 v111, v111
  v_mfma_f32_32x32x16_bf16 v[56:71], v[172:175], v[148:151], v[56:71]
  ds_read_b128 v[168:171], v3 offset:19200
  v_cvt_pk_bf16_f32 v136, v104, v105
  v_cvt_pk_bf16_f32 v137, v106, v107
  v_cvt_pk_bf16_f32 v138, v108, v109
  v_cvt_pk_bf16_f32 v139, v110, v111
  v_exp_f32 v112, v112
  v_exp_f32 v113, v113
  v_exp_f32 v114, v114
  v_mfma_f32_32x32x16_bf16 v[40:55], v[176:179], v[136:139], v[40:55]
  ds_read_b128 v[172:175], v3 offset:19824
  v_exp_f32 v115, v115
  v_exp_f32 v116, v116
  v_exp_f32 v117, v117
  v_exp_f32 v118, v118
  v_exp_f32 v119, v119
  v_mfma_f32_32x32x16_bf16 v[72:87], v[152:155], v[8:11], v[72:87]
  v_cvt_pk_bf16_f32 v140, v112, v113
  v_cvt_pk_bf16_f32 v141, v114, v115
  v_cvt_pk_bf16_f32 v142, v116, v117
  v_cvt_pk_bf16_f32 v143, v118, v119
  v_exp_f32 v120, v120
  v_exp_f32 v121, v121
  v_exp_f32 v122, v122
  v_mfma_f32_32x32x16_bf16 v[88:103], v[152:155], v[12:15], v[88:103]
  v_exp_f32 v123, v123
  v_exp_f32 v124, v124
  v_exp_f32 v125, v125
  v_exp_f32 v126, v126
  v_exp_f32 v127, v127
  v_mfma_f32_32x32x16_bf16 v[40:55], v[180:183], v[140:143], v[40:55]
  v_cvt_pk_bf16_f32 v144, v120, v121
  v_cvt_pk_bf16_f32 v145, v122, v123
  v_cvt_pk_bf16_f32 v146, v124, v125
  v_cvt_pk_bf16_f32 v147, v126, v127
  v_exp_f32 v128, v128
  v_exp_f32 v129, v129
  v_exp_f32 v130, v130
  v_mfma_f32_32x32x16_bf16 v[56:71], v[176:179], v[144:147], v[56:71]
  s_waitcnt lgkmcnt(0)
  s_cmp_lg_u32 s7, 0
  s_cbranch_scc1 L_k2_nob
  s_barrier
L_k2_nob:
  s_add_u32 s7, s7, 1
  s_cmp_lt_u32 s7, 8
  v_exp_f32 v131, v131
  v_exp_f32 v132, v132
  v_exp_f32 v133, v133
  v_exp_f32 v134, v134
  v_exp_f32 v135, v135
  v_cvt_pk_bf16_f32 v148, v128, v129
  v_cvt_pk_bf16_f32 v149, v130, v131
  v_cvt_pk_bf16_f32 v150, v132, v133
  v_cvt_pk_bf16_f32 v151, v134, v135
  v_add_u32 v2, 19200, v2
  v_add_u32 v3, 19200, v3
  v_add_u32 v4, 19200, v4
  s_cbranch_scc1 L_k2_loop
  v_mfma_f32_32x32x16_bf16 v[56:71], v[180:183], v[148:151], v[56:71]
L_k2_epi:
  s_cmp_ge_u32 s2, 16
  s_cbranch_scc1 L_pfs_k2_kernel_2
  s_cmp_lg_u32 s3, 0
  s_cbranch_scc1 L_pfs_k2_kernel_2
  s_getpc_b64 s[32:33]
L_pf_k2_kernel_1:
  s_add_u32 s32, s32, k3_kernel-L_pf_k2_kernel_1
  s_addc_u32 s33, s33, 0
  s_and_b32 s33, s33, 0xffff
  s_mov_b32 s34, L_end_k3_kernel-k3_kernel
  s_mov_b32 s35, 0x20000
  v_lshlrev_b32 v90, 7, v1
  buffer_load_dword v91, v90, s[32:35], 0 offen
  v_add_u32 v90, 0x2000, v90
  buffer_load_dword v91, v90, s[32:35], 0 offen
  v_add_u32 v90, 0x2000, v90
  buffer_load_dword v91, v90, s[32:35], 0 offen
  v_add_u32 v90, 0x2000, v90
  buffer_load_dword v91, v90, s[32:35], 0 offen
L_pfs_k2_kernel_2:
  v_bfe_u32 v74, v1, 4, 1
  s_lshl_b32 s6, s4, 1
  v_add_u32 v74, s6, v74
  v_mul_u32_u24 v74, 18432, v74
  v_and_b32 v75, 15, v1
  v_lshl_add_u32 v74, v75, 4, v74
  v_lshl_add_u32 v75, v6, 8, v74
  s_lshl_b32 s6, s5, 9
  s_lshr_b32 s7, s5, 2
  s_lshl_b32 s7, s7, 8
  s_and_b32 s8, s5, 3
  s_lshl_b32 s8, s8, 2
  s_add_u32 s7, s7, s8
  s_add_u32 s7, s7, 16384
  v_cmp_eq_u32 vcc, 0, v6
  v_mov_b32 v76, 2146435072
  s_nop 0
  v_cndmask_b32 v74, v76, v74, vcc
  v_mov_b32 v72, v50
  v_mov_b32 v73, v50
  s_nop 1
  v_permlane32_swap_b32 v72, v73
  v_rcp_f32 v72, v72
  s_nop 0
  v_pk_mul_f32 v[40:41], v[40:41], v[72:73] op_sel_hi:[1,0]
  v_cvt_pk_bf16_f32 v80, v40, v41
  v_pk_mul_f32 v[42:43], v[42:43], v[72:73] op_sel_hi:[1,0]
  v_cvt_pk_bf16_f32 v81, v42, v43
  v_pk_mul_f32 v[44:45], v[44:45], v[72:73] op_sel_hi:[1,0]
  v_cvt_pk_bf16_f32 v82, v44, v45
  v_pk_mul_f32 v[46:47], v[46:47], v[72:73] op_sel_hi:[1,0]
  v_cvt_pk_bf16_f32 v83, v46, v47
  v_pk_mul_f32 v[48:49], v[48:49], v[72:73] op_sel_hi:[1,0]
  v_cvt_pk_bf16_f32 v88, v48, v49
  buffer_store_dwordx4 v[80:83], v75, s[28:31], s6 offen offset:0
  v_mov_b32 v72, v66
  v_mov_b32 v73, v66
  s_nop 1
  v_permlane32_swap_b32 v72, v73
  v_rcp_f32 v72, v72
  s_nop 0
  v_pk_mul_f32 v[56:57], v[56:57], v[72:73] op_sel_hi:[1,0]
  v_cvt_pk_bf16_f32 v84, v56, v57
  v_pk_mul_f32 v[58:59], v[58:59], v[72:73] op_sel_hi:[1,0]
  v_cvt_pk_bf16_f32 v85, v58, v59
  v_pk_mul_f32 v[60:61], v[60:61], v[72:73] op_sel_hi:[1,0]
  v_cvt_pk_bf16_f32 v86, v60, v61
  v_pk_mul_f32 v[62:63], v[62:63], v[72:73] op_sel_hi:[1,0]
  v_cvt_pk_bf16_f32 v87, v62, v63
  v_pk_mul_f32 v[64:65], v[64:65], v[72:73] op_sel_hi:[1,0]
  v_cvt_pk_bf16_f32 v89, v64, v65
  buffer_store_dwordx4 v[84:87], v75, s[28:31], s6 offen offset:512
  buffer_store_dwordx2 v[88:89], v74, s[28:31], s7 offen
  s_endpgm
L_k2_slow:
  s_barrier
  v_mov_b32 v184, 0xff61b1e6
  v_mov_b32 v185, 0xff61b1e6
  s_mov_b32 s7, 0
L_k2_sl:
  ds_read_b128 v[152:155], v2
  ds_read_b32 v160, v4
  ds_read_b128 v[168:171], v3
  ds_read_b128 v[172:175], v3 offset:624
  v_mov_b32 v161, 0
  v_mov_b32 v162, 0
  v_mov_b32 v163, 0
  s_waitcnt lgkmcnt(0)
  v_mfma_f32_32x32x16_bf16 v[72:87], v[152:155], v[8:11], 0
  v_mfma_f32_32x32x16_bf16 v[72:87], v[160:163], v[18:21], v[72:87]
  s_nop 11
  v_max3_f32 v188, v72, v73, v74
  v_max3_f32 v188, v188, v75, v76
  v_max3_f32 v188, v188, v77, v78
  v_max3_f32 v188, v188, v79, v80
  v_max3_f32 v188, v188, v81, v82
  v_max3_f32 v188, v188, v83, v84
  v_max3_f32 v188, v188, v85, v86
  v_max_f32 v188, v188, v87
  v_mov_b32 v189, v188
  s_nop 1
  v_permlane32_swap_b32 v188, v189
  v_max_f32 v188, v188, v189
  v_max_f32 v188, v188, v184
  v_sub_f32 v186, v184, v188
  v_exp_f32 v186, v186
  v_mov_b32 v184, v188
  v_sub_f32 v72, v72, v188
  v_exp_f32 v72, v72
  v_mul_f32 v40, v40, v186
  v_sub_f32 v73, v73, v188
  v_exp_f32 v73, v73
  v_mul_f32 v41, v41, v186
  v_sub_f32 v74, v74, v188
  v_exp_f32 v74, v74
  v_mul_f32 v42, v42, v186
  v_sub_f32 v75, v75, v188
  v_exp_f32 v75, v75
  v_mul_f32 v43, v43, v186
  v_sub_f32 v76, v76, v188
  v_exp_f32 v76, v76
  v_mul_f32 v44, v44, v186
  v_sub_f32 v77, v77, v188
  v_exp_f32 v77, v77
  v_mul_f32 v45, v45, v186
  v_sub_f32 v78, v78, v188
  v_exp_f32 v78, v78
  v_mul_f32 v46, v46, v186
  v_sub_f32 v79, v79, v188
  v_exp_f32 v79, v79
  v_mul_f32 v47, v47, v186
  v_sub_f32 v80, v80, v188
  v_exp_f32 v80, v80
  v_mul_f32 v48, v48, v186
  v_sub_f32 v81, v81, v188
  v_exp_f32 v81, v81
  v_mul_f32 v49, v49, v186
  v_sub_f32 v82, v82, v188
  v_exp_f32 v82, v82
  v_mul_f32 v50, v50, v186
  v_sub_f32 v83, v83, v188
  v_exp_f32 v83, v83
  v_mul_f32 v51, v51, v186
  v_sub_f32 v84, v84, v188
  v_exp_f32 v84, v84
  v_mul_f32 v52, v52, v186
  v_sub_f32 v85, v85, v188
  v_exp_f32 v85, v85
  v_mul_f32 v53, v53, v186
  v_sub_f32 v86, v86, v188
  v_exp_f32 v86, v86
  v_mul_f32 v54, v54, v186
  v_sub_f32 v87, v87, v188
  v_exp_f32 v87, v87
  v_mul_f32 v55, v55, v186
  v_cvt_pk_bf16_f32 v136, v72, v73
  v_cvt_pk_bf16_f32 v137, v74, v75
  v_cvt_pk_bf16_f32 v138, v76, v77
  v_cvt_pk_bf16_f32 v139, v78, v79
  v_cvt_pk_bf16_f32 v140, v80, v81
  v_cvt_pk_bf16_f32 v141, v82, v83
  v_cvt_pk_bf16_f32 v142, v84, v85
  v_cvt_pk_bf16_f32 v143, v86, v87
  v_mfma_f32_32x32x16_bf16 v[40:55], v[168:171], v[136:139], v[40:55]
  s_nop 0
  v_mfma_f32_32x32x16_bf16 v[40:55], v[172:175], v[140:143], v[40:55]
  v_mfma_f32_32x32x16_bf16 v[104:119], v[152:155], v[12:15], 0
  v_mfma_f32_32x32x16_bf16 v[104:119], v[160:163], v[30:33], v[104:119]
  s_nop 11
  v_max3_f32 v188, v104, v105, v106
  v_max3_f32 v188, v188, v107, v108
  v_max3_f32 v188, v188, v109, v110
  v_max3_f32 v188, v188, v111, v112
  v_max3_f32 v188, v188, v113, v114
  v_max3_f32 v188, v188, v115, v116
  v_max3_f32 v188, v188, v117, v118
  v_max_f32 v188, v188, v119
  v_mov_b32 v189, v188
  s_nop 1
  v_permlane32_swap_b32 v188, v189
  v_max_f32 v188, v188, v189
  v_max_f32 v188, v188, v185
  v_sub_f32 v186, v185, v188
  v_exp_f32 v186, v186
  v_mov_b32 v185, v188
  v_sub_f32 v104, v104, v188
  v_exp_f32 v104, v104
  v_mul_f32 v56, v56, v186
  v_sub_f32 v105, v105, v188
  v_exp_f32 v105, v105
  v_mul_f32 v57, v57, v186
  v_sub_f32 v106, v106, v188
  v_exp_f32 v106, v106
  v_mul_f32 v58, v58, v186
  v_sub_f32 v107, v107, v188
  v_exp_f32 v107, v107
  v_mul_f32 v59, v59, v186
  v_sub_f32 v108, v108, v188
  v_exp_f32 v108, v108
  v_mul_f32 v60, v60, v186
  v_sub_f32 v109, v109, v188
  v_exp_f32 v109, v109
  v_mul_f32 v61, v61, v186
  v_sub_f32 v110, v110, v188
  v_exp_f32 v110, v110
  v_mul_f32 v62, v62, v186
  v_sub_f32 v111, v111, v188
  v_exp_f32 v111, v111
  v_mul_f32 v63, v63, v186
  v_sub_f32 v112, v112, v188
  v_exp_f32 v112, v112
  v_mul_f32 v64, v64, v186
  v_sub_f32 v113, v113, v188
  v_exp_f32 v113, v113
  v_mul_f32 v65, v65, v186
  v_sub_f32 v114, v114, v188
  v_exp_f32 v114, v114
  v_mul_f32 v66, v66, v186
  v_sub_f32 v115, v115, v188
  v_exp_f32 v115, v115
  v_mul_f32 v67, v67, v186
  v_sub_f32 v116, v116, v188
  v_exp_f32 v116, v116
  v_mul_f32 v68, v68, v186
  v_sub_f32 v117, v117, v188
  v_exp_f32 v117, v117
  v_mul_f32 v69, v69, v186
  v_sub_f32 v118, v118, v188
  v_exp_f32 v118, v118
  v_mul_f32 v70, v70, v186
  v_sub_f32 v119, v119, v188
  v_exp_f32 v119, v119
  v_mul_f32 v71, v71, v186
  v_cvt_pk_bf16_f32 v144, v104, v105
  v_cvt_pk_bf16_f32 v145, v106, v107
  v_cvt_pk_bf16_f32 v146, v108, v109
  v_cvt_pk_bf16_f32 v147, v110, v111
  v_cvt_pk_bf16_f32 v148, v112, v113
  v_cvt_pk_bf16_f32 v149, v114, v115
  v_cvt_pk_bf16_f32 v150, v116, v117
  v_cvt_pk_bf16_f32 v151, v118, v119
  v_mfma_f32_32x32x16_bf16 v[56:71], v[168:171], v[144:147], v[56:71]
  s_nop 0
  v_mfma_f32_32x32x16_bf16 v[56:71], v[172:175], v[148:151], v[56:71]
  s_add_u32 s7, s7, 1
  s_and_b32 s8, s7, 3
  s_cmp_eq_u32 s8, 0
  s_cselect_b32 s8, 512, 0
  s_add_u32 s8, s8, 2272
  s_cmp_eq_u32 s8, 2784
  s_cselect_b32 s9, 9588, 4
  v_add_u32 v2, s8, v2
  v_add_u32 v3, s8, v3
  v_add_u32 v4, s9, v4
  s_cmp_lt_u32 s7, 64
  s_cbranch_scc1 L_k2_sl
  s_branch L_k2_epi
L_k2_loader:
  s_sub_u32 s3, s3, 4
  s_waitcnt lgkmcnt(0)
  s_add_u32 s20, s16, 131072
  s_addc_u32 s21, s17, 0
  s_and_b32 s21, s21, 0xffff
  s_mov_b32 s22, 153600
  s_mov_b32 s23, 0x20000
  s_mul_i32 s4, s3, 8192
  s_mov_b32 m0, s4
  s_nop 0
  buffer_load_dwordx4 v2, s[20:23], s4 offen offset:0 lds
  buffer_load_dwordx4 v2, s[20:23], s4 offen offset:1024 lds
  buffer_load_dwordx4 v2, s[20:23], s4 offen offset:2048 lds
  buffer_load_dwordx4 v2, s[20:23], s4 offen offset:3072 lds
  s_add_u32 s4, s4, 4096
  s_mov_b32 m0, s4
  s_nop 0
  buffer_load_dwordx4 v2, s[20:23], s4 offen offset:0 lds
  buffer_load_dwordx4 v2, s[20:23], s4 offen offset:1024 lds
  buffer_load_dwordx4 v2, s[20:23], s4 offen offset:2048 lds
  buffer_load_dwordx4 v2, s[20:23], s4 offen offset:3072 lds
  s_mul_i32 s4, s3, 30720
  s_min_u32 s4, s4, 90112
  s_add_u32 s4, s4, 32768
  s_mov_b32 m0, s4
  s_nop 0
  buffer_load_dwordx4 v2, s[20:23], s4 offen offset:0 lds
  buffer_load_dwordx4 v2, s[20:23], s4 offen offset:1024 lds
  buffer_load_dwordx4 v2, s[20:23], s4 offen offset:2048 lds
  buffer_load_dwordx4 v2, s[20:23], s4 offen offset:3072 lds
  s_waitcnt vmcnt(4)
  s_barrier
  s_add_u32 s4, s4, 4096
  s_mov_b32 m0, s4
  s_nop 0
  buffer_load_dwordx4 v2, s[20:23], s4 offen offset:0 lds
  buffer_load_dwordx4 v2, s[20:23], s4 offen offset:1024 lds
  buffer_load_dwordx4 v2, s[20:23], s4 offen offset:2048 lds
  buffer_load_dwordx4 v2, s[20:23], s4 offen offset:3072 lds
  s_add_u32 s4, s4, 4096
  s_mov_b32 m0, s4
  s_nop 0
  buffer_load_dwordx4 v2, s[20:23], s4 offen offset:0 lds
  buffer_load_dwordx4 v2, s[20:23], s4 offen offset:1024 lds
  buffer_load_dwordx4 v2, s[20:23], s4 offen offset:2048 lds
  buffer_load_dwordx4 v2, s[20:23], s4 offen offset:3072 lds
  s_add_u32 s4, s4, 4096
  s_mov_b32 m0, s4
  s_nop 0
  buffer_load_dwordx4 v2, s[20:23], s4 offen offset:0 lds
  buffer_load_dwordx4 v2, s[20:23], s4 offen offset:1024 lds
  buffer_load_dwordx4 v2, s[20:23], s4 offen offset:2048 lds
  buffer_load_dwordx4 v2, s[20:23], s4 offen offset:3072 lds
  s_add_u32 s4, s4, 4096
  s_mov_b32 m0, s4
  s_nop 0
  buffer_load_dwordx4 v2, s[20:23], s4 offen offset:0 lds
  buffer_load_dwordx4 v2, s[20:23], s4 offen offset:1024 lds
  buffer_load_dwordx4 v2, s[20:23], s4 offen offset:2048 lds
  buffer_load_dwordx4 v2, s[20:23], s4 offen offset:3072 lds
  s_add_u32 s4, s4, 4096
  s_mov_b32 m0, s4
  s_nop 0
  buffer_load_dwordx4 v2, s[20:23], s4 offen offset:0 lds
  buffer_load_dwordx4 v2, s[20:23], s4 offen offset:1024 lds
  buffer_load_dwordx4 v2, s[20:23], s4 offen offset:2048 lds
  buffer_load_dwordx4 v2, s[20:23], s4 offen offset:3072 lds
  s_add_u32 s4, s4, 4096
  s_mov_b32 m0, s4
  s_nop 0
  buffer_load_dwordx4 v2, s[20:23], s4 offen offset:0 lds
  buffer_load_dwordx4 v2, s[20:23], s4 offen offset:1024 lds
  buffer_load_dwordx4 v2, s[20:23], s4 offen offset:2048 lds
  buffer_load_dwordx4 v2, s[20:23], s4 offen offset:3072 lds
  s_add_u32 s4, s4, 4096
  s_mov_b32 m0, s4
  s_nop 0
  buffer_load_dwordx4 v2, s[20:23], s4 offen offset:0 lds
  buffer_load_dwordx4 v2, s[20:23], s4 offen offset:1024 lds
  s_waitcnt vmcnt(0)
  s_barrier
  s_load_dwordx2 s[4:5], s[0:1], 32
  s_load_dwordx2 s[8:9], s[0:1], 56
  s_load_dwordx2 s[6:7], s[0:1], 48
  s_load_dwordx2 s[12:13], s[0:1], 72
  s_and_b32 s18, s3, 1
  s_lshl_b32 s19, s2, 1
  s_add_u32 s18, s18, s19
  s_and_b32 s19, s3, 1
  s_mul_i32 s19, s19, 5120
  s_add_u32 s19, s19, 153600
  s_waitcnt lgkmcnt(0)
  s_cmp_ge_u32 s3, 2
  s_cbranch_scc1 L_h_lds
  s_mov_b32 s20, s8
  s_and_b32 s21, s9, 0xffff
  s_mov_b32 s22, 8388608
  s_mov_b32 s23, 0x20000
  s_add_u32 s24, s16, 28311552
  s_addc_u32 s25, s17, 0
  s_and_b32 s25, s25, 0xffff
  s_mov_b32 s26, 8388608
  s_mov_b32 s27, 0x20000
  v_and_b32 v2, 15, v1
  v_lshlrev_b32 v2, 12, v2
  v_lshrrev_b32 v3, 4, v1
  v_lshl_add_u32 v2, v3, 4, v2
  v_lshlrev_b32 v3, 4, v1
  s_lshr_b32 s32, s18, 2
  s_lshl_b32 s32, s32, 16
  s_and_b32 s33, s18, 3
  s_lshl_b32 s33, s33, 10
  s_add_u32 s32, s32, s33
  s_lshr_b32 s33, s18, 3
  s_lshl_b32 s33, s33, 17
  s_and_b32 s34, s18, 3
  s_lshl_b32 s34, s34, 15
  s_add_u32 s33, s33, s34
  s_bfe_u32 s34, s18, 0x10002
  s_lshl_b32 s34, s34, 10
  s_add_u32 s33, s33, s34
  buffer_load_dwordx4 v[8:11], v2, s[20:23], s32 offen offset:0
  buffer_load_dwordx4 v[12:15], v2, s[20:23], s32 offen offset:64
  buffer_load_dwordx4 v[16:19], v2, s[20:23], s32 offen offset:128
  buffer_load_dwordx4 v[20:23], v2, s[20:23], s32 offen offset:192
  buffer_load_dwordx4 v[24:27], v2, s[20:23], s32 offen offset:256
  buffer_load_dwordx4 v[28:31], v2, s[20:23], s32 offen offset:320
  buffer_load_dwordx4 v[32:35], v2, s[20:23], s32 offen offset:384
  buffer_load_dwordx4 v[36:39], v2, s[20:23], s32 offen offset:448
  buffer_load_dwordx4 v[40:43], v2, s[20:23], s32 offen offset:512
  buffer_load_dwordx4 v[44:47], v2, s[20:23], s32 offen offset:576
  buffer_load_dwordx4 v[48:51], v2, s[20:23], s32 offen offset:640
  buffer_load_dwordx4 v[52:55], v2, s[20:23], s32 offen offset:704
  buffer_load_dwordx4 v[56:59], v2, s[20:23], s32 offen offset:768
  buffer_load_dwordx4 v[60:63], v2, s[20:23], s32 offen offset:832
  buffer_load_dwordx4 v[64:67], v2, s[20:23], s32 offen offset:896
  buffer_load_dwordx4 v[68:71], v2, s[20:23], s32 offen offset:960
  s_waitcnt vmcnt(15)
  buffer_store_dwordx4 v[8:11], v3, s[24:27], s33 offen offset:0 sc1
  s_waitcnt vmcnt(15)
  buffer_store_dwordx4 v[12:15], v3, s[24:27], s33 offen offset:2048 sc1
  s_add_u32 s33, s33, 4096
  s_waitcnt vmcnt(15)
  buffer_store_dwordx4 v[16:19], v3, s[24:27], s33 offen offset:0 sc1
  s_waitcnt vmcnt(15)
  buffer_store_dwordx4 v[20:23], v3, s[24:27], s33 offen offset:2048 sc1
  s_add_u32 s33, s33, 4096
  s_waitcnt vmcnt(15)
  buffer_store_dwordx4 v[24:27], v3, s[24:27], s33 offen offset:0 sc1
  s_waitcnt vmcnt(15)
  buffer_store_dwordx4 v[28:31], v3, s[24:27], s33 offen offset:2048 sc1
  s_add_u32 s33, s33, 4096
  s_waitcnt vmcnt(15)
  buffer_store_dwordx4 v[32:35], v3, s[24:27], s33 offen offset:0 sc1
  s_waitcnt vmcnt(15)
  buffer_store_dwordx4 v[36:39], v3, s[24:27], s33 offen offset:2048 sc1
  s_add_u32 s33, s33, 4096
  s_waitcnt vmcnt(15)
  buffer_store_dwordx4 v[40:43], v3, s[24:27], s33 offen offset:0 sc1
  s_waitcnt vmcnt(15)
  buffer_store_dwordx4 v[44:47], v3, s[24:27], s33 offen offset:2048 sc1
  s_add_u32 s33, s33, 4096
  s_waitcnt vmcnt(15)
  buffer_store_dwordx4 v[48:51], v3, s[24:27], s33 offen offset:0 sc1
  s_waitcnt vmcnt(15)
  buffer_store_dwordx4 v[52:55], v3, s[24:27], s33 offen offset:2048 sc1
  s_add_u32 s33, s33, 4096
  s_waitcnt vmcnt(15)
  buffer_store_dwordx4 v[56:59], v3, s[24:27], s33 offen offset:0 sc1
  s_waitcnt vmcnt(15)
  buffer_store_dwordx4 v[60:63], v3, s[24:27], s33 offen offset:2048 sc1
  s_add_u32 s33, s33, 4096
  s_waitcnt vmcnt(15)
  buffer_store_dwordx4 v[64:67], v3, s[24:27], s33 offen offset:0 sc1
  s_waitcnt vmcnt(15)
  buffer_store_dwordx4 v[68:71], v3, s[24:27], s33 offen offset:2048 sc1
  s_add_u32 s33, s33, 4096
  s_endpgm
L_h_lds:
  s_cmp_ge_u32 s18, 288
  s_cbranch_scc1 L_h_t
  s_mov_b32 s20, s6
  s_and_b32 s21, s7, 0xffff
  s_mov_b32 s22, 5308416
  s_mov_b32 s23, 0x20000
  s_add_u32 s24, s16, 18874368
  s_addc_u32 s25, s17, 0
  s_and_b32 s25, s25, 0xffff
  s_mov_b32 s26, 5455872
  s_mov_b32 s27, 0x20000
  s_add_u32 s28, s16, 81920
  s_addc_u32 s29, s17, 0
  s_and_b32 s29, s29, 0xffff
  s_mov_b32 s30, 2304
  s_mov_b32 s31, 0x20000
  v_lshlrev_b32 v2, 4, v1
  buffer_load_dwordx4 v[8:11], v2, s[28:31], 0 offen sc1
  buffer_load_dwordx4 v[12:15], v2, s[28:31], 0 offen offset:1024 sc1
  buffer_load_dwordx4 v[16:19], v2, s[28:31], 0 offen offset:2048 sc1
  v_lshrrev_b32 v3, 2, v1
  v_mul_u32_u24 v36, 9216, v3
  v_and_b32 v5, 3, v1
  v_lshl_add_u32 v36, v5, 4, v36
  s_lshr_b32 s34, s18, 1
  s_and_b32 s35, s18, 1
  s_lshl_b32 s33, s34, 6
  s_mul_i32 s36, s35, 2654208
  s_add_u32 s33, s33, s36
  buffer_load_dwordx4 v[40:43], v36, s[20:23], s33 offen
  s_add_u32 s33, s33, 147456
  buffer_load_dwordx4 v[44:47], v36, s[20:23], s33 offen
  s_add_u32 s33, s33, 147456
  buffer_load_dwordx4 v[48:51], v36, s[20:23], s33 offen
  s_add_u32 s33, s33, 147456
  buffer_load_dwordx4 v[52:55], v36, s[20:23], s33 offen
  s_add_u32 s33, s33, 147456
  buffer_load_dwordx4 v[56:59], v36, s[20:23], s33 offen
  s_add_u32 s33, s33, 147456
  buffer_load_dwordx4 v[60:63], v36, s[20:23], s33 offen
  s_add_u32 s33, s33, 147456
  buffer_load_dwordx4 v[64:67], v36, s[20:23], s33 offen
  s_add_u32 s33, s33, 147456
  buffer_load_dwordx4 v[68:71], v36, s[20:23], s33 offen
  s_add_u32 s33, s33, 147456
  buffer_load_dwordx4 v[72:75], v36, s[20:23], s33 offen
  s_add_u32 s33, s33, 147456
  buffer_load_dwordx4 v[76:79], v36, s[20:23], s33 offen
  s_add_u32 s33, s33, 147456
  buffer_load_dwordx4 v[80:83], v36, s[20:23], s33 offen
  s_add_u32 s33, s33, 147456
  buffer_load_dwordx4 v[84:87], v36, s[20:23], s33 offen
  s_add_u32 s33, s33, 147456
  buffer_load_dwordx4 v[88:91], v36, s[20:23], s33 offen
  s_add_u32 s33, s33, 147456
  buffer_load_dwordx4 v[92:95], v36, s[20:23], s33 offen
  s_add_u32 s33, s33, 147456
  buffer_load_dwordx4 v[96:99], v36, s[20:23], s33 offen
  s_add_u32 s33, s33, 147456
  buffer_load_dwordx4 v[100:103], v36, s[20:23], s33 offen
  s_add_u32 s33, s33, 147456
  buffer_load_dwordx4 v[104:107], v36, s[20:23], s33 offen
  s_add_u32 s33, s33, 147456
  buffer_load_dwordx4 v[108:111], v36, s[20:23], s33 offen
  s_add_u32 s33, s33, 147456
  v_mul_u32_u24 v3, 80, v3
  v_lshl_add_u32 v3, v5, 4, v3
  v_add_u32 v3, s19, v3
  v_add_u32 v3, 2560, v3
  v_lshrrev_b32 v4, 5, v1
  v_lshlrev_b32 v4, 3, v4
  v_bfe_u32 v6, v1, 2, 2
  v_add_u32 v4, v4, v6
  v_mul_u32_u24 v4, 80, v4
  v_bfe_u32 v6, v1, 4, 1
  v_lshl_add_u32 v4, v6, 5, v4
  v_and_b32 v6, 1, v1
  v_lshl_add_u32 v4, v6, 4, v4
  v_bfe_u32 v7, v1, 1, 1
  v_lshl_add_u32 v4, v7, 3, v4
  v_add_u32 v4, s19, v4
  v_add_u32 v4, 2560, v4
  v_mul_u32_u24 v5, 1152, v6
  v_lshrrev_b32 v6, 5, v1
  v_lshl_add_u32 v5, v6, 4, v5
  s_mul_i32 s36, s35, 576
  s_add_u32 s36, s36, s19
  v_add_u32 v5, s36, v5
  v_add_u32 v6, s19, v2
  s_mul_i32 s32, s34, 37888
  s_lshl_b32 s37, s35, 9
  s_add_u32 s37, s37, s32
  s_add_u32 s37, s37, 36864
  s_mul_i32 s36, s35, 18432
  s_add_u32 s32, s32, s36
  s_waitcnt vmcnt(18)
  ds_write_b128 v6, v[8:11]
  ds_write_b128 v6, v[12:15] offset:1024
  ds_write_b128 v6, v[16:19] offset:2048
  s_waitcnt vmcnt(17)
  ds_write_b128 v3, v[40:43] offset:0
  s_waitcnt lgkmcnt(0)
  ds_read_b64_tr_b16 v[8:9], v4 offset:0
  ds_read_b64_tr_b16 v[10:11], v4 offset:320
  ds_read_b128 v[16:19], v5 offset:0
  s_waitcnt vmcnt(16)
  ds_write_b128 v3, v[44:47] offset:1280
  s_waitcnt lgkmcnt(1)
  v_mfma_f32_32x32x16_bf16 v[112:127], v[16:19], v[8:11], 0
  buffer_store_dwordx4 v[8:11], v2, s[24:27], s32 offen offset:0 sc1
  s_waitcnt lgkmcnt(0)
  ds_read_b64_tr_b16 v[12:13], v4 offset:1280
  ds_read_b64_tr_b16 v[14:15], v4 offset:1600
  ds_read_b128 v[20:23], v5 offset:32
  s_waitcnt vmcnt(16)
  ds_write_b128 v3, v[48:51] offset:0
  s_waitcnt lgkmcnt(1)
  v_mfma_f32_32x32x16_bf16 v[112:127], v[20:23], v[12:15], v[112:127]
  buffer_store_dwordx4 v[12:15], v2, s[24:27], s32 offen offset:1024 sc1
  s_waitcnt lgkmcnt(0)
  ds_read_b64_tr_b16 v[8:9], v4 offset:0
  ds_read_b64_tr_b16 v[10:11], v4 offset:320
  ds_read_b128 v[16:19], v5 offset:64
  s_waitcnt vmcnt(16)
  ds_write_b128 v3, v[52:55] offset:1280
  s_waitcnt lgkmcnt(1)
  v_mfma_f32_32x32x16_bf16 v[112:127], v[16:19], v[8:11], v[112:127]
  buffer_store_dwordx4 v[8:11], v2, s[24:27], s32 offen offset:2048 sc1
  s_waitcnt lgkmcnt(0)
  ds_read_b64_tr_b16 v[12:13], v4 offset:1280
  ds_read_b64_tr_b16 v[14:15], v4 offset:1600
  ds_read_b128 v[20:23], v5 offset:96
  s_waitcnt vmcnt(16)
  ds_write_b128 v3, v[56:59] offset:0
  s_waitcnt lgkmcnt(1)
  v_mfma_f32_32x32x16_bf16 v[112:127], v[20:23], v[12:15], v[112:127]
  buffer_store_dwordx4 v[12:15], v2, s[24:27], s32 offen offset:3072 sc1
  s_add_u32 s32, s32, 4096
  s_waitcnt lgkmcnt(0)
  ds_read_b64_tr_b16 v[8:9], v4 offset:0
  ds_read_b64_tr_b16 v[10:11], v4 offset:320
  ds_read_b128 v[16:19], v5 offset:128
  s_waitcnt vmcnt(16)
  ds_write_b128 v3, v[60:63] offset:1280
  s_waitcnt lgkmcnt(1)
  v_mfma_f32_32x32x16_bf16 v[112:127], v[16:19], v[8:11], v[112:127]
  buffer_store_dwordx4 v[8:11], v2, s[24:27], s32 offen offset:0 sc1
  s_waitcnt lgkmcnt(0)
  ds_read_b64_tr_b16 v[12:13], v4 offset:1280
  ds_read_b64_tr_b16 v[14:15], v4 offset:1600
  ds_read_b128 v[20:23], v5 offset:160
  s_waitcnt vmcnt(16)
  ds_write_b128 v3, v[64:67] offset:0
  s_waitcnt lgkmcnt(1)
  v_mfma_f32_32x32x16_bf16 v[112:127], v[20:23], v[12:15], v[112:127]
  buffer_store_dwordx4 v[12:15], v2, s[24:27], s32 offen offset:1024 sc1
  s_waitcnt lgkmcnt(0)
  ds_read_b64_tr_b16 v[8:9], v4 offset:0
  ds_read_b64_tr_b16 v[10:11], v4 offset:320
  ds_read_b128 v[16:19], v5 offset:192
  s_waitcnt vmcnt(16)
  ds_write_b128 v3, v[68:71] offset:1280
  s_waitcnt lgkmcnt(1)
  v_mfma_f32_32x32x16_bf16 v[112:127], v[16:19], v[8:11], v[112:127]
  buffer_store_dwordx4 v[8:11], v2, s[24:27], s32 offen offset:2048 sc1
  s_waitcnt lgkmcnt(0)
  ds_read_b64_tr_b16 v[12:13], v4 offset:1280
  ds_read_b64_tr_b16 v[14:15], v4 offset:1600
  ds_read_b128 v[20:23], v5 offset:224
  s_waitcnt vmcnt(16)
  ds_write_b128 v3, v[72:75] offset:0
  s_waitcnt lgkmcnt(1)
  v_mfma_f32_32x32x16_bf16 v[112:127], v[20:23], v[12:15], v[112:127]
  buffer_store_dwordx4 v[12:15], v2, s[24:27], s32 offen offset:3072 sc1
  s_add_u32 s32, s32, 4096
  s_waitcnt lgkmcnt(0)
  ds_read_b64_tr_b16 v[8:9], v4 offset:0
  ds_read_b64_tr_b16 v[10:11], v4 offset:320
  ds_read_b128 v[16:19], v5 offset:256
  s_waitcnt vmcnt(16)
  ds_write_b128 v3, v[76:79] offset:1280
  s_waitcnt lgkmcnt(1)
  v_mfma_f32_32x32x16_bf16 v[112:127], v[16:19], v[8:11], v[112:127]
  buffer_store_dwordx4 v[8:11], v2, s[24:27], s32 offen offset:0 sc1
  s_waitcnt lgkmcnt(0)
  ds_read_b64_tr_b16 v[12:13], v4 offset:1280
  ds_read_b64_tr_b16 v[14:15], v4 offset:1600
  ds_read_b128 v[20:23], v5 offset:288
  s_waitcnt vmcnt(16)
  ds_write_b128 v3, v[80:83] offset:0
  s_waitcnt lgkmcnt(1)
  v_mfma_f32_32x32x16_bf16 v[112:127], v[20:23], v[12:15], v[112:127]
  buffer_store_dwordx4 v[12:15], v2, s[24:27], s32 offen offset:1024 sc1
  s_waitcnt lgkmcnt(0)
  ds_read_b64_tr_b16 v[8:9], v4 offset:0
  ds_read_b64_tr_b16 v[10:11], v4 offset:320
  ds_read_b128 v[16:19], v5 offset:320
  s_waitcnt vmcnt(16)
  ds_write_b128 v3, v[84:87] offset:1280
  s_waitcnt lgkmcnt(1)
  v_mfma_f32_32x32x16_bf16 v[112:127], v[16:19], v[8:11], v[112:127]
  buffer_store_dwordx4 v[8:11], v2, s[24:27], s32 offen offset:2048 sc1
  s_waitcnt lgkmcnt(0)
  ds_read_b64_tr_b16 v[12:13], v4 offset:1280
  ds_read_b64_tr_b16 v[14:15], v4 offset:1600
  ds_read_b128 v[20:23], v5 offset:352
  s_waitcnt vmcnt(16)
  ds_write_b128 v3, v[88:91] offset:0
  s_waitcnt lgkmcnt(1)
  v_mfma_f32_32x32x16_bf16 v[112:127], v[20:23], v[12:15], v[112:127]
  buffer_store_dwordx4 v[12:15], v2, s[24:27], s32 offen offset:3072 sc1
  s_add_u32 s32, s32, 4096
  s_waitcnt lgkmcnt(0)
  ds_read_b64_tr_b16 v[8:9], v4 offset:0
  ds_read_b64_tr_b16 v[10:11], v4 offset:320
  ds_read_b128 v[16:19], v5 offset:384
  s_waitcnt vmcnt(16)
  ds_write_b128 v3, v[92:95] offset:1280
  s_waitcnt lgkmcnt(1)
  v_mfma_f32_32x32x16_bf16 v[112:127], v[16:19], v[8:11], v[112:127]
  buffer_store_dwordx4 v[8:11], v2, s[24:27], s32 offen offset:0 sc1
  s_waitcnt lgkmcnt(0)
  ds_read_b64_tr_b16 v[12:13], v4 offset:1280
  ds_read_b64_tr_b16 v[14:15], v4 offset:1600
  ds_read_b128 v[20:23], v5 offset:416
  s_waitcnt vmcnt(16)
  ds_write_b128 v3, v[96:99] offset:0
  s_waitcnt lgkmcnt(1)
  v_mfma_f32_32x32x16_bf16 v[112:127], v[20:23], v[12:15], v[112:127]
  buffer_store_dwordx4 v[12:15], v2, s[24:27], s32 offen offset:1024 sc1
  s_waitcnt lgkmcnt(0)
  ds_read_b64_tr_b16 v[8:9], v4 offset:0
  ds_read_b64_tr_b16 v[10:11], v4 offset:320
  ds_read_b128 v[16:19], v5 offset:448
  s_waitcnt vmcnt(16)
  ds_write_b128 v3, v[100:103] offset:1280
  s_waitcnt lgkmcnt(1)
  v_mfma_f32_32x32x16_bf16 v[112:127], v[16:19], v[8:11], v[112:127]
  buffer_store_dwordx4 v[8:11], v2, s[24:27], s32 offen offset:2048 sc1
  s_waitcnt lgkmcnt(0)
  ds_read_b64_tr_b16 v[12:13], v4 offset:1280
  ds_read_b64_tr_b16 v[14:15], v4 offset:1600
  ds_read_b128 v[20:23], v5 offset:480
  s_waitcnt vmcnt(16)
  ds_write_b128 v3, v[104:107] offset:0
  s_waitcnt lgkmcnt(1)
  v_mfma_f32_32x32x16_bf16 v[112:127], v[20:23], v[12:15], v[112:127]
  buffer_store_dwordx4 v[12:15], v2, s[24:27], s32 offen offset:3072 sc1
  s_add_u32 s32, s32, 4096
  s_waitcnt lgkmcnt(0)
  ds_read_b64_tr_b16 v[8:9], v4 offset:0
  ds_read_b64_tr_b16 v[10:11], v4 offset:320
  ds_read_b128 v[16:19], v5 offset:512
  s_waitcnt vmcnt(16)
  ds_write_b128 v3, v[108:111] offset:1280
  s_waitcnt lgkmcnt(1)
  v_mfma_f32_32x32x16_bf16 v[112:127], v[16:19], v[8:11], v[112:127]
  buffer_store_dwordx4 v[8:11], v2, s[24:27], s32 offen offset:0 sc1
  s_waitcnt lgkmcnt(0)
  ds_read_b64_tr_b16 v[12:13], v4 offset:1280
  ds_read_b64_tr_b16 v[14:15], v4 offset:1600
  ds_read_b128 v[20:23], v5 offset:544
  s_waitcnt lgkmcnt(0)
  v_mfma_f32_32x32x16_bf16 v[112:127], v[20:23], v[12:15], v[112:127]
  buffer_store_dwordx4 v[12:15], v2, s[24:27], s32 offen offset:1024 sc1
  s_nop 10
  v_cvt_pk_bf16_f32 v24, v112, v113
  v_lshlrev_b32 v25, 16, v24
  v_and_b32 v26, 0xffff0000, v24
  v_sub_f32 v27, v112, v25
  v_sub_f32 v28, v113, v26
  v_cvt_pk_bf16_f32 v27, v27, v28
  v_lshrrev_b32 v32, 16, v25
  v_or_b32 v32, v32, v25
  v_and_b32 v33, 0xffff, v27
  v_or_b32 v33, v33, v26
  v_lshrrev_b32 v34, 16, v26
  v_and_b32 v28, 0xffff0000, v27
  v_or_b32 v34, v34, v28
  v_mov_b32 v35, 0
  v_cmp_gt_u32 vcc, 32, v1
  v_mov_b32 v28, 2146435072
  s_nop 0
  v_cndmask_b32 v2, v28, v2, vcc
  buffer_store_dwordx4 v[32:35], v2, s[24:27], s37 offen sc1
  s_endpgm
L_h_t:
  s_sub_u32 s18, s18, 288
  s_cmp_ge_u32 s18, 72
  s_cbranch_scc1 L_h_wout
  s_lshl_b32 s18, s18, 1
  s_mov_b32 s20, s4
  s_and_b32 s21, s5, 0xffff
  s_mov_b32 s22, 663552
  s_mov_b32 s23, 0x20000
  s_add_u32 s24, s16, 17825792
  s_addc_u32 s25, s17, 0
  s_and_b32 s25, s25, 0xffff
  s_mov_b32 s26, 663552
  s_mov_b32 s27, 0x20000
  s_mul_i32 s32, s18, 57
  s_lshr_b32 s32, s32, 10
  s_mul_i32 s33, s32, 18
  s_sub_u32 s33, s18, s33
  s_mul_i32 s32, s32, 144
  v_lshrrev_b32 v4, 3, v1
  v_and_b32 v5, 7, v1
  v_and_b32 v6, 31, v1
  v_mul_u32_u24 v8, 160, v4
  v_lshl_add_u32 v8, v5, 4, v8
  v_add_u32 v8, s19, v8
  v_mul_u32_u24 v9, 160, v6
  v_lshrrev_b32 v7, 5, v1
  v_lshl_add_u32 v9, v7, 4, v9
  v_add_u32 v9, s19, v9
  s_cmp_ge_u32 s33, 16
  s_cbranch_scc1 L_wa_k2_kernel_3
  v_lshrrev_b32 v7, 4, v6
  v_lshl_add_u32 v6, v7, 1, v6
  s_mul_i32 s35, s33, 41472
  s_mov_b32 s34, 41472
  s_mov_b32 s36, 9216
  s_mov_b32 s37, 20736
  s_mov_b32 s38, 29952
  s_branch L_wb_k2_kernel_4
L_wa_k2_kernel_3:
  v_lshrrev_b32 v7, 1, v4
  v_and_b32 v4, 1, v4
  v_mad_u32_u24 v4, v7, 18, v4
  v_add_u32 v4, 16, v4
  v_lshrrev_b32 v7, 1, v6
  v_and_b32 v6, 1, v6
  v_mad_u32_u24 v6, v7, 18, v6
  v_add_u32 v6, 16, v6
  s_mov_b32 s35, 0
  s_mov_b32 s34, 331776
  s_mov_b32 s36, 82944
  s_mov_b32 s37, 165888
  s_mov_b32 s38, 248832
L_wb_k2_kernel_4:
  v_mul_u32_u24 v2, 1152, v4
  v_lshl_add_u32 v2, v5, 4, v2
  v_mul_u32_u24 v3, 1152, v6
  v_cmp_gt_u32 vcc, 32, v1
  v_mov_b32 v7, 2146435072
  s_add_u32 s35, s35, s32
  v_cndmask_b32 v3, v7, v3, vcc
  s_add_u32 s40, s35, s36
  s_add_u32 s41, s35, s37
  s_add_u32 s42, s35, s38
  buffer_load_dwordx4 v[20:23], v2, s[20:23], s35 offen
  buffer_load_dwordx4 v[24:27], v2, s[20:23], s40 offen
  buffer_load_dwordx4 v[28:31], v2, s[20:23], s41 offen
  buffer_load_dwordx4 v[32:35], v2, s[20:23], s42 offen
  buffer_load_dwordx4 v[36:39], v3, s[20:23], s35 offen offset:128
  s_add_u32 s35, s35, s34
  s_add_u32 s40, s35, s36
  s_add_u32 s41, s35, s37
  s_add_u32 s42, s35, s38
  buffer_load_dwordx4 v[40:43], v2, s[20:23], s35 offen
  buffer_load_dwordx4 v[44:47], v2, s[20:23], s40 offen
  buffer_load_dwordx4 v[48:51], v2, s[20:23], s41 offen
  buffer_load_dwordx4 v[52:55], v2, s[20:23], s42 offen
  buffer_load_dwordx4 v[56:59], v3, s[20:23], s35 offen offset:128
  s_add_u32 s35, s35, s34
  v_lshrrev_b32 v18, 4, v1
  v_lshlrev_b32 v18, 3, v18
  v_bfe_u32 v19, v1, 2, 2
  v_add_u32 v18, v18, v19
  v_mul_u32_u24 v18, 160, v18
  v_add_u32 v18, s19, v18
  v_and_b32 v19, 3, v1
  v_lshl_add_u32 v16, v19, 4, v18
  v_lshl_add_u32 v17, v19, 3, v18
  v_lshlrev_b32 v2, 4, v1
  v_lshrrev_b32 v3, 4, v1
  v_lshlrev_b32 v3, 7, v3
  v_and_b32 v4, 15, v1
  v_lshl_add_u32 v3, v4, 4, v3
  v_cmp_gt_u32 vcc, 8, v4
  s_mul_i32 s34, s18, 4608
  s_nop 0
  v_cndmask_b32 v3, v7, v3, vcc
  s_waitcnt vmcnt(5)
  ds_write_b128 v8, v[20:23] offset:0
  ds_write_b128 v8, v[24:27] offset:1280
  ds_write_b128 v8, v[28:31] offset:2560
  ds_write_b128 v8, v[32:35] offset:3840
  ds_write_b128 v9, v[36:39] offset:128
  s_add_u32 s35, s34, 4096
  s_waitcnt lgkmcnt(0)
  ds_read_b64_tr_b16 v[100:101], v16 offset:0
  ds_read_b64_tr_b16 v[102:103], v16 offset:640
  ds_read_b64_tr_b16 v[104:105], v16 offset:8
  ds_read_b64_tr_b16 v[106:107], v16 offset:648
  ds_read_b64_tr_b16 v[108:109], v16 offset:64
  ds_read_b64_tr_b16 v[110:111], v16 offset:704
  ds_read_b64_tr_b16 v[112:113], v16 offset:72
  ds_read_b64_tr_b16 v[114:115], v16 offset:712
  ds_read_b64_tr_b16 v[116:117], v17 offset:128
  ds_read_b64_tr_b16 v[118:119], v17 offset:768
  s_waitcnt lgkmcnt(0)
  buffer_store_dwordx4 v[100:103], v2, s[24:27], s34 offen offset:0 sc1
  buffer_store_dwordx4 v[104:107], v2, s[24:27], s34 offen offset:1024 sc1
  buffer_store_dwordx4 v[108:111], v2, s[24:27], s34 offen offset:2048 sc1
  buffer_store_dwordx4 v[112:115], v2, s[24:27], s34 offen offset:3072 sc1
  buffer_store_dwordx4 v[116:119], v3, s[24:27], s35 offen sc1
  s_add_u32 s34, s34, 4608
  s_waitcnt vmcnt(5)
  ds_write_b128 v8, v[40:43] offset:0
  ds_write_b128 v8, v[44:47] offset:1280
  ds_write_b128 v8, v[48:51] offset:2560
  ds_write_b128 v8, v[52:55] offset:3840
  ds_write_b128 v9, v[56:59] offset:128
  s_add_u32 s35, s34, 4096
  s_waitcnt lgkmcnt(0)
  ds_read_b64_tr_b16 v[120:121], v16 offset:0
  ds_read_b64_tr_b16 v[122:123], v16 offset:640
  ds_read_b64_tr_b16 v[124:125], v16 offset:8
  ds_read_b64_tr_b16 v[126:127], v16 offset:648
  ds_read_b64_tr_b16 v[128:129], v16 offset:64
  ds_read_b64_tr_b16 v[130:131], v16 offset:704
  ds_read_b64_tr_b16 v[132:133], v16 offset:72
  ds_read_b64_tr_b16 v[134:135], v16 offset:712
  ds_read_b64_tr_b16 v[136:137], v17 offset:128
  ds_read_b64_tr_b16 v[138:139], v17 offset:768
  s_waitcnt lgkmcnt(0)
  buffer_store_dwordx4 v[120:123], v2, s[24:27], s34 offen offset:0 sc1
  buffer_store_dwordx4 v[124:127], v2, s[24:27], s34 offen offset:1024 sc1
  buffer_store_dwordx4 v[128:131], v2, s[24:27], s34 offen offset:2048 sc1
  buffer_store_dwordx4 v[132:135], v2, s[24:27], s34 offen offset:3072 sc1
  buffer_store_dwordx4 v[136:139], v3, s[24:27], s35 offen sc1
  s_endpgm
L_h_wout:
  s_sub_u32 s18, s18, 72
  s_cmp_ge_u32 s18, 144
  s_cbranch_scc1 L_h_none
  s_lshl_b32 s18, s18, 2
  s_mov_b32 s20, s12
  s_and_b32 s21, s13, 0xffff
  s_mov_b32 s22, 2654208
  s_mov_b32 s23, 0x20000
  s_add_u32 s24, s16, 25165824
  s_addc_u32 s25, s17, 0
  s_and_b32 s25, s25, 0xffff
  s_mov_b32 s26, 2654208
  s_mov_b32 s27, 0x20000
  s_mul_i32 s32, s18, 911
  s_lshr_b32 s32, s32, 16
  s_mul_i32 s33, s32, 72
  s_sub_u32 s33, s18, s33
  s_mul_i32 s32, s32, 144
  v_lshrrev_b32 v4, 3, v1
  v_and_b32 v5, 7, v1
  v_and_b32 v6, 31, v1
  v_mul_u32_u24 v8, 160, v4
  v_lshl_add_u32 v8, v5, 4, v8
  v_add_u32 v8, s19, v8
  v_mul_u32_u24 v9, 160, v6
  v_lshrrev_b32 v7, 5, v1
  v_lshl_add_u32 v9, v7, 4, v9
  v_add_u32 v9, s19, v9
  s_mul_i32 s35, s33, 36864
  s_mov_b32 s34, 36864
  s_mov_b32 s36, 9216
  s_mov_b32 s37, 18432
  s_mov_b32 s38, 27648
  v_mul_u32_u24 v2, 1152, v4
  v_lshl_add_u32 v2, v5, 4, v2
  v_mul_u32_u24 v3, 1152, v6
  v_cmp_gt_u32 vcc, 32, v1
  v_mov_b32 v7, 2146435072
  s_add_u32 s35, s35, s32
  v_cndmask_b32 v3, v7, v3, vcc
  s_add_u32 s40, s35, s36
  s_add_u32 s41, s35, s37
  s_add_u32 s42, s35, s38
  buffer_load_dwordx4 v[20:23], v2, s[20:23], s35 offen
  buffer_load_dwordx4 v[24:27], v2, s[20:23], s40 offen
  buffer_load_dwordx4 v[28:31], v2, s[20:23], s41 offen
  buffer_load_dwordx4 v[32:35], v2, s[20:23], s42 offen
  buffer_load_dwordx4 v[36:39], v3, s[20:23], s35 offen offset:128
  s_add_u32 s35, s35, s34
  s_add_u32 s40, s35, s36
  s_add_u32 s41, s35, s37
  s_add_u32 s42, s35, s38
  buffer_load_dwordx4 v[40:43], v2, s[20:23], s35 offen
  buffer_load_dwordx4 v[44:47], v2, s[20:23], s40 offen
  buffer_load_dwordx4 v[48:51], v2, s[20:23], s41 offen
  buffer_load_dwordx4 v[52:55], v2, s[20:23], s42 offen
  buffer_load_dwordx4 v[56:59], v3, s[20:23], s35 offen offset:128
  s_add_u32 s35, s35, s34
  s_add_u32 s40, s35, s36
  s_add_u32 s41, s35, s37
  s_add_u32 s42, s35, s38
  buffer_load_dwordx4 v[60:63], v2, s[20:23], s35 offen
  buffer_load_dwordx4 v[64:67], v2, s[20:23], s40 offen
  buffer_load_dwordx4 v[68:71], v2, s[20:23], s41 offen
  buffer_load_dwordx4 v[72:75], v2, s[20:23], s42 offen
  buffer_load_dwordx4 v[76:79], v3, s[20:23], s35 offen offset:128
  s_add_u32 s35, s35, s34
  s_add_u32 s40, s35, s36
  s_add_u32 s41, s35, s37
  s_add_u32 s42, s35, s38
  buffer_load_dwordx4 v[80:83], v2, s[20:23], s35 offen
  buffer_load_dwordx4 v[84:87], v2, s[20:23], s40 offen
  buffer_load_dwordx4 v[88:91], v2, s[20:23], s41 offen
  buffer_load_dwordx4 v[92:95], v2, s[20:23], s42 offen
  buffer_load_dwordx4 v[96:99], v3, s[20:23], s35 offen offset:128
  s_add_u32 s35, s35, s34
  v_lshrrev_b32 v18, 4, v1
  v_lshlrev_b32 v18, 3, v18
  v_bfe_u32 v19, v1, 2, 2
  v_add_u32 v18, v18, v19
  v_mul_u32_u24 v18, 160, v18
  v_add_u32 v18, s19, v18
  v_and_b32 v19, 3, v1
  v_lshl_add_u32 v16, v19, 4, v18
  v_lshl_add_u32 v17, v19, 3, v18
  v_lshlrev_b32 v2, 4, v1
  v_lshrrev_b32 v3, 4, v1
  v_lshlrev_b32 v3, 7, v3
  v_and_b32 v4, 15, v1
  v_lshl_add_u32 v3, v4, 4, v3
  v_cmp_gt_u32 vcc, 8, v4
  s_mul_i32 s34, s18, 4608
  s_nop 0
  v_cndmask_b32 v3, v7, v3, vcc
  s_waitcnt vmcnt(15)
  ds_write_b128 v8, v[20:23] offset:0
  ds_write_b128 v8, v[24:27] offset:1280
  ds_write_b128 v8, v[28:31] offset:2560
  ds_write_b128 v8, v[32:35] offset:3840
  ds_write_b128 v9, v[36:39] offset:128
  s_add_u32 s35, s34, 4096
  s_waitcnt lgkmcnt(0)
  ds_read_b64_tr_b16 v[100:101], v16 offset:0
  ds_read_b64_tr_b16 v[102:103], v16 offset:640
  ds_read_b64_tr_b16 v[104:105], v16 offset:8
  ds_read_b64_tr_b16 v[106:107], v16 offset:648
  ds_read_b64_tr_b16 v[108:109], v16 offset:64
  ds_read_b64_tr_b16 v[110:111], v16 offset:704
  ds_read_b64_tr_b16 v[112:113], v16 offset:72
  ds_read_b64_tr_b16 v[114:115], v16 offset:712
  ds_read_b64_tr_b16 v[116:117], v17 offset:128
  ds_read_b64_tr_b16 v[118:119], v17 offset:768
  s_waitcnt lgkmcnt(0)
  buffer_store_dwordx4 v[100:103], v2, s[24:27], s34 offen offset:0 sc1
  buffer_store_dwordx4 v[104:107], v2, s[24:27], s34 offen offset:1024 sc1
  buffer_store_dwordx4 v[108:111], v2, s[24:27], s34 offen offset:2048 sc1
  buffer_store_dwordx4 v[112:115], v2, s[24:27], s34 offen offset:3072 sc1
  buffer_store_dwordx4 v[116:119], v3, s[24:27], s35 offen sc1
  s_add_u32 s34, s34, 4608
  s_waitcnt vmcnt(15)
  ds_write_b128 v8, v[40:43] offset:0
  ds_write_b128 v8, v[44:47] offset:1280
  ds_write_b128 v8, v[48:51] offset:2560
  ds_write_b128 v8, v[52:55] offset:3840
  ds_write_b128 v9, v[56:59] offset:128
  s_add_u32 s35, s34, 4096
  s_waitcnt lgkmcnt(0)
  ds_read_b64_tr_b16 v[120:121], v16 offset:0
  ds_read_b64_tr_b16 v[122:123], v16 offset:640
  ds_read_b64_tr_b16 v[124:125], v16 offset:8
  ds_read_b64_tr_b16 v[126:127], v16 offset:648
  ds_read_b64_tr_b16 v[128:129], v16 offset:64
  ds_read_b64_tr_b16 v[130:131], v16 offset:704
  ds_read_b64_tr_b16 v[132:133], v16 offset:72
  ds_read_b64_tr_b16 v[134:135], v16 offset:712
  ds_read_b64_tr_b16 v[136:137], v17 offset:128
  ds_read_b64_tr_b16 v[138:139], v17 offset:768
  s_waitcnt lgkmcnt(0)
  buffer_store_dwordx4 v[120:123], v2, s[24:27], s34 offen offset:0 sc1
  buffer_store_dwordx4 v[124:127], v2, s[24:27], s34 offen offset:1024 sc1
  buffer_store_dwordx4 v[128:131], v2, s[24:27], s34 offen offset:2048 sc1
  buffer_store_dwordx4 v[132:135], v2, s[24:27], s34 offen offset:3072 sc1
  buffer_store_dwordx4 v[136:139], v3, s[24:27], s35 offen sc1
  s_add_u32 s34, s34, 4608
  s_waitcnt vmcnt(15)
  ds_write_b128 v8, v[60:63] offset:0
  ds_write_b128 v8, v[64:67] offset:1280
  ds_write_b128 v8, v[68:71] offset:2560
  ds_write_b128 v8, v[72:75] offset:3840
  ds_write_b128 v9, v[76:79] offset:128
  s_add_u32 s35, s34, 4096
  s_waitcnt lgkmcnt(0)
  ds_read_b64_tr_b16 v[100:101], v16 offset:0
  ds_read_b64_tr_b16 v[102:103], v16 offset:640
  ds_read_b64_tr_b16 v[104:105], v16 offset:8
  ds_read_b64_tr_b16 v[106:107], v16 offset:648
  ds_read_b64_tr_b16 v[108:109], v16 offset:64
  ds_read_b64_tr_b16 v[110:111], v16 offset:704
  ds_read_b64_tr_b16 v[112:113], v16 offset:72
  ds_read_b64_tr_b16 v[114:115], v16 offset:712
  ds_read_b64_tr_b16 v[116:117], v17 offset:128
  ds_read_b64_tr_b16 v[118:119], v17 offset:768
  s_waitcnt lgkmcnt(0)
  buffer_store_dwordx4 v[100:103], v2, s[24:27], s34 offen offset:0 sc1
  buffer_store_dwordx4 v[104:107], v2, s[24:27], s34 offen offset:1024 sc1
  buffer_store_dwordx4 v[108:111], v2, s[24:27], s34 offen offset:2048 sc1
  buffer_store_dwordx4 v[112:115], v2, s[24:27], s34 offen offset:3072 sc1
  buffer_store_dwordx4 v[116:119], v3, s[24:27], s35 offen sc1
  s_add_u32 s34, s34, 4608
  s_waitcnt vmcnt(15)
  ds_write_b128 v8, v[80:83] offset:0
  ds_write_b128 v8, v[84:87] offset:1280
  ds_write_b128 v8, v[88:91] offset:2560
  ds_write_b128 v8, v[92:95] offset:3840
  ds_write_b128 v9, v[96:99] offset:128
  s_add_u32 s35, s34, 4096
  s_waitcnt lgkmcnt(0)
  ds_read_b64_tr_b16 v[120:121], v16 offset:0
  ds_read_b64_tr_b16 v[122:123], v16 offset:640
  ds_read_b64_tr_b16 v[124:125], v16 offset:8
  ds_read_b64_tr_b16 v[126:127], v16 offset:648
  ds_read_b64_tr_b16 v[128:129], v16 offset:64
  ds_read_b64_tr_b16 v[130:131], v16 offset:704
  ds_read_b64_tr_b16 v[132:133], v16 offset:72
  ds_read_b64_tr_b16 v[134:135], v16 offset:712
  ds_read_b64_tr_b16 v[136:137], v17 offset:128
  ds_read_b64_tr_b16 v[138:139], v17 offset:768
  s_waitcnt lgkmcnt(0)
  buffer_store_dwordx4 v[120:123], v2, s[24:27], s34 offen offset:0 sc1
  buffer_store_dwordx4 v[124:127], v2, s[24:27], s34 offen offset:1024 sc1
  buffer_store_dwordx4 v[128:131], v2, s[24:27], s34 offen offset:2048 sc1
  buffer_store_dwordx4 v[132:135], v2, s[24:27], s34 offen offset:3072 sc1
  buffer_store_dwordx4 v[136:139], v3, s[24:27], s35 offen sc1
  s_endpgm
L_h_none:
L_k2_end:
  s_endpgm
L_end_k2_kernel:
.section .rodata,"a"
.p2align 6
.amdhsa_kernel k2_kernel
  .amdhsa_next_free_vgpr 192
  .amdhsa_next_free_sgpr 64
  .amdhsa_accum_offset 192
  .amdhsa_group_segment_fixed_size 0
  .amdhsa_kernarg_size 120
  .amdhsa_user_sgpr_count 2
  .amdhsa_user_sgpr_kernarg_segment_ptr 1
  .amdhsa_system_sgpr_workgroup_id_x 1
  .amdhsa_float_denorm_mode_32 3
.end_amdhsa_kernel
.text
.globl k3_kernel
.p2align 8
.type k3_kernel,@function
k3_kernel:
  s_cmp_ge_u32 s2, 256
  s_cbranch_scc1 L_k4_end
  s_load_dwordx2 s[16:17], s[0:1], 112
  s_load_dwordx2 s[18:19], s[0:1], 0
  s_load_dwordx2 s[54:55], s[0:1], 64
  v_lshrrev_b32 v1, 6, v0
  s_nop 0
  v_readfirstlane_b32 s3, v1
  s_and_b32 s6, s2, 7
  s_lshr_b32 s7, s2, 3
  s_and_b32 s4, s6, 1
  s_lshl_b32 s4, s4, 3
  s_and_b32 s5, s7, 7
  s_add_u32 s4, s4, s5
  s_lshr_b32 s5, s6, 1
  s_lshl_b32 s5, s5, 2
  s_lshr_b32 s7, s7, 3
  s_add_u32 s5, s5, s7
  v_and_b32 v1, 63, v0
  v_lshlrev_b32 v2, 4, v1
  s_mul_i32 s10, s3, 9216
  s_and_b32 s6, s5, 1
  s_lshr_b32 s7, s5, 1
  s_mul_i32 s7, s7, 9
  s_lshl_b32 s8, s4, 2
  s_add_u32 s8, s8, s3
  s_mul_i32 s9, s6, 5
  s_add_u32 s9, s9, s7
  s_add_u32 s9, s9, 72
  s_mul_i32 s44, s9, 37888
  s_add_u32 s44, s44, s10
  s_add_u32 s45, s44, 37888
  s_add_u32 s46, s45, 37888
  s_add_u32 s47, s46, 37888
  s_mul_i32 s9, s6, 72
  s_add_u32 s9, s9, s7
  s_add_u32 s9, s9, 4
  s_mul_i32 s48, s9, 37888
  s_add_u32 s48, s48, s10
  s_lshr_b32 s53, s5, 1
  s_lshl_b32 s53, s53, 10
  s_cmp_eq_u32 s6, 1
  s_cselect_b32 s53, 2146435072, s53
  s_mul_i32 s9, s6, 5
  s_add_u32 s9, s9, s7
  s_mul_i32 s49, s9, 37888
  s_add_u32 s49, s49, s10
  s_add_u32 s50, s49, 37888
  s_add_u32 s51, s50, 37888
  s_add_u32 s52, s51, 37888
  s_and_b32 s62, s2, 7
  s_lshr_b32 s63, s2, 3
  s_lshr_b32 s60, s62, 1
  s_lshl_b32 s60, s60, 3
  s_and_b32 s61, s63, 7
  s_add_u32 s60, s60, s61
  s_and_b32 s61, s62, 1
  s_lshl_b32 s61, s61, 2
  s_lshr_b32 s63, s63, 3
  s_add_u32 s61, s61, s63
  v_and_b32 v1, 63, v0
  v_lshlrev_b32 v2, 4, v1
  v_and_b32 v8, 15, v1
  v_lshrrev_b32 v9, 4, v1
  v_and_b32 v5, 7, v1
  v_lshlrev_b32 v5, 4, v5
  v_lshl_add_u32 v5, v9, 7, v5
  s_lshl_b32 s62, s60, 2
  s_add_u32 s62, s62, s3
  s_mul_i32 s63, s62, 18432
  s_mul_i32 s58, s61, 82944
  s_waitcnt lgkmcnt(0)
  s_add_u32 s20, s16, 7340032
  s_addc_u32 s21, s17, 0
  s_and_b32 s21, s21, 0xffff
  s_mov_b32 s22, 2359296
  s_mov_b32 s23, 0x20000
  s_add_u32 s28, s16, 17825792
  s_addc_u32 s29, s17, 0
  s_and_b32 s29, s29, 0xffff
  s_mov_b32 s30, 663552
  s_mov_b32 s31, 0x20000
  s_mul_i32 s59, s3, 4608
  s_and_b32 s59, s59, 0xfc00
  s_add_u32 s59, s59, 0
  s_add_u32 m0, s59, 73728
  s_add_u32 s15, s59, s58
  buffer_load_dwordx4 v2, s[28:31], s15 offen offset:0 lds
  buffer_load_dwordx4 v2, s[28:31], s15 offen offset:1024 lds
  buffer_load_dwordx4 v2, s[28:31], s15 offen offset:2048 lds
  buffer_load_dwordx4 v2, s[28:31], s15 offen offset:3072 lds
  s_add_u32 s59, s59, 4096
  s_add_u32 m0, s59, 73728
  s_add_u32 s15, s59, s58
  buffer_load_dwordx4 v2, s[28:31], s15 offen offset:0 lds
  buffer_load_dwordx4 v[64:67], v2, s[20:23], s63 offen offset:0
  buffer_load_dwordx4 v[68:71], v2, s[20:23], s63 offen offset:1024
  buffer_load_dwordx4 v[72:75], v2, s[20:23], s63 offen offset:2048
  buffer_load_dwordx4 v[76:79], v2, s[20:23], s63 offen offset:3072
  s_mul_i32 s59, s3, 4608
  s_and_b32 s59, s59, 0xfc00
  s_add_u32 s59, s59, 18432
  s_add_u32 m0, s59, 73728
  s_add_u32 s15, s59, s58
  buffer_load_dwordx4 v2, s[28:31], s15 offen offset:0 lds
  buffer_load_dwordx4 v2, s[28:31], s15 offen offset:1024 lds
  buffer_load_dwordx4 v2, s[28:31], s15 offen offset:2048 lds
  buffer_load_dwordx4 v2, s[28:31], s15 offen offset:3072 lds
  s_add_u32 s59, s59, 4096
  s_add_u32 m0, s59, 73728
  s_add_u32 s15, s59, s58
  buffer_load_dwordx4 v2, s[28:31], s15 offen offset:0 lds
  s_add_u32 s63, s63, 4096
  buffer_load_dwordx4 v[80:83], v2, s[20:23], s63 offen offset:0
  buffer_load_dwordx4 v[84:87], v2, s[20:23], s63 offen offset:1024
  buffer_load_dwordx4 v[88:91], v2, s[20:23], s63 offen offset:2048
  buffer_load_dwordx4 v[92:95], v2, s[20:23], s63 offen offset:3072
  s_add_u32 s24, s16, 18874368
  s_addc_u32 s25, s17, 0
  s_and_b32 s25, s25, 0xffff
  s_mov_b32 s26, 5455872
  s_mov_b32 s27, 0x20000
  s_mov_b32 s40, 0
  s_lshl_b32 s40, s62, 4
  v_add_u32 v8, s40, v8
  v_mov_b32 v7, 2146435072
  v_cmp_gt_u32 vcc, 2, v9
  v_mul_u32_u24 v10, 1152, v8
  s_mul_i32 s40, s61, 144
  v_add_u32 v10, s40, v10
  v_lshl_add_u32 v11, v9, 3, v10
  v_add_u32 v11, 128, v11
  v_cndmask_b32 v11, v7, v11, vcc
  v_lshl_add_u32 v10, v9, 4, v10
  v_lshrrev_b32 v12, 5, v8
  v_mul_u32_u24 v12, 36864, v12
  v_and_b32 v13, 31, v8
  v_lshl_add_u32 v12, v13, 4, v12
  s_mul_i32 s40, s61, 4608
  v_add_u32 v12, s40, v12
  v_lshl_add_u32 v13, v9, 3, v12
  v_add_u32 v13, 4096, v13
  v_cndmask_b32 v13, v7, v13, vcc
  v_lshl_add_u32 v12, v9, 9, v12
  s_mul_i32 s40, s61, 288
  v_lshlrev_b32 v14, 5, v9
  v_add_u32 v14, s40, v14
  v_lshlrev_b32 v15, 4, v9
  v_add_u32 v15, s40, v15
  v_add_u32 v15, 256, v15
  v_cndmask_b32 v15, v7, v15, vcc
  s_add_u32 s32, s16, 65536
  s_addc_u32 s33, s17, 0
  s_and_b32 s33, s33, 0xffff
  s_mov_b32 s34, 13824
  s_mov_b32 s35, 0x20000
  s_mov_b32 s36, s18
  s_and_b32 s37, s19, 0xffff
  s_mov_b32 s38, 2359296
  s_mov_b32 s39, 0x20000
  v_mov_b32 v40, 0
  v_mov_b32 v41, 0
  v_mov_b32 v42, 0
  v_mov_b32 v43, 0
  v_mov_b32 v44, 0
  v_mov_b32 v45, 0
  v_mov_b32 v46, 0
  v_mov_b32 v47, 0
  v_mov_b32 v48, 0
  v_mov_b32 v49, 0
  v_mov_b32 v50, 0
  v_mov_b32 v51, 0
  v_mov_b32 v52, 0
  v_mov_b32 v53, 0
  v_mov_b32 v54, 0
  v_mov_b32 v55, 0
  v_mov_b32 v56, 0
  v_mov_b32 v57, 0
  v_mov_b32 v58, 0
  v_mov_b32 v59, 0
  v_add_u32 v3, 73728, v2
  v_add_u32 v4, 139264, v2
  v_add_u32 v6, 139264, v5
  v_add_u32 v5, 73728, v5
  s_waitcnt vmcnt(13)
  s_barrier
  ds_read_b128 v[140:143], v3 offset:0
  ds_read_b128 v[144:147], v3 offset:1024
  ds_read_b128 v[148:151], v3 offset:2048
  ds_read_b128 v[152:155], v3 offset:3072
  ds_read_b128 v[156:159], v5 offset:4096
  ds_read_b128 v[160:163], v3 offset:4608
  ds_read_b128 v[164:167], v3 offset:5632
  ds_read_b128 v[168:171], v3 offset:6656
  ds_read_b128 v[172:175], v3 offset:7680
  ds_read_b128 v[176:179], v5 offset:8704
  s_waitcnt vmcnt(12)
  s_waitcnt lgkmcnt(5)
  v_mfma_f32_16x16x32_bf16 v[40:43], v[140:143], v[64:67], v[40:43]
  ds_read_b128 v[228:231], v3 offset:9216
  v_mfma_f32_16x16x32_bf16 v[44:47], v[144:147], v[64:67], v[44:47]
  ds_read_b128 v[232:235], v3 offset:10240
  v_mfma_f32_16x16x32_bf16 v[48:51], v[148:151], v[64:67], v[48:51]
  ds_read_b128 v[236:239], v3 offset:11264
  v_mfma_f32_16x16x32_bf16 v[52:55], v[152:155], v[64:67], v[52:55]
  ds_read_b128 v[240:243], v3 offset:12288
  v_mfma_f32_16x16x32_bf16 v[56:59], v[156:159], v[64:67], v[56:59]
  ds_read_b128 v[244:247], v5 offset:13312
  s_mul_i32 s59, s3, 4608
  s_and_b32 s59, s59, 0xfc00
  s_add_u32 s59, s59, 36864
  s_add_u32 m0, s59, 73728
  s_add_u32 s15, s59, s58
  buffer_load_dwordx4 v2, s[28:31], s15 offen offset:0 lds
  buffer_load_dwordx4 v2, s[28:31], s15 offen offset:1024 lds
  buffer_load_dwordx4 v2, s[28:31], s15 offen offset:2048 lds
  buffer_load_dwordx4 v2, s[28:31], s15 offen offset:3072 lds
  s_waitcnt vmcnt(15)
  s_waitcnt lgkmcnt(5)
  v_mfma_f32_16x16x32_bf16 v[40:43], v[160:163], v[68:71], v[40:43]
  ds_read_b128 v[140:143], v3 offset:13824
  v_mfma_f32_16x16x32_bf16 v[44:47], v[164:167], v[68:71], v[44:47]
  ds_read_b128 v[144:147], v3 offset:14848
  v_mfma_f32_16x16x32_bf16 v[48:51], v[168:171], v[68:71], v[48:51]
  ds_read_b128 v[148:151], v3 offset:15872
  v_mfma_f32_16x16x32_bf16 v[52:55], v[172:175], v[68:71], v[52:55]
  ds_read_b128 v[152:155], v3 offset:16896
  v_mfma_f32_16x16x32_bf16 v[56:59], v[176:179], v[68:71], v[56:59]
  ds_read_b128 v[156:159], v5 offset:17920
  s_add_u32 s59, s59, 4096
  s_add_u32 m0, s59, 73728
  s_add_u32 s15, s59, s58
  buffer_load_dwordx4 v2, s[28:31], s15 offen offset:0 lds
  s_add_u32 s63, s63, 4096
  buffer_load_dwordx4 v[96:99], v2, s[20:23], s63 offen offset:0
  buffer_load_dwordx4 v[100:103], v2, s[20:23], s63 offen offset:1024
  buffer_load_dwordx4 v[104:107], v2, s[20:23], s63 offen offset:2048
  v_and_b32 v36, 31, v1
  v_lshrrev_b32 v32, 5, v1
  v_mul_u32_u24 v32, 4608, v32
  v_cmp_gt_u32 vcc, 18, v36
  v_lshl_add_u32 v36, v36, 4, v32
  s_nop 0
  v_cndmask_b32 v36, v7, v36, vcc
  s_mul_i32 s41, s61, 288
  s_add_u32 s41, s41, 4608
  buffer_load_dwordx4 v[32:35], v36, s[32:35], s41 offen
  s_waitcnt vmcnt(13)
  s_barrier
  s_waitcnt vmcnt(19)
  s_waitcnt lgkmcnt(5)
  v_mfma_f32_16x16x32_bf16 v[40:43], v[228:231], v[72:75], v[40:43]
  ds_read_b128 v[160:163], v3 offset:18432
  v_mfma_f32_16x16x32_bf16 v[44:47], v[232:235], v[72:75], v[44:47]
  ds_read_b128 v[164:167], v3 offset:19456
  v_mfma_f32_16x16x32_bf16 v[48:51], v[236:239], v[72:75], v[48:51]
  ds_read_b128 v[168:171], v3 offset:20480
  v_mfma_f32_16x16x32_bf16 v[52:55], v[240:243], v[72:75], v[52:55]
  ds_read_b128 v[172:175], v3 offset:21504
  v_mfma_f32_16x16x32_bf16 v[56:59], v[244:247], v[72:75], v[56:59]
  ds_read_b128 v[176:179], v5 offset:22528
  buffer_load_dwordx4 v[108:111], v2, s[20:23], s63 offen offset:3072
  s_mul_i32 s59, s3, 4608
  s_and_b32 s59, s59, 0xfc00
  s_add_u32 s59, s59, 55296
  s_add_u32 m0, s59, 73728
  s_add_u32 s15, s59, s58
  buffer_load_dwordx4 v2, s[28:31], s15 offen offset:0 lds
  buffer_load_dwordx4 v2, s[28:31], s15 offen offset:1024 lds
  buffer_load_dwordx4 v2, s[28:31], s15 offen offset:2048 lds
  s_waitcnt vmcnt(22)
  s_waitcnt lgkmcnt(5)
  v_mfma_f32_16x16x32_bf16 v[40:43], v[140:143], v[76:79], v[40:43]
  ds_read_b128 v[228:231], v3 offset:23040
  v_mfma_f32_16x16x32_bf16 v[44:47], v[144:147], v[76:79], v[44:47]
  ds_read_b128 v[232:235], v3 offset:24064
  v_mfma_f32_16x16x32_bf16 v[48:51], v[148:151], v[76:79], v[48:51]
  ds_read_b128 v[236:239], v3 offset:25088
  v_mfma_f32_16x16x32_bf16 v[52:55], v[152:155], v[76:79], v[52:55]
  ds_read_b128 v[240:243], v3 offset:26112
  v_mfma_f32_16x16x32_bf16 v[56:59], v[156:159], v[76:79], v[56:59]
  ds_read_b128 v[244:247], v5 offset:27136
  buffer_load_dwordx4 v2, s[28:31], s15 offen offset:3072 lds
  s_add_u32 s59, s59, 4096
  s_add_u32 m0, s59, 73728
  s_add_u32 s15, s59, s58
  buffer_load_dwordx4 v2, s[28:31], s15 offen offset:0 lds
  s_add_u32 s63, s63, 4096
  buffer_load_dwordx4 v[112:115], v2, s[20:23], s63 offen offset:0
  buffer_load_dwordx4 v[116:119], v2, s[20:23], s63 offen offset:1024
  s_waitcnt vmcnt(20)
  s_waitcnt lgkmcnt(5)
  v_mfma_f32_16x16x32_bf16 v[40:43], v[160:163], v[80:83], v[40:43]
  ds_read_b128 v[140:143], v3 offset:27648
  v_mfma_f32_16x16x32_bf16 v[44:47], v[164:167], v[80:83], v[44:47]
  ds_read_b128 v[144:147], v3 offset:28672
  v_mfma_f32_16x16x32_bf16 v[48:51], v[168:171], v[80:83], v[48:51]
  ds_read_b128 v[148:151], v3 offset:29696
  v_mfma_f32_16x16x32_bf16 v[52:55], v[172:175], v[80:83], v[52:55]
  ds_read_b128 v[152:155], v3 offset:30720
  v_mfma_f32_16x16x32_bf16 v[56:59], v[176:179], v[80:83], v[56:59]
  ds_read_b128 v[156:159], v5 offset:31744
  buffer_load_dwordx4 v[120:123], v2, s[20:23], s63 offen offset:2048
  buffer_load_dwordx4 v[124:127], v2, s[20:23], s63 offen offset:3072
  s_mul_i32 s59, s3, 2048
  s_add_u32 s59, s59, 73728
  s_add_u32 m0, s59, 73728
  s_add_u32 s15, s59, s58
  buffer_load_dwordx4 v2, s[28:31], s15 offen offset:0 lds
  buffer_load_dwordx4 v2, s[28:31], s15 offen offset:1024 lds
  s_waitcnt vmcnt(23)
  s_waitcnt lgkmcnt(5)
  v_mfma_f32_16x16x32_bf16 v[40:43], v[228:231], v[84:87], v[40:43]
  ds_read_b128 v[160:163], v3 offset:32256
  v_mfma_f32_16x16x32_bf16 v[44:47], v[232:235], v[84:87], v[44:47]
  ds_read_b128 v[164:167], v3 offset:33280
  v_mfma_f32_16x16x32_bf16 v[48:51], v[236:239], v[84:87], v[48:51]
  ds_read_b128 v[168:171], v3 offset:34304
  v_mfma_f32_16x16x32_bf16 v[52:55], v[240:243], v[84:87], v[52:55]
  ds_read_b128 v[172:175], v3 offset:35328
  v_mfma_f32_16x16x32_bf16 v[56:59], v[244:247], v[84:87], v[56:59]
  ds_read_b128 v[176:179], v5 offset:36352
  buffer_load_dwordx4 v2, s[28:31], s15 offen offset:2048 lds
  s_add_u32 s63, s63, 4096
  buffer_load_dwordx4 v[128:131], v2, s[20:23], s63 offen offset:0
  buffer_load_dwordx4 v[132:135], v2, s[20:23], s63 offen offset:1024
  s_waitcnt vmcnt(19)
  s_barrier
  s_waitcnt vmcnt(25)
  s_waitcnt lgkmcnt(5)
  v_mfma_f32_16x16x32_bf16 v[40:43], v[140:143], v[88:91], v[40:43]
  ds_read_b128 v[228:231], v3 offset:36864
  v_mfma_f32_16x16x32_bf16 v[44:47], v[144:147], v[88:91], v[44:47]
  ds_read_b128 v[232:235], v3 offset:37888
  v_mfma_f32_16x16x32_bf16 v[48:51], v[148:151], v[88:91], v[48:51]
  ds_read_b128 v[236:239], v3 offset:38912
  v_mfma_f32_16x16x32_bf16 v[52:55], v[152:155], v[88:91], v[52:55]
  ds_read_b128 v[240:243], v3 offset:39936
  v_mfma_f32_16x16x32_bf16 v[56:59], v[156:159], v[88:91], v[56:59]
  ds_read_b128 v[244:247], v5 offset:40960
  buffer_load_dwordx4 v[20:23], v10, s[36:39], 0 offen
  buffer_load_dwordx4 v[24:27], v10, s[36:39], 0 offen offset:64
  s_waitcnt vmcnt(26)
  s_waitcnt lgkmcnt(5)
  v_mfma_f32_16x16x32_bf16 v[40:43], v[160:163], v[92:95], v[40:43]
  ds_read_b128 v[140:143], v3 offset:41472
  v_mfma_f32_16x16x32_bf16 v[44:47], v[164:167], v[92:95], v[44:47]
  ds_read_b128 v[144:147], v3 offset:42496
  v_mfma_f32_16x16x32_bf16 v[48:51], v[168:171], v[92:95], v[48:51]
  ds_read_b128 v[148:151], v3 offset:43520
  v_mfma_f32_16x16x32_bf16 v[52:55], v[172:175], v[92:95], v[52:55]
  ds_read_b128 v[152:155], v3 offset:44544
  v_mfma_f32_16x16x32_bf16 v[56:59], v[176:179], v[92:95], v[56:59]
  ds_read_b128 v[156:159], v5 offset:45568
  buffer_load_dwordx2 v[28:29], v11, s[36:39], 0 offen
  s_waitcnt vmcnt(21)
  s_waitcnt lgkmcnt(5)
  v_mfma_f32_16x16x32_bf16 v[40:43], v[228:231], v[96:99], v[40:43]
  ds_read_b128 v[160:163], v3 offset:46080
  v_mfma_f32_16x16x32_bf16 v[44:47], v[232:235], v[96:99], v[44:47]
  ds_read_b128 v[164:167], v3 offset:47104
  v_mfma_f32_16x16x32_bf16 v[48:51], v[236:239], v[96:99], v[48:51]
  ds_read_b128 v[168:171], v3 offset:48128
  v_mfma_f32_16x16x32_bf16 v[52:55], v[240:243], v[96:99], v[52:55]
  ds_read_b128 v[172:175], v3 offset:49152
  v_mfma_f32_16x16x32_bf16 v[56:59], v[244:247], v[96:99], v[56:59]
  ds_read_b128 v[176:179], v5 offset:50176
  s_waitcnt vmcnt(20)
  s_waitcnt lgkmcnt(5)
  v_mfma_f32_16x16x32_bf16 v[40:43], v[140:143], v[100:103], v[40:43]
  ds_read_b128 v[228:231], v3 offset:50688
  v_mfma_f32_16x16x32_bf16 v[44:47], v[144:147], v[100:103], v[44:47]
  ds_read_b128 v[232:235], v3 offset:51712
  v_mfma_f32_16x16x32_bf16 v[48:51], v[148:151], v[100:103], v[48:51]
  ds_read_b128 v[236:239], v3 offset:52736
  v_mfma_f32_16x16x32_bf16 v[52:55], v[152:155], v[100:103], v[52:55]
  ds_read_b128 v[240:243], v3 offset:53760
  v_mfma_f32_16x16x32_bf16 v[56:59], v[156:159], v[100:103], v[56:59]
  ds_read_b128 v[244:247], v5 offset:54784
  s_waitcnt vmcnt(12)
  s_barrier
  s_waitcnt vmcnt(19)
  s_waitcnt lgkmcnt(5)
  v_mfma_f32_16x16x32_bf16 v[40:43], v[160:163], v[104:107], v[40:43]
  ds_read_b128 v[140:143], v3 offset:55296
  v_mfma_f32_16x16x32_bf16 v[44:47], v[164:167], v[104:107], v[44:47]
  ds_read_b128 v[144:147], v3 offset:56320
  v_mfma_f32_16x16x32_bf16 v[48:51], v[168:171], v[104:107], v[48:51]
  ds_read_b128 v[148:151], v3 offset:57344
  v_mfma_f32_16x16x32_bf16 v[52:55], v[172:175], v[104:107], v[52:55]
  ds_read_b128 v[152:155], v3 offset:58368
  v_mfma_f32_16x16x32_bf16 v[56:59], v[176:179], v[104:107], v[56:59]
  ds_read_b128 v[156:159], v5 offset:59392
  s_waitcnt vmcnt(17)
  s_waitcnt lgkmcnt(5)
  v_mfma_f32_16x16x32_bf16 v[40:43], v[228:231], v[108:111], v[40:43]
  ds_read_b128 v[160:163], v3 offset:59904
  v_mfma_f32_16x16x32_bf16 v[44:47], v[232:235], v[108:111], v[44:47]
  ds_read_b128 v[164:167], v3 offset:60928
  v_mfma_f32_16x16x32_bf16 v[48:51], v[236:239], v[108:111], v[48:51]
  ds_read_b128 v[168:171], v3 offset:61952
  v_mfma_f32_16x16x32_bf16 v[52:55], v[240:243], v[108:111], v[52:55]
  ds_read_b128 v[172:175], v3 offset:62976
  v_mfma_f32_16x16x32_bf16 v[56:59], v[244:247], v[108:111], v[56:59]
  ds_read_b128 v[176:179], v5 offset:64000
  s_waitcnt vmcnt(11)
  s_waitcnt lgkmcnt(5)
  v_mfma_f32_16x16x32_bf16 v[40:43], v[140:143], v[112:115], v[40:43]
  ds_read_b128 v[228:231], v3 offset:64512
  v_mfma_f32_16x16x32_bf16 v[44:47], v[144:147], v[112:115], v[44:47]
  ds_read_b128 v[232:235], v4 offset:0
  v_mfma_f32_16x16x32_bf16 v[48:51], v[148:151], v[112:115], v[48:51]
  ds_read_b128 v[236:239], v4 offset:1024
  v_mfma_f32_16x16x32_bf16 v[52:55], v[152:155], v[112:115], v[52:55]
  ds_read_b128 v[240:243], v4 offset:2048
  v_mfma_f32_16x16x32_bf16 v[56:59], v[156:159], v[112:115], v[56:59]
  ds_read_b128 v[244:247], v6 offset:3072
  s_waitcnt vmcnt(18)
  s_lshl_b32 s41, s3, 10
  s_add_u32 s41, s41, 156672
  v_add_u32 v36, s41, v2
  ds_write_b128 v36, v[32:35]
  v_lshlrev_b32 v36, 5, v9
  v_add_u32 v36, s41, v36
  v_lshlrev_b32 v37, 4, v9
  v_add_u32 v37, s41, v37
  s_waitcnt lgkmcnt(0)
  ds_read_b128 v[184:187], v36 offset:0
  ds_read_b128 v[188:191], v36 offset:16
  ds_read_b128 v[192:195], v36 offset:128
  ds_read_b128 v[196:199], v36 offset:144
  ds_read_b128 v[200:203], v37 offset:256
  ds_read_b128 v[208:211], v36 offset:512
  ds_read_b128 v[212:215], v36 offset:528
  ds_read_b128 v[216:219], v36 offset:640
  ds_read_b128 v[220:223], v36 offset:656
  ds_read_b128 v[224:227], v37 offset:768
  s_waitcnt vmcnt(10)
  s_waitcnt lgkmcnt(0)
  v_mfma_f32_16x16x32_bf16 v[40:43], v[160:163], v[116:119], v[40:43]
  ds_read_b128 v[140:143], v4 offset:3584
  v_mfma_f32_16x16x32_bf16 v[44:47], v[164:167], v[116:119], v[44:47]
  ds_read_b128 v[144:147], v4 offset:4608
  v_mfma_f32_16x16x32_bf16 v[48:51], v[168:171], v[116:119], v[48:51]
  ds_read_b128 v[148:151], v4 offset:5632
  v_mfma_f32_16x16x32_bf16 v[52:55], v[172:175], v[116:119], v[52:55]
  ds_read_b128 v[152:155], v4 offset:6656
  v_mfma_f32_16x16x32_bf16 v[56:59], v[176:179], v[116:119], v[56:59]
  ds_read_b128 v[156:159], v6 offset:7680
  s_waitcnt vmcnt(5)
  s_barrier
  s_waitcnt vmcnt(9)
  s_waitcnt lgkmcnt(5)
  v_mfma_f32_16x16x32_bf16 v[40:43], v[228:231], v[120:123], v[40:43]
  ds_read_b128 v[160:163], v4 offset:8192
  v_mfma_f32_16x16x32_bf16 v[44:47], v[232:235], v[120:123], v[44:47]
  ds_read_b128 v[164:167], v4 offset:9216
  v_mfma_f32_16x16x32_bf16 v[48:51], v[236:239], v[120:123], v[48:51]
  ds_read_b128 v[168:171], v4 offset:10240
  v_mfma_f32_16x16x32_bf16 v[52:55], v[240:243], v[120:123], v[52:55]
  ds_read_b128 v[172:175], v4 offset:11264
  v_mfma_f32_16x16x32_bf16 v[56:59], v[244:247], v[120:123], v[56:59]
  ds_read_b128 v[176:179], v6 offset:12288
  s_waitcnt vmcnt(8)
  s_waitcnt lgkmcnt(5)
  v_mfma_f32_16x16x32_bf16 v[40:43], v[140:143], v[124:127], v[40:43]
  ds_read_b128 v[228:231], v4 offset:12800
  v_mfma_f32_16x16x32_bf16 v[44:47], v[144:147], v[124:127], v[44:47]
  ds_read_b128 v[232:235], v4 offset:13824
  v_mfma_f32_16x16x32_bf16 v[48:51], v[148:151], v[124:127], v[48:51]
  ds_read_b128 v[236:239], v4 offset:14848
  v_mfma_f32_16x16x32_bf16 v[52:55], v[152:155], v[124:127], v[52:55]
  ds_read_b128 v[240:243], v4 offset:15872
  v_mfma_f32_16x16x32_bf16 v[56:59], v[156:159], v[124:127], v[56:59]
  ds_read_b128 v[244:247], v6 offset:16896
  s_waitcnt vmcnt(4)
  s_waitcnt lgkmcnt(5)
  v_mfma_f32_16x16x32_bf16 v[40:43], v[160:163], v[128:131], v[40:43]
  v_mfma_f32_16x16x32_bf16 v[44:47], v[164:167], v[128:131], v[44:47]
  v_mfma_f32_16x16x32_bf16 v[48:51], v[168:171], v[128:131], v[48:51]
  v_mfma_f32_16x16x32_bf16 v[52:55], v[172:175], v[128:131], v[52:55]
  v_mfma_f32_16x16x32_bf16 v[56:59], v[176:179], v[128:131], v[56:59]
  s_waitcnt vmcnt(3)
  s_waitcnt lgkmcnt(0)
  v_mfma_f32_16x16x32_bf16 v[40:43], v[228:231], v[132:135], v[40:43]
  v_mfma_f32_16x16x32_bf16 v[44:47], v[232:235], v[132:135], v[44:47]
  v_mfma_f32_16x16x32_bf16 v[48:51], v[236:239], v[132:135], v[48:51]
  v_mfma_f32_16x16x32_bf16 v[52:55], v[240:243], v[132:135], v[52:55]
  v_mfma_f32_16x16x32_bf16 v[56:59], v[244:247], v[132:135], v[56:59]
  s_waitcnt vmcnt(0)
  s_add_u32 s28, s16, 13631488
  s_addc_u32 s29, s17, 0
  s_and_b32 s29, s29, 0xffff
  s_mov_b32 s30, 2359296
  s_mov_b32 s31, 0x20000
  s_add_u32 s20, s16, 524288
  s_addc_u32 s21, s17, 0
  s_and_b32 s21, s21, 0xffff
  s_mov_b32 s22, 131072
  s_mov_b32 s23, 0x20000
  v_lshlrev_b32 v64, 16, v20
  v_and_b32 v65, 0xffff0000, v20
  v_lshlrev_b32 v66, 16, v21
  v_and_b32 v67, 0xffff0000, v21
  v_lshlrev_b32 v68, 16, v22
  v_and_b32 v69, 0xffff0000, v22
  v_lshlrev_b32 v70, 16, v23
  v_and_b32 v71, 0xffff0000, v23
  v_lshlrev_b32 v72, 16, v24
  v_and_b32 v73, 0xffff0000, v24
  v_lshlrev_b32 v74, 16, v25
  v_and_b32 v75, 0xffff0000, v25
  v_lshlrev_b32 v76, 16, v26
  v_and_b32 v77, 0xffff0000, v26
  v_lshlrev_b32 v78, 16, v27
  v_and_b32 v79, 0xffff0000, v27
  v_lshlrev_b32 v80, 16, v28
  v_and_b32 v81, 0xffff0000, v28
  v_lshlrev_b32 v82, 16, v29
  v_and_b32 v83, 0xffff0000, v29
  v_pk_fma_f32 v[64:65], v[40:41], v[184:185], v[64:65]
  v_pk_fma_f32 v[66:67], v[42:43], v[186:187], v[66:67]
  v_pk_fma_f32 v[68:69], v[44:45], v[188:189], v[68:69]
  v_pk_fma_f32 v[70:71], v[46:47], v[190:191], v[70:71]
  v_pk_fma_f32 v[72:73], v[48:49], v[192:193], v[72:73]
  v_pk_fma_f32 v[74:75], v[50:51], v[194:195], v[74:75]
  v_pk_fma_f32 v[76:77], v[52:53], v[196:197], v[76:77]
  v_pk_fma_f32 v[78:79], v[54:55], v[198:199], v[78:79]
  v_pk_fma_f32 v[80:81], v[56:57], v[200:201], v[80:81]
  v_pk_fma_f32 v[82:83], v[58:59], v[202:203], v[82:83]
  v_cvt_pk_bf16_f32 v84, v64, v65
  v_cvt_pk_bf16_f32 v85, v66, v67
  v_cvt_pk_bf16_f32 v86, v68, v69
  v_cvt_pk_bf16_f32 v87, v70, v71
  v_cvt_pk_bf16_f32 v88, v72, v73
  v_cvt_pk_bf16_f32 v89, v74, v75
  v_cvt_pk_bf16_f32 v90, v76, v77
  v_cvt_pk_bf16_f32 v91, v78, v79
  v_cvt_pk_bf16_f32 v92, v80, v81
  v_cvt_pk_bf16_f32 v93, v82, v83
  v_lshlrev_b32 v64, 16, v84
  v_and_b32 v65, 0xffff0000, v84
  v_lshlrev_b32 v66, 16, v85
  v_and_b32 v67, 0xffff0000, v85
  v_lshlrev_b32 v68, 16, v86
  v_and_b32 v69, 0xffff0000, v86
  v_lshlrev_b32 v70, 16, v87
  v_and_b32 v71, 0xffff0000, v87
  v_lshlrev_b32 v72, 16, v88
  v_and_b32 v73, 0xffff0000, v88
  v_lshlrev_b32 v74, 16, v89
  v_and_b32 v75, 0xffff0000, v89
  v_lshlrev_b32 v76, 16, v90
  v_and_b32 v77, 0xffff0000, v90
  v_lshlrev_b32 v78, 16, v91
  v_and_b32 v79, 0xffff0000, v91
  v_lshlrev_b32 v80, 16, v92
  v_and_b32 v81, 0xffff0000, v92
  v_lshlrev_b32 v82, 16, v93
  v_and_b32 v83, 0xffff0000, v93
  v_pk_mul_f32 v[108:109], v[64:65], v[208:209]
  v_cvt_pk_bf16_f32 v96, v108, v109
  v_pk_mul_f32 v[110:111], v[66:67], v[210:211]
  v_cvt_pk_bf16_f32 v97, v110, v111
  v_pk_mul_f32 v[112:113], v[68:69], v[212:213]
  v_cvt_pk_bf16_f32 v98, v112, v113
  v_pk_mul_f32 v[114:115], v[70:71], v[214:215]
  v_cvt_pk_bf16_f32 v99, v114, v115
  v_pk_mul_f32 v[116:117], v[72:73], v[216:217]
  v_cvt_pk_bf16_f32 v100, v116, v117
  v_pk_mul_f32 v[118:119], v[74:75], v[218:219]
  v_cvt_pk_bf16_f32 v101, v118, v119
  v_pk_mul_f32 v[120:121], v[76:77], v[220:221]
  v_cvt_pk_bf16_f32 v102, v120, v121
  v_pk_mul_f32 v[122:123], v[78:79], v[222:223]
  v_cvt_pk_bf16_f32 v103, v122, v123
  v_pk_mul_f32 v[124:125], v[80:81], v[224:225]
  v_cvt_pk_bf16_f32 v104, v124, v125
  v_pk_mul_f32 v[126:127], v[82:83], v[226:227]
  v_cvt_pk_bf16_f32 v105, v126, v127
  buffer_store_dwordx4 v[96:99], v12, s[28:31], 0 offen sc1
  buffer_store_dwordx4 v[100:103], v12, s[28:31], 0 offen offset:2048 sc1
  v_mov_b32 v128, v104
  v_mov_b32 v129, v105
  v_cmp_eq_u32 vcc, 0, v9
  s_nop 1
  v_cndmask_b32 v13, v7, v13, vcc
  v_permlane16_swap_b32 v128, v106
  v_permlane16_swap_b32 v129, v107
  buffer_store_dwordx4 v[104:107], v13, s[28:31], 0 offen sc1
  v_accvgpr_write_b32 a244, v84
  v_accvgpr_write_b32 a245, v85
  v_accvgpr_write_b32 a246, v86
  v_accvgpr_write_b32 a247, v87
  v_accvgpr_write_b32 a248, v88
  v_accvgpr_write_b32 a249, v89
  v_accvgpr_write_b32 a250, v90
  v_accvgpr_write_b32 a251, v91
  v_accvgpr_write_b32 a252, v92
  v_accvgpr_write_b32 a253, v93
  v_pk_add_f32 v[16:17], v[64:65], v[66:67]
  v_pk_mul_f32 v[18:19], v[64:65], v[64:65]
  v_pk_fma_f32 v[18:19], v[66:67], v[66:67], v[18:19]
  v_pk_add_f32 v[16:17], v[16:17], v[68:69]
  v_pk_fma_f32 v[18:19], v[68:69], v[68:69], v[18:19]
  v_pk_add_f32 v[16:17], v[16:17], v[70:71]
  v_pk_fma_f32 v[18:19], v[70:71], v[70:71], v[18:19]
  v_pk_add_f32 v[16:17], v[16:17], v[72:73]
  v_pk_fma_f32 v[18:19], v[72:73], v[72:73], v[18:19]
  v_pk_add_f32 v[16:17], v[16:17], v[74:75]
  v_pk_fma_f32 v[18:19], v[74:75], v[74:75], v[18:19]
  v_pk_add_f32 v[16:17], v[16:17], v[76:77]
  v_pk_fma_f32 v[18:19], v[76:77], v[76:77], v[18:19]
  v_pk_add_f32 v[16:17], v[16:17], v[78:79]
  v_pk_fma_f32 v[18:19], v[78:79], v[78:79], v[18:19]
  v_pk_add_f32 v[16:17], v[16:17], v[80:81]
  v_pk_fma_f32 v[18:19], v[80:81], v[80:81], v[18:19]
  v_pk_add_f32 v[16:17], v[16:17], v[82:83]
  v_pk_fma_f32 v[18:19], v[82:83], v[82:83], v[18:19]
  v_add_f32 v16, v16, v17
  v_add_f32 v17, v18, v19
  v_mov_b32 v18, v16
  s_nop 1
  v_permlane16_swap_b32 v16, v18
  v_add_f32 v16, v16, v18
  v_mov_b32 v19, v17
  s_nop 1
  v_permlane16_swap_b32 v17, v19
  v_add_f32 v17, v17, v19
  v_mov_b32 v18, v16
  s_nop 1
  v_permlane32_swap_b32 v16, v18
  v_add_f32 v16, v16, v18
  v_mov_b32 v19, v17
  s_nop 1
  v_permlane32_swap_b32 v17, v19
  v_add_f32 v17, v17, v19
  v_lshlrev_b32 v18, 3, v1
  v_cmp_eq_u32 vcc, 0, v9
  s_nop 1
  v_cndmask_b32 v18, v7, v18, vcc
  s_lshl_b32 s15, s62, 3
  s_add_u32 s15, s15, s61
  s_lshl_b32 s15, s15, 7
  s_waitcnt vmcnt(0)
  buffer_store_dwordx2 v[16:17], v18, s[20:23], s15 offen sc1
  s_barrier
L_k3_done:
  s_add_u32 m0, s10, 0
  s_nop 0
  buffer_load_dwordx4 v2, s[24:27], s44 offen offset:0 lds
  buffer_load_dwordx4 v2, s[24:27], s44 offen offset:1024 lds
  buffer_load_dwordx4 v2, s[24:27], s44 offen offset:2048 lds
  buffer_load_dwordx4 v2, s[24:27], s44 offen offset:3072 lds
  s_add_u32 m0, s10, 4096
  s_add_u32 s14, s44, 4096
  buffer_load_dwordx4 v2, s[24:27], s14 offen offset:0 lds
  buffer_load_dwordx4 v2, s[24:27], s14 offen offset:1024 lds
  buffer_load_dwordx4 v2, s[24:27], s14 offen offset:2048 lds
  buffer_load_dwordx4 v2, s[24:27], s14 offen offset:3072 lds
  s_add_u32 m0, s10, 8192
  s_add_u32 s14, s44, 8192
  buffer_load_dwordx4 v2, s[24:27], s14 offen offset:0 lds
  s_cmp_eq_u32 s3, 1
  s_cselect_b32 s11, s45, s44
  s_cselect_b32 s12, s49, s48
  s_cmp_eq_u32 s3, 2
  s_cselect_b32 s11, s46, s11
  s_cselect_b32 s12, s50, s12
  s_cmp_eq_u32 s3, 3
  s_cselect_b32 s11, s47, s11
  s_cselect_b32 s12, s51, s12
  s_sub_u32 s9, 36864, s10
  s_lshl_b32 s13, s3, 10
  s_add_u32 m0, s13, 147456
  s_add_u32 s11, s11, s9
  buffer_load_dwordx4 v2, s[24:27], s11 offen lds
  s_add_u32 m0, s13, 151552
  s_add_u32 s12, s12, s9
  buffer_load_dwordx4 v2, s[24:27], s12 offen lds
  s_mov_b32 m0, 155648
  s_add_u32 s12, s52, s9
  buffer_load_dwordx4 v2, s[24:27], s12 offen lds
  s_add_u32 m0, s10, 36864
  s_nop 0
  buffer_load_dwordx4 v2, s[24:27], s45 offen offset:0 lds
  buffer_load_dwordx4 v2, s[24:27], s45 offen offset:1024 lds
  buffer_load_dwordx4 v2, s[24:27], s45 offen offset:2048 lds
  buffer_load_dwordx4 v2, s[24:27], s45 offen offset:3072 lds
  s_add_u32 m0, s10, 40960
  s_add_u32 s14, s45, 4096
  buffer_load_dwordx4 v2, s[24:27], s14 offen offset:0 lds
  buffer_load_dwordx4 v2, s[24:27], s14 offen offset:1024 lds
  buffer_load_dwordx4 v2, s[24:27], s14 offen offset:2048 lds
  buffer_load_dwordx4 v2, s[24:27], s14 offen offset:3072 lds
  s_add_u32 m0, s10, 45056
  s_add_u32 s14, s45, 8192
  buffer_load_dwordx4 v2, s[24:27], s14 offen offset:0 lds
  s_mov_b32 s36, s54
  s_and_b32 s37, s55, 0xffff
  s_mov_b32 s38, 4096
  s_mov_b32 s39, 0x20000
  v_and_b32 v19, 15, v1
  s_lshl_b32 s9, s8, 5
  v_add_u32 v19, s9, v19
  v_lshlrev_b32 v19, 1, v19
  buffer_load_ushort v222, v19, s[36:39], 0 offen
  buffer_load_ushort v223, v19, s[36:39], 0 offen offset:32
  s_add_u32 s32, s16, 56623104
  s_addc_u32 s33, s17, 0
  s_and_b32 s33, s33, 0xffff
  s_mov_b32 s34, 1048576
  s_mov_b32 s35, 0x20000
  s_add_u32 s36, s16, 786432
  s_addc_u32 s37, s17, 0
  s_and_b32 s37, s37, 0xffff
  s_mov_b32 s38, 262144
  s_mov_b32 s39, 0x20000
  v_and_b32 v5, 31, v1
  v_lshrrev_b32 v6, 5, v1
  s_lshl_b32 s9, s8, 11
  v_and_b32 v19, 15, v1
  v_lshlrev_b32 v7, 3, v19
  v_bfe_u32 v18, v1, 4, 1
  v_lshl_add_u32 v7, v18, 10, v7
  v_lshl_add_u32 v7, v6, 9, v7
  v_add_u32 v7, s9, v7
  v_mov_b32 v147, 0
  v_mov_b32 v180, 0
  v_mov_b32 v181, 0
  v_mov_b32 v182, 0
  v_mov_b32 v183, 0
  v_add_u32 v3, 36864, v2
  v_add_u32 v4, 73728, v2
  v_add_u32 v31, 110592, v2
  v_add_u32 v17, 147456, v2
  s_lshl_b32 s9, s8, 1
  v_add_u32 v18, s9, v18
  v_lshlrev_b32 v18, 13, v18
  v_lshl_add_u32 v18, v19, 4, v18
  v_lshl_add_u32 v18, v6, 8, v18
  v_lshlrev_b32 v26, 3, v5
  v_cmp_eq_u32 vcc, 0, v6
  v_mov_b32 v27, 2146435072
  s_nop 0
  v_cndmask_b32 v27, v27, v26, vcc
  v_lshl_add_u32 v26, v6, 13, v26
  s_mul_i32 s9, s3, 5120
  s_add_u32 s9, s9, 36864
  v_mul_u32_u24 v21, 80, v5
  v_lshl_add_u32 v21, v6, 4, v21
  v_add_u32 v21, s9, v21
  v_lshrrev_b32 v23, 4, v1
  v_lshlrev_b32 v23, 3, v23
  v_bfe_u32 v19, v1, 2, 2
  v_add_u32 v23, v23, v19
  v_mul_u32_u24 v23, 80, v23
  v_and_b32 v19, 3, v1
  v_lshl_add_u32 v23, v19, 4, v23
  v_add_u32 v23, s9, v23
  s_lshl_b32 s15, s4, 14
  s_lshl_b32 s12, s3, 8
  s_add_u32 s15, s15, s12
  s_lshl_b32 s64, s5, 6
  s_lshl_b32 s65, s3, 4
  s_add_u32 s64, s64, s65
  s_add_u32 s64, s64, s4
  s_mul_i32 s64, s64, 9216
  s_add_u32 s65, s64, 4096
  s_add_u32 s66, s64, 8192
  s_sub_u32 s67, s66, 589824
  s_cmp_eq_u32 s6, 0
  s_cselect_b32 s66, 2146435072, s66
  s_cselect_b32 s67, 2146435072, s67
  s_mul_i32 s11, s8, 36864
  s_mov_b32 s13, 0
  s_sleep 2
L_k34_poll:
  buffer_load_dwordx2 v[8:9], v7, s[20:23], 0 offen sc1
  buffer_load_dwordx2 v[10:11], v7, s[20:23], 0 offen offset:128 sc1
  buffer_load_dwordx2 v[12:13], v7, s[20:23], 0 offen offset:256 sc1
  buffer_load_dwordx2 v[14:15], v7, s[20:23], 0 offen offset:384 sc1
  s_waitcnt vmcnt(0)
L_k34_chk:
  s_add_u32 s13, s13, 1
  v_max_u32 v16, v9, v11
  v_max3_u32 v16, v16, v13, v15
  v_cmp_eq_u32 vcc, -1, v16
  s_cmp_lt_u32 s13, 0x40000
  s_nop 0
  s_cselect_b64 vcc, vcc, 0
  s_cbranch_vccz L_k34_ok
  s_sleep 12
  s_branch L_k34_poll
L_k34_ok:
  buffer_load_dwordx4 a[0:3], v2, s[28:31], s11 offen offset:0 sc1
  buffer_load_dwordx4 a[4:7], v2, s[28:31], s11 offen offset:1024 sc1
  buffer_load_dwordx4 a[8:11], v2, s[28:31], s11 offen offset:2048 sc1
  buffer_load_dwordx4 a[12:15], v2, s[28:31], s11 offen offset:3072 sc1
  s_add_u32 s11, s11, 4096
  buffer_load_dwordx4 a[16:19], v2, s[28:31], s11 offen offset:0 sc1
  buffer_load_dwordx4 a[20:23], v2, s[28:31], s11 offen offset:1024 sc1
  buffer_load_dwordx4 a[24:27], v2, s[28:31], s11 offen offset:2048 sc1
  buffer_load_dwordx4 a[28:31], v2, s[28:31], s11 offen offset:3072 sc1
  s_add_u32 s11, s11, 4096
  buffer_load_dwordx4 a[32:35], v2, s[28:31], s11 offen offset:0 sc1
  buffer_load_dwordx4 a[36:39], v2, s[28:31], s11 offen offset:1024 sc1
  buffer_load_dwordx4 a[40:43], v2, s[28:31], s11 offen offset:2048 sc1
  buffer_load_dwordx4 a[44:47], v2, s[28:31], s11 offen offset:3072 sc1
  s_add_u32 s11, s11, 4096
  buffer_load_dwordx4 a[48:51], v2, s[28:31], s11 offen offset:0 sc1
  buffer_load_dwordx4 a[52:55], v2, s[28:31], s11 offen offset:1024 sc1
  s_add_u32 s20, s16, 47185920
  s_addc_u32 s21, s17, 0
  s_and_b32 s21, s21, 0xffff
  s_mov_b32 s22, 9437184
  s_mov_b32 s23, 0x20000
  s_waitcnt vmcnt(14)
  s_barrier
  v_pk_add_f32 v[8:9], v[8:9], v[10:11]
  v_pk_add_f32 v[12:13], v[12:13], v[14:15]
  v_pk_add_f32 v[8:9], v[8:9], v[12:13]
  ds_read_b128 a[144:147], v2 offset:0
  ds_read_b128 a[148:151], v3 offset:0
  ds_read_b128 a[152:155], v2 offset:1024
  ds_read_b128 a[156:159], v3 offset:1024
  ds_read_b128 a[160:163], v2 offset:2048
  ds_read_b128 a[164:167], v3 offset:2048
  ds_read_b128 a[232:235], v2 offset:3072
  ds_read_b128 a[236:239], v3 offset:3072
  v_mov_b32 v10, v8
  s_nop 1
  v_permlane32_swap_b32 v8, v10
  v_add_f32 v8, v8, v10
  v_mov_b32 v11, v9
  s_nop 1
  v_permlane32_swap_b32 v9, v11
  v_add_f32 v9, v9, v11
  v_mul_f32 v8, 0xbae38e39, v8
  v_mul_f32 v9, 0x3ae38e39, v9
  v_fma_f32 v9, -v8, v8, v9
  v_max_f32 v9, 0, v9
  v_add_f32 v9, 0x3727c5ac, v9
  v_rsq_f32 v24, v9
  v_sqrt_f32 v9, v9
  v_mul_f32 v20, 0xc0135761, v24
  v_mul_f32 v22, v24, v24
  v_mul_f32 v22, v22, v24
  v_mul_f32 v22, 0xbdd2d3e8, v22
  v_cvt_pk_bf16_f32 v10, v8, v9
  v_lshlrev_b32 v11, 16, v10
  v_and_b32 v12, 0xffff0000, v10
  v_sub_f32 v13, v8, v11
  v_sub_f32 v14, v9, v12
  v_cvt_pk_bf16_f32 v13, v13, v14
  v_and_b32 v144, 0xffff, v10
  v_lshl_or_b32 v144, v13, 16, v144
  v_mov_b32 v145, v10
  v_lshrrev_b32 v146, 16, v13
  v_or_b32 v146, v146, v12
  s_add_u32 s40, s16, 491520
  s_addc_u32 s41, s17, 0
  s_and_b32 s41, s41, 0xffff
  s_mov_b32 s42, 8192
  s_mov_b32 s43, 0x20000
  s_lshl_b32 s12, s8, 7
  s_cmp_eq_u32 s5, 0
  s_cselect_b32 s12, s12, 2146435072
  v_lshrrev_b32 v8, 1, v27
  buffer_store_dword v24, v8, s[40:43], s12 offen sc1
  s_waitcnt vmcnt(14)
  s_waitcnt lgkmcnt(6)
  v_mfma_f32_32x32x16_bf16 v[32:47], a[144:147], a[0:3], 0
  ds_read_b128 a[240:243], v2 offset:4096
  v_mfma_f32_32x32x16_bf16 v[48:63], a[148:151], a[0:3], 0
  ds_read_b128 a[144:147], v3 offset:4096
  buffer_load_dwordx4 a[56:59], v2, s[28:31], s11 offen offset:2048 sc1
  s_waitcnt vmcnt(14)
  s_waitcnt lgkmcnt(6)
  v_mfma_f32_32x32x16_bf16 v[32:47], a[152:155], a[4:7], v[32:47]
  ds_read_b128 a[148:151], v2 offset:5120
  v_mfma_f32_32x32x16_bf16 v[48:63], a[156:159], a[4:7], v[48:63]
  ds_read_b128 a[152:155], v3 offset:5120
  buffer_load_dwordx4 a[60:63], v2, s[28:31], s11 offen offset:3072 sc1
  s_waitcnt vmcnt(14)
  s_waitcnt lgkmcnt(6)
  v_mfma_f32_32x32x16_bf16 v[32:47], a[160:163], a[8:11], v[32:47]
  ds_read_b128 a[156:159], v2 offset:6144
  v_mfma_f32_32x32x16_bf16 v[48:63], a[164:167], a[8:11], v[48:63]
  ds_read_b128 a[160:163], v3 offset:6144
  s_add_u32 s11, s11, 4096
  buffer_load_dwordx4 a[64:67], v2, s[28:31], s11 offen offset:0 sc1
  s_waitcnt vmcnt(14)
  s_waitcnt lgkmcnt(6)
  v_mfma_f32_32x32x16_bf16 v[32:47], a[232:235], a[12:15], v[32:47]
  ds_read_b128 a[164:167], v2 offset:7168
  v_mfma_f32_32x32x16_bf16 v[48:63], a[236:239], a[12:15], v[48:63]
  ds_read_b128 a[232:235], v3 offset:7168
  buffer_load_dwordx4 a[68:71], v2, s[28:31], s11 offen offset:1024 sc1
  s_waitcnt vmcnt(14)
  s_waitcnt lgkmcnt(6)
  v_mfma_f32_32x32x16_bf16 v[32:47], a[240:243], a[16:19], v[32:47]
  ds_read_b128 a[236:239], v2 offset:8192
  v_mfma_f32_32x32x16_bf16 v[48:63], a[144:147], a[16:19], v[48:63]
  ds_read_b128 a[240:243], v3 offset:8192
  buffer_load_dwordx4 a[72:75], v2, s[28:31], s11 offen offset:2048 sc1
  s_waitcnt vmcnt(14)
  s_waitcnt lgkmcnt(6)
  v_mfma_f32_32x32x16_bf16 v[32:47], a[148:151], a[20:23], v[32:47]
  ds_read_b128 a[144:147], v2 offset:9216
  v_mfma_f32_32x32x16_bf16 v[48:63], a[152:155], a[20:23], v[48:63]
  ds_read_b128 a[148:151], v3 offset:9216
  buffer_load_dwordx4 a[76:79], v2, s[28:31], s11 offen offset:3072 sc1
  s_waitcnt vmcnt(14)
  s_waitcnt lgkmcnt(6)
  v_mfma_f32_32x32x16_bf16 v[32:47], a[156:159], a[24:27], v[32:47]
  ds_read_b128 a[152:155], v2 offset:10240
  v_mfma_f32_32x32x16_bf16 v[48:63], a[160:163], a[24:27], v[48:63]
  ds_read_b128 a[156:159], v3 offset:10240
  s_add_u32 s11, s11, 4096
  buffer_load_dwordx4 a[80:83], v2, s[28:31], s11 offen offset:0 sc1
  s_waitcnt vmcnt(14)
  s_waitcnt lgkmcnt(6)
  v_mfma_f32_32x32x16_bf16 v[32:47], a[164:167], a[28:31], v[32:47]
  ds_read_b128 a[160:163], v2 offset:11264
  v_mfma_f32_32x32x16_bf16 v[48:63], a[232:235], a[28:31], v[48:63]
  ds_read_b128 a[164:167], v3 offset:11264
  buffer_load_dwordx4 a[84:87], v2, s[28:31], s11 offen offset:1024 sc1
  s_waitcnt vmcnt(14)
  s_waitcnt lgkmcnt(6)
  v_mfma_f32_32x32x16_bf16 v[32:47], a[236:239], a[32:35], v[32:47]
  ds_read_b128 a[232:235], v2 offset:12288
  v_mfma_f32_32x32x16_bf16 v[48:63], a[240:243], a[32:35], v[48:63]
  ds_read_b128 a[236:239], v3 offset:12288
  buffer_load_dwordx4 a[88:91], v2, s[28:31], s11 offen offset:2048 sc1
  s_waitcnt vmcnt(14)
  s_waitcnt lgkmcnt(6)
  v_mfma_f32_32x32x16_bf16 v[32:47], a[144:147], a[36:39], v[32:47]
  ds_read_b128 a[240:243], v2 offset:13312
  v_mfma_f32_32x32x16_bf16 v[48:63], a[148:151], a[36:39], v[48:63]
  ds_read_b128 a[144:147], v3 offset:13312
  buffer_load_dwordx4 a[92:95], v2, s[28:31], s11 offen offset:3072 sc1
  s_waitcnt vmcnt(14)
  s_waitcnt lgkmcnt(6)
  v_mfma_f32_32x32x16_bf16 v[32:47], a[152:155], a[40:43], v[32:47]
  ds_read_b128 a[148:151], v2 offset:14336
  v_mfma_f32_32x32x16_bf16 v[48:63], a[156:159], a[40:43], v[48:63]
  ds_read_b128 a[152:155], v3 offset:14336
  s_add_u32 s11, s11, 4096
  buffer_load_dwordx4 a[96:99], v2, s[28:31], s11 offen offset:0 sc1
  s_waitcnt vmcnt(14)
  s_waitcnt lgkmcnt(6)
  v_mfma_f32_32x32x16_bf16 v[32:47], a[160:163], a[44:47], v[32:47]
  ds_read_b128 a[156:159], v2 offset:15360
  v_mfma_f32_32x32x16_bf16 v[48:63], a[164:167], a[44:47], v[48:63]
  ds_read_b128 a[160:163], v3 offset:15360
  buffer_load_dwordx4 a[100:103], v2, s[28:31], s11 offen offset:1024 sc1
  s_waitcnt vmcnt(14)
  s_waitcnt lgkmcnt(6)
  v_mfma_f32_32x32x16_bf16 v[32:47], a[232:235], a[48:51], v[32:47]
  ds_read_b128 a[164:167], v2 offset:16384
  v_mfma_f32_32x32x16_bf16 v[48:63], a[236:239], a[48:51], v[48:63]
  ds_read_b128 a[232:235], v3 offset:16384
  buffer_load_dwordx4 a[104:107], v2, s[28:31], s11 offen offset:2048 sc1
  s_waitcnt vmcnt(14)
  s_waitcnt lgkmcnt(6)
  v_mfma_f32_32x32x16_bf16 v[32:47], a[240:243], a[52:55], v[32:47]
  ds_read_b128 a[236:239], v2 offset:17408
  v_mfma_f32_32x32x16_bf16 v[48:63], a[144:147], a[52:55], v[48:63]
  ds_read_b128 a[240:243], v3 offset:17408
  buffer_load_dwordx4 a[108:111], v2, s[28:31], s11 offen offset:3072 sc1
  s_waitcnt vmcnt(13)
  s_waitcnt lgkmcnt(6)
  v_mfma_f32_32x32x16_bf16 v[32:47], a[148:151], a[56:59], v[32:47]
  ds_read_b128 a[144:147], v2 offset:18432
  v_mfma_f32_32x32x16_bf16 v[48:63], a[152:155], a[56:59], v[48:63]
  ds_read_b128 a[148:151], v3 offset:18432
  s_add_u32 s11, s11, 4096
  buffer_load_dwordx4 a[112:115], v2, s[28:31], s11 offen offset:0 sc1
  s_waitcnt vmcnt(13)
  s_waitcnt lgkmcnt(6)
  v_mfma_f32_32x32x16_bf16 v[32:47], a[156:159], a[60:63], v[32:47]
  ds_read_b128 a[152:155], v2 offset:19456
  v_mfma_f32_32x32x16_bf16 v[48:63], a[160:163], a[60:63], v[48:63]
  ds_read_b128 a[156:159], v3 offset:19456
  buffer_load_dwordx4 a[116:119], v2, s[28:31], s11 offen offset:1024 sc1
  s_waitcnt vmcnt(13)
  s_waitcnt lgkmcnt(6)
  v_mfma_f32_32x32x16_bf16 v[32:47], a[164:167], a[64:67], v[32:47]
  ds_read_b128 a[160:163], v2 offset:20480
  v_mfma_f32_32x32x16_bf16 v[48:63], a[232:235], a[64:67], v[48:63]
  ds_read_b128 a[164:167], v3 offset:20480
  buffer_load_dwordx4 a[120:123], v2, s[28:31], s11 offen offset:2048 sc1
  s_waitcnt vmcnt(13)
  s_waitcnt lgkmcnt(6)
  v_mfma_f32_32x32x16_bf16 v[32:47], a[236:239], a[68:71], v[32:47]
  ds_read_b128 a[232:235], v2 offset:21504
  v_mfma_f32_32x32x16_bf16 v[48:63], a[240:243], a[68:71], v[48:63]
  ds_read_b128 a[236:239], v3 offset:21504
  buffer_load_dwordx4 a[124:127], v2, s[28:31], s11 offen offset:3072 sc1
  s_waitcnt vmcnt(13)
  s_waitcnt lgkmcnt(6)
  v_mfma_f32_32x32x16_bf16 v[32:47], a[144:147], a[72:75], v[32:47]
  ds_read_b128 a[240:243], v2 offset:22528
  v_mfma_f32_32x32x16_bf16 v[48:63], a[148:151], a[72:75], v[48:63]
  ds_read_b128 a[144:147], v3 offset:22528
  s_add_u32 s11, s11, 4096
  buffer_load_dwordx4 a[128:131], v2, s[28:31], s11 offen offset:0 sc1
  s_waitcnt vmcnt(13)
  s_waitcnt lgkmcnt(6)
  v_mfma_f32_32x32x16_bf16 v[32:47], a[152:155], a[76:79], v[32:47]
  ds_read_b128 a[148:151], v2 offset:23552
  v_mfma_f32_32x32x16_bf16 v[48:63], a[156:159], a[76:79], v[48:63]
  ds_read_b128 a[152:155], v3 offset:23552
  buffer_load_dwordx4 a[132:135], v2, s[28:31], s11 offen offset:1024 sc1
  s_waitcnt vmcnt(13)
  s_waitcnt lgkmcnt(6)
  v_mfma_f32_32x32x16_bf16 v[32:47], a[160:163], a[80:83], v[32:47]
  ds_read_b128 a[156:159], v2 offset:24576
  v_mfma_f32_32x32x16_bf16 v[48:63], a[164:167], a[80:83], v[48:63]
  ds_read_b128 a[160:163], v3 offset:24576
  buffer_load_dwordx4 a[136:139], v2, s[28:31], s11 offen offset:2048 sc1
  s_waitcnt vmcnt(13)
  s_waitcnt lgkmcnt(6)
  v_mfma_f32_32x32x16_bf16 v[32:47], a[232:235], a[84:87], v[32:47]
  ds_read_b128 a[164:167], v2 offset:25600
  v_mfma_f32_32x32x16_bf16 v[48:63], a[236:239], a[84:87], v[48:63]
  ds_read_b128 a[232:235], v3 offset:25600
  buffer_load_dwordx4 a[140:143], v2, s[28:31], s11 offen offset:3072 sc1
  s_waitcnt vmcnt(13)
  s_waitcnt lgkmcnt(6)
  v_mfma_f32_32x32x16_bf16 v[32:47], a[240:243], a[88:91], v[32:47]
  ds_read_b128 a[236:239], v2 offset:26624
  v_mfma_f32_32x32x16_bf16 v[48:63], a[144:147], a[88:91], v[48:63]
  ds_read_b128 a[240:243], v3 offset:26624
  s_add_u32 m0, s10, 73728
  s_nop 0
  buffer_load_dwordx4 v2, s[24:27], s46 offen offset:0 lds
  s_waitcnt vmcnt(13)
  s_waitcnt lgkmcnt(6)
  v_mfma_f32_32x32x16_bf16 v[32:47], a[148:151], a[92:95], v[32:47]
  ds_read_b128 a[144:147], v2 offset:27648
  v_mfma_f32_32x32x16_bf16 v[48:63], a[152:155], a[92:95], v[48:63]
  ds_read_b128 a[148:151], v3 offset:27648
  buffer_load_dwordx4 v2, s[24:27], s46 offen offset:1024 lds
  s_waitcnt vmcnt(13)
  s_waitcnt lgkmcnt(6)
  v_mfma_f32_32x32x16_bf16 v[32:47], a[156:159], a[96:99], v[32:47]
  ds_read_b128 a[152:155], v2 offset:28672
  v_mfma_f32_32x32x16_bf16 v[48:63], a[160:163], a[96:99], v[48:63]
  ds_read_b128 a[156:159], v3 offset:28672
  buffer_load_dwordx4 v2, s[24:27], s46 offen offset:2048 lds
  s_waitcnt vmcnt(13)
  s_waitcnt lgkmcnt(6)
  v_mfma_f32_32x32x16_bf16 v[32:47], a[164:167], a[100:103], v[32:47]
  ds_read_b128 a[160:163], v2 offset:29696
  v_mfma_f32_32x32x16_bf16 v[48:63], a[232:235], a[100:103], v[48:63]
  ds_read_b128 a[164:167], v3 offset:29696
  buffer_load_dwordx4 v2, s[24:27], s46 offen offset:3072 lds
  s_waitcnt vmcnt(13)
  s_waitcnt lgkmcnt(6)
  v_mfma_f32_32x32x16_bf16 v[32:47], a[236:239], a[104:107], v[32:47]
  ds_read_b128 a[232:235], v2 offset:30720
  v_mfma_f32_32x32x16_bf16 v[48:63], a[240:243], a[104:107], v[48:63]
  ds_read_b128 a[236:239], v3 offset:30720
  s_add_u32 m0, s10, 77824
  s_add_u32 s14, s46, 4096
  buffer_load_dwordx4 v2, s[24:27], s14 offen offset:0 lds
  s_waitcnt vmcnt(13)
  s_waitcnt lgkmcnt(6)
  v_mfma_f32_32x32x16_bf16 v[32:47], a[144:147], a[108:111], v[32:47]
  ds_read_b128 a[240:243], v2 offset:31744
  v_mfma_f32_32x32x16_bf16 v[48:63], a[148:151], a[108:111], v[48:63]
  ds_read_b128 a[144:147], v3 offset:31744
  buffer_load_dwordx4 v2, s[24:27], s14 offen offset:1024 lds
  s_waitcnt vmcnt(13)
  s_waitcnt lgkmcnt(6)
  v_mfma_f32_32x32x16_bf16 v[32:47], a[152:155], a[112:115], v[32:47]
  ds_read_b128 a[148:151], v2 offset:32768
  v_mfma_f32_32x32x16_bf16 v[48:63], a[156:159], a[112:115], v[48:63]
  ds_read_b128 a[152:155], v3 offset:32768
  buffer_load_dwordx4 v2, s[24:27], s14 offen offset:2048 lds
  s_waitcnt vmcnt(13)
  s_waitcnt lgkmcnt(6)
  v_mfma_f32_32x32x16_bf16 v[32:47], a[160:163], a[116:119], v[32:47]
  ds_read_b128 a[156:159], v2 offset:33792
  v_mfma_f32_32x32x16_bf16 v[48:63], a[164:167], a[116:119], v[48:63]
  ds_read_b128 a[160:163], v3 offset:33792
  buffer_load_dwordx4 v2, s[24:27], s14 offen offset:3072 lds
  s_waitcnt vmcnt(13)
  s_waitcnt lgkmcnt(6)
  v_mfma_f32_32x32x16_bf16 v[32:47], a[232:235], a[120:123], v[32:47]
  ds_read_b128 a[164:167], v2 offset:34816
  v_mfma_f32_32x32x16_bf16 v[48:63], a[236:239], a[120:123], v[48:63]
  ds_read_b128 a[232:235], v3 offset:34816
  s_add_u32 m0, s10, 81920
  s_add_u32 s14, s46, 8192
  buffer_load_dwordx4 v2, s[24:27], s14 offen offset:0 lds
  s_waitcnt vmcnt(13)
  s_waitcnt lgkmcnt(6)
  v_mfma_f32_32x32x16_bf16 v[32:47], a[240:243], a[124:127], v[32:47]
  ds_read_b128 a[236:239], v2 offset:35840
  v_mfma_f32_32x32x16_bf16 v[48:63], a[144:147], a[124:127], v[48:63]
  ds_read_b128 a[240:243], v3 offset:35840
  s_waitcnt vmcnt(12)
  s_waitcnt lgkmcnt(6)
  v_mfma_f32_32x32x16_bf16 v[32:47], a[148:151], a[128:131], v[32:47]
  ds_read_b128 a[144:147], v17 offset:0
  v_mfma_f32_32x32x16_bf16 v[48:63], a[152:155], a[128:131], v[48:63]
  ds_read_b128 a[148:151], v17 offset:1024
  s_waitcnt vmcnt(11)
  s_waitcnt lgkmcnt(6)
  v_mfma_f32_32x32x16_bf16 v[32:47], a[156:159], a[132:135], v[32:47]
  v_mfma_f32_32x32x16_bf16 v[48:63], a[160:163], a[132:135], v[48:63]
  s_waitcnt vmcnt(10)
  s_waitcnt lgkmcnt(4)
  v_mfma_f32_32x32x16_bf16 v[32:47], a[164:167], a[136:139], v[32:47]
  v_mfma_f32_32x32x16_bf16 v[48:63], a[232:235], a[136:139], v[48:63]
  s_waitcnt vmcnt(9)
  s_waitcnt lgkmcnt(2)
  v_mfma_f32_32x32x16_bf16 v[32:47], a[236:239], a[140:143], v[32:47]
  v_mfma_f32_32x32x16_bf16 v[48:63], a[240:243], a[140:143], v[48:63]
  s_waitcnt lgkmcnt(0)
  v_mfma_f32_32x32x16_bf16 v[32:47], a[144:147], v[144:147], v[32:47]
  v_mfma_f32_32x32x16_bf16 v[48:63], a[148:151], v[144:147], v[48:63]
  s_barrier
  s_nop 9
  v_pk_mul_f32 v[164:165], v[32:33], v[32:33]
  v_pk_mul_f32 v[166:167], v[34:35], v[34:35]
  v_pk_mul_f32 v[168:169], v[36:37], v[36:37]
  v_pk_mul_f32 v[170:171], v[38:39], v[38:39]
  v_pk_fma_f32 v[164:165], v[164:165], v[22:23], v[20:21] op_sel_hi:[1,0,0]
  v_pk_fma_f32 v[166:167], v[166:167], v[22:23], v[20:21] op_sel_hi:[1,0,0]
  v_pk_fma_f32 v[168:169], v[168:169], v[22:23], v[20:21] op_sel_hi:[1,0,0]
  v_pk_fma_f32 v[170:171], v[170:171], v[22:23], v[20:21] op_sel_hi:[1,0,0]
  s_add_u32 m0, s10, 110592
  s_nop 0
  buffer_load_dwordx4 v2, s[24:27], s47 offen offset:0 lds
  v_pk_mul_f32 v[164:165], v[164:165], v[32:33]
  v_pk_mul_f32 v[166:167], v[166:167], v[34:35]
  v_pk_mul_f32 v[168:169], v[168:169], v[36:37]
  v_pk_mul_f32 v[170:171], v[170:171], v[38:39]
  v_exp_f32 v164, v164
  v_exp_f32 v165, v165
  v_exp_f32 v166, v166
  v_exp_f32 v167, v167
  buffer_load_dwordx4 v2, s[24:27], s47 offen offset:1024 lds
  v_exp_f32 v168, v168
  v_exp_f32 v169, v169
  v_exp_f32 v170, v170
  v_exp_f32 v171, v171
  v_pk_add_f32 v[164:165], v[164:165], 1.0 op_sel_hi:[1,0]
  v_pk_add_f32 v[166:167], v[166:167], 1.0 op_sel_hi:[1,0]
  v_pk_add_f32 v[168:169], v[168:169], 1.0 op_sel_hi:[1,0]
  v_pk_add_f32 v[170:171], v[170:171], 1.0 op_sel_hi:[1,0]
  buffer_load_dwordx4 v2, s[24:27], s47 offen offset:2048 lds
  v_rcp_f32 v164, v164
  v_rcp_f32 v165, v165
  v_rcp_f32 v166, v166
  v_rcp_f32 v167, v167
  v_rcp_f32 v168, v168
  v_rcp_f32 v169, v169
  v_rcp_f32 v170, v170
  v_rcp_f32 v171, v171
  buffer_load_dwordx4 v2, s[24:27], s47 offen offset:3072 lds
  v_pk_mul_f32 v[64:65], v[164:165], v[32:33]
  v_pk_mul_f32 v[66:67], v[166:167], v[34:35]
  v_pk_mul_f32 v[68:69], v[168:169], v[36:37]
  v_pk_mul_f32 v[70:71], v[170:171], v[38:39]
  v_pk_add_f32 v[180:181], v[180:181], v[64:65]
  v_pk_fma_f32 v[182:183], v[64:65], v[64:65], v[182:183]
  v_pk_add_f32 v[180:181], v[180:181], v[66:67]
  v_pk_fma_f32 v[182:183], v[66:67], v[66:67], v[182:183]
  s_add_u32 m0, s10, 114688
  s_add_u32 s14, s47, 4096
  buffer_load_dwordx4 v2, s[24:27], s14 offen offset:0 lds
  v_pk_add_f32 v[180:181], v[180:181], v[68:69]
  v_pk_fma_f32 v[182:183], v[68:69], v[68:69], v[182:183]
  v_pk_add_f32 v[180:181], v[180:181], v[70:71]
  v_pk_fma_f32 v[182:183], v[70:71], v[70:71], v[182:183]
  v_pk_mul_f32 v[172:173], v[40:41], v[40:41]
  v_pk_mul_f32 v[174:175], v[42:43], v[42:43]
  v_pk_mul_f32 v[176:177], v[44:45], v[44:45]
  v_pk_mul_f32 v[178:179], v[46:47], v[46:47]
  buffer_load_dwordx4 v2, s[24:27], s14 offen offset:1024 lds
  v_pk_fma_f32 v[172:173], v[172:173], v[22:23], v[20:21] op_sel_hi:[1,0,0]
  v_pk_fma_f32 v[174:175], v[174:175], v[22:23], v[20:21] op_sel_hi:[1,0,0]
  v_pk_fma_f32 v[176:177], v[176:177], v[22:23], v[20:21] op_sel_hi:[1,0,0]
  v_pk_fma_f32 v[178:179], v[178:179], v[22:23], v[20:21] op_sel_hi:[1,0,0]
  v_pk_mul_f32 v[172:173], v[172:173], v[40:41]
  v_pk_mul_f32 v[174:175], v[174:175], v[42:43]
  v_pk_mul_f32 v[176:177], v[176:177], v[44:45]
  v_pk_mul_f32 v[178:179], v[178:179], v[46:47]
  buffer_load_dwordx4 v2, s[24:27], s14 offen offset:2048 lds
  v_exp_f32 v172, v172
  v_exp_f32 v173, v173
  v_exp_f32 v174, v174
  v_exp_f32 v175, v175
  v_exp_f32 v176, v176
  v_exp_f32 v177, v177
  v_exp_f32 v178, v178
  v_exp_f32 v179, v179
  buffer_load_dwordx4 v2, s[24:27], s14 offen offset:3072 lds
  v_pk_add_f32 v[172:173], v[172:173], 1.0 op_sel_hi:[1,0]
  s_waitcnt vmcnt(8)
  s_barrier
  ds_read_b128 a[152:155], v4 offset:0
  ds_read_b128 a[156:159], v4 offset:1024
  ds_read_b128 a[160:163], v4 offset:2048
  ds_read_b128 a[164:167], v4 offset:3072
  ds_read_b128 a[232:235], v4 offset:4096
  ds_read_b128 a[236:239], v4 offset:5120
  ds_read_b128 a[240:243], v4 offset:6144
  ds_read_b128 a[144:147], v4 offset:7168
  v_pk_add_f32 v[174:175], v[174:175], 1.0 op_sel_hi:[1,0]
  v_pk_add_f32 v[176:177], v[176:177], 1.0 op_sel_hi:[1,0]
  v_pk_add_f32 v[178:179], v[178:179], 1.0 op_sel_hi:[1,0]
  v_rcp_f32 v172, v172
  v_rcp_f32 v173, v173
  v_rcp_f32 v174, v174
  v_rcp_f32 v175, v175
  s_add_u32 m0, s10, 118784
  s_add_u32 s14, s47, 8192
  buffer_load_dwordx4 v2, s[24:27], s14 offen offset:0 lds
  v_rcp_f32 v176, v176
  v_rcp_f32 v177, v177
  v_rcp_f32 v178, v178
  v_rcp_f32 v179, v179
  v_pk_mul_f32 v[72:73], v[172:173], v[40:41]
  v_pk_mul_f32 v[74:75], v[174:175], v[42:43]
  v_pk_mul_f32 v[76:77], v[176:177], v[44:45]
  v_pk_mul_f32 v[78:79], v[178:179], v[46:47]
  v_pk_add_f32 v[180:181], v[180:181], v[72:73]
  v_pk_fma_f32 v[182:183], v[72:73], v[72:73], v[182:183]
  v_pk_add_f32 v[180:181], v[180:181], v[74:75]
  v_pk_fma_f32 v[182:183], v[74:75], v[74:75], v[182:183]
  v_pk_add_f32 v[180:181], v[180:181], v[76:77]
  v_pk_fma_f32 v[182:183], v[76:77], v[76:77], v[182:183]
  v_pk_add_f32 v[180:181], v[180:181], v[78:79]
  v_pk_fma_f32 v[182:183], v[78:79], v[78:79], v[182:183]
  s_waitcnt lgkmcnt(4)
  v_mfma_f32_32x32x16_bf16 v[32:47], a[152:155], a[0:3], 0
  ds_read_b128 a[148:151], v4 offset:8192
  v_mul_f32 v164, v48, v48
  v_fma_f32 v164, v164, v22, v20
  v_mul_f32 v164, v164, v48
  v_mul_f32 v165, v49, v49
  v_exp_f32 v164, v164
  v_mfma_f32_32x32x16_bf16 v[32:47], a[156:159], a[4:7], v[32:47]
  ds_read_b128 a[152:155], v4 offset:9216
  s_add_u32 m0, s10, 0
  s_nop 0
  buffer_load_dwordx4 v2, s[24:27], s48 offen offset:0 lds
  v_fma_f32 v165, v165, v22, v20
  v_add_f32 v164, 1.0, v164
  v_mul_f32 v165, v165, v49
  v_mul_f32 v166, v50, v50
  v_mfma_f32_32x32x16_bf16 v[32:47], a[160:163], a[8:11], v[32:47]
  ds_read_b128 a[156:159], v4 offset:10240
  v_rcp_f32 v164, v164
  v_exp_f32 v165, v165
  v_fma_f32 v166, v166, v22, v20
  v_mfma_f32_32x32x16_bf16 v[32:47], a[164:167], a[12:15], v[32:47]
  ds_read_b128 a[160:163], v4 offset:11264
  v_mul_f32 v80, v164, v48
  v_add_f32 v165, 1.0, v165
  v_mul_f32 v166, v166, v50
  v_mul_f32 v167, v51, v51
  v_add_f32 v180, v180, v80
  s_waitcnt lgkmcnt(4)
  v_mfma_f32_32x32x16_bf16 v[32:47], a[232:235], a[16:19], v[32:47]
  ds_read_b128 a[164:167], v4 offset:12288
  buffer_load_dwordx4 v2, s[24:27], s48 offen offset:1024 lds
  v_rcp_f32 v165, v165
  v_exp_f32 v166, v166
  v_mfma_f32_32x32x16_bf16 v[32:47], a[236:239], a[20:23], v[32:47]
  ds_read_b128 a[232:235], v4 offset:13312
  v_fma_f32 v167, v167, v22, v20
  v_fmac_f32 v182, v80, v80
  v_mul_f32 v81, v165, v49
  v_add_f32 v166, 1.0, v166
  v_mul_f32 v167, v167, v51
  v_mfma_f32_32x32x16_bf16 v[32:47], a[240:243], a[24:27], v[32:47]
  ds_read_b128 a[236:239], v4 offset:14336
  v_mul_f32 v168, v52, v52
  v_add_f32 v181, v181, v81
  v_rcp_f32 v166, v166
  v_exp_f32 v167, v167
  v_mfma_f32_32x32x16_bf16 v[32:47], a[144:147], a[28:31], v[32:47]
  ds_read_b128 a[240:243], v4 offset:15360
  buffer_load_dwordx4 v2, s[24:27], s48 offen offset:2048 lds
  v_fma_f32 v168, v168, v22, v20
  v_fmac_f32 v183, v81, v81
  v_mul_f32 v82, v166, v50
  v_add_f32 v167, 1.0, v167
  s_waitcnt lgkmcnt(4)
  v_mfma_f32_32x32x16_bf16 v[32:47], a[148:151], a[32:35], v[32:47]
  ds_read_b128 a[144:147], v4 offset:16384
  v_mul_f32 v168, v168, v52
  v_mul_f32 v169, v53, v53
  v_add_f32 v180, v180, v82
  v_rcp_f32 v167, v167
  v_mfma_f32_32x32x16_bf16 v[32:47], a[152:155], a[36:39], v[32:47]
  ds_read_b128 a[148:151], v4 offset:17408
  v_exp_f32 v168, v168
  v_fma_f32 v169, v169, v22, v20
  v_fmac_f32 v182, v82, v82
  v_mfma_f32_32x32x16_bf16 v[32:47], a[156:159], a[40:43], v[32:47]
  ds_read_b128 a[152:155], v4 offset:18432
  buffer_load_dwordx4 v2, s[24:27], s48 offen offset:3072 lds
  v_mul_f32 v83, v167, v51
  v_add_f32 v168, 1.0, v168
  v_mul_f32 v169, v169, v53
  v_mul_f32 v170, v54, v54
  v_add_f32 v181, v181, v83
  v_mfma_f32_32x32x16_bf16 v[32:47], a[160:163], a[44:47], v[32:47]
  ds_read_b128 a[156:159], v4 offset:19456
  v_rcp_f32 v168, v168
  v_exp_f32 v169, v169
  v_fma_f32 v170, v170, v22, v20
  s_waitcnt lgkmcnt(4)
  v_mfma_f32_32x32x16_bf16 v[32:47], a[164:167], a[48:51], v[32:47]
  ds_read_b128 a[160:163], v4 offset:20480
  v_fmac_f32 v183, v83, v83
  v_mul_f32 v84, v168, v52
  v_add_f32 v169, 1.0, v169
  v_mul_f32 v170, v170, v54
  v_mfma_f32_32x32x16_bf16 v[32:47], a[232:235], a[52:55], v[32:47]
  ds_read_b128 a[164:167], v4 offset:21504
  s_add_u32 m0, s10, 4096
  s_add_u32 s14, s48, 4096
  buffer_load_dwordx4 v2, s[24:27], s14 offen offset:0 lds
  v_mul_f32 v171, v55, v55
  v_add_f32 v180, v180, v84
  v_rcp_f32 v169, v169
  v_exp_f32 v170, v170
  v_mfma_f32_32x32x16_bf16 v[32:47], a[236:239], a[56:59], v[32:47]
  ds_read_b128 a[232:235], v4 offset:22528
  v_fma_f32 v171, v171, v22, v20
  v_fmac_f32 v182, v84, v84
  v_mul_f32 v85, v169, v53
  v_add_f32 v170, 1.0, v170
  v_mfma_f32_32x32x16_bf16 v[32:47], a[240:243], a[60:63], v[32:47]
  ds_read_b128 a[236:239], v4 offset:23552
  v_mul_f32 v171, v171, v55
  v_add_f32 v181, v181, v85
  v_rcp_f32 v170, v170
  v_exp_f32 v171, v171
  s_waitcnt lgkmcnt(4)
  v_mfma_f32_32x32x16_bf16 v[32:47], a[144:147], a[64:67], v[32:47]
  ds_read_b128 a[240:243], v4 offset:24576
  buffer_load_dwordx4 v2, s[24:27], s14 offen offset:1024 lds
  v_fmac_f32 v183, v85, v85
  v_mul_f32 v86, v170, v54
  v_add_f32 v171, 1.0, v171
  v_mfma_f32_32x32x16_bf16 v[32:47], a[148:151], a[68:71], v[32:47]
  ds_read_b128 a[144:147], v4 offset:25600
  v_add_f32 v180, v180, v86
  v_rcp_f32 v171, v171
  v_fmac_f32 v182, v86, v86
  v_mul_f32 v87, v171, v55
  v_mfma_f32_32x32x16_bf16 v[32:47], a[152:155], a[72:75], v[32:47]
  ds_read_b128 a[148:151], v4 offset:26624
  v_add_f32 v181, v181, v87
  v_fmac_f32 v183, v87, v87
  v_mul_f32 v172, v56, v56
  v_fma_f32 v172, v172, v22, v20
  v_mul_f32 v172, v172, v56
  v_mfma_f32_32x32x16_bf16 v[32:47], a[156:159], a[76:79], v[32:47]
  ds_read_b128 a[152:155], v4 offset:27648
  buffer_load_dwordx4 v2, s[24:27], s14 offen offset:2048 lds
  v_mul_f32 v173, v57, v57
  v_exp_f32 v172, v172
  v_fma_f32 v173, v173, v22, v20
  v_add_f32 v172, 1.0, v172
  s_waitcnt lgkmcnt(4)
  v_mfma_f32_32x32x16_bf16 v[32:47], a[160:163], a[80:83], v[32:47]
  ds_read_b128 a[156:159], v4 offset:28672
  v_mul_f32 v173, v173, v57
  v_mul_f32 v174, v58, v58
  v_rcp_f32 v172, v172
  v_mfma_f32_32x32x16_bf16 v[32:47], a[164:167], a[84:87], v[32:47]
  ds_read_b128 a[160:163], v4 offset:29696
  v_exp_f32 v173, v173
  v_fma_f32 v174, v174, v22, v20
  v_mul_f32 v88, v172, v56
  v_add_f32 v173, 1.0, v173
  v_mfma_f32_32x32x16_bf16 v[32:47], a[232:235], a[88:91], v[32:47]
  ds_read_b128 a[164:167], v4 offset:30720
  buffer_load_dwordx4 v2, s[24:27], s14 offen offset:3072 lds
  v_mul_f32 v174, v174, v58
  v_mul_f32 v175, v59, v59
  v_add_f32 v180, v180, v88
  v_rcp_f32 v173, v173
  v_mfma_f32_32x32x16_bf16 v[32:47], a[236:239], a[92:95], v[32:47]
  ds_read_b128 a[232:235], v4 offset:31744
  v_exp_f32 v174, v174
  v_fma_f32 v175, v175, v22, v20
  v_fmac_f32 v182, v88, v88
  v_mul_f32 v89, v173, v57
  s_waitcnt lgkmcnt(4)
  v_mfma_f32_32x32x16_bf16 v[32:47], a[240:243], a[96:99], v[32:47]
  ds_read_b128 a[236:239], v4 offset:32768
  v_add_f32 v174, 1.0, v174
  v_mul_f32 v175, v175, v59
  v_mul_f32 v176, v60, v60
  v_add_f32 v181, v181, v89
  v_mfma_f32_32x32x16_bf16 v[32:47], a[144:147], a[100:103], v[32:47]
  ds_read_b128 a[240:243], v4 offset:33792
  s_add_u32 m0, s10, 8192
  s_add_u32 s14, s48, 8192
  buffer_load_dwordx4 v2, s[24:27], s14 offen offset:0 lds
  v_rcp_f32 v174, v174
  v_exp_f32 v175, v175
  v_fma_f32 v176, v176, v22, v20
  v_mfma_f32_32x32x16_bf16 v[32:47], a[148:151], a[104:107], v[32:47]
  ds_read_b128 a[144:147], v4 offset:34816
  v_fmac_f32 v183, v89, v89
  v_mul_f32 v90, v174, v58
  v_add_f32 v175, 1.0, v175
  v_mul_f32 v176, v176, v60
  v_mul_f32 v177, v61, v61
  v_mfma_f32_32x32x16_bf16 v[32:47], a[152:155], a[108:111], v[32:47]
  ds_read_b128 a[148:151], v4 offset:35840
  v_add_f32 v180, v180, v90
  v_rcp_f32 v175, v175
  v_exp_f32 v176, v176
  s_waitcnt lgkmcnt(4)
  v_mfma_f32_32x32x16_bf16 v[32:47], a[156:159], a[112:115], v[32:47]
  ds_read_b128 a[152:155], v17 offset:2048
  v_fma_f32 v177, v177, v22, v20
  v_fmac_f32 v182, v90, v90
  v_mul_f32 v91, v175, v59
  v_add_f32 v176, 1.0, v176
  v_mfma_f32_32x32x16_bf16 v[32:47], a[160:163], a[116:119], v[32:47]
  s_waitcnt vmcnt(9)
  s_barrier
  ds_read_b128 a[156:159], v31 offset:0
  v_mul_f32 v177, v177, v61
  v_mul_f32 v178, v62, v62
  v_add_f32 v181, v181, v91
  v_rcp_f32 v176, v176
  v_mfma_f32_32x32x16_bf16 v[32:47], a[164:167], a[120:123], v[32:47]
  ds_read_b128 a[160:163], v31 offset:1024
  v_exp_f32 v177, v177
  v_fma_f32 v178, v178, v22, v20
  v_fmac_f32 v183, v91, v91
  v_mul_f32 v92, v176, v60
  v_mfma_f32_32x32x16_bf16 v[32:47], a[232:235], a[124:127], v[32:47]
  ds_read_b128 a[164:167], v31 offset:2048
  v_add_f32 v177, 1.0, v177
  v_mul_f32 v178, v178, v62
  v_mul_f32 v179, v63, v63
  v_add_f32 v180, v180, v92
  v_rcp_f32 v177, v177
  s_waitcnt lgkmcnt(4)
  v_mfma_f32_32x32x16_bf16 v[32:47], a[236:239], a[128:131], v[32:47]
  ds_read_b128 a[232:235], v31 offset:3072
  v_exp_f32 v178, v178
  v_fma_f32 v179, v179, v22, v20
  v_mfma_f32_32x32x16_bf16 v[32:47], a[240:243], a[132:135], v[32:47]
  ds_read_b128 a[236:239], v31 offset:4096
  v_fmac_f32 v182, v92, v92
  v_mul_f32 v93, v177, v61
  v_add_f32 v178, 1.0, v178
  v_mul_f32 v179, v179, v63
  v_add_f32 v181, v181, v93
  v_mfma_f32_32x32x16_bf16 v[32:47], a[144:147], a[136:139], v[32:47]
  ds_read_b128 a[240:243], v31 offset:5120
  v_rcp_f32 v178, v178
  v_exp_f32 v179, v179
  v_fmac_f32 v183, v93, v93
  v_mfma_f32_32x32x16_bf16 v[32:47], a[148:151], a[140:143], v[32:47]
  ds_read_b128 a[144:147], v31 offset:6144
  v_mul_f32 v94, v178, v62
  v_add_f32 v179, 1.0, v179
  v_add_f32 v180, v180, v94
  v_rcp_f32 v179, v179
  s_waitcnt lgkmcnt(4)
  v_mfma_f32_32x32x16_bf16 v[32:47], a[152:155], v[144:147], v[32:47]
  ds_read_b128 a[148:151], v31 offset:7168
  v_fmac_f32 v182, v94, v94
  v_mul_f32 v95, v179, v63
  v_add_f32 v181, v181, v95
  v_fmac_f32 v183, v95, v95
  v_mfma_f32_32x32x16_bf16 v[48:63], a[156:159], a[0:3], 0
  ds_read_b128 a[152:155], v31 offset:8192
  v_mfma_f32_32x32x16_bf16 v[48:63], a[160:163], a[4:7], v[48:63]
  ds_read_b128 a[156:159], v31 offset:9216
  s_add_u32 m0, s10, 36864
  s_nop 0
  buffer_load_dwordx4 v2, s[24:27], s49 offen offset:0 lds
  v_mfma_f32_32x32x16_bf16 v[48:63], a[164:167], a[8:11], v[48:63]
  ds_read_b128 a[160:163], v31 offset:10240
  v_mul_f32 v164, v32, v32
  v_fma_f32 v164, v164, v22, v20
  v_mul_f32 v164, v164, v32
  v_mul_f32 v165, v33, v33
  v_exp_f32 v164, v164
  s_waitcnt lgkmcnt(4)
  v_mfma_f32_32x32x16_bf16 v[48:63], a[232:235], a[12:15], v[48:63]
  ds_read_b128 a[164:167], v31 offset:11264
  s_add_u32 s60, s16, 28311552
  s_addc_u32 s61, s17, 0
  s_and_b32 s61, s61, 0xffff
  s_mov_b32 s62, 8388608
  s_mov_b32 s63, 0x20000
  s_lshl_b32 s58, s4, 3
  s_lshl_b32 s59, s3, 1
  s_add_u32 s58, s58, s59
  s_lshl_b32 s58, s58, 16
  s_add_u32 s40, s58, 0
  buffer_load_dwordx4 a[168:171], v2, s[60:63], s40 offen offset:0
  v_fma_f32 v165, v165, v22, v20
  v_add_f32 v164, 1.0, v164
  v_mul_f32 v165, v165, v33
  v_mul_f32 v166, v34, v34
  v_rcp_f32 v164, v164
  v_mfma_f32_32x32x16_bf16 v[48:63], a[236:239], a[16:19], v[48:63]
  ds_read_b128 a[232:235], v31 offset:12288
  buffer_load_dwordx4 v2, s[24:27], s49 offen offset:1024 lds
  v_exp_f32 v165, v165
  v_fma_f32 v166, v166, v22, v20
  v_mul_f32 v96, v164, v32
  v_mfma_f32_32x32x16_bf16 v[48:63], a[240:243], a[20:23], v[48:63]
  ds_read_b128 a[236:239], v31 offset:13312
  v_add_f32 v165, 1.0, v165
  v_mul_f32 v166, v166, v34
  v_mul_f32 v167, v35, v35
  v_add_f32 v180, v180, v96
  v_rcp_f32 v165, v165
  v_mfma_f32_32x32x16_bf16 v[48:63], a[144:147], a[24:27], v[48:63]
  ds_read_b128 a[240:243], v31 offset:14336
  v_exp_f32 v166, v166
  v_fma_f32 v167, v167, v22, v20
  v_fmac_f32 v182, v96, v96
  s_waitcnt lgkmcnt(4)
  v_mfma_f32_32x32x16_bf16 v[48:63], a[148:151], a[28:31], v[48:63]
  ds_read_b128 a[144:147], v31 offset:15360
  buffer_load_dwordx4 v2, s[24:27], s49 offen offset:2048 lds
  buffer_load_dwordx4 a[172:175], v2, s[60:63], s40 offen offset:1024
  v_mul_f32 v97, v165, v33
  v_add_f32 v166, 1.0, v166
  v_mul_f32 v167, v167, v35
  v_mul_f32 v168, v36, v36
  v_add_f32 v181, v181, v97
  v_mfma_f32_32x32x16_bf16 v[48:63], a[152:155], a[32:35], v[48:63]
  ds_read_b128 a[148:151], v31 offset:16384
  v_rcp_f32 v166, v166
  v_exp_f32 v167, v167
  v_fma_f32 v168, v168, v22, v20
  v_mfma_f32_32x32x16_bf16 v[48:63], a[156:159], a[36:39], v[48:63]
  ds_read_b128 a[152:155], v31 offset:17408
  v_fmac_f32 v183, v97, v97
  v_mul_f32 v98, v166, v34
  v_add_f32 v167, 1.0, v167
  v_mul_f32 v168, v168, v36
  v_mul_f32 v169, v37, v37
  v_mfma_f32_32x32x16_bf16 v[48:63], a[160:163], a[40:43], v[48:63]
  ds_read_b128 a[156:159], v31 offset:18432
  buffer_load_dwordx4 v2, s[24:27], s49 offen offset:3072 lds
  v_add_f32 v180, v180, v98
  v_rcp_f32 v167, v167
  v_exp_f32 v168, v168
  s_waitcnt lgkmcnt(4)
  v_mfma_f32_32x32x16_bf16 v[48:63], a[164:167], a[44:47], v[48:63]
  ds_read_b128 a[160:163], v31 offset:19456
  buffer_load_dwordx4 a[176:179], v2, s[60:63], s40 offen offset:2048
  v_fma_f32 v169, v169, v22, v20
  v_fmac_f32 v182, v98, v98
  v_mul_f32 v99, v167, v35
  v_add_f32 v168, 1.0, v168
  v_mul_f32 v169, v169, v37
  v_mfma_f32_32x32x16_bf16 v[48:63], a[232:235], a[48:51], v[48:63]
  ds_read_b128 a[164:167], v31 offset:20480
  v_mul_f32 v170, v38, v38
  v_add_f32 v181, v181, v99
  v_rcp_f32 v168, v168
  v_exp_f32 v169, v169
  v_mfma_f32_32x32x16_bf16 v[48:63], a[236:239], a[52:55], v[48:63]
  ds_read_b128 a[232:235], v31 offset:21504
  s_add_u32 m0, s10, 40960
  s_add_u32 s14, s49, 4096
  buffer_load_dwordx4 v2, s[24:27], s14 offen offset:0 lds
  v_fma_f32 v170, v170, v22, v20
  v_fmac_f32 v183, v99, v99
  v_mul_f32 v100, v168, v36
  v_add_f32 v169, 1.0, v169
  v_mfma_f32_32x32x16_bf16 v[48:63], a[240:243], a[56:59], v[48:63]
  ds_read_b128 a[236:239], v31 offset:22528
  v_mul_f32 v170, v170, v38
  v_mul_f32 v171, v39, v39
  v_add_f32 v180, v180, v100
  v_rcp_f32 v169, v169
  s_waitcnt lgkmcnt(4)
  v_mfma_f32_32x32x16_bf16 v[48:63], a[144:147], a[60:63], v[48:63]
  ds_read_b128 a[240:243], v31 offset:23552
  buffer_load_dwordx4 a[180:183], v2, s[60:63], s40 offen offset:3072
  v_exp_f32 v170, v170
  v_fma_f32 v171, v171, v22, v20
  v_fmac_f32 v182, v100, v100
  v_mul_f32 v101, v169, v37
  v_mfma_f32_32x32x16_bf16 v[48:63], a[148:151], a[64:67], v[48:63]
  ds_read_b128 a[144:147], v31 offset:24576
  buffer_load_dwordx4 v2, s[24:27], s14 offen offset:1024 lds
  v_add_f32 v170, 1.0, v170
  v_mul_f32 v171, v171, v39
  v_add_f32 v181, v181, v101
  v_rcp_f32 v170, v170
  v_mfma_f32_32x32x16_bf16 v[48:63], a[152:155], a[68:71], v[48:63]
  ds_read_b128 a[148:151], v31 offset:25600
  v_exp_f32 v171, v171
  v_fmac_f32 v183, v101, v101
  v_mul_f32 v102, v170, v38
  v_add_f32 v171, 1.0, v171
  v_mfma_f32_32x32x16_bf16 v[48:63], a[156:159], a[72:75], v[48:63]
  ds_read_b128 a[152:155], v31 offset:26624
  v_add_f32 v180, v180, v102
  v_rcp_f32 v171, v171
  v_fmac_f32 v182, v102, v102
  v_mul_f32 v103, v171, v39
  s_waitcnt lgkmcnt(4)
  v_mfma_f32_32x32x16_bf16 v[48:63], a[160:163], a[76:79], v[48:63]
  ds_read_b128 a[156:159], v31 offset:27648
  buffer_load_dwordx4 v2, s[24:27], s14 offen offset:2048 lds
  s_add_u32 s40, s58, 4096
  buffer_load_dwordx4 a[184:187], v2, s[60:63], s40 offen offset:0
  v_add_f32 v181, v181, v103
  v_fmac_f32 v183, v103, v103
  v_mul_f32 v172, v40, v40
  v_fma_f32 v172, v172, v22, v20
  v_mul_f32 v172, v172, v40
  v_mfma_f32_32x32x16_bf16 v[48:63], a[164:167], a[80:83], v[48:63]
  ds_read_b128 a[160:163], v31 offset:28672
  v_mul_f32 v173, v41, v41
  v_exp_f32 v172, v172
  v_fma_f32 v173, v173, v22, v20
  v_add_f32 v172, 1.0, v172
  v_mfma_f32_32x32x16_bf16 v[48:63], a[232:235], a[84:87], v[48:63]
  ds_read_b128 a[164:167], v31 offset:29696
  v_mul_f32 v173, v173, v41
  v_mul_f32 v174, v42, v42
  v_rcp_f32 v172, v172
  v_exp_f32 v173, v173
  v_mfma_f32_32x32x16_bf16 v[48:63], a[236:239], a[88:91], v[48:63]
  ds_read_b128 a[232:235], v31 offset:30720
  buffer_load_dwordx4 v2, s[24:27], s14 offen offset:3072 lds
  v_fma_f32 v174, v174, v22, v20
  v_mul_f32 v104, v172, v40
  v_add_f32 v173, 1.0, v173
  v_mul_f32 v174, v174, v42
  s_waitcnt lgkmcnt(4)
  v_mfma_f32_32x32x16_bf16 v[48:63], a[240:243], a[92:95], v[48:63]
  ds_read_b128 a[236:239], v31 offset:31744
  buffer_load_dwordx4 a[188:191], v2, s[60:63], s40 offen offset:1024
  v_mul_f32 v175, v43, v43
  v_add_f32 v180, v180, v104
  v_rcp_f32 v173, v173
  v_exp_f32 v174, v174
  v_mfma_f32_32x32x16_bf16 v[48:63], a[144:147], a[96:99], v[48:63]
  ds_read_b128 a[240:243], v31 offset:32768
  v_fma_f32 v175, v175, v22, v20
  v_fmac_f32 v182, v104, v104
  v_mul_f32 v105, v173, v41
  v_add_f32 v174, 1.0, v174
  v_mfma_f32_32x32x16_bf16 v[48:63], a[148:151], a[100:103], v[48:63]
  ds_read_b128 a[144:147], v31 offset:33792
  s_add_u32 m0, s10, 45056
  s_add_u32 s14, s49, 8192
  buffer_load_dwordx4 v2, s[24:27], s14 offen offset:0 lds
  v_mul_f32 v175, v175, v43
  v_mul_f32 v176, v44, v44
  v_add_f32 v181, v181, v105
  v_rcp_f32 v174, v174
  v_mfma_f32_32x32x16_bf16 v[48:63], a[152:155], a[104:107], v[48:63]
  ds_read_b128 a[148:151], v31 offset:34816
  v_exp_f32 v175, v175
  v_fma_f32 v176, v176, v22, v20
  v_fmac_f32 v183, v105, v105
  v_mul_f32 v106, v174, v42
  s_waitcnt lgkmcnt(4)
  v_mfma_f32_32x32x16_bf16 v[48:63], a[156:159], a[108:111], v[48:63]
  ds_read_b128 a[152:155], v31 offset:35840
  buffer_load_dwordx4 a[192:195], v2, s[60:63], s40 offen offset:2048
  v_add_f32 v175, 1.0, v175
  v_mul_f32 v176, v176, v44
  v_mul_f32 v177, v45, v45
  v_add_f32 v180, v180, v106
  v_rcp_f32 v175, v175
  v_mfma_f32_32x32x16_bf16 v[48:63], a[160:163], a[112:115], v[48:63]
  ds_read_b128 a[156:159], v17 offset:3072
  v_exp_f32 v176, v176
  v_fma_f32 v177, v177, v22, v20
  v_fmac_f32 v182, v106, v106
  v_mfma_f32_32x32x16_bf16 v[48:63], a[164:167], a[116:119], v[48:63]
  s_waitcnt vmcnt(16)
  s_barrier
  ds_read_b128 a[160:163], v2 offset:0
  v_mul_f32 v107, v175, v43
  v_add_f32 v176, 1.0, v176
  v_mul_f32 v177, v177, v45
  v_mul_f32 v178, v46, v46
  v_add_f32 v181, v181, v107
  v_mfma_f32_32x32x16_bf16 v[48:63], a[232:235], a[120:123], v[48:63]
  ds_read_b128 a[164:167], v2 offset:1024
  v_rcp_f32 v176, v176
  v_exp_f32 v177, v177
  v_fma_f32 v178, v178, v22, v20
  s_waitcnt lgkmcnt(4)
  v_mfma_f32_32x32x16_bf16 v[48:63], a[236:239], a[124:127], v[48:63]
  ds_read_b128 a[232:235], v2 offset:2048
  buffer_load_dwordx4 a[196:199], v2, s[60:63], s40 offen offset:3072
  v_fmac_f32 v183, v107, v107
  v_mul_f32 v108, v176, v44
  v_add_f32 v177, 1.0, v177
  v_mul_f32 v178, v178, v46
  v_mul_f32 v179, v47, v47
  v_mfma_f32_32x32x16_bf16 v[48:63], a[240:243], a[128:131], v[48:63]
  ds_read_b128 a[236:239], v2 offset:3072
  v_add_f32 v180, v180, v108
  v_rcp_f32 v177, v177
  v_exp_f32 v178, v178
  v_mfma_f32_32x32x16_bf16 v[48:63], a[144:147], a[132:135], v[48:63]
  ds_read_b128 a[240:243], v2 offset:4096
  v_fma_f32 v179, v179, v22, v20
  v_fmac_f32 v182, v108, v108
  v_mul_f32 v109, v177, v45
  v_add_f32 v178, 1.0, v178
  v_mul_f32 v179, v179, v47
  v_mfma_f32_32x32x16_bf16 v[48:63], a[148:151], a[136:139], v[48:63]
  ds_read_b128 a[144:147], v2 offset:5120
  v_add_f32 v181, v181, v109
  v_rcp_f32 v178, v178
  v_exp_f32 v179, v179
  s_waitcnt lgkmcnt(4)
  v_mfma_f32_32x32x16_bf16 v[48:63], a[152:155], a[140:143], v[48:63]
  ds_read_b128 a[148:151], v2 offset:6144
  v_fmac_f32 v183, v109, v109
  v_mul_f32 v110, v178, v46
  v_add_f32 v179, 1.0, v179
  v_add_f32 v180, v180, v110
  v_rcp_f32 v179, v179
  v_mfma_f32_32x32x16_bf16 v[48:63], a[156:159], v[144:147], v[48:63]
  ds_read_b128 a[152:155], v2 offset:7168
  v_fmac_f32 v182, v110, v110
  v_mul_f32 v111, v179, v47
  v_add_f32 v181, v181, v111
  v_fmac_f32 v183, v111, v111
  s_cmp_ge_u32 s2, 16
  s_cbranch_scc1 L_pfs_k3_kernel_2
  s_cmp_lg_u32 s3, 0
  s_cbranch_scc1 L_pfs_k3_kernel_2
  s_getpc_b64 s[40:41]
L_pf_k3_kernel_1:
  s_add_u32 s40, s40, L_k4_done-L_pf_k3_kernel_1
  s_addc_u32 s41, s41, 0
  s_and_b32 s41, s41, 0xffff
  s_mov_b32 s42, L_k5_done-L_k4_done
  s_mov_b32 s43, 0x20000
  v_lshlrev_b32 v220, 7, v1
  buffer_load_dword v221, v220, s[40:43], 0 offen
  v_add_u32 v220, 0x2000, v220
  buffer_load_dword v221, v220, s[40:43], 0 offen
  v_add_u32 v220, 0x2000, v220
  buffer_load_dword v221, v220, s[40:43], 0 offen
L_pfs_k3_kernel_2:
  v_mfma_f32_32x32x16_bf16 v[32:47], a[160:163], a[0:3], 0
  ds_read_b128 a[156:159], v2 offset:8192
  v_mfma_f32_32x32x16_bf16 v[32:47], a[164:167], a[4:7], v[32:47]
  ds_read_b128 a[160:163], v2 offset:9216
  s_add_u32 m0, s10, 73728
  s_nop 0
  buffer_load_dwordx4 v2, s[24:27], s50 offen offset:0 lds
  s_waitcnt lgkmcnt(4)
  v_mfma_f32_32x32x16_bf16 v[32:47], a[232:235], a[8:11], v[32:47]
  ds_read_b128 a[164:167], v2 offset:10240
  v_mul_f32 v164, v48, v48
  v_fma_f32 v164, v164, v22, v20
  v_mul_f32 v164, v164, v48
  v_mul_f32 v165, v49, v49
  v_exp_f32 v164, v164
  v_mfma_f32_32x32x16_bf16 v[32:47], a[236:239], a[12:15], v[32:47]
  ds_read_b128 a[232:235], v2 offset:11264
  s_add_u32 s40, s58, 8192
  buffer_load_dwordx4 a[200:203], v2, s[60:63], s40 offen offset:0
  v_fma_f32 v165, v165, v22, v20
  v_add_f32 v164, 1.0, v164
  v_mul_f32 v165, v165, v49
  v_mul_f32 v166, v50, v50
  v_rcp_f32 v164, v164
  v_mfma_f32_32x32x16_bf16 v[32:47], a[240:243], a[16:19], v[32:47]
  ds_read_b128 a[236:239], v2 offset:12288
  buffer_load_dwordx4 v2, s[24:27], s50 offen offset:1024 lds
  v_exp_f32 v165, v165
  v_fma_f32 v166, v166, v22, v20
  v_mul_f32 v112, v164, v48
  v_mfma_f32_32x32x16_bf16 v[32:47], a[144:147], a[20:23], v[32:47]
  ds_read_b128 a[240:243], v2 offset:13312
  v_add_f32 v165, 1.0, v165
  v_mul_f32 v166, v166, v50
  v_mul_f32 v167, v51, v51
  v_add_f32 v180, v180, v112
  v_rcp_f32 v165, v165
  s_waitcnt lgkmcnt(4)
  v_mfma_f32_32x32x16_bf16 v[32:47], a[148:151], a[24:27], v[32:47]
  ds_read_b128 a[144:147], v2 offset:14336
  v_exp_f32 v166, v166
  v_fma_f32 v167, v167, v22, v20
  v_fmac_f32 v182, v112, v112
  v_mfma_f32_32x32x16_bf16 v[32:47], a[152:155], a[28:31], v[32:47]
  ds_read_b128 a[148:151], v2 offset:15360
  buffer_load_dwordx4 v2, s[24:27], s50 offen offset:2048 lds
  buffer_load_dwordx4 a[204:207], v2, s[60:63], s40 offen offset:1024
  v_mul_f32 v113, v165, v49
  v_add_f32 v166, 1.0, v166
  v_mul_f32 v167, v167, v51
  v_mul_f32 v168, v52, v52
  v_add_f32 v181, v181, v113
  v_mfma_f32_32x32x16_bf16 v[32:47], a[156:159], a[32:35], v[32:47]
  ds_read_b128 a[152:155], v2 offset:16384
  v_rcp_f32 v166, v166
  v_exp_f32 v167, v167
  v_fma_f32 v168, v168, v22, v20
  v_mfma_f32_32x32x16_bf16 v[32:47], a[160:163], a[36:39], v[32:47]
  ds_read_b128 a[156:159], v2 offset:17408
  v_fmac_f32 v183, v113, v113
  v_mul_f32 v114, v166, v50
  v_add_f32 v167, 1.0, v167
  v_mul_f32 v168, v168, v52
  v_mul_f32 v169, v53, v53
  s_waitcnt lgkmcnt(4)
  v_mfma_f32_32x32x16_bf16 v[32:47], a[164:167], a[40:43], v[32:47]
  ds_read_b128 a[160:163], v2 offset:18432
  buffer_load_dwordx4 v2, s[24:27], s50 offen offset:3072 lds
  v_add_f32 v180, v180, v114
  v_rcp_f32 v167, v167
  v_exp_f32 v168, v168
  v_mfma_f32_32x32x16_bf16 v[32:47], a[232:235], a[44:47], v[32:47]
  ds_read_b128 a[164:167], v2 offset:19456
  buffer_load_dwordx4 a[208:211], v2, s[60:63], s40 offen offset:2048
  v_fma_f32 v169, v169, v22, v20
  v_fmac_f32 v182, v114, v114
  v_mul_f32 v115, v167, v51
  v_add_f32 v168, 1.0, v168
  v_mul_f32 v169, v169, v53
  v_mfma_f32_32x32x16_bf16 v[32:47], a[236:239], a[48:51], v[32:47]
  ds_read_b128 a[232:235], v2 offset:20480
  v_mul_f32 v170, v54, v54
  v_add_f32 v181, v181, v115
  v_rcp_f32 v168, v168
  v_exp_f32 v169, v169
  v_mfma_f32_32x32x16_bf16 v[32:47], a[240:243], a[52:55], v[32:47]
  ds_read_b128 a[236:239], v2 offset:21504
  s_add_u32 m0, s10, 77824
  s_add_u32 s14, s50, 4096
  buffer_load_dwordx4 v2, s[24:27], s14 offen offset:0 lds
  v_fma_f32 v170, v170, v22, v20
  v_fmac_f32 v183, v115, v115
  v_mul_f32 v116, v168, v52
  v_add_f32 v169, 1.0, v169
  s_waitcnt lgkmcnt(4)
  v_mfma_f32_32x32x16_bf16 v[32:47], a[144:147], a[56:59], v[32:47]
  ds_read_b128 a[240:243], v2 offset:22528
  v_mul_f32 v170, v170, v54
  v_mul_f32 v171, v55, v55
  v_add_f32 v180, v180, v116
  v_rcp_f32 v169, v169
  v_mfma_f32_32x32x16_bf16 v[32:47], a[148:151], a[60:63], v[32:47]
  ds_read_b128 a[144:147], v2 offset:23552
  buffer_load_dwordx4 a[212:215], v2, s[60:63], s40 offen offset:3072
  v_exp_f32 v170, v170
  v_fma_f32 v171, v171, v22, v20
  v_fmac_f32 v182, v116, v116
  v_mul_f32 v117, v169, v53
  v_mfma_f32_32x32x16_bf16 v[32:47], a[152:155], a[64:67], v[32:47]
  ds_read_b128 a[148:151], v2 offset:24576
  buffer_load_dwordx4 v2, s[24:27], s14 offen offset:1024 lds
  v_add_f32 v170, 1.0, v170
  v_mul_f32 v171, v171, v55
  v_add_f32 v181, v181, v117
  v_rcp_f32 v170, v170
  v_mfma_f32_32x32x16_bf16 v[32:47], a[156:159], a[68:71], v[32:47]
  ds_read_b128 a[152:155], v2 offset:25600
  v_exp_f32 v171, v171
  v_fmac_f32 v183, v117, v117
  v_mul_f32 v118, v170, v54
  v_add_f32 v171, 1.0, v171
  s_waitcnt lgkmcnt(4)
  v_mfma_f32_32x32x16_bf16 v[32:47], a[160:163], a[72:75], v[32:47]
  ds_read_b128 a[156:159], v2 offset:26624
  v_add_f32 v180, v180, v118
  v_rcp_f32 v171, v171
  v_fmac_f32 v182, v118, v118
  v_mul_f32 v119, v171, v55
  v_mfma_f32_32x32x16_bf16 v[32:47], a[164:167], a[76:79], v[32:47]
  ds_read_b128 a[160:163], v2 offset:27648
  buffer_load_dwordx4 v2, s[24:27], s14 offen offset:2048 lds
  s_add_u32 s40, s58, 12288
  buffer_load_dwordx4 a[216:219], v2, s[60:63], s40 offen offset:0
  v_add_f32 v181, v181, v119
  v_fmac_f32 v183, v119, v119
  v_mul_f32 v172, v56, v56
  v_fma_f32 v172, v172, v22, v20
  v_mul_f32 v172, v172, v56
  v_mfma_f32_32x32x16_bf16 v[32:47], a[232:235], a[80:83], v[32:47]
  ds_read_b128 a[164:167], v2 offset:28672
  v_mul_f32 v173, v57, v57
  v_exp_f32 v172, v172
  v_fma_f32 v173, v173, v22, v20
  v_add_f32 v172, 1.0, v172
  v_mfma_f32_32x32x16_bf16 v[32:47], a[236:239], a[84:87], v[32:47]
  ds_read_b128 a[232:235], v2 offset:29696
  v_mul_f32 v173, v173, v57
  v_mul_f32 v174, v58, v58
  v_rcp_f32 v172, v172
  v_exp_f32 v173, v173
  s_waitcnt lgkmcnt(4)
  v_mfma_f32_32x32x16_bf16 v[32:47], a[240:243], a[88:91], v[32:47]
  ds_read_b128 a[236:239], v2 offset:30720
  buffer_load_dwordx4 v2, s[24:27], s14 offen offset:3072 lds
  v_fma_f32 v174, v174, v22, v20
  v_mul_f32 v120, v172, v56
  v_add_f32 v173, 1.0, v173
  v_mul_f32 v174, v174, v58
  v_mfma_f32_32x32x16_bf16 v[32:47], a[144:147], a[92:95], v[32:47]
  ds_read_b128 a[240:243], v2 offset:31744
  buffer_load_dwordx4 a[220:223], v2, s[60:63], s40 offen offset:1024
  v_mul_f32 v175, v59, v59
  v_add_f32 v180, v180, v120
  v_rcp_f32 v173, v173
  v_exp_f32 v174, v174
  v_mfma_f32_32x32x16_bf16 v[32:47], a[148:151], a[96:99], v[32:47]
  ds_read_b128 a[144:147], v2 offset:32768
  v_fma_f32 v175, v175, v22, v20
  v_fmac_f32 v182, v120, v120
  v_mul_f32 v121, v173, v57
  v_add_f32 v174, 1.0, v174
  v_mfma_f32_32x32x16_bf16 v[32:47], a[152:155], a[100:103], v[32:47]
  ds_read_b128 a[148:151], v2 offset:33792
  s_add_u32 m0, s10, 81920
  s_add_u32 s14, s50, 8192
  buffer_load_dwordx4 v2, s[24:27], s14 offen offset:0 lds
  v_mul_f32 v175, v175, v59
  v_mul_f32 v176, v60, v60
  v_add_f32 v181, v181, v121
  v_rcp_f32 v174, v174
  s_waitcnt lgkmcnt(4)
  v_mfma_f32_32x32x16_bf16 v[32:47], a[156:159], a[104:107], v[32:47]
  ds_read_b128 a[152:155], v2 offset:34816
  v_exp_f32 v175, v175
  v_fma_f32 v176, v176, v22, v20
  v_fmac_f32 v183, v121, v121
  v_mul_f32 v122, v174, v58
  v_mfma_f32_32x32x16_bf16 v[32:47], a[160:163], a[108:111], v[32:47]
  ds_read_b128 a[156:159], v2 offset:35840
  buffer_load_dwordx4 a[224:227], v2, s[60:63], s40 offen offset:2048
  v_add_f32 v175, 1.0, v175
  v_mul_f32 v176, v176, v60
  v_mul_f32 v177, v61, v61
  v_add_f32 v180, v180, v122
  v_rcp_f32 v175, v175
  v_mfma_f32_32x32x16_bf16 v[32:47], a[164:167], a[112:115], v[32:47]
  ds_read_b128 a[160:163], v17 offset:4096
  v_exp_f32 v176, v176
  v_fma_f32 v177, v177, v22, v20
  v_fmac_f32 v182, v122, v122
  v_mfma_f32_32x32x16_bf16 v[32:47], a[232:235], a[116:119], v[32:47]
  s_waitcnt vmcnt(18)
  s_barrier
  ds_read_b128 a[164:167], v3 offset:0
  v_mul_f32 v123, v175, v59
  v_add_f32 v176, 1.0, v176
  v_mul_f32 v177, v177, v61
  v_mul_f32 v178, v62, v62
  v_add_f32 v181, v181, v123
  s_waitcnt lgkmcnt(4)
  v_mfma_f32_32x32x16_bf16 v[32:47], a[236:239], a[120:123], v[32:47]
  ds_read_b128 a[232:235], v3 offset:1024
  v_rcp_f32 v176, v176
  v_exp_f32 v177, v177
  v_fma_f32 v178, v178, v22, v20
  v_mfma_f32_32x32x16_bf16 v[32:47], a[240:243], a[124:127], v[32:47]
  ds_read_b128 a[236:239], v3 offset:2048
  buffer_load_dwordx4 a[228:231], v2, s[60:63], s40 offen offset:3072
  v_fmac_f32 v183, v123, v123
  v_mul_f32 v124, v176, v60
  v_add_f32 v177, 1.0, v177
  v_mul_f32 v178, v178, v62
  v_mul_f32 v179, v63, v63
  v_mfma_f32_32x32x16_bf16 v[32:47], a[144:147], a[128:131], v[32:47]
  ds_read_b128 a[240:243], v3 offset:3072
  v_add_f32 v180, v180, v124
  v_rcp_f32 v177, v177
  v_exp_f32 v178, v178
  v_mfma_f32_32x32x16_bf16 v[32:47], a[148:151], a[132:135], v[32:47]
  ds_read_b128 a[144:147], v3 offset:4096
  v_fma_f32 v179, v179, v22, v20
  v_fmac_f32 v182, v124, v124
  v_mul_f32 v125, v177, v61
  v_add_f32 v178, 1.0, v178
  v_mul_f32 v179, v179, v63
  s_waitcnt lgkmcnt(4)
  v_mfma_f32_32x32x16_bf16 v[32:47], a[152:155], a[136:139], v[32:47]
  ds_read_b128 a[148:151], v3 offset:5120
  v_add_f32 v181, v181, v125
  v_rcp_f32 v178, v178
  v_exp_f32 v179, v179
  v_mfma_f32_32x32x16_bf16 v[32:47], a[156:159], a[140:143], v[32:47]
  ds_read_b128 a[152:155], v3 offset:6144
  v_fmac_f32 v183, v125, v125
  v_mul_f32 v126, v178, v62
  v_add_f32 v179, 1.0, v179
  v_add_f32 v180, v180, v126
  v_rcp_f32 v179, v179
  v_mfma_f32_32x32x16_bf16 v[32:47], a[160:163], v[144:147], v[32:47]
  ds_read_b128 a[156:159], v3 offset:7168
  v_fmac_f32 v182, v126, v126
  v_mul_f32 v127, v179, v63
  v_add_f32 v181, v181, v127
  v_fmac_f32 v183, v127, v127
  v_mfma_f32_32x32x16_bf16 v[48:63], a[164:167], a[0:3], 0
  ds_read_b128 a[160:163], v3 offset:8192
  s_waitcnt lgkmcnt(4)
  v_mfma_f32_32x32x16_bf16 v[48:63], a[232:235], a[4:7], v[48:63]
  ds_read_b128 a[164:167], v3 offset:9216
  s_add_u32 m0, s10, 110592
  s_nop 0
  buffer_load_dwordx4 v2, s[24:27], s51 offen offset:0 lds
  v_mfma_f32_32x32x16_bf16 v[48:63], a[236:239], a[8:11], v[48:63]
  ds_read_b128 a[232:235], v3 offset:10240
  v_mov_b32 v184, v180
  v_mov_b32 v185, v181
  v_mov_b32 v186, v182
  v_mov_b32 v187, v183
  v_mul_f32 v164, v32, v32
  v_fma_f32 v164, v164, v22, v20
  v_mfma_f32_32x32x16_bf16 v[48:63], a[240:243], a[12:15], v[48:63]
  ds_read_b128 a[236:239], v3 offset:11264
  v_mul_f32 v164, v164, v32
  v_mul_f32 v165, v33, v33
  v_exp_f32 v164, v164
  v_fma_f32 v165, v165, v22, v20
  v_mfma_f32_32x32x16_bf16 v[48:63], a[144:147], a[16:19], v[48:63]
  ds_read_b128 a[240:243], v3 offset:12288
  buffer_load_dwordx4 v2, s[24:27], s51 offen offset:1024 lds
  v_add_f32 v164, 1.0, v164
  v_mul_f32 v165, v165, v33
  v_mul_f32 v166, v34, v34
  v_rcp_f32 v164, v164
  v_exp_f32 v165, v165
  s_waitcnt lgkmcnt(4)
  v_mfma_f32_32x32x16_bf16 v[48:63], a[148:151], a[20:23], v[48:63]
  ds_read_b128 a[144:147], v3 offset:13312
  v_fma_f32 v166, v166, v22, v20
  v_mul_f32 v128, v164, v32
  v_add_f32 v165, 1.0, v165
  v_mul_f32 v166, v166, v34
  v_mfma_f32_32x32x16_bf16 v[48:63], a[152:155], a[24:27], v[48:63]
  ds_read_b128 a[148:151], v3 offset:14336
  v_mul_f32 v167, v35, v35
  v_add_f32 v180, v180, v128
  v_rcp_f32 v165, v165
  v_exp_f32 v166, v166
  v_mfma_f32_32x32x16_bf16 v[48:63], a[156:159], a[28:31], v[48:63]
  ds_read_b128 a[152:155], v3 offset:15360
  buffer_load_dwordx4 v2, s[24:27], s51 offen offset:2048 lds
  v_fma_f32 v167, v167, v22, v20
  v_fmac_f32 v182, v128, v128
  v_mul_f32 v129, v165, v33
  v_add_f32 v166, 1.0, v166
  v_mul_f32 v167, v167, v35
  v_mfma_f32_32x32x16_bf16 v[48:63], a[160:163], a[32:35], v[48:63]
  ds_read_b128 a[156:159], v3 offset:16384
  v_mul_f32 v168, v36, v36
  v_add_f32 v181, v181, v129
  v_rcp_f32 v166, v166
  v_exp_f32 v167, v167
  s_waitcnt lgkmcnt(4)
  v_mfma_f32_32x32x16_bf16 v[48:63], a[164:167], a[36:39], v[48:63]
  ds_read_b128 a[160:163], v3 offset:17408
  v_fma_f32 v168, v168, v22, v20
  v_fmac_f32 v183, v129, v129
  v_mul_f32 v130, v166, v34
  v_add_f32 v167, 1.0, v167
  v_mul_f32 v168, v168, v36
  v_mfma_f32_32x32x16_bf16 v[48:63], a[232:235], a[40:43], v[48:63]
  ds_read_b128 a[164:167], v3 offset:18432
  buffer_load_dwordx4 v2, s[24:27], s51 offen offset:3072 lds
  v_mul_f32 v169, v37, v37
  v_cvt_pk_bf16_f32 v148, v128, v129
  v_add_f32 v180, v180, v130
  v_rcp_f32 v167, v167
  v_mfma_f32_32x32x16_bf16 v[48:63], a[236:239], a[44:47], v[48:63]
  ds_read_b128 a[232:235], v3 offset:19456
  v_exp_f32 v168, v168
  v_fma_f32 v169, v169, v22, v20
  v_fmac_f32 v182, v130, v130
  v_mul_f32 v131, v167, v35
  v_add_f32 v168, 1.0, v168
  v_mfma_f32_32x32x16_bf16 v[48:63], a[240:243], a[48:51], v[48:63]
  ds_read_b128 a[236:239], v3 offset:20480
  v_mul_f32 v169, v169, v37
  v_mul_f32 v170, v38, v38
  v_add_f32 v181, v181, v131
  v_rcp_f32 v168, v168
  s_waitcnt lgkmcnt(4)
  v_mfma_f32_32x32x16_bf16 v[48:63], a[144:147], a[52:55], v[48:63]
  ds_read_b128 a[240:243], v3 offset:21504
  s_add_u32 m0, s10, 114688
  s_add_u32 s14, s51, 4096
  buffer_load_dwordx4 v2, s[24:27], s14 offen offset:0 lds
  v_exp_f32 v169, v169
  v_fma_f32 v170, v170, v22, v20
  v_fmac_f32 v183, v131, v131
  v_mul_f32 v132, v168, v36
  v_add_f32 v169, 1.0, v169
  v_mfma_f32_32x32x16_bf16 v[48:63], a[148:151], a[56:59], v[48:63]
  ds_read_b128 a[144:147], v3 offset:22528
  v_mul_f32 v170, v170, v38
  v_mul_f32 v171, v39, v39
  v_cvt_pk_bf16_f32 v149, v130, v131
  v_add_f32 v180, v180, v132
  v_rcp_f32 v169, v169
  v_mfma_f32_32x32x16_bf16 v[48:63], a[152:155], a[60:63], v[48:63]
  ds_read_b128 a[148:151], v3 offset:23552
  v_exp_f32 v170, v170
  v_fma_f32 v171, v171, v22, v20
  v_fmac_f32 v182, v132, v132
  v_mfma_f32_32x32x16_bf16 v[48:63], a[156:159], a[64:67], v[48:63]
  ds_read_b128 a[152:155], v3 offset:24576
  buffer_load_dwordx4 v2, s[24:27], s14 offen offset:1024 lds
  v_mul_f32 v133, v169, v37
  v_add_f32 v170, 1.0, v170
  v_mul_f32 v171, v171, v39
  v_add_f32 v181, v181, v133
  v_rcp_f32 v170, v170
  s_waitcnt lgkmcnt(4)
  v_mfma_f32_32x32x16_bf16 v[48:63], a[160:163], a[68:71], v[48:63]
  ds_read_b128 a[156:159], v3 offset:25600
  v_exp_f32 v171, v171
  v_fmac_f32 v183, v133, v133
  v_mul_f32 v134, v170, v38
  v_add_f32 v171, 1.0, v171
  v_mfma_f32_32x32x16_bf16 v[48:63], a[164:167], a[72:75], v[48:63]
  ds_read_b128 a[160:163], v3 offset:26624
  v_cvt_pk_bf16_f32 v150, v132, v133
  v_add_f32 v180, v180, v134
  v_rcp_f32 v171, v171
  v_fmac_f32 v182, v134, v134
  v_mul_f32 v135, v171, v39
  v_mfma_f32_32x32x16_bf16 v[48:63], a[232:235], a[76:79], v[48:63]
  ds_read_b128 a[164:167], v3 offset:27648
  buffer_load_dwordx4 v2, s[24:27], s14 offen offset:2048 lds
  v_add_f32 v181, v181, v135
  v_fmac_f32 v183, v135, v135
  v_cvt_pk_bf16_f32 v151, v134, v135
  buffer_store_dwordx4 v[148:151], v18, s[32:35], s53 offen offset:0 sc1
  v_mul_f32 v172, v40, v40
  v_mfma_f32_32x32x16_bf16 v[48:63], a[236:239], a[80:83], v[48:63]
  ds_read_b128 a[232:235], v3 offset:28672
  v_fma_f32 v172, v172, v22, v20
  v_mul_f32 v172, v172, v40
  v_mul_f32 v173, v41, v41
  v_exp_f32 v172, v172
  v_fma_f32 v173, v173, v22, v20
  s_waitcnt lgkmcnt(4)
  v_mfma_f32_32x32x16_bf16 v[48:63], a[240:243], a[84:87], v[48:63]
  ds_read_b128 a[236:239], v3 offset:29696
  v_add_f32 v172, 1.0, v172
  v_mul_f32 v173, v173, v41
  v_mul_f32 v174, v42, v42
  v_rcp_f32 v172, v172
  v_mfma_f32_32x32x16_bf16 v[48:63], a[144:147], a[88:91], v[48:63]
  ds_read_b128 a[240:243], v3 offset:30720
  buffer_load_dwordx4 v2, s[24:27], s14 offen offset:3072 lds
  v_exp_f32 v173, v173
  v_fma_f32 v174, v174, v22, v20
  v_mul_f32 v136, v172, v40
  v_add_f32 v173, 1.0, v173
  v_mfma_f32_32x32x16_bf16 v[48:63], a[148:151], a[92:95], v[48:63]
  ds_read_b128 a[144:147], v3 offset:31744
  v_mul_f32 v174, v174, v42
  v_mul_f32 v175, v43, v43
  v_add_f32 v180, v180, v136
  v_rcp_f32 v173, v173
  v_exp_f32 v174, v174
  v_mfma_f32_32x32x16_bf16 v[48:63], a[152:155], a[96:99], v[48:63]
  ds_read_b128 a[148:151], v3 offset:32768
  v_fma_f32 v175, v175, v22, v20
  v_fmac_f32 v182, v136, v136
  v_mul_f32 v137, v173, v41
  v_add_f32 v174, 1.0, v174
  s_waitcnt lgkmcnt(4)
  v_mfma_f32_32x32x16_bf16 v[48:63], a[156:159], a[100:103], v[48:63]
  ds_read_b128 a[152:155], v3 offset:33792
  s_add_u32 m0, s10, 118784
  s_add_u32 s14, s51, 8192
  buffer_load_dwordx4 v2, s[24:27], s14 offen offset:0 lds
  v_mul_f32 v175, v175, v43
  v_mul_f32 v176, v44, v44
  v_add_f32 v181, v181, v137
  v_rcp_f32 v174, v174
  v_exp_f32 v175, v175
  v_mfma_f32_32x32x16_bf16 v[48:63], a[160:163], a[104:107], v[48:63]
  ds_read_b128 a[156:159], v3 offset:34816
  v_fma_f32 v176, v176, v22, v20
  v_fmac_f32 v183, v137, v137
  v_mul_f32 v138, v174, v42
  v_add_f32 v175, 1.0, v175
  v_mfma_f32_32x32x16_bf16 v[48:63], a[164:167], a[108:111], v[48:63]
  ds_read_b128 a[160:163], v3 offset:35840
  v_mul_f32 v176, v176, v44
  v_mul_f32 v177, v45, v45
  v_cvt_pk_bf16_f32 v152, v136, v137
  v_add_f32 v180, v180, v138
  v_rcp_f32 v175, v175
  v_mfma_f32_32x32x16_bf16 v[48:63], a[232:235], a[112:115], v[48:63]
  ds_read_b128 a[164:167], v17 offset:5120
  v_exp_f32 v176, v176
  v_fma_f32 v177, v177, v22, v20
  v_fmac_f32 v182, v138, v138
  v_mul_f32 v139, v175, v43
  s_waitcnt lgkmcnt(4)
  v_mfma_f32_32x32x16_bf16 v[48:63], a[236:239], a[116:119], v[48:63]
  s_waitcnt vmcnt(12)
  s_barrier
  ds_read_b128 a[232:235], v4 offset:0
  v_add_f32 v176, 1.0, v176
  v_mul_f32 v177, v177, v45
  v_mul_f32 v178, v46, v46
  v_add_f32 v181, v181, v139
  v_rcp_f32 v176, v176
  v_mfma_f32_32x32x16_bf16 v[48:63], a[240:243], a[120:123], v[48:63]
  ds_read_b128 a[236:239], v4 offset:1024
  v_exp_f32 v177, v177
  v_fma_f32 v178, v178, v22, v20
  v_fmac_f32 v183, v139, v139
  v_mul_f32 v140, v176, v44
  v_mfma_f32_32x32x16_bf16 v[48:63], a[144:147], a[124:127], v[48:63]
  ds_read_b128 a[240:243], v4 offset:2048
  v_add_f32 v177, 1.0, v177
  v_mul_f32 v178, v178, v46
  v_mul_f32 v179, v47, v47
  v_cvt_pk_bf16_f32 v153, v138, v139
  v_add_f32 v180, v180, v140
  v_mfma_f32_32x32x16_bf16 v[48:63], a[148:151], a[128:131], v[48:63]
  ds_read_b128 a[144:147], v4 offset:3072
  v_rcp_f32 v177, v177
  v_exp_f32 v178, v178
  v_fma_f32 v179, v179, v22, v20
  v_fmac_f32 v182, v140, v140
  s_waitcnt lgkmcnt(4)
  v_mfma_f32_32x32x16_bf16 v[48:63], a[152:155], a[132:135], v[48:63]
  ds_read_b128 a[148:151], v4 offset:4096
  v_mul_f32 v141, v177, v45
  v_add_f32 v178, 1.0, v178
  v_mul_f32 v179, v179, v47
  v_add_f32 v181, v181, v141
  v_rcp_f32 v178, v178
  v_mfma_f32_32x32x16_bf16 v[48:63], a[156:159], a[136:139], v[48:63]
  ds_read_b128 a[152:155], v4 offset:5120
  v_exp_f32 v179, v179
  v_fmac_f32 v183, v141, v141
  v_mul_f32 v142, v178, v46
  v_add_f32 v179, 1.0, v179
  v_mfma_f32_32x32x16_bf16 v[48:63], a[160:163], a[140:143], v[48:63]
  ds_read_b128 a[156:159], v4 offset:6144
  v_cvt_pk_bf16_f32 v154, v140, v141
  v_add_f32 v180, v180, v142
  v_rcp_f32 v179, v179
  v_fmac_f32 v182, v142, v142
  v_mfma_f32_32x32x16_bf16 v[48:63], a[164:167], v[144:147], v[48:63]
  ds_read_b128 a[160:163], v4 offset:7168
  v_mul_f32 v143, v179, v47
  v_add_f32 v181, v181, v143
  v_fmac_f32 v183, v143, v143
  v_cvt_pk_bf16_f32 v155, v142, v143
  buffer_store_dwordx4 v[152:155], v18, s[32:35], s53 offen offset:512 sc1
  s_cmp_eq_u32 s6, 1
  s_cbranch_scc1 L_k4_odd
  v_mov_b32 v180, v184
  v_mov_b32 v181, v185
  v_mov_b32 v182, v186
  v_mov_b32 v183, v187
L_k4_odd:
  v_add_f32 v180, v180, v181
  v_add_f32 v181, v182, v183
  v_mov_b32 v182, v180
  v_mov_b32 v183, v181
  s_lshl_b32 s12, s5, 10
  s_add_u32 s12, s12, s15
  v_permlane32_swap_b32 v180, v182
  v_permlane32_swap_b32 v181, v183
  v_add_f32 v180, v180, v182
  v_add_f32 v181, v181, v183
  buffer_store_dwordx2 v[180:181], v27, s[36:39], s12 offen sc1
  s_waitcnt lgkmcnt(4)
  v_mfma_f32_32x32x16_bf16 v[32:47], a[232:235], a[0:3], 0
  ds_read_b128 a[164:167], v4 offset:8192
  v_mfma_f32_32x32x16_bf16 v[32:47], a[236:239], a[4:7], v[32:47]
  ds_read_b128 a[232:235], v4 offset:9216
  s_add_u32 m0, s10, 0
  s_nop 0
  buffer_load_dwordx4 v2, s[24:27], s52 offen offset:0 lds
  v_mfma_f32_32x32x16_bf16 v[32:47], a[240:243], a[8:11], v[32:47]
  ds_read_b128 a[236:239], v4 offset:10240
  v_mul_f32 v164, v48, v48
  v_fma_f32 v164, v164, v22, v20
  v_mul_f32 v164, v164, v48
  v_mul_f32 v165, v49, v49
  v_exp_f32 v164, v164
  v_mfma_f32_32x32x16_bf16 v[32:47], a[144:147], a[12:15], v[32:47]
  ds_read_b128 a[240:243], v4 offset:11264
  v_fma_f32 v165, v165, v22, v20
  v_add_f32 v164, 1.0, v164
  v_mul_f32 v165, v165, v49
  s_waitcnt lgkmcnt(4)
  v_mfma_f32_32x32x16_bf16 v[32:47], a[148:151], a[16:19], v[32:47]
  ds_read_b128 a[144:147], v4 offset:12288
  buffer_load_dwordx4 v2, s[24:27], s52 offen offset:1024 lds
  v_mul_f32 v166, v50, v50
  v_rcp_f32 v164, v164
  v_exp_f32 v165, v165
  v_mfma_f32_32x32x16_bf16 v[32:47], a[152:155], a[20:23], v[32:47]
  ds_read_b128 a[148:151], v4 offset:13312
  v_fma_f32 v166, v166, v22, v20
  v_mul_f32 v164, v164, v48
  v_add_f32 v165, 1.0, v165
  v_mul_f32 v166, v166, v50
  v_mfma_f32_32x32x16_bf16 v[32:47], a[156:159], a[24:27], v[32:47]
  ds_read_b128 a[152:155], v4 offset:14336
  v_mul_f32 v167, v51, v51
  v_rcp_f32 v165, v165
  v_exp_f32 v166, v166
  v_mfma_f32_32x32x16_bf16 v[32:47], a[160:163], a[28:31], v[32:47]
  ds_read_b128 a[156:159], v4 offset:15360
  buffer_load_dwordx4 v2, s[24:27], s52 offen offset:2048 lds
  v_fma_f32 v167, v167, v22, v20
  v_mul_f32 v165, v165, v49
  v_add_f32 v166, 1.0, v166
  v_mul_f32 v167, v167, v51
  s_waitcnt lgkmcnt(4)
  v_mfma_f32_32x32x16_bf16 v[32:47], a[164:167], a[32:35], v[32:47]
  ds_read_b128 a[160:163], v4 offset:16384
  v_mul_f32 v168, v52, v52
  v_cvt_pk_bf16_f32 v224, v164, v165
  v_rcp_f32 v166, v166
  v_mfma_f32_32x32x16_bf16 v[32:47], a[232:235], a[36:39], v[32:47]
  ds_read_b128 a[164:167], v4 offset:17408
  v_exp_f32 v167, v167
  v_fma_f32 v168, v168, v22, v20
  v_mul_f32 v166, v166, v50
  v_mfma_f32_32x32x16_bf16 v[32:47], a[236:239], a[40:43], v[32:47]
  ds_read_b128 a[232:235], v4 offset:18432
  buffer_load_dwordx4 v2, s[24:27], s52 offen offset:3072 lds
  v_add_f32 v167, 1.0, v167
  v_mul_f32 v168, v168, v52
  v_mul_f32 v169, v53, v53
  v_rcp_f32 v167, v167
  v_mfma_f32_32x32x16_bf16 v[32:47], a[240:243], a[44:47], v[32:47]
  ds_read_b128 a[236:239], v4 offset:19456
  v_exp_f32 v168, v168
  v_fma_f32 v169, v169, v22, v20
  v_mul_f32 v167, v167, v51
  s_waitcnt lgkmcnt(4)
  v_mfma_f32_32x32x16_bf16 v[32:47], a[144:147], a[48:51], v[32:47]
  ds_read_b128 a[240:243], v4 offset:20480
  v_add_f32 v168, 1.0, v168
  v_mul_f32 v169, v169, v53
  v_mul_f32 v170, v54, v54
  v_cvt_pk_bf16_f32 v225, v166, v167
  v_mfma_f32_32x32x16_bf16 v[32:47], a[148:151], a[52:55], v[32:47]
  ds_read_b128 a[144:147], v4 offset:21504
  s_add_u32 m0, s10, 4096
  s_add_u32 s14, s52, 4096
  buffer_load_dwordx4 v2, s[24:27], s14 offen offset:0 lds
  v_rcp_f32 v168, v168
  v_exp_f32 v169, v169
  v_fma_f32 v170, v170, v22, v20
  v_mfma_f32_32x32x16_bf16 v[32:47], a[152:155], a[56:59], v[32:47]
  ds_read_b128 a[148:151], v4 offset:22528
  v_mul_f32 v168, v168, v52
  v_add_f32 v169, 1.0, v169
  v_mul_f32 v170, v170, v54
  v_mul_f32 v171, v55, v55
  v_mfma_f32_32x32x16_bf16 v[32:47], a[156:159], a[60:63], v[32:47]
  ds_read_b128 a[152:155], v4 offset:23552
  v_rcp_f32 v169, v169
  v_exp_f32 v170, v170
  s_waitcnt lgkmcnt(4)
  v_mfma_f32_32x32x16_bf16 v[32:47], a[160:163], a[64:67], v[32:47]
  ds_read_b128 a[156:159], v4 offset:24576
  buffer_load_dwordx4 v2, s[24:27], s14 offen offset:1024 lds
  v_fma_f32 v171, v171, v22, v20
  v_mul_f32 v169, v169, v53
  v_add_f32 v170, 1.0, v170
  v_mul_f32 v171, v171, v55
  v_cvt_pk_bf16_f32 v226, v168, v169
  v_mfma_f32_32x32x16_bf16 v[32:47], a[164:167], a[68:71], v[32:47]
  ds_read_b128 a[160:163], v4 offset:25600
  v_rcp_f32 v170, v170
  v_exp_f32 v171, v171
  v_mfma_f32_32x32x16_bf16 v[32:47], a[232:235], a[72:75], v[32:47]
  ds_read_b128 a[164:167], v4 offset:26624
  v_mul_f32 v170, v170, v54
  v_add_f32 v171, 1.0, v171
  v_rcp_f32 v171, v171
  v_mfma_f32_32x32x16_bf16 v[32:47], a[236:239], a[76:79], v[32:47]
  ds_read_b128 a[232:235], v4 offset:27648
  buffer_load_dwordx4 v2, s[24:27], s14 offen offset:2048 lds
  v_mul_f32 v171, v171, v55
  v_cvt_pk_bf16_f32 v227, v170, v171
  v_mul_f32 v172, v56, v56
  v_fma_f32 v172, v172, v22, v20
  v_mul_f32 v172, v172, v56
  s_waitcnt lgkmcnt(4)
  v_mfma_f32_32x32x16_bf16 v[32:47], a[240:243], a[80:83], v[32:47]
  ds_read_b128 a[236:239], v4 offset:28672
  v_mul_f32 v173, v57, v57
  v_exp_f32 v172, v172
  v_fma_f32 v173, v173, v22, v20
  v_mfma_f32_32x32x16_bf16 v[32:47], a[144:147], a[84:87], v[32:47]
  ds_read_b128 a[240:243], v4 offset:29696
  v_add_f32 v172, 1.0, v172
  v_mul_f32 v173, v173, v57
  v_mul_f32 v174, v58, v58
  v_rcp_f32 v172, v172
  v_mfma_f32_32x32x16_bf16 v[32:47], a[148:151], a[88:91], v[32:47]
  ds_read_b128 a[144:147], v4 offset:30720
  buffer_load_dwordx4 v2, s[24:27], s14 offen offset:3072 lds
  v_exp_f32 v173, v173
  v_fma_f32 v174, v174, v22, v20
  v_mul_f32 v172, v172, v56
  v_mfma_f32_32x32x16_bf16 v[32:47], a[152:155], a[92:95], v[32:47]
  ds_read_b128 a[148:151], v4 offset:31744
  v_add_f32 v173, 1.0, v173
  v_mul_f32 v174, v174, v58
  v_mul_f32 v175, v59, v59
  v_rcp_f32 v173, v173
  s_waitcnt lgkmcnt(4)
  v_mfma_f32_32x32x16_bf16 v[32:47], a[156:159], a[96:99], v[32:47]
  ds_read_b128 a[152:155], v4 offset:32768
  v_exp_f32 v174, v174
  v_fma_f32 v175, v175, v22, v20
  v_mfma_f32_32x32x16_bf16 v[32:47], a[160:163], a[100:103], v[32:47]
  ds_read_b128 a[156:159], v4 offset:33792
  s_add_u32 m0, s10, 8192
  s_add_u32 s14, s52, 8192
  buffer_load_dwordx4 v2, s[24:27], s14 offen offset:0 lds
  v_mul_f32 v173, v173, v57
  v_add_f32 v174, 1.0, v174
  v_mul_f32 v175, v175, v59
  v_mul_f32 v176, v60, v60
  v_cvt_pk_bf16_f32 v228, v172, v173
  v_mfma_f32_32x32x16_bf16 v[32:47], a[164:167], a[104:107], v[32:47]
  ds_read_b128 a[160:163], v4 offset:34816
  v_rcp_f32 v174, v174
  v_exp_f32 v175, v175
  v_mfma_f32_32x32x16_bf16 v[32:47], a[232:235], a[108:111], v[32:47]
  ds_read_b128 a[164:167], v4 offset:35840
  buffer_load_dwordx2 v[204:205], v26, s[36:39], s15 offen offset:0 sc1
  v_fma_f32 v176, v176, v22, v20
  v_mul_f32 v174, v174, v58
  v_add_f32 v175, 1.0, v175
  v_mul_f32 v176, v176, v60
  s_waitcnt lgkmcnt(4)
  v_mfma_f32_32x32x16_bf16 v[32:47], a[236:239], a[112:115], v[32:47]
  ds_read_b128 a[232:235], v17 offset:6144
  buffer_load_dwordx2 v[206:207], v26, s[36:39], s15 offen offset:1024 sc1
  v_mul_f32 v177, v61, v61
  v_rcp_f32 v175, v175
  v_exp_f32 v176, v176
  v_mfma_f32_32x32x16_bf16 v[32:47], a[240:243], a[116:119], v[32:47]
  s_waitcnt vmcnt(13)
  s_barrier
  ds_read_b128 a[236:239], v31 offset:0
  buffer_load_dwordx2 v[208:209], v26, s[36:39], s15 offen offset:2048 sc1
  v_fma_f32 v177, v177, v22, v20
  v_mul_f32 v175, v175, v59
  v_add_f32 v176, 1.0, v176
  v_mul_f32 v177, v177, v61
  v_mfma_f32_32x32x16_bf16 v[32:47], a[144:147], a[120:123], v[32:47]
  ds_read_b128 a[240:243], v31 offset:1024
  buffer_load_dwordx2 v[210:211], v26, s[36:39], s15 offen offset:3072 sc1
  v_mul_f32 v178, v62, v62
  v_cvt_pk_bf16_f32 v229, v174, v175
  v_rcp_f32 v176, v176
  v_mfma_f32_32x32x16_bf16 v[32:47], a[148:151], a[124:127], v[32:47]
  ds_read_b128 a[144:147], v31 offset:2048
  s_add_u32 s12, s15, 4096
  buffer_load_dwordx2 v[212:213], v26, s[36:39], s12 offen offset:0 sc1
  v_exp_f32 v177, v177
  v_fma_f32 v178, v178, v22, v20
  v_mul_f32 v176, v176, v60
  v_add_f32 v177, 1.0, v177
  s_waitcnt lgkmcnt(4)
  v_mfma_f32_32x32x16_bf16 v[32:47], a[152:155], a[128:131], v[32:47]
  ds_read_b128 a[148:151], v31 offset:3072
  buffer_load_dwordx2 v[214:215], v26, s[36:39], s12 offen offset:1024 sc1
  v_mul_f32 v178, v178, v62
  v_mul_f32 v179, v63, v63
  v_rcp_f32 v177, v177
  v_mfma_f32_32x32x16_bf16 v[32:47], a[156:159], a[132:135], v[32:47]
  ds_read_b128 a[152:155], v31 offset:4096
  buffer_load_dwordx2 v[216:217], v26, s[36:39], s12 offen offset:2048 sc1
  v_exp_f32 v178, v178
  v_fma_f32 v179, v179, v22, v20
  v_mul_f32 v177, v177, v61
  v_mfma_f32_32x32x16_bf16 v[32:47], a[160:163], a[136:139], v[32:47]
  ds_read_b128 a[156:159], v31 offset:5120
  buffer_load_dwordx2 v[218:219], v26, s[36:39], s12 offen offset:3072 sc1
  v_add_f32 v178, 1.0, v178
  v_mul_f32 v179, v179, v63
  v_cvt_pk_bf16_f32 v230, v176, v177
  v_rcp_f32 v178, v178
  v_mfma_f32_32x32x16_bf16 v[32:47], a[164:167], a[140:143], v[32:47]
  ds_read_b128 a[160:163], v31 offset:6144
  v_exp_f32 v179, v179
  v_mul_f32 v178, v178, v62
  v_add_f32 v179, 1.0, v179
  s_waitcnt lgkmcnt(4)
  v_mfma_f32_32x32x16_bf16 v[32:47], a[232:235], v[144:147], v[32:47]
  ds_read_b128 a[164:167], v31 offset:7168
  v_rcp_f32 v179, v179
  s_nop 0
  v_mul_f32 v179, v179, v63
  v_cvt_pk_bf16_f32 v231, v178, v179
  v_mfma_f32_32x32x16_bf16 v[48:63], a[236:239], a[0:3], 0
  ds_read_b128 a[232:235], v31 offset:8192
  v_mfma_f32_32x32x16_bf16 v[48:63], a[240:243], a[4:7], v[48:63]
  ds_read_b128 a[236:239], v31 offset:9216
  v_mfma_f32_32x32x16_bf16 v[48:63], a[144:147], a[8:11], v[48:63]
  ds_read_b128 a[240:243], v31 offset:10240
  s_nop 0
  v_mul_f32 v164, v32, v32
  v_fma_f32 v164, v164, v22, v20
  v_mul_f32 v164, v164, v32
  v_mul_f32 v165, v33, v33
  v_exp_f32 v164, v164
  v_fma_f32 v165, v165, v22, v20
  v_add_f32 v164, 1.0, v164
  v_mul_f32 v165, v165, v33
  v_mul_f32 v166, v34, v34
  s_waitcnt lgkmcnt(4)
  v_mfma_f32_32x32x16_bf16 v[48:63], a[148:151], a[12:15], v[48:63]
  ds_read_b128 a[144:147], v31 offset:11264
  v_rcp_f32 v164, v164
  v_exp_f32 v165, v165
  v_fma_f32 v166, v166, v22, v20
  v_mul_f32 v164, v164, v32
  v_add_f32 v165, 1.0, v165
  v_mul_f32 v166, v166, v34
  v_mul_f32 v167, v35, v35
  v_rcp_f32 v165, v165
  v_mfma_f32_32x32x16_bf16 v[48:63], a[152:155], a[16:19], v[48:63]
  ds_read_b128 a[148:151], v31 offset:12288
  v_exp_f32 v166, v166
  v_fma_f32 v167, v167, v22, v20
  v_mul_f32 v165, v165, v33
  v_add_f32 v166, 1.0, v166
  v_mul_f32 v167, v167, v35
  v_mul_f32 v168, v36, v36
  v_cvt_pk_bf16_f32 v232, v164, v165
  v_rcp_f32 v166, v166
  v_mfma_f32_32x32x16_bf16 v[48:63], a[156:159], a[20:23], v[48:63]
  ds_read_b128 a[152:155], v31 offset:13312
  v_exp_f32 v167, v167
  v_fma_f32 v168, v168, v22, v20
  v_mul_f32 v166, v166, v34
  v_add_f32 v167, 1.0, v167
  v_mul_f32 v168, v168, v36
  v_mul_f32 v169, v37, v37
  v_rcp_f32 v167, v167
  v_mfma_f32_32x32x16_bf16 v[48:63], a[160:163], a[24:27], v[48:63]
  ds_read_b128 a[156:159], v31 offset:14336
  v_exp_f32 v168, v168
  v_fma_f32 v169, v169, v22, v20
  v_mul_f32 v167, v167, v35
  v_add_f32 v168, 1.0, v168
  v_mul_f32 v169, v169, v37
  v_mul_f32 v170, v38, v38
  v_cvt_pk_bf16_f32 v233, v166, v167
  v_rcp_f32 v168, v168
  s_waitcnt lgkmcnt(4)
  v_mfma_f32_32x32x16_bf16 v[48:63], a[164:167], a[28:31], v[48:63]
  ds_read_b128 a[160:163], v31 offset:15360
  v_exp_f32 v169, v169
  v_fma_f32 v170, v170, v22, v20
  v_mul_f32 v168, v168, v36
  v_add_f32 v169, 1.0, v169
  v_mul_f32 v170, v170, v38
  v_mul_f32 v171, v39, v39
  v_rcp_f32 v169, v169
  v_mfma_f32_32x32x16_bf16 v[48:63], a[232:235], a[32:35], v[48:63]
  ds_read_b128 a[164:167], v31 offset:16384
  v_exp_f32 v170, v170
  v_fma_f32 v171, v171, v22, v20
  v_mul_f32 v169, v169, v37
  v_add_f32 v170, 1.0, v170
  v_mul_f32 v171, v171, v39
  v_cvt_pk_bf16_f32 v234, v168, v169
  v_rcp_f32 v170, v170
  v_exp_f32 v171, v171
  v_mfma_f32_32x32x16_bf16 v[48:63], a[236:239], a[36:39], v[48:63]
  ds_read_b128 a[232:235], v31 offset:17408
  s_waitcnt vmcnt(0)
  s_mov_b32 s13, 0
L_k4_chk:
  v_max_u32 v8, v205, v207
  v_max3_u32 v8, v8, v209, v211
  v_max3_u32 v8, v8, v213, v215
  v_max3_u32 v8, v8, v217, v219
  v_cmp_eq_u32 vcc, -1, v8
  s_nop 1
  s_cbranch_vccz L_k4_rdy
  s_add_u32 s13, s13, 1
  s_cmp_ge_u32 s13, 0x40000
  s_cbranch_scc1 L_k4_rdy
  s_sleep 8
  buffer_load_dwordx2 v[204:205], v26, s[36:39], s15 offen offset:0 sc1
  buffer_load_dwordx2 v[206:207], v26, s[36:39], s15 offen offset:1024 sc1
  buffer_load_dwordx2 v[208:209], v26, s[36:39], s15 offen offset:2048 sc1
  buffer_load_dwordx2 v[210:211], v26, s[36:39], s15 offen offset:3072 sc1
  s_add_u32 s12, s15, 4096
  buffer_load_dwordx2 v[212:213], v26, s[36:39], s12 offen offset:0 sc1
  buffer_load_dwordx2 v[214:215], v26, s[36:39], s12 offen offset:1024 sc1
  buffer_load_dwordx2 v[216:217], v26, s[36:39], s12 offen offset:2048 sc1
  buffer_load_dwordx2 v[218:219], v26, s[36:39], s12 offen offset:3072 sc1
  s_waitcnt vmcnt(0)
  s_branch L_k4_chk
L_k4_rdy:
  v_mul_f32 v170, v170, v38
  v_add_f32 v171, 1.0, v171
  v_rcp_f32 v171, v171
  s_nop 0
  v_mul_f32 v171, v171, v39
  v_cvt_pk_bf16_f32 v235, v170, v171
  v_mul_f32 v172, v40, v40
  v_fma_f32 v172, v172, v22, v20
  v_mul_f32 v172, v172, v40
  v_mfma_f32_32x32x16_bf16 v[48:63], a[240:243], a[40:43], v[48:63]
  ds_read_b128 a[236:239], v31 offset:18432
  v_mul_f32 v173, v41, v41
  v_exp_f32 v172, v172
  v_fma_f32 v173, v173, v22, v20
  v_add_f32 v172, 1.0, v172
  v_mul_f32 v173, v173, v41
  v_mul_f32 v174, v42, v42
  v_rcp_f32 v172, v172
  v_exp_f32 v173, v173
  s_waitcnt lgkmcnt(4)
  v_mfma_f32_32x32x16_bf16 v[48:63], a[144:147], a[44:47], v[48:63]
  ds_read_b128 a[240:243], v31 offset:19456
  v_fma_f32 v174, v174, v22, v20
  v_mul_f32 v172, v172, v40
  v_add_f32 v173, 1.0, v173
  v_add_f32 v8, v204, v206
  v_add_f32 v10, v208, v210
  v_add_f32 v12, v212, v214
  v_add_f32 v14, v216, v218
  v_mul_f32 v174, v174, v42
  v_mfma_f32_32x32x16_bf16 v[48:63], a[148:151], a[48:51], v[48:63]
  ds_read_b128 a[144:147], v31 offset:20480
  v_add_f32 v9, v205, v207
  v_add_f32 v11, v209, v211
  v_add_f32 v13, v213, v215
  v_add_f32 v15, v217, v219
  v_mul_f32 v175, v43, v43
  v_add_f32 v8, v8, v10
  v_add_f32 v12, v12, v14
  v_add_f32 v9, v9, v11
  v_add_f32 v13, v13, v15
  v_rcp_f32 v173, v173
  v_mfma_f32_32x32x16_bf16 v[48:63], a[152:155], a[52:55], v[48:63]
  ds_read_b128 a[148:151], v31 offset:21504
  v_add_f32 v8, v8, v12
  v_add_f32 v9, v9, v13
  v_mov_b32 v10, v8
  v_mov_b32 v11, v9
  v_exp_f32 v174, v174
  v_mul_f32 v12, v24, v24
  v_mov_b32 v13, 0x3727c5ac
  v_permlane32_swap_b32 v8, v10
  v_mfma_f32_32x32x16_bf16 v[48:63], a[156:159], a[56:59], v[48:63]
  ds_read_b128 a[152:155], v31 offset:22528
  v_permlane32_swap_b32 v9, v11
  v_fma_f32 v175, v175, v22, v20
  v_add_f32 v8, v8, v10
  v_add_f32 v9, v9, v11
  v_mul_f32 v8, 0x39e38e39, v8
  v_mul_f32 v9, 0x39e38e39, v9
  v_mul_f32 v173, v173, v41
  v_fma_f32 v9, -v8, v8, v9
  v_max_f32 v9, 0, v9
  v_fma_f32 v9, v9, v12, v13
  s_waitcnt lgkmcnt(4)
  v_mfma_f32_32x32x16_bf16 v[48:63], a[160:163], a[60:63], v[48:63]
  ds_read_b128 a[156:159], v31 offset:23552
  v_rsq_f32 v9, v9
  v_add_f32 v174, 1.0, v174
  v_mul_f32 v28, v9, v24
  v_mul_f32 v29, -v8, v28
  v_fma_f32 v64, v64, v28, v29
  v_fma_f32 v65, v65, v28, v29
  v_mul_f32 v175, v175, v43
  v_fma_f32 v66, v66, v28, v29
  v_fma_f32 v67, v67, v28, v29
  v_fma_f32 v68, v68, v28, v29
  v_mfma_f32_32x32x16_bf16 v[48:63], a[164:167], a[64:67], v[48:63]
  ds_read_b128 a[160:163], v31 offset:24576
  v_fma_f32 v69, v69, v28, v29
  v_mul_f32 v176, v44, v44
  v_fma_f32 v70, v70, v28, v29
  v_fma_f32 v71, v71, v28, v29
  v_cvt_pk_bf16_f32 v188, v64, v65
  v_cvt_pk_bf16_f32 v189, v66, v67
  v_cvt_pk_bf16_f32 v236, v172, v173
  v_cvt_pk_bf16_f32 v190, v68, v69
  v_cvt_pk_bf16_f32 v191, v70, v71
  v_mfma_f32_32x32x16_bf16 v[48:63], a[232:235], a[68:71], v[48:63]
  ds_read_b128 a[164:167], v31 offset:25600
  ds_write_b128 v21, v[188:191] offset:0
  v_fma_f32 v72, v72, v28, v29
  v_rcp_f32 v174, v174
  v_fma_f32 v73, v73, v28, v29
  v_fma_f32 v74, v74, v28, v29
  v_fma_f32 v75, v75, v28, v29
  v_fma_f32 v76, v76, v28, v29
  v_exp_f32 v175, v175
  v_mfma_f32_32x32x16_bf16 v[48:63], a[236:239], a[72:75], v[48:63]
  ds_read_b128 a[232:235], v31 offset:26624
  v_fma_f32 v77, v77, v28, v29
  v_fma_f32 v78, v78, v28, v29
  v_fma_f32 v79, v79, v28, v29
  v_cvt_pk_bf16_f32 v192, v72, v73
  v_fma_f32 v176, v176, v22, v20
  v_cvt_pk_bf16_f32 v193, v74, v75
  v_cvt_pk_bf16_f32 v194, v76, v77
  v_cvt_pk_bf16_f32 v195, v78, v79
  ds_write_b128 v21, v[192:195] offset:32
  v_mul_f32 v174, v174, v42
  s_waitcnt lgkmcnt(6)
  v_mfma_f32_32x32x16_bf16 v[48:63], a[240:243], a[76:79], v[48:63]
  ds_read_b128 a[236:239], v31 offset:27648
  v_fma_f32 v80, v80, v28, v29
  v_fma_f32 v81, v81, v28, v29
  v_fma_f32 v82, v82, v28, v29
  v_fma_f32 v83, v83, v28, v29
  v_add_f32 v175, 1.0, v175
  v_fma_f32 v84, v84, v28, v29
  v_fma_f32 v85, v85, v28, v29
  v_fma_f32 v86, v86, v28, v29
  v_fma_f32 v87, v87, v28, v29
  s_waitcnt lgkmcnt(1)
  v_mfma_f32_32x32x16_bf16 v[48:63], a[144:147], a[80:83], v[48:63]
  ds_read_b128 a[240:243], v31 offset:28672
  v_mul_f32 v176, v176, v44
  ds_read_b64_tr_b16 v[196:197], v23 offset:0
  ds_read_b64_tr_b16 v[198:199], v23 offset:320
  ds_read_b64_tr_b16 v[200:201], v23 offset:8
  ds_read_b64_tr_b16 v[202:203], v23 offset:328
  v_mul_f32 v177, v45, v45
  v_cvt_pk_bf16_f32 v188, v80, v81
  v_cvt_pk_bf16_f32 v189, v82, v83
  v_cvt_pk_bf16_f32 v190, v84, v85
  v_cvt_pk_bf16_f32 v191, v86, v87
  v_mfma_f32_32x32x16_bf16 v[48:63], a[148:151], a[84:87], v[48:63]
  ds_read_b128 a[144:147], v31 offset:29696
  v_rcp_f32 v175, v175
  ds_write_b128 v21, v[188:191] offset:2560
  v_fma_f32 v88, v88, v28, v29
  v_fma_f32 v89, v89, v28, v29
  v_fma_f32 v90, v90, v28, v29
  v_exp_f32 v176, v176
  v_fma_f32 v91, v91, v28, v29
  v_mfma_f32_32x32x16_bf16 v[48:63], a[152:155], a[88:91], v[48:63]
  ds_read_b128 a[148:151], v31 offset:30720
  v_fma_f32 v92, v92, v28, v29
  v_fma_f32 v93, v93, v28, v29
  v_fma_f32 v94, v94, v28, v29
  v_fma_f32 v177, v177, v22, v20
  s_waitcnt lgkmcnt(3)
  buffer_store_dwordx4 v[196:199], v2, s[20:23], s64 offen offset:0 sc1
  buffer_store_dwordx4 v[200:203], v2, s[20:23], s64 offen offset:1024 sc1
  v_fma_f32 v95, v95, v28, v29
  v_mul_f32 v175, v175, v43
  v_cvt_pk_bf16_f32 v192, v88, v89
  s_waitcnt lgkmcnt(10)
  v_mfma_f32_32x32x16_bf16 v[48:63], a[156:159], a[92:95], v[48:63]
  ds_read_b128 a[152:155], v31 offset:31744
  v_cvt_pk_bf16_f32 v193, v90, v91
  v_cvt_pk_bf16_f32 v194, v92, v93
  v_cvt_pk_bf16_f32 v195, v94, v95
  v_add_f32 v176, 1.0, v176
  ds_write_b128 v21, v[192:195] offset:2592
  v_fma_f32 v96, v96, v28, v29
  v_fma_f32 v97, v97, v28, v29
  v_fma_f32 v98, v98, v28, v29
  v_mul_f32 v177, v177, v45
  v_fma_f32 v99, v99, v28, v29
  v_mfma_f32_32x32x16_bf16 v[48:63], a[160:163], a[96:99], v[48:63]
  ds_read_b128 a[156:159], v31 offset:32768
  v_fma_f32 v100, v100, v28, v29
  v_fma_f32 v101, v101, v28, v29
  v_fma_f32 v102, v102, v28, v29
  v_mul_f32 v178, v46, v46
  v_fma_f32 v103, v103, v28, v29
  s_waitcnt lgkmcnt(1)
  ds_read_b64_tr_b16 v[196:197], v23 offset:2560
  ds_read_b64_tr_b16 v[198:199], v23 offset:2880
  v_cvt_pk_bf16_f32 v237, v174, v175
  ds_read_b64_tr_b16 v[200:201], v23 offset:2568
  v_mfma_f32_32x32x16_bf16 v[48:63], a[164:167], a[100:103], v[48:63]
  ds_read_b128 a[160:163], v31 offset:33792
  ds_read_b64_tr_b16 v[202:203], v23 offset:2888
  v_cvt_pk_bf16_f32 v188, v96, v97
  v_cvt_pk_bf16_f32 v189, v98, v99
  v_rcp_f32 v176, v176
  v_cvt_pk_bf16_f32 v190, v100, v101
  v_cvt_pk_bf16_f32 v191, v102, v103
  ds_write_b128 v21, v[188:191] offset:0
  v_fma_f32 v104, v104, v28, v29
  v_exp_f32 v177, v177
  v_mfma_f32_32x32x16_bf16 v[48:63], a[232:235], a[104:107], v[48:63]
  ds_read_b128 a[164:167], v31 offset:34816
  v_fma_f32 v105, v105, v28, v29
  v_fma_f32 v106, v106, v28, v29
  v_fma_f32 v107, v107, v28, v29
  v_fma_f32 v108, v108, v28, v29
  v_fma_f32 v178, v178, v22, v20
  v_fma_f32 v109, v109, v28, v29
  v_fma_f32 v110, v110, v28, v29
  s_waitcnt lgkmcnt(2)
  s_waitcnt lgkmcnt(10)
  v_mfma_f32_32x32x16_bf16 v[48:63], a[236:239], a[108:111], v[48:63]
  ds_read_b128 a[232:235], v31 offset:35840
  buffer_store_dwordx4 v[196:199], v2, s[20:23], s64 offen offset:2048 sc1
  v_mul_f32 v176, v176, v44
  buffer_store_dwordx4 v[200:203], v2, s[20:23], s64 offen offset:3072 sc1
  v_fma_f32 v111, v111, v28, v29
  v_cvt_pk_bf16_f32 v192, v104, v105
  v_cvt_pk_bf16_f32 v193, v106, v107
  v_add_f32 v177, 1.0, v177
  v_cvt_pk_bf16_f32 v194, v108, v109
  v_cvt_pk_bf16_f32 v195, v110, v111
  ds_write_b128 v21, v[192:195] offset:32
  v_mfma_f32_32x32x16_bf16 v[48:63], a[240:243], a[112:115], v[48:63]
  ds_read_b128 a[236:239], v17 offset:7168
  v_fma_f32 v112, v112, v28, v29
  v_mul_f32 v178, v178, v46
  v_fma_f32 v113, v113, v28, v29
  v_fma_f32 v114, v114, v28, v29
  v_fma_f32 v115, v115, v28, v29
  v_fma_f32 v116, v116, v28, v29
  v_fma_f32 v117, v117, v28, v29
  v_mul_f32 v179, v47, v47
  v_fma_f32 v118, v118, v28, v29
  v_fma_f32 v119, v119, v28, v29
  v_mfma_f32_32x32x16_bf16 v[48:63], a[144:147], a[116:119], v[48:63]
  s_waitcnt vmcnt(12)
  s_barrier
  ds_read_b128 a[240:243], v2 offset:0
  s_waitcnt lgkmcnt(2)
  ds_read_b64_tr_b16 v[196:197], v23 offset:0
  v_rcp_f32 v177, v177
  ds_read_b64_tr_b16 v[198:199], v23 offset:320
  ds_read_b64_tr_b16 v[200:201], v23 offset:8
  ds_read_b64_tr_b16 v[202:203], v23 offset:328
  v_cvt_pk_bf16_f32 v188, v112, v113
  v_exp_f32 v178, v178
  v_mfma_f32_32x32x16_bf16 v[48:63], a[148:151], a[120:123], v[48:63]
  ds_read_b128 a[144:147], v2 offset:1024
  v_cvt_pk_bf16_f32 v189, v114, v115
  v_cvt_pk_bf16_f32 v190, v116, v117
  v_cvt_pk_bf16_f32 v191, v118, v119
  ds_write_b128 v21, v[188:191] offset:2560
  v_fma_f32 v179, v179, v22, v20
  v_fma_f32 v120, v120, v28, v29
  v_fma_f32 v121, v121, v28, v29
  v_fma_f32 v122, v122, v28, v29
  v_fma_f32 v123, v123, v28, v29
  v_mul_f32 v177, v177, v45
  s_waitcnt lgkmcnt(10)
  v_mfma_f32_32x32x16_bf16 v[48:63], a[152:155], a[124:127], v[48:63]
  ds_read_b128 a[148:151], v2 offset:2048
  v_fma_f32 v124, v124, v28, v29
  v_fma_f32 v125, v125, v28, v29
  v_fma_f32 v126, v126, v28, v29
  s_waitcnt lgkmcnt(3)
  v_add_f32 v178, 1.0, v178
  buffer_store_dwordx4 v[196:199], v2, s[20:23], s65 offen offset:0 sc1
  buffer_store_dwordx4 v[200:203], v2, s[20:23], s65 offen offset:1024 sc1
  v_fma_f32 v127, v127, v28, v29
  v_cvt_pk_bf16_f32 v192, v120, v121
  v_mfma_f32_32x32x16_bf16 v[48:63], a[156:159], a[128:131], v[48:63]
  ds_read_b128 a[152:155], v2 offset:3072
  v_mul_f32 v179, v179, v47
  v_cvt_pk_bf16_f32 v193, v122, v123
  v_cvt_pk_bf16_f32 v194, v124, v125
  v_cvt_pk_bf16_f32 v195, v126, v127
  ds_write_b128 v21, v[192:195] offset:2592
  v_cvt_pk_bf16_f32 v238, v176, v177
  v_fma_f32 v128, v128, v28, v29
  v_fma_f32 v129, v129, v28, v29
  v_fma_f32 v130, v130, v28, v29
  v_fma_f32 v131, v131, v28, v29
  v_mfma_f32_32x32x16_bf16 v[48:63], a[160:163], a[132:135], v[48:63]
  ds_read_b128 a[156:159], v2 offset:4096
  v_rcp_f32 v178, v178
  v_fma_f32 v132, v132, v28, v29
  v_fma_f32 v133, v133, v28, v29
  v_fma_f32 v134, v134, v28, v29
  v_fma_f32 v135, v135, v28, v29
  v_exp_f32 v179, v179
  s_waitcnt lgkmcnt(1)
  ds_read_b64_tr_b16 v[196:197], v23 offset:2560
  v_mfma_f32_32x32x16_bf16 v[48:63], a[164:167], a[136:139], v[48:63]
  ds_read_b128 a[160:163], v2 offset:5120
  ds_read_b64_tr_b16 v[198:199], v23 offset:2880
  ds_read_b64_tr_b16 v[200:201], v23 offset:2568
  v_mul_f32 v178, v178, v46
  ds_read_b64_tr_b16 v[202:203], v23 offset:2888
  v_cvt_pk_bf16_f32 v188, v128, v129
  v_cvt_pk_bf16_f32 v189, v130, v131
  v_cvt_pk_bf16_f32 v190, v132, v133
  v_add_f32 v179, 1.0, v179
  v_cvt_pk_bf16_f32 v191, v134, v135
  ds_write_b128 v21, v[188:191] offset:0
  s_waitcnt lgkmcnt(11)
  v_mfma_f32_32x32x16_bf16 v[48:63], a[232:235], a[140:143], v[48:63]
  ds_read_b128 a[164:167], v2 offset:6144
  v_fma_f32 v136, v136, v28, v29
  v_fma_f32 v137, v137, v28, v29
  v_rcp_f32 v179, v179
  v_fma_f32 v138, v138, v28, v29
  v_fma_f32 v139, v139, v28, v29
  v_fma_f32 v140, v140, v28, v29
  v_fma_f32 v141, v141, v28, v29
  v_mul_f32 v179, v179, v47
  v_fma_f32 v142, v142, v28, v29
  v_mfma_f32_32x32x16_bf16 v[48:63], a[236:239], v[144:147], v[48:63]
  ds_read_b128 a[232:235], v2 offset:7168
  s_waitcnt lgkmcnt(3)
  buffer_store_dwordx4 v[196:199], v2, s[20:23], s65 offen offset:2048 sc1
  buffer_store_dwordx4 v[200:203], v2, s[20:23], s65 offen offset:3072 sc1
  v_cvt_pk_bf16_f32 v239, v178, v179
  v_fma_f32 v143, v143, v28, v29
  v_cvt_pk_bf16_f32 v192, v136, v137
  v_cvt_pk_bf16_f32 v193, v138, v139
  v_cvt_pk_bf16_f32 v194, v140, v141
  v_cvt_pk_bf16_f32 v195, v142, v143
  v_mfma_f32_32x32x16_bf16 v[32:47], a[240:243], a[0:3], 0
  ds_read_b128 a[236:239], v2 offset:8192
  v_mfma_f32_32x32x16_bf16 v[32:47], a[144:147], a[4:7], v[32:47]
  ds_read_b128 a[240:243], v2 offset:9216
  s_waitcnt lgkmcnt(8)
  v_mfma_f32_32x32x16_bf16 v[32:47], a[148:151], a[8:11], v[32:47]
  ds_read_b128 a[144:147], v2 offset:10240
  v_mul_f32 v164, v48, v48
  v_fma_f32 v164, v164, v22, v20
  ds_write_b128 v21, v[192:195] offset:32
  v_mul_f32 v164, v164, v48
  s_nop 0
  v_mfma_f32_32x32x16_bf16 v[32:47], a[152:155], a[12:15], v[32:47]
  ds_read_b128 a[148:151], v2 offset:11264
  v_mul_f32 v165, v49, v49
  s_nop 0
  v_exp_f32 v164, v164
  v_fma_f32 v165, v165, v22, v20
  v_mfma_f32_32x32x16_bf16 v[32:47], a[156:159], a[16:19], v[32:47]
  ds_read_b128 a[152:155], v2 offset:12288
  s_nop 0
  v_add_f32 v164, 1.0, v164
  s_waitcnt lgkmcnt(2)
  v_mul_f32 v165, v165, v49
  ds_read_b64_tr_b16 v[196:197], v23 offset:0
  v_mfma_f32_32x32x16_bf16 v[32:47], a[160:163], a[20:23], v[32:47]
  ds_read_b128 a[156:159], v2 offset:13312
  v_mul_f32 v166, v50, v50
  v_rcp_f32 v164, v164
  ds_read_b64_tr_b16 v[198:199], v23 offset:320
  v_exp_f32 v165, v165
  s_waitcnt lgkmcnt(7)
  v_mfma_f32_32x32x16_bf16 v[32:47], a[164:167], a[24:27], v[32:47]
  ds_read_b128 a[160:163], v2 offset:14336
  ds_read_b64_tr_b16 v[200:201], v23 offset:8
  v_fma_f32 v166, v166, v22, v20
  ds_read_b64_tr_b16 v[202:203], v23 offset:328
  v_mul_f32 v164, v164, v48
  v_mfma_f32_32x32x16_bf16 v[32:47], a[232:235], a[28:31], v[32:47]
  ds_read_b128 a[164:167], v2 offset:15360
  v_add_f32 v165, 1.0, v165
  s_nop 0
  v_mul_f32 v166, v166, v50
  s_nop 0
  v_mul_f32 v167, v51, v51
  v_mfma_f32_32x32x16_bf16 v[32:47], a[236:239], a[32:35], v[32:47]
  ds_read_b128 a[232:235], v2 offset:16384
  s_nop 0
  v_rcp_f32 v165, v165
  v_exp_f32 v166, v166
  v_mfma_f32_32x32x16_bf16 v[32:47], a[240:243], a[36:39], v[32:47]
  ds_read_b128 a[236:239], v2 offset:17408
  s_add_u32 s40, s58, 16384
  buffer_load_dwordx4 a[0:3], v2, s[60:63], s40 offen offset:0
  s_nop 0
  v_fma_f32 v167, v167, v22, v20
  s_nop 0
  v_mul_f32 v165, v165, v49
  s_nop 0
  s_waitcnt lgkmcnt(7)
  v_mfma_f32_32x32x16_bf16 v[32:47], a[144:147], a[40:43], v[32:47]
  ds_read_b128 a[240:243], v2 offset:18432
  v_add_f32 v166, 1.0, v166
  v_mul_f32 v167, v167, v51
  s_waitcnt lgkmcnt(4)
  v_mul_f32 v168, v52, v52
  v_mfma_f32_32x32x16_bf16 v[32:47], a[148:151], a[44:47], v[32:47]
  ds_read_b128 a[144:147], v2 offset:19456
  buffer_store_dwordx4 v[196:199], v2, s[20:23], s67 offen sc1
  v_cvt_pk_bf16_f32 v240, v164, v165
  buffer_store_dwordx4 v[200:203], v2, s[20:23], s66 offen sc1
  v_rcp_f32 v166, v166
  v_mfma_f32_32x32x16_bf16 v[32:47], a[152:155], a[48:51], v[32:47]
  ds_read_b128 a[148:151], v2 offset:20480
  buffer_load_dwordx4 a[4:7], v2, s[60:63], s40 offen offset:1024
  v_exp_f32 v167, v167
  v_fma_f32 v168, v168, v22, v20
  v_mul_f32 v166, v166, v50
  v_add_f32 v167, 1.0, v167
  v_mfma_f32_32x32x16_bf16 v[32:47], a[156:159], a[52:55], v[32:47]
  ds_read_b128 a[152:155], v2 offset:21504
  v_mul_f32 v168, v168, v52
  v_mul_f32 v169, v53, v53
  v_rcp_f32 v167, v167
  v_exp_f32 v168, v168
  s_waitcnt lgkmcnt(4)
  v_mfma_f32_32x32x16_bf16 v[32:47], a[160:163], a[56:59], v[32:47]
  ds_read_b128 a[156:159], v2 offset:22528
  v_fma_f32 v169, v169, v22, v20
  v_mul_f32 v167, v167, v51
  v_add_f32 v168, 1.0, v168
  v_mul_f32 v169, v169, v53
  v_mfma_f32_32x32x16_bf16 v[32:47], a[164:167], a[60:63], v[32:47]
  ds_read_b128 a[160:163], v2 offset:23552
  buffer_load_dwordx4 a[8:11], v2, s[60:63], s40 offen offset:2048
  v_mul_f32 v170, v54, v54
  v_cvt_pk_bf16_f32 v241, v166, v167
  v_rcp_f32 v168, v168
  v_exp_f32 v169, v169
  v_mfma_f32_32x32x16_bf16 v[32:47], a[232:235], a[64:67], v[32:47]
  ds_read_b128 a[164:167], v2 offset:24576
  v_fma_f32 v170, v170, v22, v20
  v_mul_f32 v168, v168, v52
  v_add_f32 v169, 1.0, v169
  v_mul_f32 v170, v170, v54
  v_mfma_f32_32x32x16_bf16 v[32:47], a[236:239], a[68:71], v[32:47]
  ds_read_b128 a[232:235], v2 offset:25600
  v_mul_f32 v171, v55, v55
  v_rcp_f32 v169, v169
  v_exp_f32 v170, v170
  s_waitcnt lgkmcnt(4)
  v_mfma_f32_32x32x16_bf16 v[32:47], a[240:243], a[72:75], v[32:47]
  ds_read_b128 a[236:239], v2 offset:26624
  buffer_load_dwordx4 a[12:15], v2, s[60:63], s40 offen offset:3072
  v_fma_f32 v171, v171, v22, v20
  v_mul_f32 v169, v169, v53
  v_add_f32 v170, 1.0, v170
  v_mul_f32 v171, v171, v55
  v_cvt_pk_bf16_f32 v242, v168, v169
  v_mfma_f32_32x32x16_bf16 v[32:47], a[144:147], a[76:79], v[32:47]
  ds_read_b128 a[240:243], v2 offset:27648
  v_rcp_f32 v170, v170
  v_exp_f32 v171, v171
  v_mfma_f32_32x32x16_bf16 v[32:47], a[148:151], a[80:83], v[32:47]
  ds_read_b128 a[144:147], v2 offset:28672
  v_mul_f32 v170, v170, v54
  v_add_f32 v171, 1.0, v171
  v_rcp_f32 v171, v171
  s_nop 0
  v_mul_f32 v171, v171, v55
  v_mfma_f32_32x32x16_bf16 v[32:47], a[152:155], a[84:87], v[32:47]
  ds_read_b128 a[148:151], v2 offset:29696
  s_add_u32 s40, s58, 20480
  buffer_load_dwordx4 a[16:19], v2, s[60:63], s40 offen offset:0
  v_cvt_pk_bf16_f32 v243, v170, v171
  v_mul_f32 v172, v56, v56
  v_fma_f32 v172, v172, v22, v20
  v_mul_f32 v172, v172, v56
  v_mul_f32 v173, v57, v57
  s_waitcnt lgkmcnt(4)
  v_mfma_f32_32x32x16_bf16 v[32:47], a[156:159], a[88:91], v[32:47]
  ds_read_b128 a[152:155], v2 offset:30720
  v_exp_f32 v172, v172
  v_fma_f32 v173, v173, v22, v20
  v_add_f32 v172, 1.0, v172
  v_mul_f32 v173, v173, v57
  v_mfma_f32_32x32x16_bf16 v[32:47], a[160:163], a[92:95], v[32:47]
  ds_read_b128 a[156:159], v2 offset:31744
  v_mul_f32 v174, v58, v58
  v_rcp_f32 v172, v172
  v_exp_f32 v173, v173
  v_mfma_f32_32x32x16_bf16 v[32:47], a[164:167], a[96:99], v[32:47]
  ds_read_b128 a[160:163], v2 offset:32768
  buffer_load_dwordx4 a[20:23], v2, s[60:63], s40 offen offset:1024
  v_fma_f32 v174, v174, v22, v20
  v_mul_f32 v172, v172, v56
  v_add_f32 v173, 1.0, v173
  v_mul_f32 v174, v174, v58
  v_mul_f32 v175, v59, v59
  v_mfma_f32_32x32x16_bf16 v[32:47], a[232:235], a[100:103], v[32:47]
  ds_read_b128 a[164:167], v2 offset:33792
  v_rcp_f32 v173, v173
  v_exp_f32 v174, v174
  v_fma_f32 v175, v175, v22, v20
  s_waitcnt lgkmcnt(4)
  v_mfma_f32_32x32x16_bf16 v[32:47], a[236:239], a[104:107], v[32:47]
  ds_read_b128 a[232:235], v2 offset:34816
  v_mul_f32 v173, v173, v57
  v_add_f32 v174, 1.0, v174
  v_mul_f32 v175, v175, v59
  v_mul_f32 v176, v60, v60
  v_cvt_pk_bf16_f32 v244, v172, v173
  v_mfma_f32_32x32x16_bf16 v[32:47], a[240:243], a[108:111], v[32:47]
  ds_read_b128 a[236:239], v2 offset:35840
  buffer_load_dwordx4 a[24:27], v2, s[60:63], s40 offen offset:2048
  s_waitcnt vmcnt(6)
  s_add_u32 s20, s16, 106496
  s_addc_u32 s21, s17, 0
  s_and_b32 s21, s21, 0xffff
  s_mov_b32 s22, 16384
  s_mov_b32 s23, 0x20000
  s_barrier
  s_cmp_lg_u32 s3, 0
  s_cbranch_scc1 L_k4_sig
  s_lshl_b32 s13, s5, 7
  v_mov_b32 v8, 1
  v_mov_b32 v9, 0
  s_mov_b64 exec, 1
  buffer_atomic_add v8, v9, s[20:23], s13 offen
  s_mov_b64 exec, -1
L_k4_sig:
  v_rcp_f32 v174, v174
  v_exp_f32 v175, v175
  v_mfma_f32_32x32x16_bf16 v[32:47], a[144:147], a[112:115], v[32:47]
  ds_read_b128 a[240:243], v17 offset:8192
  v_fma_f32 v176, v176, v22, v20
  v_mul_f32 v174, v174, v58
  v_add_f32 v175, 1.0, v175
  v_mul_f32 v176, v176, v60
  v_mfma_f32_32x32x16_bf16 v[32:47], a[148:151], a[116:119], v[32:47]
  v_mul_f32 v177, v61, v61
  v_rcp_f32 v175, v175
  v_exp_f32 v176, v176
  s_waitcnt lgkmcnt(3)
  v_mfma_f32_32x32x16_bf16 v[32:47], a[152:155], a[120:123], v[32:47]
  buffer_load_dwordx4 a[28:31], v2, s[60:63], s40 offen offset:3072
  v_fma_f32 v177, v177, v22, v20
  v_mul_f32 v175, v175, v59
  v_add_f32 v176, 1.0, v176
  v_mul_f32 v177, v177, v61
  v_mul_f32 v178, v62, v62
  v_mfma_f32_32x32x16_bf16 v[32:47], a[156:159], a[124:127], v[32:47]
  v_cvt_pk_bf16_f32 v245, v174, v175
  v_rcp_f32 v176, v176
  v_exp_f32 v177, v177
  v_mfma_f32_32x32x16_bf16 v[32:47], a[160:163], a[128:131], v[32:47]
  v_fma_f32 v178, v178, v22, v20
  v_mul_f32 v176, v176, v60
  v_add_f32 v177, 1.0, v177
  v_mul_f32 v178, v178, v62
  v_mul_f32 v179, v63, v63
  v_mfma_f32_32x32x16_bf16 v[32:47], a[164:167], a[132:135], v[32:47]
  v_rcp_f32 v177, v177
  v_exp_f32 v178, v178
  v_fma_f32 v179, v179, v22, v20
  s_waitcnt lgkmcnt(0)
  v_mfma_f32_32x32x16_bf16 v[32:47], a[232:235], a[136:139], v[32:47]
  v_mul_f32 v177, v177, v61
  v_add_f32 v178, 1.0, v178
  v_mul_f32 v179, v179, v63
  v_cvt_pk_bf16_f32 v246, v176, v177
  v_rcp_f32 v178, v178
  v_mfma_f32_32x32x16_bf16 v[32:47], a[236:239], a[140:143], v[32:47]
  v_exp_f32 v179, v179
  v_mul_f32 v178, v178, v62
  v_add_f32 v179, 1.0, v179
  v_mfma_f32_32x32x16_bf16 v[32:47], a[240:243], v[144:147], v[32:47]
  v_rcp_f32 v179, v179
  s_nop 0
  v_mul_f32 v179, v179, v63
  v_cvt_pk_bf16_f32 v247, v178, v179
  s_nop 7
  v_pk_mul_f32 v[164:165], v[32:33], v[32:33]
  v_pk_mul_f32 v[166:167], v[34:35], v[34:35]
  v_pk_mul_f32 v[168:169], v[36:37], v[36:37]
  v_pk_mul_f32 v[170:171], v[38:39], v[38:39]
  v_pk_fma_f32 v[164:165], v[164:165], v[22:23], v[20:21] op_sel_hi:[1,0,0]
  v_pk_fma_f32 v[166:167], v[166:167], v[22:23], v[20:21] op_sel_hi:[1,0,0]
  v_pk_fma_f32 v[168:169], v[168:169], v[22:23], v[20:21] op_sel_hi:[1,0,0]
  v_pk_fma_f32 v[170:171], v[170:171], v[22:23], v[20:21] op_sel_hi:[1,0,0]
  v_pk_mul_f32 v[164:165], v[164:165], v[32:33]
  v_pk_mul_f32 v[166:167], v[166:167], v[34:35]
  v_pk_mul_f32 v[168:169], v[168:169], v[36:37]
  v_pk_mul_f32 v[170:171], v[170:171], v[38:39]
  v_exp_f32 v164, v164
  v_exp_f32 v165, v165
  v_exp_f32 v166, v166
  v_exp_f32 v167, v167
  v_exp_f32 v168, v168
  v_exp_f32 v169, v169
  v_exp_f32 v170, v170
  v_exp_f32 v171, v171
  v_pk_add_f32 v[164:165], v[164:165], 1.0 op_sel_hi:[1,0]
  v_pk_add_f32 v[166:167], v[166:167], 1.0 op_sel_hi:[1,0]
  v_pk_add_f32 v[168:169], v[168:169], 1.0 op_sel_hi:[1,0]
  v_pk_add_f32 v[170:171], v[170:171], 1.0 op_sel_hi:[1,0]
  v_rcp_f32 v164, v164
  v_rcp_f32 v165, v165
  v_rcp_f32 v166, v166
  v_rcp_f32 v167, v167
  v_rcp_f32 v168, v168
  v_rcp_f32 v169, v169
  v_rcp_f32 v170, v170
  v_rcp_f32 v171, v171
  v_pk_mul_f32 v[164:165], v[164:165], v[32:33]
  v_pk_mul_f32 v[166:167], v[166:167], v[34:35]
  v_pk_mul_f32 v[168:169], v[168:169], v[36:37]
  v_pk_mul_f32 v[170:171], v[170:171], v[38:39]
  v_cvt_pk_bf16_f32 v248, v164, v165
  v_cvt_pk_bf16_f32 v249, v166, v167
  v_cvt_pk_bf16_f32 v250, v168, v169
  v_cvt_pk_bf16_f32 v251, v170, v171
  v_pk_mul_f32 v[172:173], v[40:41], v[40:41]
  v_pk_mul_f32 v[174:175], v[42:43], v[42:43]
  v_pk_mul_f32 v[176:177], v[44:45], v[44:45]
  v_pk_mul_f32 v[178:179], v[46:47], v[46:47]
  v_pk_fma_f32 v[172:173], v[172:173], v[22:23], v[20:21] op_sel_hi:[1,0,0]
  v_pk_fma_f32 v[174:175], v[174:175], v[22:23], v[20:21] op_sel_hi:[1,0,0]
  v_pk_fma_f32 v[176:177], v[176:177], v[22:23], v[20:21] op_sel_hi:[1,0,0]
  v_pk_fma_f32 v[178:179], v[178:179], v[22:23], v[20:21] op_sel_hi:[1,0,0]
  v_pk_mul_f32 v[172:173], v[172:173], v[40:41]
  v_pk_mul_f32 v[174:175], v[174:175], v[42:43]
  v_pk_mul_f32 v[176:177], v[176:177], v[44:45]
  v_pk_mul_f32 v[178:179], v[178:179], v[46:47]
  v_exp_f32 v172, v172
  v_exp_f32 v173, v173
  v_exp_f32 v174, v174
  v_exp_f32 v175, v175
  v_exp_f32 v176, v176
  v_exp_f32 v177, v177
  v_exp_f32 v178, v178
  v_exp_f32 v179, v179
  s_cmp_lg_u32 s3, 0
  s_cbranch_scc1 L_k4_np
  s_and_b32 s13, s5, 14
  s_lshl_b32 s13, s13, 7
  v_and_b32 v12, 1, v1
  v_lshlrev_b32 v12, 7, v12
  buffer_load_dword v13, v12, s[20:23], s13 offen sc1
L_k4_np:
  v_pk_add_f32 v[172:173], v[172:173], 1.0 op_sel_hi:[1,0]
  v_pk_add_f32 v[174:175], v[174:175], 1.0 op_sel_hi:[1,0]
  v_pk_add_f32 v[176:177], v[176:177], 1.0 op_sel_hi:[1,0]
  v_pk_add_f32 v[178:179], v[178:179], 1.0 op_sel_hi:[1,0]
  v_rcp_f32 v172, v172
  v_rcp_f32 v173, v173
  v_rcp_f32 v174, v174
  v_rcp_f32 v175, v175
  v_rcp_f32 v176, v176
  v_rcp_f32 v177, v177
  v_rcp_f32 v178, v178
  v_rcp_f32 v179, v179
  v_pk_mul_f32 v[172:173], v[172:173], v[40:41]
  v_pk_mul_f32 v[174:175], v[174:175], v[42:43]
  v_pk_mul_f32 v[176:177], v[176:177], v[44:45]
  v_pk_mul_f32 v[178:179], v[178:179], v[46:47]
  v_cvt_pk_bf16_f32 v252, v172, v173
  v_cvt_pk_bf16_f32 v253, v174, v175
  v_cvt_pk_bf16_f32 v254, v176, v177
  v_cvt_pk_bf16_f32 v255, v178, v179
L_k4_done:
  v_add_u32 v4, 36864, v2
  v_add_u32 v5, 73728, v2
  v_add_u32 v6, 110592, v2
  s_lshl_b32 s8, s4, 3
  s_lshl_b32 s9, s3, 1
  s_add_u32 s8, s8, s9
  s_mul_i32 s12, s5, 589824
  s_lshl_b32 s13, s10, 4
  s_add_u32 s12, s12, s13
  s_add_u32 s28, s16, 47185920
  s_addc_u32 s29, s17, 0
  s_and_b32 s29, s29, 0xffff
  s_mov_b32 s30, 9437184
  s_mov_b32 s31, 0x20000
  v_lshlrev_b32 v212, 16, v222
  v_mov_b32 v213, v212
  v_mov_b32 v214, v212
  v_mov_b32 v215, v212
  v_lshlrev_b32 v216, 16, v223
  v_mov_b32 v217, v216
  v_mov_b32 v218, v216
  v_mov_b32 v219, v216
  s_mul_i32 s44, s5, 9
  s_add_u32 s44, s44, 1
  s_lshr_b32 s44, s44, 1
  s_and_b32 s45, s5, 1
  s_cmp_eq_u32 s45, 1
  s_cselect_b32 s46, -1, 4
  s_add_u32 s46, s46, s44
  s_mul_i32 s47, s8, 72
  s_add_u32 s44, s44, s47
  s_lshl_b32 s44, s44, 10
  s_add_u32 s46, s46, s47
  s_lshl_b32 s46, s46, 10
  s_lshl_b32 s15, s45, 9
  s_add_u32 s46, s46, s15
  s_lshl_b32 s15, s45, 3
  s_lshl_b32 s56, s8, 13
  s_add_u32 s15, s15, s56
  s_lshr_b32 s56, s5, 1
  s_lshl_b32 s56, s56, 10
  s_add_u32 s15, s15, s56
  s_add_u32 s56, s15, 8192
  s_add_u32 s45, s44, 73728
  s_add_u32 s47, s46, 73728
  v_lshlrev_b32 v3, 3, v1
  v_and_b32 v18, 7, v1
  v_lshlrev_b32 v18, 4, v18
  v_lshrrev_b32 v19, 4, v1
  v_lshl_add_u32 v18, v19, 7, v18
  s_and_b32 s13, s5, 14
  s_add_u32 s24, s16, 37748736
  s_addc_u32 s25, s17, 0
  s_and_b32 s25, s25, 0xffff
  s_mov_b32 s26, 9437184
  s_mov_b32 s27, 0x20000
  s_waitcnt vmcnt(0)
  v_cmp_gt_u32 vcc, 16, v13
  s_nop 1
  s_cbranch_vccz L_k5_go
  s_cmp_lg_u32 s3, 0
  s_cbranch_scc1 L_aw_k3_kernel_3
  s_lshl_b32 s13, s13, 7
  v_lshlrev_b32 v10, 7, v1
  s_mov_b32 s14, 0
  s_mov_b64 exec, 3
  s_sleep 1
L_awl_k3_kernel_4:
  buffer_load_dword v11, v10, s[20:23], s13 offen sc1
  s_add_u32 s14, s14, 1
  s_waitcnt vmcnt(0)
  v_cmp_gt_u32 vcc, 16, v11
  s_cmp_lt_u32 s14, 0x80000
  s_nop 0
  s_cselect_b64 vcc, vcc, 0
  s_cbranch_vccz L_awl_k3_kernel_4_d
  s_sleep 12
  s_branch L_awl_k3_kernel_4
L_awl_k3_kernel_4_d:
  s_mov_b64 exec, -1
L_aw_k3_kernel_3:
L_k5_go:
  s_barrier
  s_add_u32 m0, s10, 0
  s_add_u32 s41, s12, 0
  buffer_load_dwordx4 v2, s[28:31], s41 offen offset:0 sc1 lds
  buffer_load_dwordx4 v2, s[28:31], s41 offen offset:1024 sc1 lds
  buffer_load_dwordx4 v2, s[28:31], s41 offen offset:2048 sc1 lds
  buffer_load_dwordx4 v2, s[28:31], s41 offen offset:3072 sc1 lds
  s_add_u32 m0, s10, 4096
  s_add_u32 s41, s12, 4096
  buffer_load_dwordx4 v2, s[28:31], s41 offen offset:0 sc1 lds
  buffer_load_dwordx4 v2, s[28:31], s41 offen offset:1024 sc1 lds
  buffer_load_dwordx4 v2, s[28:31], s41 offen offset:2048 sc1 lds
  buffer_load_dwordx4 v2, s[28:31], s41 offen offset:3072 sc1 lds
  s_add_u32 m0, s10, 8192
  s_add_u32 s41, s12, 8192
  buffer_load_dwordx4 v2, s[28:31], s41 offen offset:0 sc1 lds
  s_add_u32 m0, s10, 36864
  s_add_u32 s41, s12, 9216
  buffer_load_dwordx4 v2, s[28:31], s41 offen offset:0 sc1 lds
  buffer_load_dwordx4 v2, s[28:31], s41 offen offset:1024 sc1 lds
  buffer_load_dwordx4 v2, s[28:31], s41 offen offset:2048 sc1 lds
  buffer_load_dwordx4 v2, s[28:31], s41 offen offset:3072 sc1 lds
  s_add_u32 m0, s10, 40960
  s_add_u32 s41, s12, 13312
  buffer_load_dwordx4 v2, s[28:31], s41 offen offset:0 sc1 lds
  buffer_load_dwordx4 v2, s[28:31], s41 offen offset:1024 sc1 lds
  buffer_load_dwordx4 v2, s[28:31], s41 offen offset:2048 sc1 lds
  buffer_load_dwordx4 v2, s[28:31], s41 offen offset:3072 sc1 lds
  s_add_u32 m0, s10, 45056
  s_add_u32 s41, s12, 17408
  buffer_load_dwordx4 v2, s[28:31], s41 offen offset:0 sc1 lds
  s_waitcnt vmcnt(9)
  s_barrier
  ds_read_b128 a[32:35], v2 offset:0
  ds_read_b128 a[36:39], v2 offset:1024
  ds_read_b128 a[40:43], v2 offset:2048
  ds_read_b128 a[44:47], v2 offset:3072
  ds_read_b128 a[48:51], v2 offset:4096
  ds_read_b128 a[52:55], v2 offset:5120
  ds_read_b128 a[56:59], v2 offset:6144
  ds_read_b128 a[60:63], v2 offset:7168
  ds_read_b128 a[64:67], v2 offset:8192
  s_waitcnt lgkmcnt(0)
  v_mfma_f32_16x16x32_bf16 v[64:67], a[32:35], a[168:171], v[212:215]
  ds_read_b128 a[68:71], v2 offset:9216
  v_mfma_f32_16x16x32_bf16 v[100:103], a[32:35], a[172:175], v[216:219]
  ds_read_b128 a[72:75], v2 offset:10240
  v_mfma_f32_16x16x32_bf16 v[68:71], a[36:39], a[168:171], v[212:215]
  ds_read_b128 a[76:79], v2 offset:11264
  v_mfma_f32_16x16x32_bf16 v[104:107], a[36:39], a[172:175], v[216:219]
  ds_read_b128 a[80:83], v2 offset:12288
  v_mfma_f32_16x16x32_bf16 v[72:75], a[40:43], a[168:171], v[212:215]
  ds_read_b128 a[84:87], v2 offset:13312
  v_mfma_f32_16x16x32_bf16 v[108:111], a[40:43], a[172:175], v[216:219]
  ds_read_b128 a[88:91], v2 offset:14336
  v_mfma_f32_16x16x32_bf16 v[76:79], a[44:47], a[168:171], v[212:215]
  ds_read_b128 a[92:95], v2 offset:15360
  v_mfma_f32_16x16x32_bf16 v[112:115], a[44:47], a[172:175], v[216:219]
  ds_read_b128 a[96:99], v2 offset:16384
  v_mfma_f32_16x16x32_bf16 v[80:83], a[48:51], a[168:171], v[212:215]
  ds_read_b128 a[100:103], v2 offset:17408
  v_mfma_f32_16x16x32_bf16 v[116:119], a[48:51], a[172:175], v[216:219]
  s_add_u32 m0, s10, 73728
  s_add_u32 s41, s12, 18432
  v_mfma_f32_16x16x32_bf16 v[84:87], a[52:55], a[168:171], v[212:215]
  buffer_load_dwordx4 v2, s[28:31], s41 offen offset:0 sc1 lds
  v_mfma_f32_16x16x32_bf16 v[120:123], a[52:55], a[172:175], v[216:219]
  buffer_load_dwordx4 v2, s[28:31], s41 offen offset:1024 sc1 lds
  v_mfma_f32_16x16x32_bf16 v[88:91], a[56:59], a[168:171], v[212:215]
  buffer_load_dwordx4 v2, s[28:31], s41 offen offset:2048 sc1 lds
  v_mfma_f32_16x16x32_bf16 v[124:127], a[56:59], a[172:175], v[216:219]
  buffer_load_dwordx4 v2, s[28:31], s41 offen offset:3072 sc1 lds
  v_mfma_f32_16x16x32_bf16 v[92:95], a[60:63], a[168:171], v[212:215]
  v_mfma_f32_16x16x32_bf16 v[128:131], a[60:63], a[172:175], v[216:219]
  v_mfma_f32_16x16x32_bf16 v[96:99], a[64:67], a[168:171], v[212:215]
  s_add_u32 m0, s10, 77824
  s_add_u32 s41, s12, 22528
  v_mfma_f32_16x16x32_bf16 v[132:135], a[64:67], a[172:175], v[216:219]
  buffer_load_dwordx4 v2, s[28:31], s41 offen offset:0 sc1 lds
  s_waitcnt lgkmcnt(0)
  v_mfma_f32_16x16x32_bf16 v[64:67], a[68:71], a[176:179], v[64:67]
  ds_read_b128 a[32:35], v2 offset:18432
  v_mfma_f32_16x16x32_bf16 v[100:103], a[68:71], a[180:183], v[100:103]
  ds_read_b128 a[36:39], v2 offset:19456
  v_mfma_f32_16x16x32_bf16 v[68:71], a[72:75], a[176:179], v[68:71]
  ds_read_b128 a[40:43], v2 offset:20480
  v_mfma_f32_16x16x32_bf16 v[104:107], a[72:75], a[180:183], v[104:107]
  ds_read_b128 a[44:47], v2 offset:21504
  v_mfma_f32_16x16x32_bf16 v[72:75], a[76:79], a[176:179], v[72:75]
  ds_read_b128 a[48:51], v2 offset:22528
  v_mfma_f32_16x16x32_bf16 v[108:111], a[76:79], a[180:183], v[108:111]
  ds_read_b128 a[52:55], v2 offset:23552
  v_mfma_f32_16x16x32_bf16 v[76:79], a[80:83], a[176:179], v[76:79]
  ds_read_b128 a[56:59], v2 offset:24576
  v_mfma_f32_16x16x32_bf16 v[112:115], a[80:83], a[180:183], v[112:115]
  ds_read_b128 a[60:63], v2 offset:25600
  v_mfma_f32_16x16x32_bf16 v[80:83], a[84:87], a[176:179], v[80:83]
  ds_read_b128 a[64:67], v2 offset:26624
  v_mfma_f32_16x16x32_bf16 v[116:119], a[84:87], a[180:183], v[116:119]
  buffer_load_dwordx4 v2, s[28:31], s41 offen offset:1024 sc1 lds
  v_mfma_f32_16x16x32_bf16 v[84:87], a[88:91], a[176:179], v[84:87]
  buffer_load_dwordx4 v2, s[28:31], s41 offen offset:2048 sc1 lds
  v_mfma_f32_16x16x32_bf16 v[120:123], a[88:91], a[180:183], v[120:123]
  buffer_load_dwordx4 v2, s[28:31], s41 offen offset:3072 sc1 lds
  v_mfma_f32_16x16x32_bf16 v[88:91], a[92:95], a[176:179], v[88:91]
  v_mfma_f32_16x16x32_bf16 v[124:127], a[92:95], a[180:183], v[124:127]
  v_mfma_f32_16x16x32_bf16 v[92:95], a[96:99], a[176:179], v[92:95]
  v_mfma_f32_16x16x32_bf16 v[128:131], a[96:99], a[180:183], v[128:131]
  s_add_u32 m0, s10, 81920
  s_add_u32 s41, s12, 26624
  v_mfma_f32_16x16x32_bf16 v[96:99], a[100:103], a[176:179], v[96:99]
  buffer_load_dwordx4 v2, s[28:31], s41 offen offset:0 sc1 lds
  v_mfma_f32_16x16x32_bf16 v[132:135], a[100:103], a[180:183], v[132:135]
  s_waitcnt lgkmcnt(0)
  v_mfma_f32_16x16x32_bf16 v[64:67], a[32:35], a[184:187], v[64:67]
  ds_read_b128 a[68:71], v2 offset:27648
  v_mfma_f32_16x16x32_bf16 v[100:103], a[32:35], a[188:191], v[100:103]
  ds_read_b128 a[72:75], v2 offset:28672
  v_mfma_f32_16x16x32_bf16 v[68:71], a[36:39], a[184:187], v[68:71]
  ds_read_b128 a[76:79], v2 offset:29696
  v_mfma_f32_16x16x32_bf16 v[104:107], a[36:39], a[188:191], v[104:107]
  ds_read_b128 a[80:83], v2 offset:30720
  v_mfma_f32_16x16x32_bf16 v[72:75], a[40:43], a[184:187], v[72:75]
  ds_read_b128 a[84:87], v2 offset:31744
  v_mfma_f32_16x16x32_bf16 v[108:111], a[40:43], a[188:191], v[108:111]
  ds_read_b128 a[88:91], v2 offset:32768
  v_mfma_f32_16x16x32_bf16 v[76:79], a[44:47], a[184:187], v[76:79]
  ds_read_b128 a[92:95], v2 offset:33792
  v_mfma_f32_16x16x32_bf16 v[112:115], a[44:47], a[188:191], v[112:115]
  ds_read_b128 a[96:99], v2 offset:34816
  v_mfma_f32_16x16x32_bf16 v[80:83], a[48:51], a[184:187], v[80:83]
  ds_read_b128 a[100:103], v2 offset:35840
  v_mfma_f32_16x16x32_bf16 v[116:119], a[48:51], a[188:191], v[116:119]
  s_add_u32 m0, s10, 110592
  s_add_u32 s41, s12, 27648
  v_mfma_f32_16x16x32_bf16 v[84:87], a[52:55], a[184:187], v[84:87]
  buffer_load_dwordx4 v2, s[28:31], s41 offen offset:0 sc1 lds
  v_mfma_f32_16x16x32_bf16 v[120:123], a[52:55], a[188:191], v[120:123]
  s_add_u32 s40, s58, 24576
  buffer_load_dwordx4 a[104:107], v2, s[60:63], s40 offen offset:0
  v_mfma_f32_16x16x32_bf16 v[88:91], a[56:59], a[184:187], v[88:91]
  buffer_load_dwordx4 v2, s[28:31], s41 offen offset:1024 sc1 lds
  v_mfma_f32_16x16x32_bf16 v[124:127], a[56:59], a[188:191], v[124:127]
  v_mfma_f32_16x16x32_bf16 v[92:95], a[60:63], a[184:187], v[92:95]
  buffer_load_dwordx4 a[108:111], v2, s[60:63], s40 offen offset:1024
  v_mfma_f32_16x16x32_bf16 v[128:131], a[60:63], a[188:191], v[128:131]
  v_mfma_f32_16x16x32_bf16 v[96:99], a[64:67], a[184:187], v[96:99]
  v_mfma_f32_16x16x32_bf16 v[132:135], a[64:67], a[188:191], v[132:135]
  s_waitcnt lgkmcnt(0)
  s_waitcnt vmcnt(13)
  s_barrier
  v_mfma_f32_16x16x32_bf16 v[64:67], a[68:71], a[192:195], v[64:67]
  ds_read_b128 a[32:35], v4 offset:0
  v_mfma_f32_16x16x32_bf16 v[100:103], a[68:71], a[196:199], v[100:103]
  ds_read_b128 a[36:39], v4 offset:1024
  v_mfma_f32_16x16x32_bf16 v[68:71], a[72:75], a[192:195], v[68:71]
  ds_read_b128 a[40:43], v4 offset:2048
  v_mfma_f32_16x16x32_bf16 v[104:107], a[72:75], a[196:199], v[104:107]
  ds_read_b128 a[44:47], v4 offset:3072
  v_mfma_f32_16x16x32_bf16 v[72:75], a[76:79], a[192:195], v[72:75]
  ds_read_b128 a[48:51], v4 offset:4096
  v_mfma_f32_16x16x32_bf16 v[108:111], a[76:79], a[196:199], v[108:111]
  ds_read_b128 a[52:55], v4 offset:5120
  v_mfma_f32_16x16x32_bf16 v[76:79], a[80:83], a[192:195], v[76:79]
  ds_read_b128 a[56:59], v4 offset:6144
  v_mfma_f32_16x16x32_bf16 v[112:115], a[80:83], a[196:199], v[112:115]
  ds_read_b128 a[60:63], v4 offset:7168
  v_mfma_f32_16x16x32_bf16 v[80:83], a[84:87], a[192:195], v[80:83]
  ds_read_b128 a[64:67], v4 offset:8192
  v_mfma_f32_16x16x32_bf16 v[116:119], a[84:87], a[196:199], v[116:119]
  buffer_load_dwordx4 v2, s[28:31], s41 offen offset:2048 sc1 lds
  v_mfma_f32_16x16x32_bf16 v[84:87], a[88:91], a[192:195], v[84:87]
  buffer_load_dwordx4 a[112:115], v2, s[60:63], s40 offen offset:2048
  v_mfma_f32_16x16x32_bf16 v[120:123], a[88:91], a[196:199], v[120:123]
  buffer_load_dwordx4 v2, s[28:31], s41 offen offset:3072 sc1 lds
  v_mfma_f32_16x16x32_bf16 v[88:91], a[92:95], a[192:195], v[88:91]
  v_mfma_f32_16x16x32_bf16 v[124:127], a[92:95], a[196:199], v[124:127]
  buffer_load_dwordx4 a[116:119], v2, s[60:63], s40 offen offset:3072
  v_mfma_f32_16x16x32_bf16 v[92:95], a[96:99], a[192:195], v[92:95]
  v_mfma_f32_16x16x32_bf16 v[128:131], a[96:99], a[196:199], v[128:131]
  v_mfma_f32_16x16x32_bf16 v[96:99], a[100:103], a[192:195], v[96:99]
  v_mfma_f32_16x16x32_bf16 v[132:135], a[100:103], a[196:199], v[132:135]
  s_waitcnt lgkmcnt(0)
  v_mfma_f32_16x16x32_bf16 v[64:67], a[32:35], a[200:203], v[64:67]
  ds_read_b128 a[68:71], v4 offset:9216
  v_mfma_f32_16x16x32_bf16 v[100:103], a[32:35], a[204:207], v[100:103]
  ds_read_b128 a[72:75], v4 offset:10240
  v_mfma_f32_16x16x32_bf16 v[68:71], a[36:39], a[200:203], v[68:71]
  ds_read_b128 a[76:79], v4 offset:11264
  v_mfma_f32_16x16x32_bf16 v[104:107], a[36:39], a[204:207], v[104:107]
  ds_read_b128 a[80:83], v4 offset:12288
  v_mfma_f32_16x16x32_bf16 v[72:75], a[40:43], a[200:203], v[72:75]
  ds_read_b128 a[84:87], v4 offset:13312
  v_mfma_f32_16x16x32_bf16 v[108:111], a[40:43], a[204:207], v[108:111]
  ds_read_b128 a[88:91], v4 offset:14336
  v_mfma_f32_16x16x32_bf16 v[76:79], a[44:47], a[200:203], v[76:79]
  ds_read_b128 a[92:95], v4 offset:15360
  v_mfma_f32_16x16x32_bf16 v[112:115], a[44:47], a[204:207], v[112:115]
  ds_read_b128 a[96:99], v4 offset:16384
  v_mfma_f32_16x16x32_bf16 v[80:83], a[48:51], a[200:203], v[80:83]
  ds_read_b128 a[100:103], v4 offset:17408
  v_mfma_f32_16x16x32_bf16 v[116:119], a[48:51], a[204:207], v[116:119]
  s_add_u32 m0, s10, 114688
  s_add_u32 s41, s12, 31744
  v_mfma_f32_16x16x32_bf16 v[84:87], a[52:55], a[200:203], v[84:87]
  buffer_load_dwordx4 v2, s[28:31], s41 offen offset:0 sc1 lds
  v_mfma_f32_16x16x32_bf16 v[120:123], a[52:55], a[204:207], v[120:123]
  s_add_u32 s40, s58, 28672
  buffer_load_dwordx4 a[120:123], v2, s[60:63], s40 offen offset:0
  v_mfma_f32_16x16x32_bf16 v[88:91], a[56:59], a[200:203], v[88:91]
  buffer_load_dwordx4 v2, s[28:31], s41 offen offset:1024 sc1 lds
  v_mfma_f32_16x16x32_bf16 v[124:127], a[56:59], a[204:207], v[124:127]
  buffer_load_dwordx4 a[124:127], v2, s[60:63], s40 offen offset:1024
  v_mfma_f32_16x16x32_bf16 v[92:95], a[60:63], a[200:203], v[92:95]
  v_mfma_f32_16x16x32_bf16 v[128:131], a[60:63], a[204:207], v[128:131]
  v_mfma_f32_16x16x32_bf16 v[96:99], a[64:67], a[200:203], v[96:99]
  buffer_load_dwordx4 v2, s[28:31], s41 offen offset:2048 sc1 lds
  v_mfma_f32_16x16x32_bf16 v[132:135], a[64:67], a[204:207], v[132:135]
  s_waitcnt lgkmcnt(0)
  v_mfma_f32_16x16x32_bf16 v[64:67], a[68:71], a[208:211], v[64:67]
  ds_read_b128 a[32:35], v4 offset:18432
  v_mfma_f32_16x16x32_bf16 v[100:103], a[68:71], a[212:215], v[100:103]
  ds_read_b128 a[36:39], v4 offset:19456
  v_mfma_f32_16x16x32_bf16 v[68:71], a[72:75], a[208:211], v[68:71]
  ds_read_b128 a[40:43], v4 offset:20480
  v_mfma_f32_16x16x32_bf16 v[104:107], a[72:75], a[212:215], v[104:107]
  ds_read_b128 a[44:47], v4 offset:21504
  v_mfma_f32_16x16x32_bf16 v[72:75], a[76:79], a[208:211], v[72:75]
  ds_read_b128 a[48:51], v4 offset:22528
  v_mfma_f32_16x16x32_bf16 v[108:111], a[76:79], a[212:215], v[108:111]
  ds_read_b128 a[52:55], v4 offset:23552
  v_mfma_f32_16x16x32_bf16 v[76:79], a[80:83], a[208:211], v[76:79]
  ds_read_b128 a[56:59], v4 offset:24576
  v_mfma_f32_16x16x32_bf16 v[112:115], a[80:83], a[212:215], v[112:115]
  ds_read_b128 a[60:63], v4 offset:25600
  v_mfma_f32_16x16x32_bf16 v[80:83], a[84:87], a[208:211], v[80:83]
  ds_read_b128 a[64:67], v4 offset:26624
  v_mfma_f32_16x16x32_bf16 v[116:119], a[84:87], a[212:215], v[116:119]
  buffer_load_dwordx4 a[128:131], v2, s[60:63], s40 offen offset:2048
  v_mfma_f32_16x16x32_bf16 v[84:87], a[88:91], a[208:211], v[84:87]
  buffer_load_dwordx4 v2, s[28:31], s41 offen offset:3072 sc1 lds
  v_mfma_f32_16x16x32_bf16 v[120:123], a[88:91], a[212:215], v[120:123]
  buffer_load_dwordx4 a[132:135], v2, s[60:63], s40 offen offset:3072
  v_mfma_f32_16x16x32_bf16 v[88:91], a[92:95], a[208:211], v[88:91]
  v_mfma_f32_16x16x32_bf16 v[124:127], a[92:95], a[212:215], v[124:127]
  v_mfma_f32_16x16x32_bf16 v[92:95], a[96:99], a[208:211], v[92:95]
  v_mfma_f32_16x16x32_bf16 v[128:131], a[96:99], a[212:215], v[128:131]
  s_add_u32 m0, s10, 118784
  s_add_u32 s41, s12, 35840
  v_mfma_f32_16x16x32_bf16 v[96:99], a[100:103], a[208:211], v[96:99]
  buffer_load_dwordx4 v2, s[28:31], s41 offen offset:0 sc1 lds
  v_mfma_f32_16x16x32_bf16 v[132:135], a[100:103], a[212:215], v[132:135]
  s_waitcnt lgkmcnt(0)
  v_mfma_f32_16x16x32_bf16 v[64:67], a[32:35], a[216:219], v[64:67]
  ds_read_b128 a[68:71], v4 offset:27648
  v_mfma_f32_16x16x32_bf16 v[100:103], a[32:35], a[220:223], v[100:103]
  ds_read_b128 a[72:75], v4 offset:28672
  v_mfma_f32_16x16x32_bf16 v[68:71], a[36:39], a[216:219], v[68:71]
  ds_read_b128 a[76:79], v4 offset:29696
  v_mfma_f32_16x16x32_bf16 v[104:107], a[36:39], a[220:223], v[104:107]
  ds_read_b128 a[80:83], v4 offset:30720
  v_mfma_f32_16x16x32_bf16 v[72:75], a[40:43], a[216:219], v[72:75]
  ds_read_b128 a[84:87], v4 offset:31744
  v_mfma_f32_16x16x32_bf16 v[108:111], a[40:43], a[220:223], v[108:111]
  ds_read_b128 a[88:91], v4 offset:32768
  v_mfma_f32_16x16x32_bf16 v[76:79], a[44:47], a[216:219], v[76:79]
  ds_read_b128 a[92:95], v4 offset:33792
  v_mfma_f32_16x16x32_bf16 v[112:115], a[44:47], a[220:223], v[112:115]
  ds_read_b128 a[96:99], v4 offset:34816
  v_mfma_f32_16x16x32_bf16 v[80:83], a[48:51], a[216:219], v[80:83]
  ds_read_b128 a[100:103], v4 offset:35840
  v_mfma_f32_16x16x32_bf16 v[116:119], a[48:51], a[220:223], v[116:119]
  s_add_u32 m0, s10, 0
  s_add_u32 s41, s12, 36864
  v_mfma_f32_16x16x32_bf16 v[84:87], a[52:55], a[216:219], v[84:87]
  buffer_load_dwordx4 v2, s[28:31], s41 offen offset:0 sc1 lds
  v_mfma_f32_16x16x32_bf16 v[120:123], a[52:55], a[220:223], v[120:123]
  s_add_u32 s40, s58, 32768
  buffer_load_dwordx4 a[168:171], v2, s[60:63], s40 offen offset:0
  v_mfma_f32_16x16x32_bf16 v[88:91], a[56:59], a[216:219], v[88:91]
  buffer_load_dwordx4 v2, s[28:31], s41 offen offset:1024 sc1 lds
  v_mfma_f32_16x16x32_bf16 v[124:127], a[56:59], a[220:223], v[124:127]
  v_mfma_f32_16x16x32_bf16 v[92:95], a[60:63], a[216:219], v[92:95]
  buffer_load_dwordx4 a[172:175], v2, s[60:63], s40 offen offset:1024
  v_mfma_f32_16x16x32_bf16 v[128:131], a[60:63], a[220:223], v[128:131]
  v_mfma_f32_16x16x32_bf16 v[96:99], a[64:67], a[216:219], v[96:99]
  v_mfma_f32_16x16x32_bf16 v[132:135], a[64:67], a[220:223], v[132:135]
  s_waitcnt lgkmcnt(0)
  s_waitcnt vmcnt(21)
  s_barrier
  v_mfma_f32_16x16x32_bf16 v[64:67], a[68:71], a[224:227], v[64:67]
  ds_read_b128 a[32:35], v5 offset:0
  v_mfma_f32_16x16x32_bf16 v[100:103], a[68:71], a[228:231], v[100:103]
  ds_read_b128 a[36:39], v5 offset:1024
  v_mfma_f32_16x16x32_bf16 v[68:71], a[72:75], a[224:227], v[68:71]
  ds_read_b128 a[40:43], v5 offset:2048
  v_mfma_f32_16x16x32_bf16 v[104:107], a[72:75], a[228:231], v[104:107]
  ds_read_b128 a[44:47], v5 offset:3072
  v_mfma_f32_16x16x32_bf16 v[72:75], a[76:79], a[224:227], v[72:75]
  ds_read_b128 a[48:51], v5 offset:4096
  v_mfma_f32_16x16x32_bf16 v[108:111], a[76:79], a[228:231], v[108:111]
  ds_read_b128 a[52:55], v5 offset:5120
  v_mfma_f32_16x16x32_bf16 v[76:79], a[80:83], a[224:227], v[76:79]
  ds_read_b128 a[56:59], v5 offset:6144
  v_mfma_f32_16x16x32_bf16 v[112:115], a[80:83], a[228:231], v[112:115]
  ds_read_b128 a[60:63], v5 offset:7168
  v_mfma_f32_16x16x32_bf16 v[80:83], a[84:87], a[224:227], v[80:83]
  ds_read_b128 a[64:67], v5 offset:8192
  v_mfma_f32_16x16x32_bf16 v[116:119], a[84:87], a[228:231], v[116:119]
  buffer_load_dwordx4 v2, s[28:31], s41 offen offset:2048 sc1 lds
  v_mfma_f32_16x16x32_bf16 v[84:87], a[88:91], a[224:227], v[84:87]
  buffer_load_dwordx4 a[176:179], v2, s[60:63], s40 offen offset:2048
  v_mfma_f32_16x16x32_bf16 v[120:123], a[88:91], a[228:231], v[120:123]
  buffer_load_dwordx4 v2, s[28:31], s41 offen offset:3072 sc1 lds
  v_mfma_f32_16x16x32_bf16 v[88:91], a[92:95], a[224:227], v[88:91]
  v_mfma_f32_16x16x32_bf16 v[124:127], a[92:95], a[228:231], v[124:127]
  buffer_load_dwordx4 a[180:183], v2, s[60:63], s40 offen offset:3072
  v_mfma_f32_16x16x32_bf16 v[92:95], a[96:99], a[224:227], v[92:95]
  v_mfma_f32_16x16x32_bf16 v[128:131], a[96:99], a[228:231], v[128:131]
  v_mfma_f32_16x16x32_bf16 v[96:99], a[100:103], a[224:227], v[96:99]
  v_mfma_f32_16x16x32_bf16 v[132:135], a[100:103], a[228:231], v[132:135]
  s_waitcnt lgkmcnt(0)
  v_mfma_f32_16x16x32_bf16 v[64:67], a[32:35], a[0:3], v[64:67]
  ds_read_b128 a[68:71], v5 offset:9216
  v_mfma_f32_16x16x32_bf16 v[100:103], a[32:35], a[4:7], v[100:103]
  ds_read_b128 a[72:75], v5 offset:10240
  v_permlane32_swap_b32 v224, v228
  v_mfma_f32_16x16x32_bf16 v[68:71], a[36:39], a[0:3], v[68:71]
  ds_read_b128 a[76:79], v5 offset:11264
  v_mfma_f32_16x16x32_bf16 v[104:107], a[36:39], a[4:7], v[104:107]
  ds_read_b128 a[80:83], v5 offset:12288
  v_permlane32_swap_b32 v225, v229
  v_mfma_f32_16x16x32_bf16 v[72:75], a[40:43], a[0:3], v[72:75]
  ds_read_b128 a[84:87], v5 offset:13312
  v_mfma_f32_16x16x32_bf16 v[108:111], a[40:43], a[4:7], v[108:111]
  ds_read_b128 a[88:91], v5 offset:14336
  v_permlane32_swap_b32 v226, v230
  v_mfma_f32_16x16x32_bf16 v[76:79], a[44:47], a[0:3], v[76:79]
  ds_read_b128 a[92:95], v5 offset:15360
  v_mfma_f32_16x16x32_bf16 v[112:115], a[44:47], a[4:7], v[112:115]
  ds_read_b128 a[96:99], v5 offset:16384
  v_permlane32_swap_b32 v227, v231
  v_mfma_f32_16x16x32_bf16 v[80:83], a[48:51], a[0:3], v[80:83]
  ds_read_b128 a[100:103], v5 offset:17408
  v_mfma_f32_16x16x32_bf16 v[116:119], a[48:51], a[4:7], v[116:119]
  s_add_u32 m0, s10, 4096
  s_add_u32 s41, s12, 40960
  v_mfma_f32_16x16x32_bf16 v[84:87], a[52:55], a[0:3], v[84:87]
  buffer_load_dwordx4 v2, s[28:31], s41 offen offset:0 sc1 lds
  v_mfma_f32_16x16x32_bf16 v[120:123], a[52:55], a[4:7], v[120:123]
  s_add_u32 s40, s58, 36864
  buffer_load_dwordx4 a[184:187], v2, s[60:63], s40 offen offset:0
  v_mfma_f32_16x16x32_bf16 v[88:91], a[56:59], a[0:3], v[88:91]
  buffer_load_dwordx4 v2, s[28:31], s41 offen offset:1024 sc1 lds
  v_mfma_f32_16x16x32_bf16 v[124:127], a[56:59], a[4:7], v[124:127]
  buffer_load_dwordx4 a[188:191], v2, s[60:63], s40 offen offset:1024
  v_mfma_f32_16x16x32_bf16 v[92:95], a[60:63], a[0:3], v[92:95]
  v_mfma_f32_16x16x32_bf16 v[128:131], a[60:63], a[4:7], v[128:131]
  v_mfma_f32_16x16x32_bf16 v[96:99], a[64:67], a[0:3], v[96:99]
  buffer_load_dwordx4 v2, s[28:31], s41 offen offset:2048 sc1 lds
  v_mfma_f32_16x16x32_bf16 v[132:135], a[64:67], a[4:7], v[132:135]
  s_waitcnt lgkmcnt(0)
  v_mfma_f32_16x16x32_bf16 v[64:67], a[68:71], a[8:11], v[64:67]
  ds_read_b128 a[32:35], v5 offset:18432
  v_mfma_f32_16x16x32_bf16 v[100:103], a[68:71], a[12:15], v[100:103]
  ds_read_b128 a[36:39], v5 offset:19456
  v_permlane32_swap_b32 v232, v236
  v_mfma_f32_16x16x32_bf16 v[68:71], a[72:75], a[8:11], v[68:71]
  ds_read_b128 a[40:43], v5 offset:20480
  v_mfma_f32_16x16x32_bf16 v[104:107], a[72:75], a[12:15], v[104:107]
  ds_read_b128 a[44:47], v5 offset:21504
  v_permlane32_swap_b32 v233, v237
  v_mfma_f32_16x16x32_bf16 v[72:75], a[76:79], a[8:11], v[72:75]
  ds_read_b128 a[48:51], v5 offset:22528
  v_mfma_f32_16x16x32_bf16 v[108:111], a[76:79], a[12:15], v[108:111]
  ds_read_b128 a[52:55], v5 offset:23552
  v_permlane32_swap_b32 v234, v238
  v_mfma_f32_16x16x32_bf16 v[76:79], a[80:83], a[8:11], v[76:79]
  ds_read_b128 a[56:59], v5 offset:24576
  v_mfma_f32_16x16x32_bf16 v[112:115], a[80:83], a[12:15], v[112:115]
  ds_read_b128 a[60:63], v5 offset:25600
  v_permlane32_swap_b32 v235, v239
  v_mfma_f32_16x16x32_bf16 v[80:83], a[84:87], a[8:11], v[80:83]
  ds_read_b128 a[64:67], v5 offset:26624
  v_mfma_f32_16x16x32_bf16 v[116:119], a[84:87], a[12:15], v[116:119]
  buffer_load_dwordx4 a[192:195], v2, s[60:63], s40 offen offset:2048
  v_mfma_f32_16x16x32_bf16 v[84:87], a[88:91], a[8:11], v[84:87]
  buffer_load_dwordx4 v2, s[28:31], s41 offen offset:3072 sc1 lds
  v_mfma_f32_16x16x32_bf16 v[120:123], a[88:91], a[12:15], v[120:123]
  buffer_load_dwordx4 a[196:199], v2, s[60:63], s40 offen offset:3072
  v_mfma_f32_16x16x32_bf16 v[88:91], a[92:95], a[8:11], v[88:91]
  v_mfma_f32_16x16x32_bf16 v[124:127], a[92:95], a[12:15], v[124:127]
  v_mfma_f32_16x16x32_bf16 v[92:95], a[96:99], a[8:11], v[92:95]
  v_mfma_f32_16x16x32_bf16 v[128:131], a[96:99], a[12:15], v[128:131]
  s_add_u32 m0, s10, 8192
  s_add_u32 s41, s12, 45056
  v_mfma_f32_16x16x32_bf16 v[96:99], a[100:103], a[8:11], v[96:99]
  buffer_load_dwordx4 v2, s[28:31], s41 offen offset:0 sc1 lds
  v_mfma_f32_16x16x32_bf16 v[132:135], a[100:103], a[12:15], v[132:135]
  s_waitcnt lgkmcnt(0)
  v_mfma_f32_16x16x32_bf16 v[64:67], a[32:35], a[16:19], v[64:67]
  ds_read_b128 a[68:71], v5 offset:27648
  v_mfma_f32_16x16x32_bf16 v[100:103], a[32:35], a[20:23], v[100:103]
  ds_read_b128 a[72:75], v5 offset:28672
  v_permlane32_swap_b32 v240, v244
  v_mfma_f32_16x16x32_bf16 v[68:71], a[36:39], a[16:19], v[68:71]
  ds_read_b128 a[76:79], v5 offset:29696
  v_mfma_f32_16x16x32_bf16 v[104:107], a[36:39], a[20:23], v[104:107]
  ds_read_b128 a[80:83], v5 offset:30720
  v_permlane32_swap_b32 v241, v245
  v_mfma_f32_16x16x32_bf16 v[72:75], a[40:43], a[16:19], v[72:75]
  ds_read_b128 a[84:87], v5 offset:31744
  v_mfma_f32_16x16x32_bf16 v[108:111], a[40:43], a[20:23], v[108:111]
  ds_read_b128 a[88:91], v5 offset:32768
  v_permlane32_swap_b32 v242, v246
  v_mfma_f32_16x16x32_bf16 v[76:79], a[44:47], a[16:19], v[76:79]
  ds_read_b128 a[92:95], v5 offset:33792
  v_mfma_f32_16x16x32_bf16 v[112:115], a[44:47], a[20:23], v[112:115]
  ds_read_b128 a[96:99], v5 offset:34816
  v_permlane32_swap_b32 v243, v247
  v_mfma_f32_16x16x32_bf16 v[80:83], a[48:51], a[16:19], v[80:83]
  ds_read_b128 a[100:103], v5 offset:35840
  v_mfma_f32_16x16x32_bf16 v[116:119], a[48:51], a[20:23], v[116:119]
  s_add_u32 m0, s10, 36864
  s_add_u32 s41, s12, 46080
  v_mfma_f32_16x16x32_bf16 v[84:87], a[52:55], a[16:19], v[84:87]
  buffer_load_dwordx4 v2, s[28:31], s41 offen offset:0 sc1 lds
  v_mfma_f32_16x16x32_bf16 v[120:123], a[52:55], a[20:23], v[120:123]
  s_add_u32 s40, s58, 40960
  buffer_load_dwordx4 a[200:203], v2, s[60:63], s40 offen offset:0
  v_mfma_f32_16x16x32_bf16 v[88:91], a[56:59], a[16:19], v[88:91]
  buffer_load_dwordx4 v2, s[28:31], s41 offen offset:1024 sc1 lds
  v_mfma_f32_16x16x32_bf16 v[124:127], a[56:59], a[20:23], v[124:127]
  v_mfma_f32_16x16x32_bf16 v[92:95], a[60:63], a[16:19], v[92:95]
  buffer_load_dwordx4 a[204:207], v2, s[60:63], s40 offen offset:1024
  v_mfma_f32_16x16x32_bf16 v[128:131], a[60:63], a[20:23], v[128:131]
  v_mfma_f32_16x16x32_bf16 v[96:99], a[64:67], a[16:19], v[96:99]
  v_mfma_f32_16x16x32_bf16 v[132:135], a[64:67], a[20:23], v[132:135]
  s_waitcnt lgkmcnt(0)
  s_waitcnt vmcnt(21)
  s_barrier
  v_mfma_f32_16x16x32_bf16 v[64:67], a[68:71], a[24:27], v[64:67]
  ds_read_b128 a[32:35], v6 offset:0
  v_mfma_f32_16x16x32_bf16 v[100:103], a[68:71], a[28:31], v[100:103]
  ds_read_b128 a[36:39], v6 offset:1024
  v_permlane32_swap_b32 v248, v252
  v_mfma_f32_16x16x32_bf16 v[68:71], a[72:75], a[24:27], v[68:71]
  ds_read_b128 a[40:43], v6 offset:2048
  v_mfma_f32_16x16x32_bf16 v[104:107], a[72:75], a[28:31], v[104:107]
  ds_read_b128 a[44:47], v6 offset:3072
  v_permlane32_swap_b32 v249, v253
  v_mfma_f32_16x16x32_bf16 v[72:75], a[76:79], a[24:27], v[72:75]
  ds_read_b128 a[48:51], v6 offset:4096
  v_mfma_f32_16x16x32_bf16 v[108:111], a[76:79], a[28:31], v[108:111]
  ds_read_b128 a[52:55], v6 offset:5120
  v_permlane32_swap_b32 v250, v254
  v_mfma_f32_16x16x32_bf16 v[76:79], a[80:83], a[24:27], v[76:79]
  ds_read_b128 a[56:59], v6 offset:6144
  v_mfma_f32_16x16x32_bf16 v[112:115], a[80:83], a[28:31], v[112:115]
  ds_read_b128 a[60:63], v6 offset:7168
  v_permlane32_swap_b32 v251, v255
  v_mfma_f32_16x16x32_bf16 v[80:83], a[84:87], a[24:27], v[80:83]
  ds_read_b128 a[64:67], v6 offset:8192
  v_mfma_f32_16x16x32_bf16 v[116:119], a[84:87], a[28:31], v[116:119]
  buffer_load_dwordx4 v2, s[28:31], s41 offen offset:2048 sc1 lds
  v_mfma_f32_16x16x32_bf16 v[84:87], a[88:91], a[24:27], v[84:87]
  buffer_load_dwordx4 a[208:211], v2, s[60:63], s40 offen offset:2048
  v_mfma_f32_16x16x32_bf16 v[120:123], a[88:91], a[28:31], v[120:123]
  buffer_load_dwordx4 v2, s[28:31], s41 offen offset:3072 sc1 lds
  v_mfma_f32_16x16x32_bf16 v[88:91], a[92:95], a[24:27], v[88:91]
  v_mfma_f32_16x16x32_bf16 v[124:127], a[92:95], a[28:31], v[124:127]
  buffer_load_dwordx4 a[212:215], v2, s[60:63], s40 offen offset:3072
  v_mfma_f32_16x16x32_bf16 v[92:95], a[96:99], a[24:27], v[92:95]
  v_mfma_f32_16x16x32_bf16 v[128:131], a[96:99], a[28:31], v[128:131]
  v_mfma_f32_16x16x32_bf16 v[96:99], a[100:103], a[24:27], v[96:99]
  v_mfma_f32_16x16x32_bf16 v[132:135], a[100:103], a[28:31], v[132:135]
  s_waitcnt lgkmcnt(0)
  v_mfma_f32_16x16x32_bf16 v[64:67], a[32:35], a[104:107], v[64:67]
  ds_read_b128 a[68:71], v6 offset:9216
  v_mfma_f32_16x16x32_bf16 v[100:103], a[32:35], a[108:111], v[100:103]
  ds_read_b128 a[72:75], v6 offset:10240
  v_permlane16_swap_b32 v224, v228
  v_mfma_f32_16x16x32_bf16 v[68:71], a[36:39], a[104:107], v[68:71]
  ds_read_b128 a[76:79], v6 offset:11264
  v_mfma_f32_16x16x32_bf16 v[104:107], a[36:39], a[108:111], v[104:107]
  ds_read_b128 a[80:83], v6 offset:12288
  v_permlane16_swap_b32 v225, v229
  v_mfma_f32_16x16x32_bf16 v[72:75], a[40:43], a[104:107], v[72:75]
  ds_read_b128 a[84:87], v6 offset:13312
  v_mfma_f32_16x16x32_bf16 v[108:111], a[40:43], a[108:111], v[108:111]
  ds_read_b128 a[88:91], v6 offset:14336
  v_permlane16_swap_b32 v226, v230
  v_mfma_f32_16x16x32_bf16 v[76:79], a[44:47], a[104:107], v[76:79]
  ds_read_b128 a[92:95], v6 offset:15360
  v_mfma_f32_16x16x32_bf16 v[112:115], a[44:47], a[108:111], v[112:115]
  ds_read_b128 a[96:99], v6 offset:16384
  v_permlane16_swap_b32 v227, v231
  v_mfma_f32_16x16x32_bf16 v[80:83], a[48:51], a[104:107], v[80:83]
  ds_read_b128 a[100:103], v6 offset:17408
  v_mfma_f32_16x16x32_bf16 v[116:119], a[48:51], a[108:111], v[116:119]
  s_add_u32 m0, s10, 40960
  s_add_u32 s41, s12, 50176
  v_mfma_f32_16x16x32_bf16 v[84:87], a[52:55], a[104:107], v[84:87]
  buffer_load_dwordx4 v2, s[28:31], s41 offen offset:0 sc1 lds
  v_mfma_f32_16x16x32_bf16 v[120:123], a[52:55], a[108:111], v[120:123]
  s_add_u32 s40, s58, 45056
  buffer_load_dwordx4 a[216:219], v2, s[60:63], s40 offen offset:0
  v_mfma_f32_16x16x32_bf16 v[88:91], a[56:59], a[104:107], v[88:91]
  buffer_load_dwordx4 v2, s[28:31], s41 offen offset:1024 sc1 lds
  v_mfma_f32_16x16x32_bf16 v[124:127], a[56:59], a[108:111], v[124:127]
  buffer_load_dwordx4 a[220:223], v2, s[60:63], s40 offen offset:1024
  v_mfma_f32_16x16x32_bf16 v[92:95], a[60:63], a[104:107], v[92:95]
  v_mfma_f32_16x16x32_bf16 v[128:131], a[60:63], a[108:111], v[128:131]
  v_mfma_f32_16x16x32_bf16 v[96:99], a[64:67], a[104:107], v[96:99]
  buffer_load_dwordx4 v2, s[28:31], s41 offen offset:2048 sc1 lds
  v_mfma_f32_16x16x32_bf16 v[132:135], a[64:67], a[108:111], v[132:135]
  s_waitcnt lgkmcnt(0)
  v_mfma_f32_16x16x32_bf16 v[64:67], a[68:71], a[112:115], v[64:67]
  ds_read_b128 a[32:35], v6 offset:18432
  v_mfma_f32_16x16x32_bf16 v[100:103], a[68:71], a[116:119], v[100:103]
  ds_read_b128 a[36:39], v6 offset:19456
  v_permlane16_swap_b32 v232, v236
  v_mfma_f32_16x16x32_bf16 v[68:71], a[72:75], a[112:115], v[68:71]
  ds_read_b128 a[40:43], v6 offset:20480
  v_mfma_f32_16x16x32_bf16 v[104:107], a[72:75], a[116:119], v[104:107]
  ds_read_b128 a[44:47], v6 offset:21504
  v_permlane16_swap_b32 v233, v237
  v_mfma_f32_16x16x32_bf16 v[72:75], a[76:79], a[112:115], v[72:75]
  ds_read_b128 a[48:51], v6 offset:22528
  v_mfma_f32_16x16x32_bf16 v[108:111], a[76:79], a[116:119], v[108:111]
  ds_read_b128 a[52:55], v6 offset:23552
  v_permlane16_swap_b32 v234, v238
  v_mfma_f32_16x16x32_bf16 v[76:79], a[80:83], a[112:115], v[76:79]
  ds_read_b128 a[56:59], v6 offset:24576
  v_mfma_f32_16x16x32_bf16 v[112:115], a[80:83], a[116:119], v[112:115]
  ds_read_b128 a[60:63], v6 offset:25600
  v_permlane16_swap_b32 v235, v239
  v_mfma_f32_16x16x32_bf16 v[80:83], a[84:87], a[112:115], v[80:83]
  ds_read_b128 a[64:67], v6 offset:26624
  v_mfma_f32_16x16x32_bf16 v[116:119], a[84:87], a[116:119], v[116:119]
  buffer_load_dwordx4 a[224:227], v2, s[60:63], s40 offen offset:2048
  v_mfma_f32_16x16x32_bf16 v[84:87], a[88:91], a[112:115], v[84:87]
  buffer_load_dwordx4 v2, s[28:31], s41 offen offset:3072 sc1 lds
  v_mfma_f32_16x16x32_bf16 v[120:123], a[88:91], a[116:119], v[120:123]
  buffer_load_dwordx4 a[228:231], v2, s[60:63], s40 offen offset:3072
  v_mfma_f32_16x16x32_bf16 v[88:91], a[92:95], a[112:115], v[88:91]
  v_mfma_f32_16x16x32_bf16 v[124:127], a[92:95], a[116:119], v[124:127]
  v_mfma_f32_16x16x32_bf16 v[92:95], a[96:99], a[112:115], v[92:95]
  v_mfma_f32_16x16x32_bf16 v[128:131], a[96:99], a[116:119], v[128:131]
  s_add_u32 m0, s10, 45056
  s_add_u32 s41, s12, 54272
  v_mfma_f32_16x16x32_bf16 v[96:99], a[100:103], a[112:115], v[96:99]
  buffer_load_dwordx4 v2, s[28:31], s41 offen offset:0 sc1 lds
  v_mfma_f32_16x16x32_bf16 v[132:135], a[100:103], a[116:119], v[132:135]
  s_waitcnt lgkmcnt(0)
  v_mfma_f32_16x16x32_bf16 v[64:67], a[32:35], a[120:123], v[64:67]
  ds_read_b128 a[68:71], v6 offset:27648
  v_mfma_f32_16x16x32_bf16 v[100:103], a[32:35], a[124:127], v[100:103]
  ds_read_b128 a[72:75], v6 offset:28672
  v_permlane16_swap_b32 v240, v244
  v_mfma_f32_16x16x32_bf16 v[68:71], a[36:39], a[120:123], v[68:71]
  ds_read_b128 a[76:79], v6 offset:29696
  v_mfma_f32_16x16x32_bf16 v[104:107], a[36:39], a[124:127], v[104:107]
  ds_read_b128 a[80:83], v6 offset:30720
  v_permlane16_swap_b32 v241, v245
  v_mfma_f32_16x16x32_bf16 v[72:75], a[40:43], a[120:123], v[72:75]
  ds_read_b128 a[84:87], v6 offset:31744
  v_mfma_f32_16x16x32_bf16 v[108:111], a[40:43], a[124:127], v[108:111]
  ds_read_b128 a[88:91], v6 offset:32768
  v_permlane16_swap_b32 v242, v246
  v_mfma_f32_16x16x32_bf16 v[76:79], a[44:47], a[120:123], v[76:79]
  ds_read_b128 a[92:95], v6 offset:33792
  v_mfma_f32_16x16x32_bf16 v[112:115], a[44:47], a[124:127], v[112:115]
  ds_read_b128 a[96:99], v6 offset:34816
  v_permlane16_swap_b32 v243, v247
  v_mfma_f32_16x16x32_bf16 v[80:83], a[48:51], a[120:123], v[80:83]
  ds_read_b128 a[100:103], v6 offset:35840
  v_mfma_f32_16x16x32_bf16 v[116:119], a[48:51], a[124:127], v[116:119]
  s_add_u32 m0, s10, 73728
  s_add_u32 s41, s12, 55296
  v_mfma_f32_16x16x32_bf16 v[84:87], a[52:55], a[120:123], v[84:87]
  buffer_load_dwordx4 v2, s[28:31], s41 offen offset:0 sc1 lds
  v_mfma_f32_16x16x32_bf16 v[120:123], a[52:55], a[124:127], v[120:123]
  s_add_u32 s40, s58, 49152
  buffer_load_dwordx4 a[0:3], v2, s[60:63], s40 offen offset:0
  v_mfma_f32_16x16x32_bf16 v[88:91], a[56:59], a[120:123], v[88:91]
  buffer_load_dwordx4 v2, s[28:31], s41 offen offset:1024 sc1 lds
  v_mfma_f32_16x16x32_bf16 v[124:127], a[56:59], a[124:127], v[124:127]
  v_mfma_f32_16x16x32_bf16 v[92:95], a[60:63], a[120:123], v[92:95]
  buffer_load_dwordx4 a[4:7], v2, s[60:63], s40 offen offset:1024
  v_mfma_f32_16x16x32_bf16 v[128:131], a[60:63], a[124:127], v[128:131]
  v_mfma_f32_16x16x32_bf16 v[96:99], a[64:67], a[120:123], v[96:99]
  v_mfma_f32_16x16x32_bf16 v[132:135], a[64:67], a[124:127], v[132:135]
  s_waitcnt lgkmcnt(0)
  s_waitcnt vmcnt(21)
  s_barrier
  v_mfma_f32_16x16x32_bf16 v[64:67], a[68:71], a[128:131], v[64:67]
  ds_read_b128 a[32:35], v2 offset:0
  v_mfma_f32_16x16x32_bf16 v[100:103], a[68:71], a[132:135], v[100:103]
  ds_read_b128 a[36:39], v2 offset:1024
  v_permlane16_swap_b32 v248, v252
  v_mfma_f32_16x16x32_bf16 v[68:71], a[72:75], a[128:131], v[68:71]
  ds_read_b128 a[40:43], v2 offset:2048
  v_mfma_f32_16x16x32_bf16 v[104:107], a[72:75], a[132:135], v[104:107]
  ds_read_b128 a[44:47], v2 offset:3072
  v_permlane16_swap_b32 v249, v253
  v_mfma_f32_16x16x32_bf16 v[72:75], a[76:79], a[128:131], v[72:75]
  ds_read_b128 a[48:51], v2 offset:4096
  v_mfma_f32_16x16x32_bf16 v[108:111], a[76:79], a[132:135], v[108:111]
  ds_read_b128 a[52:55], v2 offset:5120
  v_permlane16_swap_b32 v250, v254
  v_mfma_f32_16x16x32_bf16 v[76:79], a[80:83], a[128:131], v[76:79]
  ds_read_b128 a[56:59], v2 offset:6144
  v_mfma_f32_16x16x32_bf16 v[112:115], a[80:83], a[132:135], v[112:115]
  ds_read_b128 a[60:63], v2 offset:7168
  v_permlane16_swap_b32 v251, v255
  v_mfma_f32_16x16x32_bf16 v[80:83], a[84:87], a[128:131], v[80:83]
  ds_read_b128 a[64:67], v2 offset:8192
  v_mfma_f32_16x16x32_bf16 v[116:119], a[84:87], a[132:135], v[116:119]
  buffer_load_dwordx4 v2, s[28:31], s41 offen offset:2048 sc1 lds
  v_mfma_f32_16x16x32_bf16 v[84:87], a[88:91], a[128:131], v[84:87]
  buffer_load_dwordx4 a[8:11], v2, s[60:63], s40 offen offset:2048
  v_mfma_f32_16x16x32_bf16 v[120:123], a[88:91], a[132:135], v[120:123]
  buffer_load_dwordx4 v2, s[28:31], s41 offen offset:3072 sc1 lds
  v_mfma_f32_16x16x32_bf16 v[88:91], a[92:95], a[128:131], v[88:91]
  v_mfma_f32_16x16x32_bf16 v[124:127], a[92:95], a[132:135], v[124:127]
  buffer_load_dwordx4 a[12:15], v2, s[60:63], s40 offen offset:3072
  v_mfma_f32_16x16x32_bf16 v[92:95], a[96:99], a[128:131], v[92:95]
  v_mfma_f32_16x16x32_bf16 v[128:131], a[96:99], a[132:135], v[128:131]
  v_mfma_f32_16x16x32_bf16 v[96:99], a[100:103], a[128:131], v[96:99]
  v_mfma_f32_16x16x32_bf16 v[132:135], a[100:103], a[132:135], v[132:135]
  s_waitcnt lgkmcnt(0)
  v_mfma_f32_16x16x32_bf16 v[64:67], a[32:35], a[168:171], v[64:67]
  ds_read_b128 a[68:71], v2 offset:9216
  v_mfma_f32_16x16x32_bf16 v[100:103], a[32:35], a[172:175], v[100:103]
  ds_read_b128 a[72:75], v2 offset:10240
  v_mfma_f32_16x16x32_bf16 v[68:71], a[36:39], a[168:171], v[68:71]
  ds_read_b128 a[76:79], v2 offset:11264
  v_mfma_f32_16x16x32_bf16 v[104:107], a[36:39], a[172:175], v[104:107]
  ds_read_b128 a[80:83], v2 offset:12288
  v_mfma_f32_16x16x32_bf16 v[72:75], a[40:43], a[168:171], v[72:75]
  ds_read_b128 a[84:87], v2 offset:13312
  v_mfma_f32_16x16x32_bf16 v[108:111], a[40:43], a[172:175], v[108:111]
  ds_read_b128 a[88:91], v2 offset:14336
  v_mfma_f32_16x16x32_bf16 v[76:79], a[44:47], a[168:171], v[76:79]
  ds_read_b128 a[92:95], v2 offset:15360
  v_mfma_f32_16x16x32_bf16 v[112:115], a[44:47], a[172:175], v[112:115]
  ds_read_b128 a[96:99], v2 offset:16384
  v_mfma_f32_16x16x32_bf16 v[80:83], a[48:51], a[168:171], v[80:83]
  ds_read_b128 a[100:103], v2 offset:17408
  v_mfma_f32_16x16x32_bf16 v[116:119], a[48:51], a[172:175], v[116:119]
  s_add_u32 m0, s10, 77824
  s_add_u32 s41, s12, 59392
  v_mfma_f32_16x16x32_bf16 v[84:87], a[52:55], a[168:171], v[84:87]
  buffer_load_dwordx4 v2, s[28:31], s41 offen offset:0 sc1 lds
  v_mfma_f32_16x16x32_bf16 v[120:123], a[52:55], a[172:175], v[120:123]
  s_add_u32 s40, s58, 53248
  buffer_load_dwordx4 a[16:19], v2, s[60:63], s40 offen offset:0
  v_mfma_f32_16x16x32_bf16 v[88:91], a[56:59], a[168:171], v[88:91]
  buffer_load_dwordx4 v2, s[28:31], s41 offen offset:1024 sc1 lds
  v_mfma_f32_16x16x32_bf16 v[124:127], a[56:59], a[172:175], v[124:127]
  buffer_load_dwordx4 a[20:23], v2, s[60:63], s40 offen offset:1024
  v_mfma_f32_16x16x32_bf16 v[92:95], a[60:63], a[168:171], v[92:95]
  v_mfma_f32_16x16x32_bf16 v[128:131], a[60:63], a[172:175], v[128:131]
  v_mfma_f32_16x16x32_bf16 v[96:99], a[64:67], a[168:171], v[96:99]
  buffer_load_dwordx4 v2, s[28:31], s41 offen offset:2048 sc1 lds
  v_mfma_f32_16x16x32_bf16 v[132:135], a[64:67], a[172:175], v[132:135]
  s_waitcnt lgkmcnt(0)
  v_mfma_f32_16x16x32_bf16 v[64:67], a[68:71], a[176:179], v[64:67]
  ds_read_b128 a[32:35], v2 offset:18432
  v_mfma_f32_16x16x32_bf16 v[100:103], a[68:71], a[180:183], v[100:103]
  ds_read_b128 a[36:39], v2 offset:19456
  v_mfma_f32_16x16x32_bf16 v[68:71], a[72:75], a[176:179], v[68:71]
  ds_read_b128 a[40:43], v2 offset:20480
  v_mfma_f32_16x16x32_bf16 v[104:107], a[72:75], a[180:183], v[104:107]
  ds_read_b128 a[44:47], v2 offset:21504
  v_mfma_f32_16x16x32_bf16 v[72:75], a[76:79], a[176:179], v[72:75]
  ds_read_b128 a[48:51], v2 offset:22528
  v_mfma_f32_16x16x32_bf16 v[108:111], a[76:79], a[180:183], v[108:111]
  ds_read_b128 a[52:55], v2 offset:23552
  v_mfma_f32_16x16x32_bf16 v[76:79], a[80:83], a[176:179], v[76:79]
  ds_read_b128 a[56:59], v2 offset:24576
  v_mfma_f32_16x16x32_bf16 v[112:115], a[80:83], a[180:183], v[112:115]
  ds_read_b128 a[60:63], v2 offset:25600
  v_mfma_f32_16x16x32_bf16 v[80:83], a[84:87], a[176:179], v[80:83]
  ds_read_b128 a[64:67], v2 offset:26624
  v_mfma_f32_16x16x32_bf16 v[116:119], a[84:87], a[180:183], v[116:119]
  buffer_load_dwordx4 a[24:27], v2, s[60:63], s40 offen offset:2048
  v_mfma_f32_16x16x32_bf16 v[84:87], a[88:91], a[176:179], v[84:87]
  buffer_load_dwordx4 v2, s[28:31], s41 offen offset:3072 sc1 lds
  v_mfma_f32_16x16x32_bf16 v[120:123], a[88:91], a[180:183], v[120:123]
  buffer_load_dwordx4 a[28:31], v2, s[60:63], s40 offen offset:3072
  v_mfma_f32_16x16x32_bf16 v[88:91], a[92:95], a[176:179], v[88:91]
  v_mfma_f32_16x16x32_bf16 v[124:127], a[92:95], a[180:183], v[124:127]
  v_mfma_f32_16x16x32_bf16 v[92:95], a[96:99], a[176:179], v[92:95]
  v_mfma_f32_16x16x32_bf16 v[128:131], a[96:99], a[180:183], v[128:131]
  s_add_u32 m0, s10, 81920
  s_add_u32 s41, s12, 63488
  v_mfma_f32_16x16x32_bf16 v[96:99], a[100:103], a[176:179], v[96:99]
  buffer_load_dwordx4 v2, s[28:31], s41 offen offset:0 sc1 lds
  v_mfma_f32_16x16x32_bf16 v[132:135], a[100:103], a[180:183], v[132:135]
  s_waitcnt lgkmcnt(0)
  v_mfma_f32_16x16x32_bf16 v[64:67], a[32:35], a[184:187], v[64:67]
  ds_read_b128 a[68:71], v2 offset:27648
  v_mfma_f32_16x16x32_bf16 v[100:103], a[32:35], a[188:191], v[100:103]
  ds_read_b128 a[72:75], v2 offset:28672
  v_mfma_f32_16x16x32_bf16 v[68:71], a[36:39], a[184:187], v[68:71]
  ds_read_b128 a[76:79], v2 offset:29696
  v_mfma_f32_16x16x32_bf16 v[104:107], a[36:39], a[188:191], v[104:107]
  ds_read_b128 a[80:83], v2 offset:30720
  v_mfma_f32_16x16x32_bf16 v[72:75], a[40:43], a[184:187], v[72:75]
  ds_read_b128 a[84:87], v2 offset:31744
  v_mfma_f32_16x16x32_bf16 v[108:111], a[40:43], a[188:191], v[108:111]
  ds_read_b128 a[88:91], v2 offset:32768
  v_mfma_f32_16x16x32_bf16 v[76:79], a[44:47], a[184:187], v[76:79]
  ds_read_b128 a[92:95], v2 offset:33792
  v_mfma_f32_16x16x32_bf16 v[112:115], a[44:47], a[188:191], v[112:115]
  ds_read_b128 a[96:99], v2 offset:34816
  v_mfma_f32_16x16x32_bf16 v[80:83], a[48:51], a[184:187], v[80:83]
  ds_read_b128 a[100:103], v2 offset:35840
  v_mfma_f32_16x16x32_bf16 v[116:119], a[48:51], a[188:191], v[116:119]
  s_add_u32 m0, s10, 110592
  s_add_u32 s41, s12, 64512
  v_mfma_f32_16x16x32_bf16 v[84:87], a[52:55], a[184:187], v[84:87]
  buffer_load_dwordx4 v2, s[28:31], s41 offen offset:0 sc1 lds
  v_mfma_f32_16x16x32_bf16 v[120:123], a[52:55], a[188:191], v[120:123]
  s_add_u32 s40, s58, 57344
  buffer_load_dwordx4 a[104:107], v2, s[60:63], s40 offen offset:0
  v_mfma_f32_16x16x32_bf16 v[88:91], a[56:59], a[184:187], v[88:91]
  buffer_load_dwordx4 v2, s[28:31], s41 offen offset:1024 sc1 lds
  v_mfma_f32_16x16x32_bf16 v[124:127], a[56:59], a[188:191], v[124:127]
  v_mfma_f32_16x16x32_bf16 v[92:95], a[60:63], a[184:187], v[92:95]
  buffer_load_dwordx4 a[108:111], v2, s[60:63], s40 offen offset:1024
  v_mfma_f32_16x16x32_bf16 v[128:131], a[60:63], a[188:191], v[128:131]
  v_mfma_f32_16x16x32_bf16 v[96:99], a[64:67], a[184:187], v[96:99]
  v_mfma_f32_16x16x32_bf16 v[132:135], a[64:67], a[188:191], v[132:135]
  s_waitcnt lgkmcnt(0)
  s_waitcnt vmcnt(21)
  s_barrier
  v_mfma_f32_16x16x32_bf16 v[64:67], a[68:71], a[192:195], v[64:67]
  ds_read_b128 a[32:35], v4 offset:0
  v_mfma_f32_16x16x32_bf16 v[100:103], a[68:71], a[196:199], v[100:103]
  ds_read_b128 a[36:39], v4 offset:1024
  v_mfma_f32_16x16x32_bf16 v[68:71], a[72:75], a[192:195], v[68:71]
  ds_read_b128 a[40:43], v4 offset:2048
  v_mfma_f32_16x16x32_bf16 v[104:107], a[72:75], a[196:199], v[104:107]
  ds_read_b128 a[44:47], v4 offset:3072
  v_mfma_f32_16x16x32_bf16 v[72:75], a[76:79], a[192:195], v[72:75]
  ds_read_b128 a[48:51], v4 offset:4096
  v_mfma_f32_16x16x32_bf16 v[108:111], a[76:79], a[196:199], v[108:111]
  ds_read_b128 a[52:55], v4 offset:5120
  v_mfma_f32_16x16x32_bf16 v[76:79], a[80:83], a[192:195], v[76:79]
  ds_read_b128 a[56:59], v4 offset:6144
  v_mfma_f32_16x16x32_bf16 v[112:115], a[80:83], a[196:199], v[112:115]
  ds_read_b128 a[60:63], v4 offset:7168
  v_mfma_f32_16x16x32_bf16 v[80:83], a[84:87], a[192:195], v[80:83]
  ds_read_b128 a[64:67], v4 offset:8192
  v_mfma_f32_16x16x32_bf16 v[116:119], a[84:87], a[196:199], v[116:119]
  buffer_load_dwordx4 v2, s[28:31], s41 offen offset:2048 sc1 lds
  v_mfma_f32_16x16x32_bf16 v[84:87], a[88:91], a[192:195], v[84:87]
  buffer_load_dwordx4 a[112:115], v2, s[60:63], s40 offen offset:2048
  v_mfma_f32_16x16x32_bf16 v[120:123], a[88:91], a[196:199], v[120:123]
  buffer_load_dwordx4 v2, s[28:31], s41 offen offset:3072 sc1 lds
  v_mfma_f32_16x16x32_bf16 v[88:91], a[92:95], a[192:195], v[88:91]
  v_mfma_f32_16x16x32_bf16 v[124:127], a[92:95], a[196:199], v[124:127]
  buffer_load_dwordx4 a[116:119], v2, s[60:63], s40 offen offset:3072
  v_mfma_f32_16x16x32_bf16 v[92:95], a[96:99], a[192:195], v[92:95]
  v_mfma_f32_16x16x32_bf16 v[128:131], a[96:99], a[196:199], v[128:131]
  v_mfma_f32_16x16x32_bf16 v[96:99], a[100:103], a[192:195], v[96:99]
  v_mfma_f32_16x16x32_bf16 v[132:135], a[100:103], a[196:199], v[132:135]
  s_waitcnt lgkmcnt(0)
  v_mfma_f32_16x16x32_bf16 v[64:67], a[32:35], a[200:203], v[64:67]
  ds_read_b128 a[68:71], v4 offset:9216
  v_mfma_f32_16x16x32_bf16 v[100:103], a[32:35], a[204:207], v[100:103]
  ds_read_b128 a[72:75], v4 offset:10240
  v_mfma_f32_16x16x32_bf16 v[68:71], a[36:39], a[200:203], v[68:71]
  ds_read_b128 a[76:79], v4 offset:11264
  v_mfma_f32_16x16x32_bf16 v[104:107], a[36:39], a[204:207], v[104:107]
  ds_read_b128 a[80:83], v4 offset:12288
  v_mfma_f32_16x16x32_bf16 v[72:75], a[40:43], a[200:203], v[72:75]
  ds_read_b128 a[84:87], v4 offset:13312
  v_mfma_f32_16x16x32_bf16 v[108:111], a[40:43], a[204:207], v[108:111]
  ds_read_b128 a[88:91], v4 offset:14336
  v_mfma_f32_16x16x32_bf16 v[76:79], a[44:47], a[200:203], v[76:79]
  ds_read_b128 a[92:95], v4 offset:15360
  v_mfma_f32_16x16x32_bf16 v[112:115], a[44:47], a[204:207], v[112:115]
  ds_read_b128 a[96:99], v4 offset:16384
  v_mfma_f32_16x16x32_bf16 v[80:83], a[48:51], a[200:203], v[80:83]
  ds_read_b128 a[100:103], v4 offset:17408
  v_mfma_f32_16x16x32_bf16 v[116:119], a[48:51], a[204:207], v[116:119]
  s_add_u32 m0, s10, 114688
  s_add_u32 s41, s12, 68608
  v_mfma_f32_16x16x32_bf16 v[84:87], a[52:55], a[200:203], v[84:87]
  buffer_load_dwordx4 v2, s[28:31], s41 offen offset:0 sc1 lds
  v_mfma_f32_16x16x32_bf16 v[120:123], a[52:55], a[204:207], v[120:123]
  s_add_u32 s40, s58, 61440
  buffer_load_dwordx4 a[120:123], v2, s[60:63], s40 offen offset:0
  v_mfma_f32_16x16x32_bf16 v[88:91], a[56:59], a[200:203], v[88:91]
  buffer_load_dwordx4 v2, s[28:31], s41 offen offset:1024 sc1 lds
  v_mfma_f32_16x16x32_bf16 v[124:127], a[56:59], a[204:207], v[124:127]
  buffer_load_dwordx4 a[124:127], v2, s[60:63], s40 offen offset:1024
  v_mfma_f32_16x16x32_bf16 v[92:95], a[60:63], a[200:203], v[92:95]
  v_mfma_f32_16x16x32_bf16 v[128:131], a[60:63], a[204:207], v[128:131]
  v_mfma_f32_16x16x32_bf16 v[96:99], a[64:67], a[200:203], v[96:99]
  buffer_load_dwordx4 v2, s[28:31], s41 offen offset:2048 sc1 lds
  v_mfma_f32_16x16x32_bf16 v[132:135], a[64:67], a[204:207], v[132:135]
  s_waitcnt lgkmcnt(0)
  v_mfma_f32_16x16x32_bf16 v[64:67], a[68:71], a[208:211], v[64:67]
  ds_read_b128 a[32:35], v4 offset:18432
  v_mfma_f32_16x16x32_bf16 v[100:103], a[68:71], a[212:215], v[100:103]
  ds_read_b128 a[36:39], v4 offset:19456
  v_mfma_f32_16x16x32_bf16 v[68:71], a[72:75], a[208:211], v[68:71]
  ds_read_b128 a[40:43], v4 offset:20480
  v_mfma_f32_16x16x32_bf16 v[104:107], a[72:75], a[212:215], v[104:107]
  ds_read_b128 a[44:47], v4 offset:21504
  v_mfma_f32_16x16x32_bf16 v[72:75], a[76:79], a[208:211], v[72:75]
  ds_read_b128 a[48:51], v4 offset:22528
  v_mfma_f32_16x16x32_bf16 v[108:111], a[76:79], a[212:215], v[108:111]
  ds_read_b128 a[52:55], v4 offset:23552
  v_mfma_f32_16x16x32_bf16 v[76:79], a[80:83], a[208:211], v[76:79]
  ds_read_b128 a[56:59], v4 offset:24576
  v_mfma_f32_16x16x32_bf16 v[112:115], a[80:83], a[212:215], v[112:115]
  ds_read_b128 a[60:63], v4 offset:25600
  v_mfma_f32_16x16x32_bf16 v[80:83], a[84:87], a[208:211], v[80:83]
  ds_read_b128 a[64:67], v4 offset:26624
  v_mfma_f32_16x16x32_bf16 v[116:119], a[84:87], a[212:215], v[116:119]
  buffer_load_dwordx4 a[128:131], v2, s[60:63], s40 offen offset:2048
  v_mfma_f32_16x16x32_bf16 v[84:87], a[88:91], a[208:211], v[84:87]
  buffer_load_dwordx4 v2, s[28:31], s41 offen offset:3072 sc1 lds
  v_mfma_f32_16x16x32_bf16 v[120:123], a[88:91], a[212:215], v[120:123]
  buffer_load_dwordx4 a[132:135], v2, s[60:63], s40 offen offset:3072
  v_mfma_f32_16x16x32_bf16 v[88:91], a[92:95], a[208:211], v[88:91]
  v_mfma_f32_16x16x32_bf16 v[124:127], a[92:95], a[212:215], v[124:127]
  v_mfma_f32_16x16x32_bf16 v[92:95], a[96:99], a[208:211], v[92:95]
  v_mfma_f32_16x16x32_bf16 v[128:131], a[96:99], a[212:215], v[128:131]
  s_add_u32 m0, s10, 118784
  s_add_u32 s41, s12, 72704
  v_mfma_f32_16x16x32_bf16 v[96:99], a[100:103], a[208:211], v[96:99]
  buffer_load_dwordx4 v2, s[28:31], s41 offen offset:0 sc1 lds
  v_mfma_f32_16x16x32_bf16 v[132:135], a[100:103], a[212:215], v[132:135]
  s_waitcnt lgkmcnt(0)
  v_mfma_f32_16x16x32_bf16 v[64:67], a[32:35], a[216:219], v[64:67]
  ds_read_b128 a[68:71], v4 offset:27648
  v_mfma_f32_16x16x32_bf16 v[100:103], a[32:35], a[220:223], v[100:103]
  ds_read_b128 a[72:75], v4 offset:28672
  v_mfma_f32_16x16x32_bf16 v[68:71], a[36:39], a[216:219], v[68:71]
  ds_read_b128 a[76:79], v4 offset:29696
  v_mfma_f32_16x16x32_bf16 v[104:107], a[36:39], a[220:223], v[104:107]
  ds_read_b128 a[80:83], v4 offset:30720
  v_mfma_f32_16x16x32_bf16 v[72:75], a[40:43], a[216:219], v[72:75]
  ds_read_b128 a[84:87], v4 offset:31744
  v_mfma_f32_16x16x32_bf16 v[108:111], a[40:43], a[220:223], v[108:111]
  ds_read_b128 a[88:91], v4 offset:32768
  v_mfma_f32_16x16x32_bf16 v[76:79], a[44:47], a[216:219], v[76:79]
  ds_read_b128 a[92:95], v4 offset:33792
  v_mfma_f32_16x16x32_bf16 v[112:115], a[44:47], a[220:223], v[112:115]
  ds_read_b128 a[96:99], v4 offset:34816
  v_mfma_f32_16x16x32_bf16 v[80:83], a[48:51], a[216:219], v[80:83]
  ds_read_b128 a[100:103], v4 offset:35840
  v_mfma_f32_16x16x32_bf16 v[116:119], a[48:51], a[220:223], v[116:119]
  s_add_u32 m0, s10, 0
  s_add_u32 s41, s12, 73728
  v_mfma_f32_16x16x32_bf16 v[84:87], a[52:55], a[216:219], v[84:87]
  buffer_load_dwordx4 v2, s[28:31], s41 offen offset:0 sc1 lds
  v_mfma_f32_16x16x32_bf16 v[120:123], a[52:55], a[220:223], v[120:123]
  s_add_u32 s40, s58, 65536
  buffer_load_dwordx4 a[168:171], v2, s[60:63], s40 offen offset:0
  v_mfma_f32_16x16x32_bf16 v[88:91], a[56:59], a[216:219], v[88:91]
  buffer_load_dwordx4 v2, s[28:31], s41 offen offset:1024 sc1 lds
  v_mfma_f32_16x16x32_bf16 v[124:127], a[56:59], a[220:223], v[124:127]
  v_mfma_f32_16x16x32_bf16 v[92:95], a[60:63], a[216:219], v[92:95]
  buffer_load_dwordx4 a[172:175], v2, s[60:63], s40 offen offset:1024
  v_mfma_f32_16x16x32_bf16 v[128:131], a[60:63], a[220:223], v[128:131]
  v_mfma_f32_16x16x32_bf16 v[96:99], a[64:67], a[216:219], v[96:99]
  v_mfma_f32_16x16x32_bf16 v[132:135], a[64:67], a[220:223], v[132:135]
  s_waitcnt lgkmcnt(0)
  s_waitcnt vmcnt(21)
  s_barrier
  v_mfma_f32_16x16x32_bf16 v[64:67], a[68:71], a[224:227], v[64:67]
  ds_read_b128 a[32:35], v5 offset:0
  v_mfma_f32_16x16x32_bf16 v[100:103], a[68:71], a[228:231], v[100:103]
  ds_read_b128 a[36:39], v5 offset:1024
  v_mfma_f32_16x16x32_bf16 v[68:71], a[72:75], a[224:227], v[68:71]
  ds_read_b128 a[40:43], v5 offset:2048
  v_mfma_f32_16x16x32_bf16 v[104:107], a[72:75], a[228:231], v[104:107]
  ds_read_b128 a[44:47], v5 offset:3072
  v_mfma_f32_16x16x32_bf16 v[72:75], a[76:79], a[224:227], v[72:75]
  ds_read_b128 a[48:51], v5 offset:4096
  v_mfma_f32_16x16x32_bf16 v[108:111], a[76:79], a[228:231], v[108:111]
  ds_read_b128 a[52:55], v5 offset:5120
  v_mfma_f32_16x16x32_bf16 v[76:79], a[80:83], a[224:227], v[76:79]
  ds_read_b128 a[56:59], v5 offset:6144
  v_mfma_f32_16x16x32_bf16 v[112:115], a[80:83], a[228:231], v[112:115]
  ds_read_b128 a[60:63], v5 offset:7168
  v_mfma_f32_16x16x32_bf16 v[80:83], a[84:87], a[224:227], v[80:83]
  ds_read_b128 a[64:67], v5 offset:8192
  v_mfma_f32_16x16x32_bf16 v[116:119], a[84:87], a[228:231], v[116:119]
  buffer_load_dwordx4 v2, s[28:31], s41 offen offset:2048 sc1 lds
  v_mfma_f32_16x16x32_bf16 v[84:87], a[88:91], a[224:227], v[84:87]
  buffer_load_dwordx4 a[176:179], v2, s[60:63], s40 offen offset:2048
  v_mfma_f32_16x16x32_bf16 v[120:123], a[88:91], a[228:231], v[120:123]
  buffer_load_dwordx4 v2, s[28:31], s41 offen offset:3072 sc1 lds
  v_mfma_f32_16x16x32_bf16 v[88:91], a[92:95], a[224:227], v[88:91]
  v_mfma_f32_16x16x32_bf16 v[124:127], a[92:95], a[228:231], v[124:127]
  buffer_load_dwordx4 a[180:183], v2, s[60:63], s40 offen offset:3072
  v_mfma_f32_16x16x32_bf16 v[92:95], a[96:99], a[224:227], v[92:95]
  v_mfma_f32_16x16x32_bf16 v[128:131], a[96:99], a[228:231], v[128:131]
  v_mfma_f32_16x16x32_bf16 v[96:99], a[100:103], a[224:227], v[96:99]
  v_mfma_f32_16x16x32_bf16 v[132:135], a[100:103], a[228:231], v[132:135]
  s_waitcnt lgkmcnt(0)
  v_mfma_f32_16x16x32_bf16 v[64:67], a[32:35], a[0:3], v[64:67]
  ds_read_b128 a[68:71], v5 offset:9216
  v_mfma_f32_16x16x32_bf16 v[100:103], a[32:35], a[4:7], v[100:103]
  ds_read_b128 a[72:75], v5 offset:10240
  v_mfma_f32_16x16x32_bf16 v[68:71], a[36:39], a[0:3], v[68:71]
  ds_read_b128 a[76:79], v5 offset:11264
  v_mfma_f32_16x16x32_bf16 v[104:107], a[36:39], a[4:7], v[104:107]
  ds_read_b128 a[80:83], v5 offset:12288
  v_mfma_f32_16x16x32_bf16 v[72:75], a[40:43], a[0:3], v[72:75]
  ds_read_b128 a[84:87], v5 offset:13312
  v_mfma_f32_16x16x32_bf16 v[108:111], a[40:43], a[4:7], v[108:111]
  ds_read_b128 a[88:91], v5 offset:14336
  v_mfma_f32_16x16x32_bf16 v[76:79], a[44:47], a[0:3], v[76:79]
  ds_read_b128 a[92:95], v5 offset:15360
  v_mfma_f32_16x16x32_bf16 v[112:115], a[44:47], a[4:7], v[112:115]
  ds_read_b128 a[96:99], v5 offset:16384
  v_mfma_f32_16x16x32_bf16 v[80:83], a[48:51], a[0:3], v[80:83]
  ds_read_b128 a[100:103], v5 offset:17408
  v_mfma_f32_16x16x32_bf16 v[116:119], a[48:51], a[4:7], v[116:119]
  s_add_u32 m0, s10, 4096
  s_add_u32 s41, s12, 77824
  v_mfma_f32_16x16x32_bf16 v[84:87], a[52:55], a[0:3], v[84:87]
  buffer_load_dwordx4 v2, s[28:31], s41 offen offset:0 sc1 lds
  v_mfma_f32_16x16x32_bf16 v[120:123], a[52:55], a[4:7], v[120:123]
  s_add_u32 s40, s58, 69632
  buffer_load_dwordx4 a[184:187], v2, s[60:63], s40 offen offset:0
  v_mfma_f32_16x16x32_bf16 v[88:91], a[56:59], a[0:3], v[88:91]
  buffer_load_dwordx4 v2, s[28:31], s41 offen offset:1024 sc1 lds
  v_mfma_f32_16x16x32_bf16 v[124:127], a[56:59], a[4:7], v[124:127]
  buffer_load_dwordx4 a[188:191], v2, s[60:63], s40 offen offset:1024
  v_mfma_f32_16x16x32_bf16 v[92:95], a[60:63], a[0:3], v[92:95]
  v_mfma_f32_16x16x32_bf16 v[128:131], a[60:63], a[4:7], v[128:131]
  v_mfma_f32_16x16x32_bf16 v[96:99], a[64:67], a[0:3], v[96:99]
  buffer_load_dwordx4 v2, s[28:31], s41 offen offset:2048 sc1 lds
  v_mfma_f32_16x16x32_bf16 v[132:135], a[64:67], a[4:7], v[132:135]
  s_waitcnt lgkmcnt(0)
  v_mfma_f32_16x16x32_bf16 v[64:67], a[68:71], a[8:11], v[64:67]
  ds_read_b128 a[32:35], v5 offset:18432
  v_mfma_f32_16x16x32_bf16 v[100:103], a[68:71], a[12:15], v[100:103]
  ds_read_b128 a[36:39], v5 offset:19456
  v_mfma_f32_16x16x32_bf16 v[68:71], a[72:75], a[8:11], v[68:71]
  ds_read_b128 a[40:43], v5 offset:20480
  v_mfma_f32_16x16x32_bf16 v[104:107], a[72:75], a[12:15], v[104:107]
  ds_read_b128 a[44:47], v5 offset:21504
  v_mfma_f32_16x16x32_bf16 v[72:75], a[76:79], a[8:11], v[72:75]
  ds_read_b128 a[48:51], v5 offset:22528
  v_mfma_f32_16x16x32_bf16 v[108:111], a[76:79], a[12:15], v[108:111]
  ds_read_b128 a[52:55], v5 offset:23552
  v_mfma_f32_16x16x32_bf16 v[76:79], a[80:83], a[8:11], v[76:79]
  ds_read_b128 a[56:59], v5 offset:24576
  v_mfma_f32_16x16x32_bf16 v[112:115], a[80:83], a[12:15], v[112:115]
  ds_read_b128 a[60:63], v5 offset:25600
  v_mfma_f32_16x16x32_bf16 v[80:83], a[84:87], a[8:11], v[80:83]
  ds_read_b128 a[64:67], v5 offset:26624
  v_mfma_f32_16x16x32_bf16 v[116:119], a[84:87], a[12:15], v[116:119]
  buffer_load_dwordx4 a[192:195], v2, s[60:63], s40 offen offset:2048
  v_mfma_f32_16x16x32_bf16 v[84:87], a[88:91], a[8:11], v[84:87]
  buffer_load_dwordx4 v2, s[28:31], s41 offen offset:3072 sc1 lds
  v_mfma_f32_16x16x32_bf16 v[120:123], a[88:91], a[12:15], v[120:123]
  buffer_load_dwordx4 a[196:199], v2, s[60:63], s40 offen offset:3072
  v_mfma_f32_16x16x32_bf16 v[88:91], a[92:95], a[8:11], v[88:91]
  v_mfma_f32_16x16x32_bf16 v[124:127], a[92:95], a[12:15], v[124:127]
  v_mfma_f32_16x16x32_bf16 v[92:95], a[96:99], a[8:11], v[92:95]
  v_mfma_f32_16x16x32_bf16 v[128:131], a[96:99], a[12:15], v[128:131]
  s_add_u32 m0, s10, 8192
  s_add_u32 s41, s12, 81920
  v_mfma_f32_16x16x32_bf16 v[96:99], a[100:103], a[8:11], v[96:99]
  buffer_load_dwordx4 v2, s[28:31], s41 offen offset:0 sc1 lds
  v_mfma_f32_16x16x32_bf16 v[132:135], a[100:103], a[12:15], v[132:135]
  s_waitcnt lgkmcnt(0)
  v_mfma_f32_16x16x32_bf16 v[64:67], a[32:35], a[16:19], v[64:67]
  ds_read_b128 a[68:71], v5 offset:27648
  v_mfma_f32_16x16x32_bf16 v[100:103], a[32:35], a[20:23], v[100:103]
  ds_read_b128 a[72:75], v5 offset:28672
  v_mfma_f32_16x16x32_bf16 v[68:71], a[36:39], a[16:19], v[68:71]
  ds_read_b128 a[76:79], v5 offset:29696
  v_mfma_f32_16x16x32_bf16 v[104:107], a[36:39], a[20:23], v[104:107]
  ds_read_b128 a[80:83], v5 offset:30720
  v_mfma_f32_16x16x32_bf16 v[72:75], a[40:43], a[16:19], v[72:75]
  ds_read_b128 a[84:87], v5 offset:31744
  v_mfma_f32_16x16x32_bf16 v[108:111], a[40:43], a[20:23], v[108:111]
  ds_read_b128 a[88:91], v5 offset:32768
  v_mfma_f32_16x16x32_bf16 v[76:79], a[44:47], a[16:19], v[76:79]
  ds_read_b128 a[92:95], v5 offset:33792
  v_mfma_f32_16x16x32_bf16 v[112:115], a[44:47], a[20:23], v[112:115]
  ds_read_b128 a[96:99], v5 offset:34816
  v_mfma_f32_16x16x32_bf16 v[80:83], a[48:51], a[16:19], v[80:83]
  ds_read_b128 a[100:103], v5 offset:35840
  v_mfma_f32_16x16x32_bf16 v[116:119], a[48:51], a[20:23], v[116:119]
  s_add_u32 m0, s10, 36864
  s_add_u32 s41, s12, 82944
  v_mfma_f32_16x16x32_bf16 v[84:87], a[52:55], a[16:19], v[84:87]
  buffer_load_dwordx4 v2, s[28:31], s41 offen offset:0 sc1 lds
  v_mfma_f32_16x16x32_bf16 v[120:123], a[52:55], a[20:23], v[120:123]
  s_add_u32 s40, s58, 73728
  buffer_load_dwordx4 a[200:203], v2, s[60:63], s40 offen offset:0
  v_mfma_f32_16x16x32_bf16 v[88:91], a[56:59], a[16:19], v[88:91]
  buffer_load_dwordx4 v2, s[28:31], s41 offen offset:1024 sc1 lds
  v_mfma_f32_16x16x32_bf16 v[124:127], a[56:59], a[20:23], v[124:127]
  v_mfma_f32_16x16x32_bf16 v[92:95], a[60:63], a[16:19], v[92:95]
  buffer_load_dwordx4 a[204:207], v2, s[60:63], s40 offen offset:1024
  v_mfma_f32_16x16x32_bf16 v[128:131], a[60:63], a[20:23], v[128:131]
  v_mfma_f32_16x16x32_bf16 v[96:99], a[64:67], a[16:19], v[96:99]
  v_mfma_f32_16x16x32_bf16 v[132:135], a[64:67], a[20:23], v[132:135]
  s_waitcnt lgkmcnt(0)
  s_waitcnt vmcnt(21)
  s_barrier
  v_mfma_f32_16x16x32_bf16 v[64:67], a[68:71], a[24:27], v[64:67]
  ds_read_b128 a[32:35], v6 offset:0
  v_mfma_f32_16x16x32_bf16 v[100:103], a[68:71], a[28:31], v[100:103]
  ds_read_b128 a[36:39], v6 offset:1024
  v_mfma_f32_16x16x32_bf16 v[68:71], a[72:75], a[24:27], v[68:71]
  ds_read_b128 a[40:43], v6 offset:2048
  v_mfma_f32_16x16x32_bf16 v[104:107], a[72:75], a[28:31], v[104:107]
  ds_read_b128 a[44:47], v6 offset:3072
  v_mfma_f32_16x16x32_bf16 v[72:75], a[76:79], a[24:27], v[72:75]
  ds_read_b128 a[48:51], v6 offset:4096
  v_mfma_f32_16x16x32_bf16 v[108:111], a[76:79], a[28:31], v[108:111]
  ds_read_b128 a[52:55], v6 offset:5120
  v_mfma_f32_16x16x32_bf16 v[76:79], a[80:83], a[24:27], v[76:79]
  ds_read_b128 a[56:59], v6 offset:6144
  v_mfma_f32_16x16x32_bf16 v[112:115], a[80:83], a[28:31], v[112:115]
  ds_read_b128 a[60:63], v6 offset:7168
  v_mfma_f32_16x16x32_bf16 v[80:83], a[84:87], a[24:27], v[80:83]
  ds_read_b128 a[64:67], v6 offset:8192
  v_mfma_f32_16x16x32_bf16 v[116:119], a[84:87], a[28:31], v[116:119]
  buffer_load_dwordx4 v2, s[28:31], s41 offen offset:2048 sc1 lds
  v_mfma_f32_16x16x32_bf16 v[84:87], a[88:91], a[24:27], v[84:87]
  buffer_load_dwordx4 a[208:211], v2, s[60:63], s40 offen offset:2048
  v_mfma_f32_16x16x32_bf16 v[120:123], a[88:91], a[28:31], v[120:123]
  buffer_load_dwordx4 v2, s[28:31], s41 offen offset:3072 sc1 lds
  v_mfma_f32_16x16x32_bf16 v[88:91], a[92:95], a[24:27], v[88:91]
  v_mfma_f32_16x16x32_bf16 v[124:127], a[92:95], a[28:31], v[124:127]
  buffer_load_dwordx4 a[212:215], v2, s[60:63], s40 offen offset:3072
  v_mfma_f32_16x16x32_bf16 v[92:95], a[96:99], a[24:27], v[92:95]
  v_mfma_f32_16x16x32_bf16 v[128:131], a[96:99], a[28:31], v[128:131]
  v_mfma_f32_16x16x32_bf16 v[96:99], a[100:103], a[24:27], v[96:99]
  v_mfma_f32_16x16x32_bf16 v[132:135], a[100:103], a[28:31], v[132:135]
  s_waitcnt lgkmcnt(0)
  v_mfma_f32_16x16x32_bf16 v[64:67], a[32:35], a[104:107], v[64:67]
  ds_read_b128 a[68:71], v6 offset:9216
  v_mfma_f32_16x16x32_bf16 v[100:103], a[32:35], a[108:111], v[100:103]
  ds_read_b128 a[72:75], v6 offset:10240
  v_mfma_f32_16x16x32_bf16 v[68:71], a[36:39], a[104:107], v[68:71]
  ds_read_b128 a[76:79], v6 offset:11264
  v_mfma_f32_16x16x32_bf16 v[104:107], a[36:39], a[108:111], v[104:107]
  ds_read_b128 a[80:83], v6 offset:12288
  v_mfma_f32_16x16x32_bf16 v[72:75], a[40:43], a[104:107], v[72:75]
  ds_read_b128 a[84:87], v6 offset:13312
  v_mfma_f32_16x16x32_bf16 v[108:111], a[40:43], a[108:111], v[108:111]
  ds_read_b128 a[88:91], v6 offset:14336
  v_mfma_f32_16x16x32_bf16 v[76:79], a[44:47], a[104:107], v[76:79]
  ds_read_b128 a[92:95], v6 offset:15360
  v_mfma_f32_16x16x32_bf16 v[112:115], a[44:47], a[108:111], v[112:115]
  ds_read_b128 a[96:99], v6 offset:16384
  v_mfma_f32_16x16x32_bf16 v[80:83], a[48:51], a[104:107], v[80:83]
  ds_read_b128 a[100:103], v6 offset:17408
  v_mfma_f32_16x16x32_bf16 v[116:119], a[48:51], a[108:111], v[116:119]
  s_add_u32 m0, s10, 40960
  s_add_u32 s41, s12, 87040
  v_mfma_f32_16x16x32_bf16 v[84:87], a[52:55], a[104:107], v[84:87]
  buffer_load_dwordx4 v2, s[28:31], s41 offen offset:0 sc1 lds
  v_mfma_f32_16x16x32_bf16 v[120:123], a[52:55], a[108:111], v[120:123]
  s_add_u32 s40, s58, 77824
  buffer_load_dwordx4 a[216:219], v2, s[60:63], s40 offen offset:0
  v_mfma_f32_16x16x32_bf16 v[88:91], a[56:59], a[104:107], v[88:91]
  buffer_load_dwordx4 v2, s[28:31], s41 offen offset:1024 sc1 lds
  v_mfma_f32_16x16x32_bf16 v[124:127], a[56:59], a[108:111], v[124:127]
  buffer_load_dwordx4 a[220:223], v2, s[60:63], s40 offen offset:1024
  v_mfma_f32_16x16x32_bf16 v[92:95], a[60:63], a[104:107], v[92:95]
  v_mfma_f32_16x16x32_bf16 v[128:131], a[60:63], a[108:111], v[128:131]
  v_mfma_f32_16x16x32_bf16 v[96:99], a[64:67], a[104:107], v[96:99]
  buffer_load_dwordx4 v2, s[28:31], s41 offen offset:2048 sc1 lds
  v_mfma_f32_16x16x32_bf16 v[132:135], a[64:67], a[108:111], v[132:135]
  s_waitcnt lgkmcnt(0)
  v_mfma_f32_16x16x32_bf16 v[64:67], a[68:71], a[112:115], v[64:67]
  ds_read_b128 a[32:35], v6 offset:18432
  v_mfma_f32_16x16x32_bf16 v[100:103], a[68:71], a[116:119], v[100:103]
  ds_read_b128 a[36:39], v6 offset:19456
  v_mfma_f32_16x16x32_bf16 v[68:71], a[72:75], a[112:115], v[68:71]
  ds_read_b128 a[40:43], v6 offset:20480
  v_mfma_f32_16x16x32_bf16 v[104:107], a[72:75], a[116:119], v[104:107]
  ds_read_b128 a[44:47], v6 offset:21504
  v_mfma_f32_16x16x32_bf16 v[72:75], a[76:79], a[112:115], v[72:75]
  ds_read_b128 a[48:51], v6 offset:22528
  v_mfma_f32_16x16x32_bf16 v[108:111], a[76:79], a[116:119], v[108:111]
  ds_read_b128 a[52:55], v6 offset:23552
  v_mfma_f32_16x16x32_bf16 v[76:79], a[80:83], a[112:115], v[76:79]
  ds_read_b128 a[56:59], v6 offset:24576
  v_mfma_f32_16x16x32_bf16 v[112:115], a[80:83], a[116:119], v[112:115]
  ds_read_b128 a[60:63], v6 offset:25600
  v_mfma_f32_16x16x32_bf16 v[80:83], a[84:87], a[112:115], v[80:83]
  ds_read_b128 a[64:67], v6 offset:26624
  v_mfma_f32_16x16x32_bf16 v[116:119], a[84:87], a[116:119], v[116:119]
  buffer_load_dwordx4 a[224:227], v2, s[60:63], s40 offen offset:2048
  v_mfma_f32_16x16x32_bf16 v[84:87], a[88:91], a[112:115], v[84:87]
  buffer_load_dwordx4 v2, s[28:31], s41 offen offset:3072 sc1 lds
  v_mfma_f32_16x16x32_bf16 v[120:123], a[88:91], a[116:119], v[120:123]
  buffer_load_dwordx4 a[228:231], v2, s[60:63], s40 offen offset:3072
  v_mfma_f32_16x16x32_bf16 v[88:91], a[92:95], a[112:115], v[88:91]
  v_mfma_f32_16x16x32_bf16 v[124:127], a[92:95], a[116:119], v[124:127]
  v_mfma_f32_16x16x32_bf16 v[92:95], a[96:99], a[112:115], v[92:95]
  v_mfma_f32_16x16x32_bf16 v[128:131], a[96:99], a[116:119], v[128:131]
  s_add_u32 m0, s10, 45056
  s_add_u32 s41, s12, 91136
  v_mfma_f32_16x16x32_bf16 v[96:99], a[100:103], a[112:115], v[96:99]
  buffer_load_dwordx4 v2, s[28:31], s41 offen offset:0 sc1 lds
  v_mfma_f32_16x16x32_bf16 v[132:135], a[100:103], a[116:119], v[132:135]
  s_waitcnt lgkmcnt(0)
  v_mfma_f32_16x16x32_bf16 v[64:67], a[32:35], a[120:123], v[64:67]
  ds_read_b128 a[68:71], v6 offset:27648
  v_mfma_f32_16x16x32_bf16 v[100:103], a[32:35], a[124:127], v[100:103]
  ds_read_b128 a[72:75], v6 offset:28672
  v_mfma_f32_16x16x32_bf16 v[68:71], a[36:39], a[120:123], v[68:71]
  ds_read_b128 a[76:79], v6 offset:29696
  v_mfma_f32_16x16x32_bf16 v[104:107], a[36:39], a[124:127], v[104:107]
  ds_read_b128 a[80:83], v6 offset:30720
  v_mfma_f32_16x16x32_bf16 v[72:75], a[40:43], a[120:123], v[72:75]
  ds_read_b128 a[84:87], v6 offset:31744
  v_mfma_f32_16x16x32_bf16 v[108:111], a[40:43], a[124:127], v[108:111]
  ds_read_b128 a[88:91], v6 offset:32768
  v_mfma_f32_16x16x32_bf16 v[76:79], a[44:47], a[120:123], v[76:79]
  ds_read_b128 a[92:95], v6 offset:33792
  v_mfma_f32_16x16x32_bf16 v[112:115], a[44:47], a[124:127], v[112:115]
  ds_read_b128 a[96:99], v6 offset:34816
  v_mfma_f32_16x16x32_bf16 v[80:83], a[48:51], a[120:123], v[80:83]
  ds_read_b128 a[100:103], v6 offset:35840
  v_mfma_f32_16x16x32_bf16 v[116:119], a[48:51], a[124:127], v[116:119]
  s_add_u32 m0, s10, 73728
  s_add_u32 s41, s12, 92160
  v_mfma_f32_16x16x32_bf16 v[84:87], a[52:55], a[120:123], v[84:87]
  buffer_load_dwordx4 v2, s[28:31], s41 offen offset:0 sc1 lds
  v_mfma_f32_16x16x32_bf16 v[120:123], a[52:55], a[124:127], v[120:123]
  s_add_u32 s40, s58, 81920
  buffer_load_dwordx4 a[0:3], v2, s[60:63], s40 offen offset:0
  v_mfma_f32_16x16x32_bf16 v[88:91], a[56:59], a[120:123], v[88:91]
  buffer_load_dwordx4 v2, s[28:31], s41 offen offset:1024 sc1 lds
  v_mfma_f32_16x16x32_bf16 v[124:127], a[56:59], a[124:127], v[124:127]
  v_mfma_f32_16x16x32_bf16 v[92:95], a[60:63], a[120:123], v[92:95]
  buffer_load_dwordx4 a[4:7], v2, s[60:63], s40 offen offset:1024
  v_mfma_f32_16x16x32_bf16 v[128:131], a[60:63], a[124:127], v[128:131]
  v_mfma_f32_16x16x32_bf16 v[96:99], a[64:67], a[120:123], v[96:99]
  v_mfma_f32_16x16x32_bf16 v[132:135], a[64:67], a[124:127], v[132:135]
  s_waitcnt lgkmcnt(0)
  s_waitcnt vmcnt(21)
  s_barrier
  v_mfma_f32_16x16x32_bf16 v[64:67], a[68:71], a[128:131], v[64:67]
  ds_read_b128 a[32:35], v2 offset:0
  v_mfma_f32_16x16x32_bf16 v[100:103], a[68:71], a[132:135], v[100:103]
  ds_read_b128 a[36:39], v2 offset:1024
  v_mfma_f32_16x16x32_bf16 v[68:71], a[72:75], a[128:131], v[68:71]
  ds_read_b128 a[40:43], v2 offset:2048
  v_mfma_f32_16x16x32_bf16 v[104:107], a[72:75], a[132:135], v[104:107]
  ds_read_b128 a[44:47], v2 offset:3072
  v_mfma_f32_16x16x32_bf16 v[72:75], a[76:79], a[128:131], v[72:75]
  ds_read_b128 a[48:51], v2 offset:4096
  v_mfma_f32_16x16x32_bf16 v[108:111], a[76:79], a[132:135], v[108:111]
  ds_read_b128 a[52:55], v2 offset:5120
  v_mfma_f32_16x16x32_bf16 v[76:79], a[80:83], a[128:131], v[76:79]
  ds_read_b128 a[56:59], v2 offset:6144
  v_mfma_f32_16x16x32_bf16 v[112:115], a[80:83], a[132:135], v[112:115]
  ds_read_b128 a[60:63], v2 offset:7168
  v_mfma_f32_16x16x32_bf16 v[80:83], a[84:87], a[128:131], v[80:83]
  ds_read_b128 a[64:67], v2 offset:8192
  v_mfma_f32_16x16x32_bf16 v[116:119], a[84:87], a[132:135], v[116:119]
  buffer_load_dwordx4 v2, s[28:31], s41 offen offset:2048 sc1 lds
  v_mfma_f32_16x16x32_bf16 v[84:87], a[88:91], a[128:131], v[84:87]
  buffer_load_dwordx4 a[8:11], v2, s[60:63], s40 offen offset:2048
  v_mfma_f32_16x16x32_bf16 v[120:123], a[88:91], a[132:135], v[120:123]
  buffer_load_dwordx4 v2, s[28:31], s41 offen offset:3072 sc1 lds
  v_mfma_f32_16x16x32_bf16 v[88:91], a[92:95], a[128:131], v[88:91]
  v_mfma_f32_16x16x32_bf16 v[124:127], a[92:95], a[132:135], v[124:127]
  buffer_load_dwordx4 a[12:15], v2, s[60:63], s40 offen offset:3072
  v_mfma_f32_16x16x32_bf16 v[92:95], a[96:99], a[128:131], v[92:95]
  v_mfma_f32_16x16x32_bf16 v[128:131], a[96:99], a[132:135], v[128:131]
  v_mfma_f32_16x16x32_bf16 v[96:99], a[100:103], a[128:131], v[96:99]
  v_mfma_f32_16x16x32_bf16 v[132:135], a[100:103], a[132:135], v[132:135]
  s_waitcnt lgkmcnt(0)
  v_mfma_f32_16x16x32_bf16 v[64:67], a[32:35], a[168:171], v[64:67]
  ds_read_b128 a[68:71], v2 offset:9216
  v_mfma_f32_16x16x32_bf16 v[100:103], a[32:35], a[172:175], v[100:103]
  ds_read_b128 a[72:75], v2 offset:10240
  v_mfma_f32_16x16x32_bf16 v[68:71], a[36:39], a[168:171], v[68:71]
  ds_read_b128 a[76:79], v2 offset:11264
  v_mfma_f32_16x16x32_bf16 v[104:107], a[36:39], a[172:175], v[104:107]
  ds_read_b128 a[80:83], v2 offset:12288
  v_mfma_f32_16x16x32_bf16 v[72:75], a[40:43], a[168:171], v[72:75]
  ds_read_b128 a[84:87], v2 offset:13312
  v_mfma_f32_16x16x32_bf16 v[108:111], a[40:43], a[172:175], v[108:111]
  ds_read_b128 a[88:91], v2 offset:14336
  v_mfma_f32_16x16x32_bf16 v[76:79], a[44:47], a[168:171], v[76:79]
  ds_read_b128 a[92:95], v2 offset:15360
  v_mfma_f32_16x16x32_bf16 v[112:115], a[44:47], a[172:175], v[112:115]
  ds_read_b128 a[96:99], v2 offset:16384
  v_mfma_f32_16x16x32_bf16 v[80:83], a[48:51], a[168:171], v[80:83]
  ds_read_b128 a[100:103], v2 offset:17408
  v_mfma_f32_16x16x32_bf16 v[116:119], a[48:51], a[172:175], v[116:119]
  s_add_u32 m0, s10, 77824
  s_add_u32 s41, s12, 96256
  v_mfma_f32_16x16x32_bf16 v[84:87], a[52:55], a[168:171], v[84:87]
  buffer_load_dwordx4 v2, s[28:31], s41 offen offset:0 sc1 lds
  v_mfma_f32_16x16x32_bf16 v[120:123], a[52:55], a[172:175], v[120:123]
  s_add_u32 s40, s58, 86016
  buffer_load_dwordx4 a[16:19], v2, s[60:63], s40 offen offset:0
  v_mfma_f32_16x16x32_bf16 v[88:91], a[56:59], a[168:171], v[88:91]
  buffer_load_dwordx4 v2, s[28:31], s41 offen offset:1024 sc1 lds
  v_mfma_f32_16x16x32_bf16 v[124:127], a[56:59], a[172:175], v[124:127]
  buffer_load_dwordx4 a[20:23], v2, s[60:63], s40 offen offset:1024
  v_mfma_f32_16x16x32_bf16 v[92:95], a[60:63], a[168:171], v[92:95]
  v_mfma_f32_16x16x32_bf16 v[128:131], a[60:63], a[172:175], v[128:131]
  v_mfma_f32_16x16x32_bf16 v[96:99], a[64:67], a[168:171], v[96:99]
  buffer_load_dwordx4 v2, s[28:31], s41 offen offset:2048 sc1 lds
  v_mfma_f32_16x16x32_bf16 v[132:135], a[64:67], a[172:175], v[132:135]
  s_waitcnt lgkmcnt(0)
  v_mfma_f32_16x16x32_bf16 v[64:67], a[68:71], a[176:179], v[64:67]
  ds_read_b128 a[32:35], v2 offset:18432
  v_mfma_f32_16x16x32_bf16 v[100:103], a[68:71], a[180:183], v[100:103]
  ds_read_b128 a[36:39], v2 offset:19456
  v_mfma_f32_16x16x32_bf16 v[68:71], a[72:75], a[176:179], v[68:71]
  ds_read_b128 a[40:43], v2 offset:20480
  v_mfma_f32_16x16x32_bf16 v[104:107], a[72:75], a[180:183], v[104:107]
  ds_read_b128 a[44:47], v2 offset:21504
  v_mfma_f32_16x16x32_bf16 v[72:75], a[76:79], a[176:179], v[72:75]
  ds_read_b128 a[48:51], v2 offset:22528
  v_mfma_f32_16x16x32_bf16 v[108:111], a[76:79], a[180:183], v[108:111]
  ds_read_b128 a[52:55], v2 offset:23552
  v_mfma_f32_16x16x32_bf16 v[76:79], a[80:83], a[176:179], v[76:79]
  ds_read_b128 a[56:59], v2 offset:24576
  v_mfma_f32_16x16x32_bf16 v[112:115], a[80:83], a[180:183], v[112:115]
  ds_read_b128 a[60:63], v2 offset:25600
  v_mfma_f32_16x16x32_bf16 v[80:83], a[84:87], a[176:179], v[80:83]
  ds_read_b128 a[64:67], v2 offset:26624
  v_mfma_f32_16x16x32_bf16 v[116:119], a[84:87], a[180:183], v[116:119]
  buffer_load_dwordx4 a[24:27], v2, s[60:63], s40 offen offset:2048
  v_mfma_f32_16x16x32_bf16 v[84:87], a[88:91], a[176:179], v[84:87]
  buffer_load_dwordx4 v2, s[28:31], s41 offen offset:3072 sc1 lds
  v_mfma_f32_16x16x32_bf16 v[120:123], a[88:91], a[180:183], v[120:123]
  buffer_load_dwordx4 a[28:31], v2, s[60:63], s40 offen offset:3072
  v_mfma_f32_16x16x32_bf16 v[88:91], a[92:95], a[176:179], v[88:91]
  v_mfma_f32_16x16x32_bf16 v[124:127], a[92:95], a[180:183], v[124:127]
  v_mfma_f32_16x16x32_bf16 v[92:95], a[96:99], a[176:179], v[92:95]
  v_mfma_f32_16x16x32_bf16 v[128:131], a[96:99], a[180:183], v[128:131]
  s_add_u32 m0, s10, 81920
  s_add_u32 s41, s12, 100352
  v_mfma_f32_16x16x32_bf16 v[96:99], a[100:103], a[176:179], v[96:99]
  buffer_load_dwordx4 v2, s[28:31], s41 offen offset:0 sc1 lds
  v_mfma_f32_16x16x32_bf16 v[132:135], a[100:103], a[180:183], v[132:135]
  s_waitcnt lgkmcnt(0)
  v_mfma_f32_16x16x32_bf16 v[64:67], a[32:35], a[184:187], v[64:67]
  ds_read_b128 a[68:71], v2 offset:27648
  v_mfma_f32_16x16x32_bf16 v[100:103], a[32:35], a[188:191], v[100:103]
  ds_read_b128 a[72:75], v2 offset:28672
  v_mfma_f32_16x16x32_bf16 v[68:71], a[36:39], a[184:187], v[68:71]
  ds_read_b128 a[76:79], v2 offset:29696
  v_mfma_f32_16x16x32_bf16 v[104:107], a[36:39], a[188:191], v[104:107]
  ds_read_b128 a[80:83], v2 offset:30720
  v_mfma_f32_16x16x32_bf16 v[72:75], a[40:43], a[184:187], v[72:75]
  ds_read_b128 a[84:87], v2 offset:31744
  v_mfma_f32_16x16x32_bf16 v[108:111], a[40:43], a[188:191], v[108:111]
  ds_read_b128 a[88:91], v2 offset:32768
  v_mfma_f32_16x16x32_bf16 v[76:79], a[44:47], a[184:187], v[76:79]
  ds_read_b128 a[92:95], v2 offset:33792
  v_mfma_f32_16x16x32_bf16 v[112:115], a[44:47], a[188:191], v[112:115]
  ds_read_b128 a[96:99], v2 offset:34816
  v_mfma_f32_16x16x32_bf16 v[80:83], a[48:51], a[184:187], v[80:83]
  ds_read_b128 a[100:103], v2 offset:35840
  v_mfma_f32_16x16x32_bf16 v[116:119], a[48:51], a[188:191], v[116:119]
  s_add_u32 m0, s10, 110592
  s_add_u32 s41, s12, 101376
  v_mfma_f32_16x16x32_bf16 v[84:87], a[52:55], a[184:187], v[84:87]
  buffer_load_dwordx4 v2, s[28:31], s41 offen offset:0 sc1 lds
  v_mfma_f32_16x16x32_bf16 v[120:123], a[52:55], a[188:191], v[120:123]
  s_add_u32 s40, s58, 90112
  buffer_load_dwordx4 a[104:107], v2, s[60:63], s40 offen offset:0
  v_mfma_f32_16x16x32_bf16 v[88:91], a[56:59], a[184:187], v[88:91]
  buffer_load_dwordx4 v2, s[28:31], s41 offen offset:1024 sc1 lds
  v_mfma_f32_16x16x32_bf16 v[124:127], a[56:59], a[188:191], v[124:127]
  v_mfma_f32_16x16x32_bf16 v[92:95], a[60:63], a[184:187], v[92:95]
  buffer_load_dwordx4 a[108:111], v2, s[60:63], s40 offen offset:1024
  v_mfma_f32_16x16x32_bf16 v[128:131], a[60:63], a[188:191], v[128:131]
  v_mfma_f32_16x16x32_bf16 v[96:99], a[64:67], a[184:187], v[96:99]
  v_mfma_f32_16x16x32_bf16 v[132:135], a[64:67], a[188:191], v[132:135]
  s_waitcnt lgkmcnt(0)
  s_waitcnt vmcnt(21)
  s_barrier
  v_mfma_f32_16x16x32_bf16 v[64:67], a[68:71], a[192:195], v[64:67]
  ds_read_b128 a[32:35], v4 offset:0
  v_mfma_f32_16x16x32_bf16 v[100:103], a[68:71], a[196:199], v[100:103]
  ds_read_b128 a[36:39], v4 offset:1024
  v_mfma_f32_16x16x32_bf16 v[68:71], a[72:75], a[192:195], v[68:71]
  ds_read_b128 a[40:43], v4 offset:2048
  v_mfma_f32_16x16x32_bf16 v[104:107], a[72:75], a[196:199], v[104:107]
  ds_read_b128 a[44:47], v4 offset:3072
  v_mfma_f32_16x16x32_bf16 v[72:75], a[76:79], a[192:195], v[72:75]
  ds_read_b128 a[48:51], v4 offset:4096
  v_mfma_f32_16x16x32_bf16 v[108:111], a[76:79], a[196:199], v[108:111]
  ds_read_b128 a[52:55], v4 offset:5120
  v_mfma_f32_16x16x32_bf16 v[76:79], a[80:83], a[192:195], v[76:79]
  ds_read_b128 a[56:59], v4 offset:6144
  v_mfma_f32_16x16x32_bf16 v[112:115], a[80:83], a[196:199], v[112:115]
  ds_read_b128 a[60:63], v4 offset:7168
  v_mfma_f32_16x16x32_bf16 v[80:83], a[84:87], a[192:195], v[80:83]
  ds_read_b128 a[64:67], v4 offset:8192
  v_mfma_f32_16x16x32_bf16 v[116:119], a[84:87], a[196:199], v[116:119]
  buffer_load_dwordx4 v2, s[28:31], s41 offen offset:2048 sc1 lds
  v_mfma_f32_16x16x32_bf16 v[84:87], a[88:91], a[192:195], v[84:87]
  buffer_load_dwordx4 a[112:115], v2, s[60:63], s40 offen offset:2048
  v_mfma_f32_16x16x32_bf16 v[120:123], a[88:91], a[196:199], v[120:123]
  buffer_load_dwordx4 v2, s[28:31], s41 offen offset:3072 sc1 lds
  v_mfma_f32_16x16x32_bf16 v[88:91], a[92:95], a[192:195], v[88:91]
  v_mfma_f32_16x16x32_bf16 v[124:127], a[92:95], a[196:199], v[124:127]
  buffer_load_dwordx4 a[116:119], v2, s[60:63], s40 offen offset:3072
  v_mfma_f32_16x16x32_bf16 v[92:95], a[96:99], a[192:195], v[92:95]
  v_mfma_f32_16x16x32_bf16 v[128:131], a[96:99], a[196:199], v[128:131]
  v_mfma_f32_16x16x32_bf16 v[96:99], a[100:103], a[192:195], v[96:99]
  v_mfma_f32_16x16x32_bf16 v[132:135], a[100:103], a[196:199], v[132:135]
  s_waitcnt lgkmcnt(0)
  v_mfma_f32_16x16x32_bf16 v[64:67], a[32:35], a[200:203], v[64:67]
  ds_read_b128 a[68:71], v4 offset:9216
  v_mfma_f32_16x16x32_bf16 v[100:103], a[32:35], a[204:207], v[100:103]
  ds_read_b128 a[72:75], v4 offset:10240
  v_mfma_f32_16x16x32_bf16 v[68:71], a[36:39], a[200:203], v[68:71]
  ds_read_b128 a[76:79], v4 offset:11264
  v_mfma_f32_16x16x32_bf16 v[104:107], a[36:39], a[204:207], v[104:107]
  ds_read_b128 a[80:83], v4 offset:12288
  v_mfma_f32_16x16x32_bf16 v[72:75], a[40:43], a[200:203], v[72:75]
  ds_read_b128 a[84:87], v4 offset:13312
  v_mfma_f32_16x16x32_bf16 v[108:111], a[40:43], a[204:207], v[108:111]
  ds_read_b128 a[88:91], v4 offset:14336
  v_mfma_f32_16x16x32_bf16 v[76:79], a[44:47], a[200:203], v[76:79]
  ds_read_b128 a[92:95], v4 offset:15360
  v_mfma_f32_16x16x32_bf16 v[112:115], a[44:47], a[204:207], v[112:115]
  ds_read_b128 a[96:99], v4 offset:16384
  v_mfma_f32_16x16x32_bf16 v[80:83], a[48:51], a[200:203], v[80:83]
  ds_read_b128 a[100:103], v4 offset:17408
  v_mfma_f32_16x16x32_bf16 v[116:119], a[48:51], a[204:207], v[116:119]
  s_add_u32 m0, s10, 114688
  s_add_u32 s41, s12, 105472
  v_mfma_f32_16x16x32_bf16 v[84:87], a[52:55], a[200:203], v[84:87]
  buffer_load_dwordx4 v2, s[28:31], s41 offen offset:0 sc1 lds
  v_mfma_f32_16x16x32_bf16 v[120:123], a[52:55], a[204:207], v[120:123]
  s_add_u32 s40, s58, 94208
  buffer_load_dwordx4 a[120:123], v2, s[60:63], s40 offen offset:0
  v_mfma_f32_16x16x32_bf16 v[88:91], a[56:59], a[200:203], v[88:91]
  buffer_load_dwordx4 v2, s[28:31], s41 offen offset:1024 sc1 lds
  v_mfma_f32_16x16x32_bf16 v[124:127], a[56:59], a[204:207], v[124:127]
  buffer_load_dwordx4 a[124:127], v2, s[60:63], s40 offen offset:1024
  v_mfma_f32_16x16x32_bf16 v[92:95], a[60:63], a[200:203], v[92:95]
  v_mfma_f32_16x16x32_bf16 v[128:131], a[60:63], a[204:207], v[128:131]
  v_mfma_f32_16x16x32_bf16 v[96:99], a[64:67], a[200:203], v[96:99]
  buffer_load_dwordx4 v2, s[28:31], s41 offen offset:2048 sc1 lds
  v_mfma_f32_16x16x32_bf16 v[132:135], a[64:67], a[204:207], v[132:135]
  s_waitcnt lgkmcnt(0)
  v_mfma_f32_16x16x32_bf16 v[64:67], a[68:71], a[208:211], v[64:67]
  ds_read_b128 a[32:35], v4 offset:18432
  v_mfma_f32_16x16x32_bf16 v[100:103], a[68:71], a[212:215], v[100:103]
  ds_read_b128 a[36:39], v4 offset:19456
  v_mfma_f32_16x16x32_bf16 v[68:71], a[72:75], a[208:211], v[68:71]
  ds_read_b128 a[40:43], v4 offset:20480
  v_mfma_f32_16x16x32_bf16 v[104:107], a[72:75], a[212:215], v[104:107]
  ds_read_b128 a[44:47], v4 offset:21504
  v_mfma_f32_16x16x32_bf16 v[72:75], a[76:79], a[208:211], v[72:75]
  ds_read_b128 a[48:51], v4 offset:22528
  v_mfma_f32_16x16x32_bf16 v[108:111], a[76:79], a[212:215], v[108:111]
  ds_read_b128 a[52:55], v4 offset:23552
  v_mfma_f32_16x16x32_bf16 v[76:79], a[80:83], a[208:211], v[76:79]
  ds_read_b128 a[56:59], v4 offset:24576
  v_mfma_f32_16x16x32_bf16 v[112:115], a[80:83], a[212:215], v[112:115]
  ds_read_b128 a[60:63], v4 offset:25600
  v_mfma_f32_16x16x32_bf16 v[80:83], a[84:87], a[208:211], v[80:83]
  ds_read_b128 a[64:67], v4 offset:26624
  v_mfma_f32_16x16x32_bf16 v[116:119], a[84:87], a[212:215], v[116:119]
  buffer_load_dwordx4 a[128:131], v2, s[60:63], s40 offen offset:2048
  v_mfma_f32_16x16x32_bf16 v[84:87], a[88:91], a[208:211], v[84:87]
  buffer_load_dwordx4 v2, s[28:31], s41 offen offset:3072 sc1 lds
  v_mfma_f32_16x16x32_bf16 v[120:123], a[88:91], a[212:215], v[120:123]
  buffer_load_dwordx4 a[132:135], v2, s[60:63], s40 offen offset:3072
  v_mfma_f32_16x16x32_bf16 v[88:91], a[92:95], a[208:211], v[88:91]
  v_mfma_f32_16x16x32_bf16 v[124:127], a[92:95], a[212:215], v[124:127]
  v_mfma_f32_16x16x32_bf16 v[92:95], a[96:99], a[208:211], v[92:95]
  v_mfma_f32_16x16x32_bf16 v[128:131], a[96:99], a[212:215], v[128:131]
  s_add_u32 m0, s10, 118784
  s_add_u32 s41, s12, 109568
  v_mfma_f32_16x16x32_bf16 v[96:99], a[100:103], a[208:211], v[96:99]
  buffer_load_dwordx4 v2, s[28:31], s41 offen offset:0 sc1 lds
  v_mfma_f32_16x16x32_bf16 v[132:135], a[100:103], a[212:215], v[132:135]
  s_waitcnt lgkmcnt(0)
  v_mfma_f32_16x16x32_bf16 v[64:67], a[32:35], a[216:219], v[64:67]
  ds_read_b128 a[68:71], v4 offset:27648
  v_mfma_f32_16x16x32_bf16 v[100:103], a[32:35], a[220:223], v[100:103]
  ds_read_b128 a[72:75], v4 offset:28672
  v_mfma_f32_16x16x32_bf16 v[68:71], a[36:39], a[216:219], v[68:71]
  ds_read_b128 a[76:79], v4 offset:29696
  v_mfma_f32_16x16x32_bf16 v[104:107], a[36:39], a[220:223], v[104:107]
  ds_read_b128 a[80:83], v4 offset:30720
  v_mfma_f32_16x16x32_bf16 v[72:75], a[40:43], a[216:219], v[72:75]
  ds_read_b128 a[84:87], v4 offset:31744
  v_mfma_f32_16x16x32_bf16 v[108:111], a[40:43], a[220:223], v[108:111]
  ds_read_b128 a[88:91], v4 offset:32768
  v_mfma_f32_16x16x32_bf16 v[76:79], a[44:47], a[216:219], v[76:79]
  ds_read_b128 a[92:95], v4 offset:33792
  v_mfma_f32_16x16x32_bf16 v[112:115], a[44:47], a[220:223], v[112:115]
  ds_read_b128 a[96:99], v4 offset:34816
  v_mfma_f32_16x16x32_bf16 v[80:83], a[48:51], a[216:219], v[80:83]
  ds_read_b128 a[100:103], v4 offset:35840
  v_mfma_f32_16x16x32_bf16 v[116:119], a[48:51], a[220:223], v[116:119]
  s_add_u32 m0, s10, 0
  s_add_u32 s41, s12, 110592
  v_mfma_f32_16x16x32_bf16 v[84:87], a[52:55], a[216:219], v[84:87]
  buffer_load_dwordx4 v2, s[28:31], s41 offen offset:0 sc1 lds
  v_mfma_f32_16x16x32_bf16 v[120:123], a[52:55], a[220:223], v[120:123]
  s_add_u32 s40, s58, 98304
  buffer_load_dwordx4 a[168:171], v2, s[60:63], s40 offen offset:0
  v_mfma_f32_16x16x32_bf16 v[88:91], a[56:59], a[216:219], v[88:91]
  buffer_load_dwordx4 v2, s[28:31], s41 offen offset:1024 sc1 lds
  v_mfma_f32_16x16x32_bf16 v[124:127], a[56:59], a[220:223], v[124:127]
  v_mfma_f32_16x16x32_bf16 v[92:95], a[60:63], a[216:219], v[92:95]
  buffer_load_dwordx4 a[172:175], v2, s[60:63], s40 offen offset:1024
  v_mfma_f32_16x16x32_bf16 v[128:131], a[60:63], a[220:223], v[128:131]
  v_mfma_f32_16x16x32_bf16 v[96:99], a[64:67], a[216:219], v[96:99]
  v_mfma_f32_16x16x32_bf16 v[132:135], a[64:67], a[220:223], v[132:135]
  s_waitcnt lgkmcnt(0)
  s_waitcnt vmcnt(21)
  s_barrier
  v_mfma_f32_16x16x32_bf16 v[64:67], a[68:71], a[224:227], v[64:67]
  ds_read_b128 a[32:35], v5 offset:0
  v_mfma_f32_16x16x32_bf16 v[100:103], a[68:71], a[228:231], v[100:103]
  ds_read_b128 a[36:39], v5 offset:1024
  v_mfma_f32_16x16x32_bf16 v[68:71], a[72:75], a[224:227], v[68:71]
  ds_read_b128 a[40:43], v5 offset:2048
  v_mfma_f32_16x16x32_bf16 v[104:107], a[72:75], a[228:231], v[104:107]
  ds_read_b128 a[44:47], v5 offset:3072
  v_mfma_f32_16x16x32_bf16 v[72:75], a[76:79], a[224:227], v[72:75]
  ds_read_b128 a[48:51], v5 offset:4096
  v_mfma_f32_16x16x32_bf16 v[108:111], a[76:79], a[228:231], v[108:111]
  ds_read_b128 a[52:55], v5 offset:5120
  v_mfma_f32_16x16x32_bf16 v[76:79], a[80:83], a[224:227], v[76:79]
  ds_read_b128 a[56:59], v5 offset:6144
  v_mfma_f32_16x16x32_bf16 v[112:115], a[80:83], a[228:231], v[112:115]
  ds_read_b128 a[60:63], v5 offset:7168
  v_mfma_f32_16x16x32_bf16 v[80:83], a[84:87], a[224:227], v[80:83]
  ds_read_b128 a[64:67], v5 offset:8192
  v_mfma_f32_16x16x32_bf16 v[116:119], a[84:87], a[228:231], v[116:119]
  buffer_load_dwordx4 v2, s[28:31], s41 offen offset:2048 sc1 lds
  v_mfma_f32_16x16x32_bf16 v[84:87], a[88:91], a[224:227], v[84:87]
  buffer_load_dwordx4 a[176:179], v2, s[60:63], s40 offen offset:2048
  v_mfma_f32_16x16x32_bf16 v[120:123], a[88:91], a[228:231], v[120:123]
  buffer_load_dwordx4 v2, s[28:31], s41 offen offset:3072 sc1 lds
  v_mfma_f32_16x16x32_bf16 v[88:91], a[92:95], a[224:227], v[88:91]
  v_mfma_f32_16x16x32_bf16 v[124:127], a[92:95], a[228:231], v[124:127]
  buffer_load_dwordx4 a[180:183], v2, s[60:63], s40 offen offset:3072
  v_mfma_f32_16x16x32_bf16 v[92:95], a[96:99], a[224:227], v[92:95]
  v_mfma_f32_16x16x32_bf16 v[128:131], a[96:99], a[228:231], v[128:131]
  v_mfma_f32_16x16x32_bf16 v[96:99], a[100:103], a[224:227], v[96:99]
  v_mfma_f32_16x16x32_bf16 v[132:135], a[100:103], a[228:231], v[132:135]
  s_waitcnt lgkmcnt(0)
  v_mfma_f32_16x16x32_bf16 v[64:67], a[32:35], a[0:3], v[64:67]
  ds_read_b128 a[68:71], v5 offset:9216
  v_mfma_f32_16x16x32_bf16 v[100:103], a[32:35], a[4:7], v[100:103]
  ds_read_b128 a[72:75], v5 offset:10240
  v_mfma_f32_16x16x32_bf16 v[68:71], a[36:39], a[0:3], v[68:71]
  ds_read_b128 a[76:79], v5 offset:11264
  v_mfma_f32_16x16x32_bf16 v[104:107], a[36:39], a[4:7], v[104:107]
  ds_read_b128 a[80:83], v5 offset:12288
  v_mfma_f32_16x16x32_bf16 v[72:75], a[40:43], a[0:3], v[72:75]
  ds_read_b128 a[84:87], v5 offset:13312
  v_mfma_f32_16x16x32_bf16 v[108:111], a[40:43], a[4:7], v[108:111]
  ds_read_b128 a[88:91], v5 offset:14336
  v_mfma_f32_16x16x32_bf16 v[76:79], a[44:47], a[0:3], v[76:79]
  ds_read_b128 a[92:95], v5 offset:15360
  v_mfma_f32_16x16x32_bf16 v[112:115], a[44:47], a[4:7], v[112:115]
  ds_read_b128 a[96:99], v5 offset:16384
  v_mfma_f32_16x16x32_bf16 v[80:83], a[48:51], a[0:3], v[80:83]
  ds_read_b128 a[100:103], v5 offset:17408
  v_mfma_f32_16x16x32_bf16 v[116:119], a[48:51], a[4:7], v[116:119]
  s_add_u32 m0, s10, 4096
  s_add_u32 s41, s12, 114688
  v_mfma_f32_16x16x32_bf16 v[84:87], a[52:55], a[0:3], v[84:87]
  buffer_load_dwordx4 v2, s[28:31], s41 offen offset:0 sc1 lds
  v_mfma_f32_16x16x32_bf16 v[120:123], a[52:55], a[4:7], v[120:123]
  s_add_u32 s40, s58, 102400
  buffer_load_dwordx4 a[184:187], v2, s[60:63], s40 offen offset:0
  v_mfma_f32_16x16x32_bf16 v[88:91], a[56:59], a[0:3], v[88:91]
  buffer_load_dwordx4 v2, s[28:31], s41 offen offset:1024 sc1 lds
  v_mfma_f32_16x16x32_bf16 v[124:127], a[56:59], a[4:7], v[124:127]
  buffer_load_dwordx4 a[188:191], v2, s[60:63], s40 offen offset:1024
  v_mfma_f32_16x16x32_bf16 v[92:95], a[60:63], a[0:3], v[92:95]
  v_mfma_f32_16x16x32_bf16 v[128:131], a[60:63], a[4:7], v[128:131]
  v_mfma_f32_16x16x32_bf16 v[96:99], a[64:67], a[0:3], v[96:99]
  buffer_load_dwordx4 v2, s[28:31], s41 offen offset:2048 sc1 lds
  v_mfma_f32_16x16x32_bf16 v[132:135], a[64:67], a[4:7], v[132:135]
  s_waitcnt lgkmcnt(0)
  v_mfma_f32_16x16x32_bf16 v[64:67], a[68:71], a[8:11], v[64:67]
  ds_read_b128 a[32:35], v5 offset:18432
  v_mfma_f32_16x16x32_bf16 v[100:103], a[68:71], a[12:15], v[100:103]
  ds_read_b128 a[36:39], v5 offset:19456
  v_mfma_f32_16x16x32_bf16 v[68:71], a[72:75], a[8:11], v[68:71]
  ds_read_b128 a[40:43], v5 offset:20480
  v_mfma_f32_16x16x32_bf16 v[104:107], a[72:75], a[12:15], v[104:107]
  ds_read_b128 a[44:47], v5 offset:21504
  v_mfma_f32_16x16x32_bf16 v[72:75], a[76:79], a[8:11], v[72:75]
  ds_read_b128 a[48:51], v5 offset:22528
  v_mfma_f32_16x16x32_bf16 v[108:111], a[76:79], a[12:15], v[108:111]
  ds_read_b128 a[52:55], v5 offset:23552
  v_mfma_f32_16x16x32_bf16 v[76:79], a[80:83], a[8:11], v[76:79]
  ds_read_b128 a[56:59], v5 offset:24576
  v_mfma_f32_16x16x32_bf16 v[112:115], a[80:83], a[12:15], v[112:115]
  ds_read_b128 a[60:63], v5 offset:25600
  v_mfma_f32_16x16x32_bf16 v[80:83], a[84:87], a[8:11], v[80:83]
  ds_read_b128 a[64:67], v5 offset:26624
  v_mfma_f32_16x16x32_bf16 v[116:119], a[84:87], a[12:15], v[116:119]
  buffer_load_dwordx4 a[192:195], v2, s[60:63], s40 offen offset:2048
  v_mfma_f32_16x16x32_bf16 v[84:87], a[88:91], a[8:11], v[84:87]
  buffer_load_dwordx4 v2, s[28:31], s41 offen offset:3072 sc1 lds
  v_mfma_f32_16x16x32_bf16 v[120:123], a[88:91], a[12:15], v[120:123]
  buffer_load_dwordx4 a[196:199], v2, s[60:63], s40 offen offset:3072
  v_mfma_f32_16x16x32_bf16 v[88:91], a[92:95], a[8:11], v[88:91]
  v_mfma_f32_16x16x32_bf16 v[124:127], a[92:95], a[12:15], v[124:127]
  v_mfma_f32_16x16x32_bf16 v[92:95], a[96:99], a[8:11], v[92:95]
  v_mfma_f32_16x16x32_bf16 v[128:131], a[96:99], a[12:15], v[128:131]
  s_add_u32 m0, s10, 8192
  s_add_u32 s41, s12, 118784
  v_mfma_f32_16x16x32_bf16 v[96:99], a[100:103], a[8:11], v[96:99]
  buffer_load_dwordx4 v2, s[28:31], s41 offen offset:0 sc1 lds
  v_mfma_f32_16x16x32_bf16 v[132:135], a[100:103], a[12:15], v[132:135]
  s_waitcnt lgkmcnt(0)
  v_mfma_f32_16x16x32_bf16 v[64:67], a[32:35], a[16:19], v[64:67]
  ds_read_b128 a[68:71], v5 offset:27648
  v_mfma_f32_16x16x32_bf16 v[100:103], a[32:35], a[20:23], v[100:103]
  ds_read_b128 a[72:75], v5 offset:28672
  v_mfma_f32_16x16x32_bf16 v[68:71], a[36:39], a[16:19], v[68:71]
  ds_read_b128 a[76:79], v5 offset:29696
  v_mfma_f32_16x16x32_bf16 v[104:107], a[36:39], a[20:23], v[104:107]
  ds_read_b128 a[80:83], v5 offset:30720
  v_mfma_f32_16x16x32_bf16 v[72:75], a[40:43], a[16:19], v[72:75]
  ds_read_b128 a[84:87], v5 offset:31744
  v_mfma_f32_16x16x32_bf16 v[108:111], a[40:43], a[20:23], v[108:111]
  ds_read_b128 a[88:91], v5 offset:32768
  v_mfma_f32_16x16x32_bf16 v[76:79], a[44:47], a[16:19], v[76:79]
  ds_read_b128 a[92:95], v5 offset:33792
  v_mfma_f32_16x16x32_bf16 v[112:115], a[44:47], a[20:23], v[112:115]
  ds_read_b128 a[96:99], v5 offset:34816
  v_mfma_f32_16x16x32_bf16 v[80:83], a[48:51], a[16:19], v[80:83]
  ds_read_b128 a[100:103], v5 offset:35840
  v_mfma_f32_16x16x32_bf16 v[116:119], a[48:51], a[20:23], v[116:119]
  s_add_u32 m0, s10, 36864
  s_add_u32 s41, s12, 119808
  v_mfma_f32_16x16x32_bf16 v[84:87], a[52:55], a[16:19], v[84:87]
  buffer_load_dwordx4 v2, s[28:31], s41 offen offset:0 sc1 lds
  v_mfma_f32_16x16x32_bf16 v[120:123], a[52:55], a[20:23], v[120:123]
  s_add_u32 s40, s58, 106496
  buffer_load_dwordx4 a[200:203], v2, s[60:63], s40 offen offset:0
  v_mfma_f32_16x16x32_bf16 v[88:91], a[56:59], a[16:19], v[88:91]
  buffer_load_dwordx4 v2, s[28:31], s41 offen offset:1024 sc1 lds
  v_mfma_f32_16x16x32_bf16 v[124:127], a[56:59], a[20:23], v[124:127]
  v_mfma_f32_16x16x32_bf16 v[92:95], a[60:63], a[16:19], v[92:95]
  buffer_load_dwordx4 a[204:207], v2, s[60:63], s40 offen offset:1024
  v_mfma_f32_16x16x32_bf16 v[128:131], a[60:63], a[20:23], v[128:131]
  v_mfma_f32_16x16x32_bf16 v[96:99], a[64:67], a[16:19], v[96:99]
  v_mfma_f32_16x16x32_bf16 v[132:135], a[64:67], a[20:23], v[132:135]
  s_waitcnt lgkmcnt(0)
  s_waitcnt vmcnt(21)
  s_barrier
  v_mfma_f32_16x16x32_bf16 v[64:67], a[68:71], a[24:27], v[64:67]
  ds_read_b128 a[32:35], v6 offset:0
  v_mfma_f32_16x16x32_bf16 v[100:103], a[68:71], a[28:31], v[100:103]
  ds_read_b128 a[36:39], v6 offset:1024
  v_mfma_f32_16x16x32_bf16 v[68:71], a[72:75], a[24:27], v[68:71]
  ds_read_b128 a[40:43], v6 offset:2048
  v_mfma_f32_16x16x32_bf16 v[104:107], a[72:75], a[28:31], v[104:107]
  ds_read_b128 a[44:47], v6 offset:3072
  v_mfma_f32_16x16x32_bf16 v[72:75], a[76:79], a[24:27], v[72:75]
  ds_read_b128 a[48:51], v6 offset:4096
  v_mfma_f32_16x16x32_bf16 v[108:111], a[76:79], a[28:31], v[108:111]
  ds_read_b128 a[52:55], v6 offset:5120
  v_mfma_f32_16x16x32_bf16 v[76:79], a[80:83], a[24:27], v[76:79]
  ds_read_b128 a[56:59], v6 offset:6144
  v_mfma_f32_16x16x32_bf16 v[112:115], a[80:83], a[28:31], v[112:115]
  ds_read_b128 a[60:63], v6 offset:7168
  v_mfma_f32_16x16x32_bf16 v[80:83], a[84:87], a[24:27], v[80:83]
  ds_read_b128 a[64:67], v6 offset:8192
  v_mfma_f32_16x16x32_bf16 v[116:119], a[84:87], a[28:31], v[116:119]
  buffer_load_dwordx4 v2, s[28:31], s41 offen offset:2048 sc1 lds
  v_mfma_f32_16x16x32_bf16 v[84:87], a[88:91], a[24:27], v[84:87]
  buffer_load_dwordx4 a[208:211], v2, s[60:63], s40 offen offset:2048
  v_mfma_f32_16x16x32_bf16 v[120:123], a[88:91], a[28:31], v[120:123]
  buffer_load_dwordx4 v2, s[28:31], s41 offen offset:3072 sc1 lds
  v_mfma_f32_16x16x32_bf16 v[88:91], a[92:95], a[24:27], v[88:91]
  v_mfma_f32_16x16x32_bf16 v[124:127], a[92:95], a[28:31], v[124:127]
  buffer_load_dwordx4 a[212:215], v2, s[60:63], s40 offen offset:3072
  v_mfma_f32_16x16x32_bf16 v[92:95], a[96:99], a[24:27], v[92:95]
  v_mfma_f32_16x16x32_bf16 v[128:131], a[96:99], a[28:31], v[128:131]
  v_mfma_f32_16x16x32_bf16 v[96:99], a[100:103], a[24:27], v[96:99]
  v_mfma_f32_16x16x32_bf16 v[132:135], a[100:103], a[28:31], v[132:135]
  s_waitcnt lgkmcnt(0)
  v_mfma_f32_16x16x32_bf16 v[64:67], a[32:35], a[104:107], v[64:67]
  ds_read_b128 a[68:71], v6 offset:9216
  v_mfma_f32_16x16x32_bf16 v[100:103], a[32:35], a[108:111], v[100:103]
  ds_read_b128 a[72:75], v6 offset:10240
  v_mfma_f32_16x16x32_bf16 v[68:71], a[36:39], a[104:107], v[68:71]
  ds_read_b128 a[76:79], v6 offset:11264
  v_mfma_f32_16x16x32_bf16 v[104:107], a[36:39], a[108:111], v[104:107]
  ds_read_b128 a[80:83], v6 offset:12288
  v_mfma_f32_16x16x32_bf16 v[72:75], a[40:43], a[104:107], v[72:75]
  ds_read_b128 a[84:87], v6 offset:13312
  v_mfma_f32_16x16x32_bf16 v[108:111], a[40:43], a[108:111], v[108:111]
  ds_read_b128 a[88:91], v6 offset:14336
  v_mfma_f32_16x16x32_bf16 v[76:79], a[44:47], a[104:107], v[76:79]
  ds_read_b128 a[92:95], v6 offset:15360
  v_mfma_f32_16x16x32_bf16 v[112:115], a[44:47], a[108:111], v[112:115]
  ds_read_b128 a[96:99], v6 offset:16384
  v_mfma_f32_16x16x32_bf16 v[80:83], a[48:51], a[104:107], v[80:83]
  ds_read_b128 a[100:103], v6 offset:17408
  v_mfma_f32_16x16x32_bf16 v[116:119], a[48:51], a[108:111], v[116:119]
  s_add_u32 m0, s10, 40960
  s_add_u32 s41, s12, 123904
  v_mfma_f32_16x16x32_bf16 v[84:87], a[52:55], a[104:107], v[84:87]
  buffer_load_dwordx4 v2, s[28:31], s41 offen offset:0 sc1 lds
  v_mfma_f32_16x16x32_bf16 v[120:123], a[52:55], a[108:111], v[120:123]
  s_add_u32 s40, s58, 110592
  buffer_load_dwordx4 a[216:219], v2, s[60:63], s40 offen offset:0
  v_mfma_f32_16x16x32_bf16 v[88:91], a[56:59], a[104:107], v[88:91]
  buffer_load_dwordx4 v2, s[28:31], s41 offen offset:1024 sc1 lds
  v_mfma_f32_16x16x32_bf16 v[124:127], a[56:59], a[108:111], v[124:127]
  buffer_load_dwordx4 a[220:223], v2, s[60:63], s40 offen offset:1024
  v_mfma_f32_16x16x32_bf16 v[92:95], a[60:63], a[104:107], v[92:95]
  v_mfma_f32_16x16x32_bf16 v[128:131], a[60:63], a[108:111], v[128:131]
  v_mfma_f32_16x16x32_bf16 v[96:99], a[64:67], a[104:107], v[96:99]
  buffer_load_dwordx4 v2, s[28:31], s41 offen offset:2048 sc1 lds
  v_mfma_f32_16x16x32_bf16 v[132:135], a[64:67], a[108:111], v[132:135]
  s_waitcnt lgkmcnt(0)
  v_mfma_f32_16x16x32_bf16 v[64:67], a[68:71], a[112:115], v[64:67]
  ds_read_b128 a[32:35], v6 offset:18432
  v_mfma_f32_16x16x32_bf16 v[100:103], a[68:71], a[116:119], v[100:103]
  ds_read_b128 a[36:39], v6 offset:19456
  v_mfma_f32_16x16x32_bf16 v[68:71], a[72:75], a[112:115], v[68:71]
  ds_read_b128 a[40:43], v6 offset:20480
  v_mfma_f32_16x16x32_bf16 v[104:107], a[72:75], a[116:119], v[104:107]
  ds_read_b128 a[44:47], v6 offset:21504
  v_mfma_f32_16x16x32_bf16 v[72:75], a[76:79], a[112:115], v[72:75]
  ds_read_b128 a[48:51], v6 offset:22528
  v_mfma_f32_16x16x32_bf16 v[108:111], a[76:79], a[116:119], v[108:111]
  ds_read_b128 a[52:55], v6 offset:23552
  v_mfma_f32_16x16x32_bf16 v[76:79], a[80:83], a[112:115], v[76:79]
  ds_read_b128 a[56:59], v6 offset:24576
  v_mfma_f32_16x16x32_bf16 v[112:115], a[80:83], a[116:119], v[112:115]
  ds_read_b128 a[60:63], v6 offset:25600
  v_mfma_f32_16x16x32_bf16 v[80:83], a[84:87], a[112:115], v[80:83]
  ds_read_b128 a[64:67], v6 offset:26624
  v_mfma_f32_16x16x32_bf16 v[116:119], a[84:87], a[116:119], v[116:119]
  buffer_load_dwordx4 a[224:227], v2, s[60:63], s40 offen offset:2048
  v_mfma_f32_16x16x32_bf16 v[84:87], a[88:91], a[112:115], v[84:87]
  buffer_load_dwordx4 v2, s[28:31], s41 offen offset:3072 sc1 lds
  v_mfma_f32_16x16x32_bf16 v[120:123], a[88:91], a[116:119], v[120:123]
  buffer_load_dwordx4 a[228:231], v2, s[60:63], s40 offen offset:3072
  v_mfma_f32_16x16x32_bf16 v[88:91], a[92:95], a[112:115], v[88:91]
  v_mfma_f32_16x16x32_bf16 v[124:127], a[92:95], a[116:119], v[124:127]
  v_mfma_f32_16x16x32_bf16 v[92:95], a[96:99], a[112:115], v[92:95]
  v_mfma_f32_16x16x32_bf16 v[128:131], a[96:99], a[116:119], v[128:131]
  s_add_u32 m0, s10, 45056
  s_add_u32 s41, s12, 128000
  v_mfma_f32_16x16x32_bf16 v[96:99], a[100:103], a[112:115], v[96:99]
  buffer_load_dwordx4 v2, s[28:31], s41 offen offset:0 sc1 lds
  v_mfma_f32_16x16x32_bf16 v[132:135], a[100:103], a[116:119], v[132:135]
  s_waitcnt lgkmcnt(0)
  v_mfma_f32_16x16x32_bf16 v[64:67], a[32:35], a[120:123], v[64:67]
  ds_read_b128 a[68:71], v6 offset:27648
  v_mfma_f32_16x16x32_bf16 v[100:103], a[32:35], a[124:127], v[100:103]
  ds_read_b128 a[72:75], v6 offset:28672
  v_mfma_f32_16x16x32_bf16 v[68:71], a[36:39], a[120:123], v[68:71]
  ds_read_b128 a[76:79], v6 offset:29696
  v_mfma_f32_16x16x32_bf16 v[104:107], a[36:39], a[124:127], v[104:107]
  ds_read_b128 a[80:83], v6 offset:30720
  v_mfma_f32_16x16x32_bf16 v[72:75], a[40:43], a[120:123], v[72:75]
  ds_read_b128 a[84:87], v6 offset:31744
  v_mfma_f32_16x16x32_bf16 v[108:111], a[40:43], a[124:127], v[108:111]
  ds_read_b128 a[88:91], v6 offset:32768
  v_mfma_f32_16x16x32_bf16 v[76:79], a[44:47], a[120:123], v[76:79]
  ds_read_b128 a[92:95], v6 offset:33792
  v_mfma_f32_16x16x32_bf16 v[112:115], a[44:47], a[124:127], v[112:115]
  ds_read_b128 a[96:99], v6 offset:34816
  v_mfma_f32_16x16x32_bf16 v[80:83], a[48:51], a[120:123], v[80:83]
  ds_read_b128 a[100:103], v6 offset:35840
  v_mfma_f32_16x16x32_bf16 v[116:119], a[48:51], a[124:127], v[116:119]
  s_add_u32 m0, s10, 73728
  s_add_u32 s41, s12, 129024
  v_mfma_f32_16x16x32_bf16 v[84:87], a[52:55], a[120:123], v[84:87]
  buffer_load_dwordx4 v2, s[28:31], s41 offen offset:0 sc1 lds
  v_mfma_f32_16x16x32_bf16 v[120:123], a[52:55], a[124:127], v[120:123]
  s_add_u32 s40, s58, 114688
  buffer_load_dwordx4 a[0:3], v2, s[60:63], s40 offen offset:0
  v_mfma_f32_16x16x32_bf16 v[88:91], a[56:59], a[120:123], v[88:91]
  buffer_load_dwordx4 v2, s[28:31], s41 offen offset:1024 sc1 lds
  v_mfma_f32_16x16x32_bf16 v[124:127], a[56:59], a[124:127], v[124:127]
  v_mfma_f32_16x16x32_bf16 v[92:95], a[60:63], a[120:123], v[92:95]
  buffer_load_dwordx4 a[4:7], v2, s[60:63], s40 offen offset:1024
  v_mfma_f32_16x16x32_bf16 v[128:131], a[60:63], a[124:127], v[128:131]
  v_mfma_f32_16x16x32_bf16 v[96:99], a[64:67], a[120:123], v[96:99]
  v_mfma_f32_16x16x32_bf16 v[132:135], a[64:67], a[124:127], v[132:135]
  s_waitcnt lgkmcnt(0)
  s_waitcnt vmcnt(21)
  s_barrier
  v_mfma_f32_16x16x32_bf16 v[64:67], a[68:71], a[128:131], v[64:67]
  ds_read_b128 a[32:35], v2 offset:0
  v_mfma_f32_16x16x32_bf16 v[100:103], a[68:71], a[132:135], v[100:103]
  ds_read_b128 a[36:39], v2 offset:1024
  v_mfma_f32_16x16x32_bf16 v[68:71], a[72:75], a[128:131], v[68:71]
  ds_read_b128 a[40:43], v2 offset:2048
  v_mfma_f32_16x16x32_bf16 v[104:107], a[72:75], a[132:135], v[104:107]
  ds_read_b128 a[44:47], v2 offset:3072
  v_mfma_f32_16x16x32_bf16 v[72:75], a[76:79], a[128:131], v[72:75]
  ds_read_b128 a[48:51], v2 offset:4096
  v_mfma_f32_16x16x32_bf16 v[108:111], a[76:79], a[132:135], v[108:111]
  ds_read_b128 a[52:55], v2 offset:5120
  v_mfma_f32_16x16x32_bf16 v[76:79], a[80:83], a[128:131], v[76:79]
  ds_read_b128 a[56:59], v2 offset:6144
  v_mfma_f32_16x16x32_bf16 v[112:115], a[80:83], a[132:135], v[112:115]
  ds_read_b128 a[60:63], v2 offset:7168
  v_mfma_f32_16x16x32_bf16 v[80:83], a[84:87], a[128:131], v[80:83]
  ds_read_b128 a[64:67], v2 offset:8192
  v_mfma_f32_16x16x32_bf16 v[116:119], a[84:87], a[132:135], v[116:119]
  buffer_load_dwordx4 v2, s[28:31], s41 offen offset:2048 sc1 lds
  v_mfma_f32_16x16x32_bf16 v[84:87], a[88:91], a[128:131], v[84:87]
  buffer_load_dwordx4 a[8:11], v2, s[60:63], s40 offen offset:2048
  v_mfma_f32_16x16x32_bf16 v[120:123], a[88:91], a[132:135], v[120:123]
  buffer_load_dwordx4 v2, s[28:31], s41 offen offset:3072 sc1 lds
  v_mfma_f32_16x16x32_bf16 v[88:91], a[92:95], a[128:131], v[88:91]
  v_mfma_f32_16x16x32_bf16 v[124:127], a[92:95], a[132:135], v[124:127]
  buffer_load_dwordx4 a[12:15], v2, s[60:63], s40 offen offset:3072
  v_mfma_f32_16x16x32_bf16 v[92:95], a[96:99], a[128:131], v[92:95]
  v_mfma_f32_16x16x32_bf16 v[128:131], a[96:99], a[132:135], v[128:131]
  v_mfma_f32_16x16x32_bf16 v[96:99], a[100:103], a[128:131], v[96:99]
  v_mfma_f32_16x16x32_bf16 v[132:135], a[100:103], a[132:135], v[132:135]
  s_waitcnt lgkmcnt(0)
  v_mfma_f32_16x16x32_bf16 v[64:67], a[32:35], a[168:171], v[64:67]
  ds_read_b128 a[68:71], v2 offset:9216
  v_mfma_f32_16x16x32_bf16 v[100:103], a[32:35], a[172:175], v[100:103]
  ds_read_b128 a[72:75], v2 offset:10240
  v_mfma_f32_16x16x32_bf16 v[68:71], a[36:39], a[168:171], v[68:71]
  ds_read_b128 a[76:79], v2 offset:11264
  v_mfma_f32_16x16x32_bf16 v[104:107], a[36:39], a[172:175], v[104:107]
  ds_read_b128 a[80:83], v2 offset:12288
  v_mfma_f32_16x16x32_bf16 v[72:75], a[40:43], a[168:171], v[72:75]
  ds_read_b128 a[84:87], v2 offset:13312
  v_mfma_f32_16x16x32_bf16 v[108:111], a[40:43], a[172:175], v[108:111]
  ds_read_b128 a[88:91], v2 offset:14336
  v_mfma_f32_16x16x32_bf16 v[76:79], a[44:47], a[168:171], v[76:79]
  ds_read_b128 a[92:95], v2 offset:15360
  v_mfma_f32_16x16x32_bf16 v[112:115], a[44:47], a[172:175], v[112:115]
  ds_read_b128 a[96:99], v2 offset:16384
  v_mfma_f32_16x16x32_bf16 v[80:83], a[48:51], a[168:171], v[80:83]
  ds_read_b128 a[100:103], v2 offset:17408
  v_mfma_f32_16x16x32_bf16 v[116:119], a[48:51], a[172:175], v[116:119]
  s_add_u32 m0, s10, 77824
  s_add_u32 s41, s12, 133120
  v_mfma_f32_16x16x32_bf16 v[84:87], a[52:55], a[168:171], v[84:87]
  buffer_load_dwordx4 v2, s[28:31], s41 offen offset:0 sc1 lds
  v_mfma_f32_16x16x32_bf16 v[120:123], a[52:55], a[172:175], v[120:123]
  s_add_u32 s40, s58, 118784
  buffer_load_dwordx4 a[16:19], v2, s[60:63], s40 offen offset:0
  v_mfma_f32_16x16x32_bf16 v[88:91], a[56:59], a[168:171], v[88:91]
  buffer_load_dwordx4 v2, s[28:31], s41 offen offset:1024 sc1 lds
  v_mfma_f32_16x16x32_bf16 v[124:127], a[56:59], a[172:175], v[124:127]
  buffer_load_dwordx4 a[20:23], v2, s[60:63], s40 offen offset:1024
  v_mfma_f32_16x16x32_bf16 v[92:95], a[60:63], a[168:171], v[92:95]
  v_mfma_f32_16x16x32_bf16 v[128:131], a[60:63], a[172:175], v[128:131]
  v_mfma_f32_16x16x32_bf16 v[96:99], a[64:67], a[168:171], v[96:99]
  buffer_load_dwordx4 v2, s[28:31], s41 offen offset:2048 sc1 lds
  v_mfma_f32_16x16x32_bf16 v[132:135], a[64:67], a[172:175], v[132:135]
  s_waitcnt lgkmcnt(0)
  v_mfma_f32_16x16x32_bf16 v[64:67], a[68:71], a[176:179], v[64:67]
  ds_read_b128 a[32:35], v2 offset:18432
  v_mfma_f32_16x16x32_bf16 v[100:103], a[68:71], a[180:183], v[100:103]
  ds_read_b128 a[36:39], v2 offset:19456
  v_mfma_f32_16x16x32_bf16 v[68:71], a[72:75], a[176:179], v[68:71]
  ds_read_b128 a[40:43], v2 offset:20480
  v_mfma_f32_16x16x32_bf16 v[104:107], a[72:75], a[180:183], v[104:107]
  ds_read_b128 a[44:47], v2 offset:21504
  v_mfma_f32_16x16x32_bf16 v[72:75], a[76:79], a[176:179], v[72:75]
  ds_read_b128 a[48:51], v2 offset:22528
  v_mfma_f32_16x16x32_bf16 v[108:111], a[76:79], a[180:183], v[108:111]
  ds_read_b128 a[52:55], v2 offset:23552
  v_mfma_f32_16x16x32_bf16 v[76:79], a[80:83], a[176:179], v[76:79]
  ds_read_b128 a[56:59], v2 offset:24576
  v_mfma_f32_16x16x32_bf16 v[112:115], a[80:83], a[180:183], v[112:115]
  ds_read_b128 a[60:63], v2 offset:25600
  v_mfma_f32_16x16x32_bf16 v[80:83], a[84:87], a[176:179], v[80:83]
  ds_read_b128 a[64:67], v2 offset:26624
  v_mfma_f32_16x16x32_bf16 v[116:119], a[84:87], a[180:183], v[116:119]
  buffer_load_dwordx4 a[24:27], v2, s[60:63], s40 offen offset:2048
  v_mfma_f32_16x16x32_bf16 v[84:87], a[88:91], a[176:179], v[84:87]
  buffer_load_dwordx4 v2, s[28:31], s41 offen offset:3072 sc1 lds
  v_mfma_f32_16x16x32_bf16 v[120:123], a[88:91], a[180:183], v[120:123]
  buffer_load_dwordx4 a[28:31], v2, s[60:63], s40 offen offset:3072
  v_mfma_f32_16x16x32_bf16 v[88:91], a[92:95], a[176:179], v[88:91]
  v_mfma_f32_16x16x32_bf16 v[124:127], a[92:95], a[180:183], v[124:127]
  v_mfma_f32_16x16x32_bf16 v[92:95], a[96:99], a[176:179], v[92:95]
  v_mfma_f32_16x16x32_bf16 v[128:131], a[96:99], a[180:183], v[128:131]
  s_add_u32 m0, s10, 81920
  s_add_u32 s41, s12, 137216
  v_mfma_f32_16x16x32_bf16 v[96:99], a[100:103], a[176:179], v[96:99]
  buffer_load_dwordx4 v2, s[28:31], s41 offen offset:0 sc1 lds
  v_mfma_f32_16x16x32_bf16 v[132:135], a[100:103], a[180:183], v[132:135]
  s_waitcnt lgkmcnt(0)
  v_mfma_f32_16x16x32_bf16 v[64:67], a[32:35], a[184:187], v[64:67]
  ds_read_b128 a[68:71], v2 offset:27648
  v_mfma_f32_16x16x32_bf16 v[100:103], a[32:35], a[188:191], v[100:103]
  ds_read_b128 a[72:75], v2 offset:28672
  v_mfma_f32_16x16x32_bf16 v[68:71], a[36:39], a[184:187], v[68:71]
  ds_read_b128 a[76:79], v2 offset:29696
  v_mfma_f32_16x16x32_bf16 v[104:107], a[36:39], a[188:191], v[104:107]
  ds_read_b128 a[80:83], v2 offset:30720
  v_mfma_f32_16x16x32_bf16 v[72:75], a[40:43], a[184:187], v[72:75]
  ds_read_b128 a[84:87], v2 offset:31744
  v_mfma_f32_16x16x32_bf16 v[108:111], a[40:43], a[188:191], v[108:111]
  ds_read_b128 a[88:91], v2 offset:32768
  v_mfma_f32_16x16x32_bf16 v[76:79], a[44:47], a[184:187], v[76:79]
  ds_read_b128 a[92:95], v2 offset:33792
  v_mfma_f32_16x16x32_bf16 v[112:115], a[44:47], a[188:191], v[112:115]
  ds_read_b128 a[96:99], v2 offset:34816
  v_mfma_f32_16x16x32_bf16 v[80:83], a[48:51], a[184:187], v[80:83]
  ds_read_b128 a[100:103], v2 offset:35840
  v_mfma_f32_16x16x32_bf16 v[116:119], a[48:51], a[188:191], v[116:119]
  s_add_u32 m0, s10, 110592
  s_add_u32 s41, s12, 138240
  v_mfma_f32_16x16x32_bf16 v[84:87], a[52:55], a[184:187], v[84:87]
  buffer_load_dwordx4 v2, s[28:31], s41 offen offset:0 sc1 lds
  v_mfma_f32_16x16x32_bf16 v[120:123], a[52:55], a[188:191], v[120:123]
  s_add_u32 s40, s58, 122880
  buffer_load_dwordx4 a[104:107], v2, s[60:63], s40 offen offset:0
  v_mfma_f32_16x16x32_bf16 v[88:91], a[56:59], a[184:187], v[88:91]
  buffer_load_dwordx4 v2, s[28:31], s41 offen offset:1024 sc1 lds
  v_mfma_f32_16x16x32_bf16 v[124:127], a[56:59], a[188:191], v[124:127]
  v_mfma_f32_16x16x32_bf16 v[92:95], a[60:63], a[184:187], v[92:95]
  buffer_load_dwordx4 a[108:111], v2, s[60:63], s40 offen offset:1024
  v_mfma_f32_16x16x32_bf16 v[128:131], a[60:63], a[188:191], v[128:131]
  v_mfma_f32_16x16x32_bf16 v[96:99], a[64:67], a[184:187], v[96:99]
  v_mfma_f32_16x16x32_bf16 v[132:135], a[64:67], a[188:191], v[132:135]
  s_waitcnt lgkmcnt(0)
  s_waitcnt vmcnt(21)
  s_barrier
  v_mfma_f32_16x16x32_bf16 v[64:67], a[68:71], a[192:195], v[64:67]
  ds_read_b128 a[32:35], v4 offset:0
  v_mfma_f32_16x16x32_bf16 v[100:103], a[68:71], a[196:199], v[100:103]
  ds_read_b128 a[36:39], v4 offset:1024
  v_mfma_f32_16x16x32_bf16 v[68:71], a[72:75], a[192:195], v[68:71]
  ds_read_b128 a[40:43], v4 offset:2048
  v_mfma_f32_16x16x32_bf16 v[104:107], a[72:75], a[196:199], v[104:107]
  ds_read_b128 a[44:47], v4 offset:3072
  v_mfma_f32_16x16x32_bf16 v[72:75], a[76:79], a[192:195], v[72:75]
  ds_read_b128 a[48:51], v4 offset:4096
  v_mfma_f32_16x16x32_bf16 v[108:111], a[76:79], a[196:199], v[108:111]
  ds_read_b128 a[52:55], v4 offset:5120
  v_mfma_f32_16x16x32_bf16 v[76:79], a[80:83], a[192:195], v[76:79]
  ds_read_b128 a[56:59], v4 offset:6144
  v_mfma_f32_16x16x32_bf16 v[112:115], a[80:83], a[196:199], v[112:115]
  ds_read_b128 a[60:63], v4 offset:7168
  v_mfma_f32_16x16x32_bf16 v[80:83], a[84:87], a[192:195], v[80:83]
  ds_read_b128 a[64:67], v4 offset:8192
  v_mfma_f32_16x16x32_bf16 v[116:119], a[84:87], a[196:199], v[116:119]
  buffer_load_dwordx4 v2, s[28:31], s41 offen offset:2048 sc1 lds
  v_mfma_f32_16x16x32_bf16 v[84:87], a[88:91], a[192:195], v[84:87]
  buffer_load_dwordx4 a[112:115], v2, s[60:63], s40 offen offset:2048
  v_mfma_f32_16x16x32_bf16 v[120:123], a[88:91], a[196:199], v[120:123]
  buffer_load_dwordx4 v2, s[28:31], s41 offen offset:3072 sc1 lds
  v_mfma_f32_16x16x32_bf16 v[88:91], a[92:95], a[192:195], v[88:91]
  v_mfma_f32_16x16x32_bf16 v[124:127], a[92:95], a[196:199], v[124:127]
  buffer_load_dwordx4 a[116:119], v2, s[60:63], s40 offen offset:3072
  v_mfma_f32_16x16x32_bf16 v[92:95], a[96:99], a[192:195], v[92:95]
  v_mfma_f32_16x16x32_bf16 v[128:131], a[96:99], a[196:199], v[128:131]
  v_mfma_f32_16x16x32_bf16 v[96:99], a[100:103], a[192:195], v[96:99]
  v_mfma_f32_16x16x32_bf16 v[132:135], a[100:103], a[196:199], v[132:135]
  s_waitcnt lgkmcnt(0)
  v_mfma_f32_16x16x32_bf16 v[64:67], a[32:35], a[200:203], v[64:67]
  ds_read_b128 a[68:71], v4 offset:9216
  v_mfma_f32_16x16x32_bf16 v[100:103], a[32:35], a[204:207], v[100:103]
  ds_read_b128 a[72:75], v4 offset:10240
  s_cmp_ge_u32 s2, 16
  s_cbranch_scc1 L_pfs_k3_kernel_6
  s_cmp_lg_u32 s3, 0
  s_cbranch_scc1 L_pfs_k3_kernel_6
  s_getpc_b64 s[36:37]
L_pf_k3_kernel_5:
  s_add_u32 s36, s36, L_k5_done-L_pf_k3_kernel_5
  s_addc_u32 s37, s37, 0
  s_and_b32 s37, s37, 0xffff
  s_mov_b32 s38, L_k4_end-L_k5_done
  s_mov_b32 s39, 0x20000
  v_lshlrev_b32 v220, 7, v1
  buffer_load_dword v221, v220, s[36:39], 0 offen
L_pfs_k3_kernel_6:
  buffer_load_dwordx2 v[208:209], v2, s[32:35], s15 offen sc1
  v_mfma_f32_16x16x32_bf16 v[68:71], a[36:39], a[200:203], v[68:71]
  ds_read_b128 a[76:79], v4 offset:11264
  v_mfma_f32_16x16x32_bf16 v[104:107], a[36:39], a[204:207], v[104:107]
  ds_read_b128 a[80:83], v4 offset:12288
  buffer_load_dwordx2 v[210:211], v2, s[32:35], s56 offen sc1
  v_mfma_f32_16x16x32_bf16 v[72:75], a[40:43], a[200:203], v[72:75]
  ds_read_b128 a[84:87], v4 offset:13312
  v_mfma_f32_16x16x32_bf16 v[108:111], a[40:43], a[204:207], v[108:111]
  ds_read_b128 a[88:91], v4 offset:14336
  s_and_b32 s50, s2, 7
  s_lshr_b32 s51, s2, 3
  s_lshr_b32 s48, s50, 1
  s_lshl_b32 s48, s48, 3
  s_and_b32 s49, s51, 7
  s_add_u32 s48, s48, s49
  s_and_b32 s49, s50, 1
  s_lshl_b32 s49, s49, 2
  s_lshr_b32 s51, s51, 3
  s_add_u32 s49, s49, s51
  s_add_u32 s52, s16, 25165824
  s_addc_u32 s53, s17, 0
  s_and_b32 s53, s53, 0xffff
  s_mov_b32 s54, 2654208
  s_mov_b32 s55, 0x20000
  s_mul_i32 s50, s49, 331776
  s_mul_i32 s51, s10, 9
  s_add_u32 s50, s50, s51
  v_mfma_f32_16x16x32_bf16 v[76:79], a[44:47], a[200:203], v[76:79]
  ds_read_b128 a[92:95], v4 offset:15360
  v_mfma_f32_16x16x32_bf16 v[112:115], a[44:47], a[204:207], v[112:115]
  ds_read_b128 a[96:99], v4 offset:16384
  v_mfma_f32_16x16x32_bf16 v[80:83], a[48:51], a[200:203], v[80:83]
  ds_read_b128 a[100:103], v4 offset:17408
  v_mfma_f32_16x16x32_bf16 v[116:119], a[48:51], a[204:207], v[116:119]
  s_add_u32 m0, s10, 114688
  s_add_u32 s41, s12, 142336
  v_mfma_f32_16x16x32_bf16 v[84:87], a[52:55], a[200:203], v[84:87]
  buffer_load_dwordx4 v2, s[28:31], s41 offen offset:0 sc1 lds
  v_mfma_f32_16x16x32_bf16 v[120:123], a[52:55], a[204:207], v[120:123]
  s_add_u32 s40, s58, 126976
  buffer_load_dwordx4 a[120:123], v2, s[60:63], s40 offen offset:0
  v_mfma_f32_16x16x32_bf16 v[88:91], a[56:59], a[200:203], v[88:91]
  buffer_load_dwordx4 v2, s[28:31], s41 offen offset:1024 sc1 lds
  v_mfma_f32_16x16x32_bf16 v[124:127], a[56:59], a[204:207], v[124:127]
  buffer_load_dwordx4 a[124:127], v2, s[60:63], s40 offen offset:1024
  v_mfma_f32_16x16x32_bf16 v[92:95], a[60:63], a[200:203], v[92:95]
  v_mfma_f32_16x16x32_bf16 v[128:131], a[60:63], a[204:207], v[128:131]
  v_mfma_f32_16x16x32_bf16 v[96:99], a[64:67], a[200:203], v[96:99]
  buffer_load_dwordx4 v2, s[28:31], s41 offen offset:2048 sc1 lds
  v_mfma_f32_16x16x32_bf16 v[132:135], a[64:67], a[204:207], v[132:135]
  s_waitcnt lgkmcnt(0)
  v_mfma_f32_16x16x32_bf16 v[64:67], a[68:71], a[208:211], v[64:67]
  ds_read_b128 a[32:35], v4 offset:18432
  v_mfma_f32_16x16x32_bf16 v[100:103], a[68:71], a[212:215], v[100:103]
  ds_read_b128 a[36:39], v4 offset:19456
  s_add_u32 s51, s50, 36864
  buffer_load_dwordx4 v[144:147], v2, s[52:55], s51 offen
  v_mfma_f32_16x16x32_bf16 v[68:71], a[72:75], a[208:211], v[68:71]
  ds_read_b128 a[40:43], v4 offset:20480
  v_mfma_f32_16x16x32_bf16 v[104:107], a[72:75], a[212:215], v[104:107]
  ds_read_b128 a[44:47], v4 offset:21504
  buffer_load_dwordx4 v[148:151], v2, s[52:55], s51 offen offset:1024
  v_mfma_f32_16x16x32_bf16 v[72:75], a[76:79], a[208:211], v[72:75]
  ds_read_b128 a[48:51], v4 offset:22528
  v_mfma_f32_16x16x32_bf16 v[108:111], a[76:79], a[212:215], v[108:111]
  ds_read_b128 a[52:55], v4 offset:23552
  buffer_load_dwordx4 v[152:155], v2, s[52:55], s51 offen offset:2048
  v_mfma_f32_16x16x32_bf16 v[76:79], a[80:83], a[208:211], v[76:79]
  ds_read_b128 a[56:59], v4 offset:24576
  v_mfma_f32_16x16x32_bf16 v[112:115], a[80:83], a[212:215], v[112:115]
  ds_read_b128 a[60:63], v4 offset:25600
  buffer_load_dwordx4 v[156:159], v2, s[52:55], s51 offen offset:3072
  v_mfma_f32_16x16x32_bf16 v[80:83], a[84:87], a[208:211], v[80:83]
  ds_read_b128 a[64:67], v4 offset:26624
  v_mfma_f32_16x16x32_bf16 v[116:119], a[84:87], a[212:215], v[116:119]
  s_add_u32 s51, s51, 4096
  buffer_load_dwordx4 v[160:163], v18, s[52:55], s51 offen
  buffer_load_dwordx4 a[128:131], v2, s[60:63], s40 offen offset:2048
  v_mfma_f32_16x16x32_bf16 v[84:87], a[88:91], a[208:211], v[84:87]
  buffer_load_dwordx4 v2, s[28:31], s41 offen offset:3072 sc1 lds
  v_mfma_f32_16x16x32_bf16 v[120:123], a[88:91], a[212:215], v[120:123]
  buffer_load_dwordx4 a[132:135], v2, s[60:63], s40 offen offset:3072
  v_mfma_f32_16x16x32_bf16 v[88:91], a[92:95], a[208:211], v[88:91]
  v_mfma_f32_16x16x32_bf16 v[124:127], a[92:95], a[212:215], v[124:127]
  v_mfma_f32_16x16x32_bf16 v[92:95], a[96:99], a[208:211], v[92:95]
  v_mfma_f32_16x16x32_bf16 v[128:131], a[96:99], a[212:215], v[128:131]
  s_add_u32 m0, s10, 118784
  s_add_u32 s41, s12, 146432
  v_mfma_f32_16x16x32_bf16 v[96:99], a[100:103], a[208:211], v[96:99]
  buffer_load_dwordx4 v2, s[28:31], s41 offen offset:0 sc1 lds
  v_mfma_f32_16x16x32_bf16 v[132:135], a[100:103], a[212:215], v[132:135]
  s_waitcnt lgkmcnt(0)
  v_mfma_f32_16x16x32_bf16 v[64:67], a[32:35], a[216:219], v[64:67]
  ds_read_b128 a[68:71], v4 offset:27648
  v_mfma_f32_16x16x32_bf16 v[100:103], a[32:35], a[220:223], v[100:103]
  ds_read_b128 a[72:75], v4 offset:28672
  s_add_u32 s51, s50, 41472
  buffer_load_dwordx4 v[164:167], v2, s[52:55], s51 offen
  v_mfma_f32_16x16x32_bf16 v[68:71], a[36:39], a[216:219], v[68:71]
  ds_read_b128 a[76:79], v4 offset:29696
  v_mfma_f32_16x16x32_bf16 v[104:107], a[36:39], a[220:223], v[104:107]
  ds_read_b128 a[80:83], v4 offset:30720
  buffer_load_dwordx4 v[168:171], v2, s[52:55], s51 offen offset:1024
  v_mfma_f32_16x16x32_bf16 v[72:75], a[40:43], a[216:219], v[72:75]
  ds_read_b128 a[84:87], v4 offset:31744
  v_mfma_f32_16x16x32_bf16 v[108:111], a[40:43], a[220:223], v[108:111]
  ds_read_b128 a[88:91], v4 offset:32768
  buffer_load_dwordx4 v[172:175], v2, s[52:55], s51 offen offset:2048
  v_mfma_f32_16x16x32_bf16 v[76:79], a[44:47], a[216:219], v[76:79]
  ds_read_b128 a[92:95], v4 offset:33792
  v_mfma_f32_16x16x32_bf16 v[112:115], a[44:47], a[220:223], v[112:115]
  ds_read_b128 a[96:99], v4 offset:34816
  buffer_load_dwordx4 v[176:179], v2, s[52:55], s51 offen offset:3072
  v_mfma_f32_16x16x32_bf16 v[80:83], a[48:51], a[216:219], v[80:83]
  ds_read_b128 a[100:103], v4 offset:35840
  v_mfma_f32_16x16x32_bf16 v[116:119], a[48:51], a[220:223], v[116:119]
  s_add_u32 s51, s51, 4096
  buffer_load_dwordx4 v[180:183], v18, s[52:55], s51 offen
  v_mfma_f32_16x16x32_bf16 v[84:87], a[52:55], a[216:219], v[84:87]
  v_mfma_f32_16x16x32_bf16 v[120:123], a[52:55], a[220:223], v[120:123]
  v_mfma_f32_16x16x32_bf16 v[88:91], a[56:59], a[216:219], v[88:91]
  v_mfma_f32_16x16x32_bf16 v[124:127], a[56:59], a[220:223], v[124:127]
  v_mfma_f32_16x16x32_bf16 v[92:95], a[60:63], a[216:219], v[92:95]
  v_mfma_f32_16x16x32_bf16 v[128:131], a[60:63], a[220:223], v[128:131]
  v_mfma_f32_16x16x32_bf16 v[96:99], a[64:67], a[216:219], v[96:99]
  v_mfma_f32_16x16x32_bf16 v[132:135], a[64:67], a[220:223], v[132:135]
  s_waitcnt lgkmcnt(0)
  s_waitcnt vmcnt(29)
  s_barrier
  v_mfma_f32_16x16x32_bf16 v[64:67], a[68:71], a[224:227], v[64:67]
  ds_read_b128 a[32:35], v5 offset:0
  v_mfma_f32_16x16x32_bf16 v[100:103], a[68:71], a[228:231], v[100:103]
  ds_read_b128 a[36:39], v5 offset:1024
  s_add_u32 s51, s50, 46080
  buffer_load_dwordx4 v[184:187], v2, s[52:55], s51 offen
  v_mfma_f32_16x16x32_bf16 v[68:71], a[72:75], a[224:227], v[68:71]
  ds_read_b128 a[40:43], v5 offset:2048
  v_mfma_f32_16x16x32_bf16 v[104:107], a[72:75], a[228:231], v[104:107]
  ds_read_b128 a[44:47], v5 offset:3072
  buffer_load_dwordx4 v[188:191], v2, s[52:55], s51 offen offset:1024
  v_mfma_f32_16x16x32_bf16 v[72:75], a[76:79], a[224:227], v[72:75]
  ds_read_b128 a[48:51], v5 offset:4096
  v_mfma_f32_16x16x32_bf16 v[108:111], a[76:79], a[228:231], v[108:111]
  ds_read_b128 a[52:55], v5 offset:5120
  buffer_load_dwordx4 v[192:195], v2, s[52:55], s51 offen offset:2048
  v_mfma_f32_16x16x32_bf16 v[76:79], a[80:83], a[224:227], v[76:79]
  ds_read_b128 a[56:59], v5 offset:6144
  v_mfma_f32_16x16x32_bf16 v[112:115], a[80:83], a[228:231], v[112:115]
  ds_read_b128 a[60:63], v5 offset:7168
  buffer_load_dwordx4 v[196:199], v2, s[52:55], s51 offen offset:3072
  v_mfma_f32_16x16x32_bf16 v[80:83], a[84:87], a[224:227], v[80:83]
  ds_read_b128 a[64:67], v5 offset:8192
  v_mfma_f32_16x16x32_bf16 v[116:119], a[84:87], a[228:231], v[116:119]
  s_add_u32 s51, s51, 4096
  buffer_load_dwordx4 v[200:203], v18, s[52:55], s51 offen
  v_mfma_f32_16x16x32_bf16 v[84:87], a[88:91], a[224:227], v[84:87]
  v_mfma_f32_16x16x32_bf16 v[120:123], a[88:91], a[228:231], v[120:123]
  v_mfma_f32_16x16x32_bf16 v[88:91], a[92:95], a[224:227], v[88:91]
  v_mfma_f32_16x16x32_bf16 v[124:127], a[92:95], a[228:231], v[124:127]
  v_mfma_f32_16x16x32_bf16 v[92:95], a[96:99], a[224:227], v[92:95]
  v_mfma_f32_16x16x32_bf16 v[128:131], a[96:99], a[228:231], v[128:131]
  v_mfma_f32_16x16x32_bf16 v[96:99], a[100:103], a[224:227], v[96:99]
  v_mfma_f32_16x16x32_bf16 v[132:135], a[100:103], a[228:231], v[132:135]
  s_waitcnt lgkmcnt(0)
  v_mfma_f32_16x16x32_bf16 v[64:67], a[32:35], a[0:3], v[64:67]
  ds_read_b128 a[68:71], v5 offset:9216
  v_mfma_f32_16x16x32_bf16 v[100:103], a[32:35], a[4:7], v[100:103]
  ds_read_b128 a[72:75], v5 offset:10240
  s_add_u32 m0, s10, 0
  s_add_u32 s41, s50, 0
  buffer_load_dwordx4 v2, s[52:55], s41 offen offset:0  lds
  v_mfma_f32_16x16x32_bf16 v[68:71], a[36:39], a[0:3], v[68:71]
  ds_read_b128 a[76:79], v5 offset:11264
  v_mfma_f32_16x16x32_bf16 v[104:107], a[36:39], a[4:7], v[104:107]
  ds_read_b128 a[80:83], v5 offset:12288
  buffer_load_dwordx4 v2, s[52:55], s41 offen offset:1024  lds
  v_mfma_f32_16x16x32_bf16 v[72:75], a[40:43], a[0:3], v[72:75]
  ds_read_b128 a[84:87], v5 offset:13312
  v_mfma_f32_16x16x32_bf16 v[108:111], a[40:43], a[4:7], v[108:111]
  ds_read_b128 a[88:91], v5 offset:14336
  buffer_load_dwordx4 v2, s[52:55], s41 offen offset:2048  lds
  v_mfma_f32_16x16x32_bf16 v[76:79], a[44:47], a[0:3], v[76:79]
  ds_read_b128 a[92:95], v5 offset:15360
  v_mfma_f32_16x16x32_bf16 v[112:115], a[44:47], a[4:7], v[112:115]
  ds_read_b128 a[96:99], v5 offset:16384
  buffer_load_dwordx4 v2, s[52:55], s41 offen offset:3072  lds
  v_mfma_f32_16x16x32_bf16 v[80:83], a[48:51], a[0:3], v[80:83]
  ds_read_b128 a[100:103], v5 offset:17408
  v_mfma_f32_16x16x32_bf16 v[116:119], a[48:51], a[4:7], v[116:119]
  s_add_u32 m0, s10, 4096
  s_add_u32 s41, s50, 4096
  buffer_load_dwordx4 v2, s[52:55], s41 offen offset:0  lds
  v_mfma_f32_16x16x32_bf16 v[84:87], a[52:55], a[0:3], v[84:87]
  v_mfma_f32_16x16x32_bf16 v[120:123], a[52:55], a[4:7], v[120:123]
  buffer_load_dwordx4 v2, s[52:55], s41 offen offset:1024  lds
  v_mfma_f32_16x16x32_bf16 v[88:91], a[56:59], a[0:3], v[88:91]
  v_mfma_f32_16x16x32_bf16 v[124:127], a[56:59], a[4:7], v[124:127]
  buffer_load_dwordx4 v2, s[52:55], s41 offen offset:2048  lds
  v_mfma_f32_16x16x32_bf16 v[92:95], a[60:63], a[0:3], v[92:95]
  v_mfma_f32_16x16x32_bf16 v[128:131], a[60:63], a[4:7], v[128:131]
  buffer_load_dwordx4 v2, s[52:55], s41 offen offset:3072  lds
  v_mfma_f32_16x16x32_bf16 v[96:99], a[64:67], a[0:3], v[96:99]
  v_mfma_f32_16x16x32_bf16 v[132:135], a[64:67], a[4:7], v[132:135]
  s_add_u32 m0, s10, 8192
  s_add_u32 s41, s50, 8192
  buffer_load_dwordx4 v2, s[52:55], s41 offen offset:0  lds
  s_waitcnt lgkmcnt(0)
  v_mfma_f32_16x16x32_bf16 v[64:67], a[68:71], a[8:11], v[64:67]
  ds_read_b128 a[32:35], v5 offset:18432
  v_mfma_f32_16x16x32_bf16 v[100:103], a[68:71], a[12:15], v[100:103]
  ds_read_b128 a[36:39], v5 offset:19456
  s_add_u32 m0, s10, 36864
  s_add_u32 s41, s50, 9216
  buffer_load_dwordx4 v2, s[52:55], s41 offen offset:0  lds
  v_mfma_f32_16x16x32_bf16 v[68:71], a[72:75], a[8:11], v[68:71]
  ds_read_b128 a[40:43], v5 offset:20480
  v_mfma_f32_16x16x32_bf16 v[104:107], a[72:75], a[12:15], v[104:107]
  ds_read_b128 a[44:47], v5 offset:21504
  buffer_load_dwordx4 v2, s[52:55], s41 offen offset:1024  lds
  v_mfma_f32_16x16x32_bf16 v[72:75], a[76:79], a[8:11], v[72:75]
  ds_read_b128 a[48:51], v5 offset:22528
  v_mfma_f32_16x16x32_bf16 v[108:111], a[76:79], a[12:15], v[108:111]
  ds_read_b128 a[52:55], v5 offset:23552
  buffer_load_dwordx4 v2, s[52:55], s41 offen offset:2048  lds
  v_mfma_f32_16x16x32_bf16 v[76:79], a[80:83], a[8:11], v[76:79]
  ds_read_b128 a[56:59], v5 offset:24576
  v_mfma_f32_16x16x32_bf16 v[112:115], a[80:83], a[12:15], v[112:115]
  ds_read_b128 a[60:63], v5 offset:25600
  buffer_load_dwordx4 v2, s[52:55], s41 offen offset:3072  lds
  v_mfma_f32_16x16x32_bf16 v[80:83], a[84:87], a[8:11], v[80:83]
  ds_read_b128 a[64:67], v5 offset:26624
  v_mfma_f32_16x16x32_bf16 v[116:119], a[84:87], a[12:15], v[116:119]
  s_add_u32 m0, s10, 40960
  s_add_u32 s41, s50, 13312
  buffer_load_dwordx4 v2, s[52:55], s41 offen offset:0  lds
  v_mfma_f32_16x16x32_bf16 v[84:87], a[88:91], a[8:11], v[84:87]
  v_mfma_f32_16x16x32_bf16 v[120:123], a[88:91], a[12:15], v[120:123]
  buffer_load_dwordx4 v2, s[52:55], s41 offen offset:1024  lds
  v_mfma_f32_16x16x32_bf16 v[88:91], a[92:95], a[8:11], v[88:91]
  v_mfma_f32_16x16x32_bf16 v[124:127], a[92:95], a[12:15], v[124:127]
  buffer_load_dwordx4 v2, s[52:55], s41 offen offset:2048  lds
  v_mfma_f32_16x16x32_bf16 v[92:95], a[96:99], a[8:11], v[92:95]
  v_mfma_f32_16x16x32_bf16 v[128:131], a[96:99], a[12:15], v[128:131]
  buffer_load_dwordx4 v2, s[52:55], s41 offen offset:3072  lds
  v_mfma_f32_16x16x32_bf16 v[96:99], a[100:103], a[8:11], v[96:99]
  v_mfma_f32_16x16x32_bf16 v[132:135], a[100:103], a[12:15], v[132:135]
  s_add_u32 m0, s10, 45056
  s_add_u32 s41, s50, 17408
  buffer_load_dwordx4 v2, s[52:55], s41 offen offset:0  lds
  s_waitcnt lgkmcnt(0)
  v_mfma_f32_16x16x32_bf16 v[64:67], a[32:35], a[16:19], v[64:67]
  ds_read_b128 a[68:71], v5 offset:27648
  v_mfma_f32_16x16x32_bf16 v[100:103], a[32:35], a[20:23], v[100:103]
  ds_read_b128 a[72:75], v5 offset:28672
  s_add_u32 s51, s50, 50688
  buffer_load_dwordx4 v[20:23], v2, s[52:55], s51 offen
  v_mfma_f32_16x16x32_bf16 v[68:71], a[36:39], a[16:19], v[68:71]
  ds_read_b128 a[76:79], v5 offset:29696
  v_mfma_f32_16x16x32_bf16 v[104:107], a[36:39], a[20:23], v[104:107]
  ds_read_b128 a[80:83], v5 offset:30720
  buffer_load_dwordx4 v[24:27], v2, s[52:55], s51 offen offset:1024
  v_mfma_f32_16x16x32_bf16 v[72:75], a[40:43], a[16:19], v[72:75]
  ds_read_b128 a[84:87], v5 offset:31744
  v_mfma_f32_16x16x32_bf16 v[108:111], a[40:43], a[20:23], v[108:111]
  ds_read_b128 a[88:91], v5 offset:32768
  buffer_load_dwordx4 v[28:31], v2, s[52:55], s51 offen offset:2048
  v_mfma_f32_16x16x32_bf16 v[76:79], a[44:47], a[16:19], v[76:79]
  ds_read_b128 a[92:95], v5 offset:33792
  v_mfma_f32_16x16x32_bf16 v[112:115], a[44:47], a[20:23], v[112:115]
  ds_read_b128 a[96:99], v5 offset:34816
  buffer_load_dwordx4 v[32:35], v2, s[52:55], s51 offen offset:3072
  v_mfma_f32_16x16x32_bf16 v[80:83], a[48:51], a[16:19], v[80:83]
  ds_read_b128 a[100:103], v5 offset:35840
  v_mfma_f32_16x16x32_bf16 v[116:119], a[48:51], a[20:23], v[116:119]
  s_add_u32 s51, s51, 4096
  buffer_load_dwordx4 v[36:39], v18, s[52:55], s51 offen
  v_mfma_f32_16x16x32_bf16 v[84:87], a[52:55], a[16:19], v[84:87]
  v_mfma_f32_16x16x32_bf16 v[120:123], a[52:55], a[20:23], v[120:123]
  v_mfma_f32_16x16x32_bf16 v[88:91], a[56:59], a[16:19], v[88:91]
  v_mfma_f32_16x16x32_bf16 v[124:127], a[56:59], a[20:23], v[124:127]
  v_mfma_f32_16x16x32_bf16 v[92:95], a[60:63], a[16:19], v[92:95]
  v_mfma_f32_16x16x32_bf16 v[128:131], a[60:63], a[20:23], v[128:131]
  v_mfma_f32_16x16x32_bf16 v[96:99], a[64:67], a[16:19], v[96:99]
  v_mfma_f32_16x16x32_bf16 v[132:135], a[64:67], a[20:23], v[132:135]
  s_waitcnt lgkmcnt(0)
  s_waitcnt vmcnt(33)
  s_barrier
  v_mfma_f32_16x16x32_bf16 v[64:67], a[68:71], a[24:27], v[64:67]
  ds_read_b128 a[32:35], v6 offset:0
  v_mfma_f32_16x16x32_bf16 v[100:103], a[68:71], a[28:31], v[100:103]
  ds_read_b128 a[36:39], v6 offset:1024
  s_add_u32 s51, s50, 55296
  buffer_load_dwordx4 v[40:43], v2, s[52:55], s51 offen
  v_mfma_f32_16x16x32_bf16 v[68:71], a[72:75], a[24:27], v[68:71]
  ds_read_b128 a[40:43], v6 offset:2048
  v_mfma_f32_16x16x32_bf16 v[104:107], a[72:75], a[28:31], v[104:107]
  ds_read_b128 a[44:47], v6 offset:3072
  buffer_load_dwordx4 v[44:47], v2, s[52:55], s51 offen offset:1024
  v_mfma_f32_16x16x32_bf16 v[72:75], a[76:79], a[24:27], v[72:75]
  ds_read_b128 a[48:51], v6 offset:4096
  v_mfma_f32_16x16x32_bf16 v[108:111], a[76:79], a[28:31], v[108:111]
  ds_read_b128 a[52:55], v6 offset:5120
  buffer_load_dwordx4 v[48:51], v2, s[52:55], s51 offen offset:2048
  v_mfma_f32_16x16x32_bf16 v[76:79], a[80:83], a[24:27], v[76:79]
  ds_read_b128 a[56:59], v6 offset:6144
  v_mfma_f32_16x16x32_bf16 v[112:115], a[80:83], a[28:31], v[112:115]
  ds_read_b128 a[60:63], v6 offset:7168
  buffer_load_dwordx4 v[52:55], v2, s[52:55], s51 offen offset:3072
  v_mfma_f32_16x16x32_bf16 v[80:83], a[84:87], a[24:27], v[80:83]
  ds_read_b128 a[64:67], v6 offset:8192
  v_mfma_f32_16x16x32_bf16 v[116:119], a[84:87], a[28:31], v[116:119]
  s_add_u32 s51, s51, 4096
  buffer_load_dwordx4 v[56:59], v18, s[52:55], s51 offen
  v_mfma_f32_16x16x32_bf16 v[84:87], a[88:91], a[24:27], v[84:87]
  v_mfma_f32_16x16x32_bf16 v[120:123], a[88:91], a[28:31], v[120:123]
  v_mfma_f32_16x16x32_bf16 v[88:91], a[92:95], a[24:27], v[88:91]
  v_mfma_f32_16x16x32_bf16 v[124:127], a[92:95], a[28:31], v[124:127]
  v_mfma_f32_16x16x32_bf16 v[92:95], a[96:99], a[24:27], v[92:95]
  v_mfma_f32_16x16x32_bf16 v[128:131], a[96:99], a[28:31], v[128:131]
  v_mfma_f32_16x16x32_bf16 v[96:99], a[100:103], a[24:27], v[96:99]
  v_mfma_f32_16x16x32_bf16 v[132:135], a[100:103], a[28:31], v[132:135]
  ds_read_b128 a[68:71], v6 offset:9216
  ds_read_b128 a[72:75], v6 offset:10240
  ds_read_b128 a[76:79], v6 offset:11264
  ds_read_b128 a[80:83], v6 offset:12288
  ds_read_b128 a[84:87], v6 offset:13312
  ds_read_b128 a[88:91], v6 offset:14336
  ds_read_b128 a[92:95], v6 offset:15360
  ds_read_b128 a[96:99], v6 offset:16384
  ds_read_b128 a[100:103], v6 offset:17408
  s_waitcnt lgkmcnt(9)
  v_mfma_f32_16x16x32_bf16 v[64:67], a[32:35], a[104:107], v[64:67]
  ds_read_b128 a[136:139], v6 offset:18432
  s_add_u32 m0, s10, 73728
  s_add_u32 s41, s50, 18432
  buffer_load_dwordx4 v2, s[52:55], s41 offen offset:0  lds
  v_mfma_f32_16x16x32_bf16 v[68:71], a[36:39], a[104:107], v[68:71]
  ds_read_b128 a[140:143], v6 offset:19456
  buffer_load_dwordx4 v2, s[52:55], s41 offen offset:1024  lds
  v_mfma_f32_16x16x32_bf16 v[72:75], a[40:43], a[104:107], v[72:75]
  ds_read_b128 a[144:147], v6 offset:20480
  buffer_load_dwordx4 v2, s[52:55], s41 offen offset:2048  lds
  v_mfma_f32_16x16x32_bf16 v[76:79], a[44:47], a[104:107], v[76:79]
  ds_read_b128 a[148:151], v6 offset:21504
  buffer_load_dwordx4 v2, s[52:55], s41 offen offset:3072  lds
  v_mfma_f32_16x16x32_bf16 v[80:83], a[48:51], a[104:107], v[80:83]
  ds_read_b128 a[152:155], v6 offset:22528
  s_add_u32 m0, s10, 77824
  s_add_u32 s41, s50, 22528
  buffer_load_dwordx4 v2, s[52:55], s41 offen offset:0  lds
  v_mfma_f32_16x16x32_bf16 v[84:87], a[52:55], a[104:107], v[84:87]
  ds_read_b128 a[156:159], v6 offset:23552
  buffer_load_dwordx4 v2, s[52:55], s41 offen offset:1024  lds
  v_mfma_f32_16x16x32_bf16 v[88:91], a[56:59], a[104:107], v[88:91]
  ds_read_b128 a[160:163], v6 offset:24576
  buffer_load_dwordx4 v2, s[52:55], s41 offen offset:2048  lds
  v_mfma_f32_16x16x32_bf16 v[92:95], a[60:63], a[104:107], v[92:95]
  ds_read_b128 a[164:167], v6 offset:25600
  buffer_load_dwordx4 v2, s[52:55], s41 offen offset:3072  lds
  v_mfma_f32_16x16x32_bf16 v[96:99], a[64:67], a[104:107], v[96:99]
  ds_read_b128 a[232:235], v6 offset:26624
  s_add_u32 m0, s10, 81920
  s_add_u32 s41, s50, 26624
  buffer_load_dwordx4 v2, s[52:55], s41 offen offset:0  lds
  s_waitcnt lgkmcnt(9)
  v_mfma_f32_16x16x32_bf16 v[64:67], a[68:71], a[112:115], v[64:67]
  ds_read_b128 a[32:35], v6 offset:27648
  v_mfma_f32_16x16x32_bf16 v[68:71], a[72:75], a[112:115], v[68:71]
  ds_read_b128 a[36:39], v6 offset:28672
  v_mfma_f32_16x16x32_bf16 v[72:75], a[76:79], a[112:115], v[72:75]
  ds_read_b128 a[40:43], v6 offset:29696
  v_mfma_f32_16x16x32_bf16 v[76:79], a[80:83], a[112:115], v[76:79]
  ds_read_b128 a[44:47], v6 offset:30720
  v_mfma_f32_16x16x32_bf16 v[80:83], a[84:87], a[112:115], v[80:83]
  ds_read_b128 a[48:51], v6 offset:31744
  v_mfma_f32_16x16x32_bf16 v[84:87], a[88:91], a[112:115], v[84:87]
  ds_read_b128 a[52:55], v6 offset:32768
  v_mfma_f32_16x16x32_bf16 v[88:91], a[92:95], a[112:115], v[88:91]
  ds_read_b128 a[56:59], v6 offset:33792
  v_mfma_f32_16x16x32_bf16 v[92:95], a[96:99], a[112:115], v[92:95]
  ds_read_b128 a[60:63], v6 offset:34816
  v_mfma_f32_16x16x32_bf16 v[96:99], a[100:103], a[112:115], v[96:99]
  ds_read_b128 a[64:67], v6 offset:35840
  s_waitcnt lgkmcnt(9)
  v_mfma_f32_16x16x32_bf16 v[64:67], a[136:139], a[120:123], v[64:67]
  ds_read_b128 a[68:71], v6 offset:0
  v_mfma_f32_16x16x32_bf16 v[68:71], a[140:143], a[120:123], v[68:71]
  ds_read_b128 a[72:75], v6 offset:1024
  v_mfma_f32_16x16x32_bf16 v[72:75], a[144:147], a[120:123], v[72:75]
  ds_read_b128 a[76:79], v6 offset:2048
  v_mfma_f32_16x16x32_bf16 v[76:79], a[148:151], a[120:123], v[76:79]
  ds_read_b128 a[80:83], v6 offset:3072
  v_mfma_f32_16x16x32_bf16 v[80:83], a[152:155], a[120:123], v[80:83]
  ds_read_b128 a[84:87], v6 offset:4096
  v_mfma_f32_16x16x32_bf16 v[84:87], a[156:159], a[120:123], v[84:87]
  ds_read_b128 a[88:91], v6 offset:5120
  v_mfma_f32_16x16x32_bf16 v[88:91], a[160:163], a[120:123], v[88:91]
  ds_read_b128 a[92:95], v6 offset:6144
  v_mfma_f32_16x16x32_bf16 v[92:95], a[164:167], a[120:123], v[92:95]
  ds_read_b128 a[96:99], v6 offset:7168
  v_mfma_f32_16x16x32_bf16 v[96:99], a[232:235], a[120:123], v[96:99]
  ds_read_b128 a[100:103], v6 offset:8192
  s_waitcnt lgkmcnt(9)
  v_mfma_f32_16x16x32_bf16 v[64:67], a[32:35], a[128:131], v[64:67]
  ds_read_b128 a[136:139], v6 offset:9216
  v_mfma_f32_16x16x32_bf16 v[68:71], a[36:39], a[128:131], v[68:71]
  ds_read_b128 a[140:143], v6 offset:10240
  v_mfma_f32_16x16x32_bf16 v[72:75], a[40:43], a[128:131], v[72:75]
  ds_read_b128 a[144:147], v6 offset:11264
  v_mfma_f32_16x16x32_bf16 v[76:79], a[44:47], a[128:131], v[76:79]
  ds_read_b128 a[148:151], v6 offset:12288
  v_mfma_f32_16x16x32_bf16 v[80:83], a[48:51], a[128:131], v[80:83]
  ds_read_b128 a[152:155], v6 offset:13312
  v_mfma_f32_16x16x32_bf16 v[84:87], a[52:55], a[128:131], v[84:87]
  ds_read_b128 a[156:159], v6 offset:14336
  v_mfma_f32_16x16x32_bf16 v[88:91], a[56:59], a[128:131], v[88:91]
  ds_read_b128 a[160:163], v6 offset:15360
  v_mfma_f32_16x16x32_bf16 v[92:95], a[60:63], a[128:131], v[92:95]
  ds_read_b128 a[164:167], v6 offset:16384
  v_mfma_f32_16x16x32_bf16 v[96:99], a[64:67], a[128:131], v[96:99]
  ds_read_b128 a[232:235], v6 offset:17408
  s_waitcnt lgkmcnt(9)
  v_mfma_f32_16x16x32_bf16 v[100:103], a[68:71], a[108:111], v[100:103]
  ds_read_b128 a[32:35], v6 offset:18432
  v_mfma_f32_16x16x32_bf16 v[104:107], a[72:75], a[108:111], v[104:107]
  ds_read_b128 a[36:39], v6 offset:19456
  s_waitcnt vmcnt(52)
  v_lshlrev_b32 v10, 16, v224
  v_mfma_f32_16x16x32_bf16 v[108:111], a[76:79], a[108:111], v[108:111]
  ds_read_b128 a[40:43], v6 offset:20480
  v_and_b32 v11, 0xffff0000, v224
  v_mul_f32 v64, v64, v10
  v_mul_f32 v65, v65, v11
  v_mfma_f32_16x16x32_bf16 v[112:115], a[80:83], a[108:111], v[112:115]
  ds_read_b128 a[44:47], v6 offset:21504
  v_cvt_pk_bf16_f32 v224, v64, v65
  v_lshlrev_b32 v12, 16, v225
  v_and_b32 v13, 0xffff0000, v225
  v_mfma_f32_16x16x32_bf16 v[116:119], a[84:87], a[108:111], v[116:119]
  ds_read_b128 a[48:51], v6 offset:22528
  v_mul_f32 v66, v66, v12
  v_mul_f32 v67, v67, v13
  v_mfma_f32_16x16x32_bf16 v[120:123], a[88:91], a[108:111], v[120:123]
  ds_read_b128 a[52:55], v6 offset:23552
  v_cvt_pk_bf16_f32 v225, v66, v67
  v_lshlrev_b32 v14, 16, v226
  v_and_b32 v15, 0xffff0000, v226
  v_mfma_f32_16x16x32_bf16 v[124:127], a[92:95], a[108:111], v[124:127]
  ds_read_b128 a[56:59], v6 offset:24576
  v_mul_f32 v68, v68, v14
  v_mul_f32 v69, v69, v15
  v_cvt_pk_bf16_f32 v226, v68, v69
  v_mfma_f32_16x16x32_bf16 v[128:131], a[96:99], a[108:111], v[128:131]
  ds_read_b128 a[60:63], v6 offset:25600
  v_lshlrev_b32 v16, 16, v227
  v_and_b32 v17, 0xffff0000, v227
  v_mul_f32 v70, v70, v16
  v_mfma_f32_16x16x32_bf16 v[132:135], a[100:103], a[108:111], v[132:135]
  ds_read_b128 a[64:67], v6 offset:26624
  v_mul_f32 v71, v71, v17
  v_cvt_pk_bf16_f32 v227, v70, v71
  s_waitcnt lgkmcnt(9)
  v_mfma_f32_16x16x32_bf16 v[100:103], a[136:139], a[116:119], v[100:103]
  ds_read_b128 a[68:71], v6 offset:27648
  buffer_store_dwordx4 v[224:227], v2, s[24:27], s44 offen offset:0 sc1
  v_lshlrev_b32 v10, 16, v232
  v_and_b32 v11, 0xffff0000, v232
  v_mfma_f32_16x16x32_bf16 v[104:107], a[140:143], a[116:119], v[104:107]
  ds_read_b128 a[72:75], v6 offset:28672
  v_mul_f32 v72, v72, v10
  v_mul_f32 v73, v73, v11
  v_cvt_pk_bf16_f32 v232, v72, v73
  v_mfma_f32_16x16x32_bf16 v[108:111], a[144:147], a[116:119], v[108:111]
  ds_read_b128 a[76:79], v6 offset:29696
  v_lshlrev_b32 v12, 16, v233
  v_and_b32 v13, 0xffff0000, v233
  v_mul_f32 v74, v74, v12
  v_mfma_f32_16x16x32_bf16 v[112:115], a[148:151], a[116:119], v[112:115]
  ds_read_b128 a[80:83], v6 offset:30720
  v_mul_f32 v75, v75, v13
  v_cvt_pk_bf16_f32 v233, v74, v75
  v_mfma_f32_16x16x32_bf16 v[116:119], a[152:155], a[116:119], v[116:119]
  ds_read_b128 a[84:87], v6 offset:31744
  v_lshlrev_b32 v14, 16, v234
  v_and_b32 v15, 0xffff0000, v234
  v_mul_f32 v76, v76, v14
  v_mfma_f32_16x16x32_bf16 v[120:123], a[156:159], a[116:119], v[120:123]
  ds_read_b128 a[88:91], v6 offset:32768
  v_mul_f32 v77, v77, v15
  v_cvt_pk_bf16_f32 v234, v76, v77
  v_lshlrev_b32 v16, 16, v235
  v_mfma_f32_16x16x32_bf16 v[124:127], a[160:163], a[116:119], v[124:127]
  ds_read_b128 a[92:95], v6 offset:33792
  v_and_b32 v17, 0xffff0000, v235
  v_mul_f32 v78, v78, v16
  v_mul_f32 v79, v79, v17
  v_mfma_f32_16x16x32_bf16 v[128:131], a[164:167], a[116:119], v[128:131]
  ds_read_b128 a[96:99], v6 offset:34816
  v_cvt_pk_bf16_f32 v235, v78, v79
  buffer_store_dwordx4 v[232:235], v2, s[24:27], s44 offen offset:1024 sc1
  v_mfma_f32_16x16x32_bf16 v[132:135], a[232:235], a[116:119], v[132:135]
  ds_read_b128 a[100:103], v6 offset:35840
  v_lshlrev_b32 v10, 16, v240
  v_and_b32 v11, 0xffff0000, v240
  v_mul_f32 v80, v80, v10
  s_waitcnt lgkmcnt(9)
  v_mfma_f32_16x16x32_bf16 v[100:103], a[32:35], a[124:127], v[100:103]
  v_mul_f32 v81, v81, v11
  v_cvt_pk_bf16_f32 v240, v80, v81
  v_lshlrev_b32 v12, 16, v241
  v_mfma_f32_16x16x32_bf16 v[104:107], a[36:39], a[124:127], v[104:107]
  v_and_b32 v13, 0xffff0000, v241
  v_mul_f32 v82, v82, v12
  v_mul_f32 v83, v83, v13
  v_mfma_f32_16x16x32_bf16 v[108:111], a[40:43], a[124:127], v[108:111]
  v_cvt_pk_bf16_f32 v241, v82, v83
  v_lshlrev_b32 v14, 16, v242
  v_mfma_f32_16x16x32_bf16 v[112:115], a[44:47], a[124:127], v[112:115]
  v_and_b32 v15, 0xffff0000, v242
  v_mul_f32 v84, v84, v14
  v_mul_f32 v85, v85, v15
  v_mfma_f32_16x16x32_bf16 v[116:119], a[48:51], a[124:127], v[116:119]
  v_cvt_pk_bf16_f32 v242, v84, v85
  v_lshlrev_b32 v16, 16, v243
  v_and_b32 v17, 0xffff0000, v243
  v_mfma_f32_16x16x32_bf16 v[120:123], a[52:55], a[124:127], v[120:123]
  v_mul_f32 v86, v86, v16
  v_mul_f32 v87, v87, v17
  v_cvt_pk_bf16_f32 v243, v86, v87
  v_mfma_f32_16x16x32_bf16 v[124:127], a[56:59], a[124:127], v[124:127]
  buffer_store_dwordx4 v[240:243], v2, s[24:27], s44 offen offset:2048 sc1
  v_lshlrev_b32 v10, 16, v248
  v_mfma_f32_16x16x32_bf16 v[128:131], a[60:63], a[124:127], v[128:131]
  v_and_b32 v11, 0xffff0000, v248
  v_mul_f32 v88, v88, v10
  v_mul_f32 v89, v89, v11
  v_mfma_f32_16x16x32_bf16 v[132:135], a[64:67], a[124:127], v[132:135]
  v_cvt_pk_bf16_f32 v248, v88, v89
  v_lshlrev_b32 v12, 16, v249
  v_and_b32 v13, 0xffff0000, v249
  s_waitcnt lgkmcnt(0)
  v_mfma_f32_16x16x32_bf16 v[100:103], a[68:71], a[132:135], v[100:103]
  v_mul_f32 v90, v90, v12
  v_mul_f32 v91, v91, v13
  v_cvt_pk_bf16_f32 v249, v90, v91
  v_mfma_f32_16x16x32_bf16 v[104:107], a[72:75], a[132:135], v[104:107]
  v_lshlrev_b32 v14, 16, v250
  v_and_b32 v15, 0xffff0000, v250
  v_mfma_f32_16x16x32_bf16 v[108:111], a[76:79], a[132:135], v[108:111]
  v_mul_f32 v92, v92, v14
  v_mul_f32 v93, v93, v15
  v_cvt_pk_bf16_f32 v250, v92, v93
  v_mfma_f32_16x16x32_bf16 v[112:115], a[80:83], a[132:135], v[112:115]
  v_lshlrev_b32 v16, 16, v251
  v_and_b32 v17, 0xffff0000, v251
  v_mul_f32 v94, v94, v16
  v_mfma_f32_16x16x32_bf16 v[116:119], a[84:87], a[132:135], v[116:119]
  v_mul_f32 v95, v95, v17
  v_cvt_pk_bf16_f32 v251, v94, v95
  buffer_store_dwordx4 v[248:251], v2, s[24:27], s44 offen offset:3072 sc1
  v_mfma_f32_16x16x32_bf16 v[120:123], a[88:91], a[132:135], v[120:123]
  v_lshlrev_b32 v10, 16, v208
  v_and_b32 v11, 0xffff0000, v208
  v_mfma_f32_16x16x32_bf16 v[124:127], a[92:95], a[132:135], v[124:127]
  v_mul_f32 v96, v96, v10
  v_mul_f32 v97, v97, v11
  v_cvt_pk_bf16_f32 v208, v96, v97
  v_mfma_f32_16x16x32_bf16 v[128:131], a[96:99], a[132:135], v[128:131]
  v_lshlrev_b32 v12, 16, v209
  v_and_b32 v13, 0xffff0000, v209
  v_mul_f32 v98, v98, v12
  v_mfma_f32_16x16x32_bf16 v[132:135], a[100:103], a[132:135], v[132:135]
  v_mul_f32 v99, v99, v13
  v_cvt_pk_bf16_f32 v209, v98, v99
  buffer_store_dwordx2 v[208:209], v3, s[24:27], s46 offen sc1
  v_lshlrev_b32 v10, 16, v228
  v_and_b32 v11, 0xffff0000, v228
  v_pk_mul_f32 v[100:101], v[100:101], v[10:11]
  v_cvt_pk_bf16_f32 v228, v100, v101
  v_lshlrev_b32 v12, 16, v229
  v_and_b32 v13, 0xffff0000, v229
  v_pk_mul_f32 v[102:103], v[102:103], v[12:13]
  v_cvt_pk_bf16_f32 v229, v102, v103
  v_lshlrev_b32 v14, 16, v230
  v_and_b32 v15, 0xffff0000, v230
  v_pk_mul_f32 v[104:105], v[104:105], v[14:15]
  v_cvt_pk_bf16_f32 v230, v104, v105
  v_lshlrev_b32 v16, 16, v231
  v_and_b32 v17, 0xffff0000, v231
  v_pk_mul_f32 v[106:107], v[106:107], v[16:17]
  v_cvt_pk_bf16_f32 v231, v106, v107
  buffer_store_dwordx4 v[228:231], v2, s[24:27], s45 offen offset:0 sc1
  v_lshlrev_b32 v10, 16, v236
  v_and_b32 v11, 0xffff0000, v236
  v_pk_mul_f32 v[108:109], v[108:109], v[10:11]
  v_cvt_pk_bf16_f32 v236, v108, v109
  v_lshlrev_b32 v12, 16, v237
  v_and_b32 v13, 0xffff0000, v237
  v_pk_mul_f32 v[110:111], v[110:111], v[12:13]
  v_cvt_pk_bf16_f32 v237, v110, v111
  v_lshlrev_b32 v14, 16, v238
  v_and_b32 v15, 0xffff0000, v238
  v_pk_mul_f32 v[112:113], v[112:113], v[14:15]
  v_cvt_pk_bf16_f32 v238, v112, v113
  v_lshlrev_b32 v16, 16, v239
  v_and_b32 v17, 0xffff0000, v239
  v_pk_mul_f32 v[114:115], v[114:115], v[16:17]
  v_cvt_pk_bf16_f32 v239, v114, v115
  buffer_store_dwordx4 v[236:239], v2, s[24:27], s45 offen offset:1024 sc1
  v_lshlrev_b32 v10, 16, v244
  v_and_b32 v11, 0xffff0000, v244
  v_pk_mul_f32 v[116:117], v[116:117], v[10:11]
  v_cvt_pk_bf16_f32 v244, v116, v117
  v_lshlrev_b32 v12, 16, v245
  v_and_b32 v13, 0xffff0000, v245
  v_pk_mul_f32 v[118:119], v[118:119], v[12:13]
  v_cvt_pk_bf16_f32 v245, v118, v119
  v_lshlrev_b32 v14, 16, v246
  v_and_b32 v15, 0xffff0000, v246
  v_pk_mul_f32 v[120:121], v[120:121], v[14:15]
  v_cvt_pk_bf16_f32 v246, v120, v121
  v_lshlrev_b32 v16, 16, v247
  v_and_b32 v17, 0xffff0000, v247
  v_pk_mul_f32 v[122:123], v[122:123], v[16:17]
  v_cvt_pk_bf16_f32 v247, v122, v123
  buffer_store_dwordx4 v[244:247], v2, s[24:27], s45 offen offset:2048 sc1
  v_lshlrev_b32 v10, 16, v252
  v_and_b32 v11, 0xffff0000, v252
  v_pk_mul_f32 v[124:125], v[124:125], v[10:11]
  v_cvt_pk_bf16_f32 v252, v124, v125
  v_lshlrev_b32 v12, 16, v253
  v_and_b32 v13, 0xffff0000, v253
  v_pk_mul_f32 v[126:127], v[126:127], v[12:13]
  v_cvt_pk_bf16_f32 v253, v126, v127
  v_lshlrev_b32 v14, 16, v254
  v_and_b32 v15, 0xffff0000, v254
  v_pk_mul_f32 v[128:129], v[128:129], v[14:15]
  v_cvt_pk_bf16_f32 v254, v128, v129
  v_lshlrev_b32 v16, 16, v255
  v_and_b32 v17, 0xffff0000, v255
  v_pk_mul_f32 v[130:131], v[130:131], v[16:17]
  v_cvt_pk_bf16_f32 v255, v130, v131
  buffer_store_dwordx4 v[252:255], v2, s[24:27], s45 offen offset:3072 sc1
  v_lshlrev_b32 v10, 16, v210
  v_and_b32 v11, 0xffff0000, v210
  v_pk_mul_f32 v[132:133], v[132:133], v[10:11]
  v_cvt_pk_bf16_f32 v210, v132, v133
  v_lshlrev_b32 v12, 16, v211
  v_and_b32 v13, 0xffff0000, v211
  v_pk_mul_f32 v[134:135], v[134:135], v[12:13]
  v_cvt_pk_bf16_f32 v211, v134, v135
  buffer_store_dwordx2 v[210:211], v3, s[24:27], s47 offen sc1
L_k5_done:
  s_load_dwordx2 s[18:19], s[0:1], 96
  s_add_u32 s56, s4, 16
  s_mov_b32 s4, s48
  s_mov_b32 s5, s49
  v_and_b32 v1, 63, v0
  v_lshlrev_b32 v2, 4, v1
  v_and_b32 v8, 15, v1
  v_lshrrev_b32 v9, 4, v1
  v_and_b32 v5, 7, v1
  v_lshlrev_b32 v5, 4, v5
  v_lshl_add_u32 v5, v9, 7, v5
  s_lshl_b32 s8, s4, 2
  s_add_u32 s8, s8, s3
  s_lshl_b32 s40, s8, 4
  v_add_u32 v8, s40, v8
  v_mov_b32 v7, 2146435072
  v_cmp_gt_u32 vcc, 2, v9
  v_mul_u32_u24 v10, 1152, v8
  s_mul_i32 s40, s5, 144
  v_add_u32 v10, s40, v10
  v_lshl_add_u32 v11, v9, 3, v10
  v_add_u32 v11, 128, v11
  v_cndmask_b32 v11, v7, v11, vcc
  v_lshl_add_u32 v10, v9, 4, v10
  v_lshrrev_b32 v12, 5, v8
  v_mul_u32_u24 v12, 36864, v12
  v_and_b32 v13, 31, v8
  v_lshl_add_u32 v12, v13, 4, v12
  s_mul_i32 s40, s5, 4608
  v_add_u32 v12, s40, v12
  v_lshl_add_u32 v13, v9, 3, v12
  v_add_u32 v13, 4096, v13
  v_cndmask_b32 v13, v7, v13, vcc
  v_lshl_add_u32 v12, v9, 9, v12
  s_mul_i32 s40, s5, 288
  v_lshlrev_b32 v14, 5, v9
  v_add_u32 v14, s40, v14
  v_lshlrev_b32 v15, 4, v9
  v_add_u32 v15, s40, v15
  v_add_u32 v15, 256, v15
  v_cndmask_b32 v15, v7, v15, vcc
  v_add_u32 v3, s10, v2
  v_add_u32 v4, s10, v5
  v_add_u32 v16, 73728, v3
  v_add_u32 v17, 73728, v4
  v_lshlrev_b32 v19, 3, v1
  s_mul_i32 s44, s4, 294912
  s_mul_i32 s45, s3, 18432
  s_add_u32 s12, s44, s45
  s_add_u32 s13, s3, 0
  s_and_b32 s13, s13, 3
  s_mul_i32 s13, s13, 73728
  s_add_u32 s44, s12, s13
  s_add_u32 s13, s3, 1
  s_and_b32 s13, s13, 3
  s_mul_i32 s13, s13, 73728
  s_add_u32 s45, s12, s13
  s_add_u32 s13, s3, 2
  s_and_b32 s13, s13, 3
  s_mul_i32 s13, s13, 73728
  s_add_u32 s46, s12, s13
  s_add_u32 s13, s3, 3
  s_and_b32 s13, s13, 3
  s_mul_i32 s13, s13, 73728
  s_add_u32 s47, s12, s13
  s_add_u32 s32, s16, 65536
  s_addc_u32 s33, s17, 0
  s_and_b32 s33, s33, 0xffff
  s_mov_b32 s34, 13824
  s_mov_b32 s35, 0x20000
  v_accvgpr_read_b32 v204, a244
  v_accvgpr_read_b32 v205, a245
  v_accvgpr_read_b32 v206, a246
  v_accvgpr_read_b32 v207, a247
  v_accvgpr_read_b32 v208, a248
  v_accvgpr_read_b32 v209, a249
  v_accvgpr_read_b32 v210, a250
  v_accvgpr_read_b32 v211, a251
  v_accvgpr_read_b32 v212, a252
  v_accvgpr_read_b32 v213, a253
  v_mov_b32 v64, 0
  v_mov_b32 v65, 0
  v_mov_b32 v66, 0
  v_mov_b32 v67, 0
  v_mov_b32 v68, 0
  v_mov_b32 v69, 0
  v_mov_b32 v70, 0
  v_mov_b32 v71, 0
  v_mov_b32 v72, 0
  v_mov_b32 v73, 0
  v_mov_b32 v74, 0
  v_mov_b32 v75, 0
  v_mov_b32 v76, 0
  v_mov_b32 v77, 0
  v_mov_b32 v78, 0
  v_mov_b32 v79, 0
  v_mov_b32 v80, 0
  v_mov_b32 v81, 0
  v_mov_b32 v82, 0
  v_mov_b32 v83, 0
  v_mov_b32 v84, 0
  v_mov_b32 v85, 0
  v_mov_b32 v86, 0
  v_mov_b32 v87, 0
  v_mov_b32 v88, 0
  v_mov_b32 v89, 0
  v_mov_b32 v90, 0
  v_mov_b32 v91, 0
  v_mov_b32 v92, 0
  v_mov_b32 v93, 0
  v_mov_b32 v94, 0
  v_mov_b32 v95, 0
  v_mov_b32 v96, 0
  v_mov_b32 v97, 0
  v_mov_b32 v98, 0
  v_mov_b32 v99, 0
  v_mov_b32 v100, 0
  v_mov_b32 v101, 0
  v_mov_b32 v102, 0
  v_mov_b32 v103, 0
  v_mov_b32 v104, 0
  v_mov_b32 v105, 0
  v_mov_b32 v106, 0
  v_mov_b32 v107, 0
  v_mov_b32 v108, 0
  v_mov_b32 v109, 0
  v_mov_b32 v110, 0
  v_mov_b32 v111, 0
  v_mov_b32 v112, 0
  v_mov_b32 v113, 0
  v_mov_b32 v114, 0
  v_mov_b32 v115, 0
  v_mov_b32 v116, 0
  v_mov_b32 v117, 0
  v_mov_b32 v118, 0
  v_mov_b32 v119, 0
  v_mov_b32 v120, 0
  v_mov_b32 v121, 0
  v_mov_b32 v122, 0
  v_mov_b32 v123, 0
  v_mov_b32 v124, 0
  v_mov_b32 v125, 0
  v_mov_b32 v126, 0
  v_mov_b32 v127, 0
  v_mov_b32 v128, 0
  v_mov_b32 v129, 0
  v_mov_b32 v130, 0
  v_mov_b32 v131, 0
  v_mov_b32 v132, 0
  v_mov_b32 v133, 0
  v_mov_b32 v134, 0
  v_mov_b32 v135, 0
  v_mov_b32 v136, 0
  v_mov_b32 v137, 0
  v_mov_b32 v138, 0
  v_mov_b32 v139, 0
  v_mov_b32 v140, 0
  v_mov_b32 v141, 0
  v_mov_b32 v142, 0
  v_mov_b32 v143, 0
  s_waitcnt lgkmcnt(0)
  s_waitcnt vmcnt(0)
  s_barrier
  s_cmp_lg_u32 s3, 0
  s_cbranch_scc1 L_sig_k3_kernel_7
  s_lshl_b32 s56, s56, 7
  v_mov_b32 v248, 1
  v_mov_b32 v249, 0
  s_mov_b64 exec, 1
  buffer_atomic_add v248, v249, s[20:23], s56 offen
  s_mov_b64 exec, -1
L_sig_k3_kernel_7:
  v_and_b32 v248, 31, v1
  v_lshrrev_b32 v244, 5, v1
  v_mul_u32_u24 v244, 0, v244
  v_cmp_gt_u32 vcc, 18, v248
  v_lshl_add_u32 v248, v248, 4, v244
  s_nop 0
  v_cndmask_b32 v248, v7, v248, vcc
  s_mul_i32 s41, s5, 288
  s_add_u32 s41, s41, 11520
  buffer_load_dwordx4 v[244:247], v248, s[32:35], s41 offen
  s_add_u32 m0, s10, 110592
  s_add_u32 s41, s50, 27648
  buffer_load_dwordx4 v2, s[52:55], s41 offen offset:0  lds
  buffer_load_dwordx4 v2, s[52:55], s41 offen offset:1024  lds
  buffer_load_dwordx4 v2, s[52:55], s41 offen offset:2048  lds
  buffer_load_dwordx4 v2, s[52:55], s41 offen offset:3072  lds
  s_add_u32 m0, s10, 114688
  s_add_u32 s41, s50, 31744
  buffer_load_dwordx4 v2, s[52:55], s41 offen offset:0  lds
  buffer_load_dwordx4 v2, s[52:55], s41 offen offset:1024  lds
  buffer_load_dwordx4 v2, s[52:55], s41 offen offset:2048  lds
  buffer_load_dwordx4 v2, s[52:55], s41 offen offset:3072  lds
  s_add_u32 m0, s10, 118784
  s_add_u32 s41, s50, 35840
  buffer_load_dwordx4 v2, s[52:55], s41 offen offset:0  lds
  s_lshr_b32 s13, s4, 1
  s_add_u32 s13, s13, 16
  s_add_u32 s51, s50, 59904
  buffer_load_dwordx4 a[0:3], v2, s[52:55], s51 offen
  buffer_load_dwordx4 a[4:7], v2, s[52:55], s51 offen offset:1024
  buffer_load_dwordx4 a[8:11], v2, s[52:55], s51 offen offset:2048
  buffer_load_dwordx4 a[12:15], v2, s[52:55], s51 offen offset:3072
  s_add_u32 s51, s51, 4096
  buffer_load_dwordx4 a[16:19], v5, s[52:55], s51 offen
  s_cmp_lg_u32 s3, 0
  s_cbranch_scc1 L_k6_np
  s_lshl_b32 s12, s13, 7
  v_mov_b32 v252, 0
  buffer_load_dword v253, v252, s[20:23], s12 offen sc1
L_k6_np:
  s_add_u32 s51, s50, 64512
  buffer_load_dwordx4 a[20:23], v2, s[52:55], s51 offen
  buffer_load_dwordx4 a[24:27], v2, s[52:55], s51 offen offset:1024
  buffer_load_dwordx4 a[28:31], v2, s[52:55], s51 offen offset:2048
  buffer_load_dwordx4 a[32:35], v2, s[52:55], s51 offen offset:3072
  s_add_u32 s51, s51, 4096
  buffer_load_dwordx4 a[36:39], v5, s[52:55], s51 offen
  s_add_u32 s51, s50, 69120
  buffer_load_dwordx4 a[40:43], v2, s[52:55], s51 offen
  buffer_load_dwordx4 a[44:47], v2, s[52:55], s51 offen offset:1024
  buffer_load_dwordx4 a[48:51], v2, s[52:55], s51 offen offset:2048
  buffer_load_dwordx4 a[52:55], v2, s[52:55], s51 offen offset:3072
  s_add_u32 s51, s51, 4096
  buffer_load_dwordx4 a[56:59], v5, s[52:55], s51 offen
  s_waitcnt vmcnt(10)
  v_cmp_gt_u32 vcc, 16, v253
  s_nop 1
  s_cbranch_vccz L_k6_go
  s_cmp_lg_u32 s3, 0
  s_cbranch_scc1 L_aw_k3_kernel_8
  s_lshl_b32 s13, s13, 7
  v_lshlrev_b32 v248, 7, v1
  s_mov_b32 s14, 0
  s_mov_b64 exec, 1
  s_sleep 4
L_awl_k3_kernel_9:
  buffer_load_dword v249, v248, s[20:23], s13 offen sc1
  s_add_u32 s14, s14, 1
  s_waitcnt vmcnt(0)
  v_cmp_gt_u32 vcc, 16, v249
  s_cmp_lt_u32 s14, 0x80000
  s_nop 0
  s_cselect_b64 vcc, vcc, 0
  s_cbranch_vccz L_awl_k3_kernel_9_d
  s_sleep 12
  s_branch L_awl_k3_kernel_9
L_awl_k3_kernel_9_d:
  s_mov_b64 exec, -1
L_aw_k3_kernel_8:
L_k6_go:
  s_barrier
  s_add_u32 s28, s16, 491520
  s_addc_u32 s29, s17, 0
  s_and_b32 s29, s29, 0xffff
  s_mov_b32 s30, 8192
  s_mov_b32 s31, 0x20000
  v_lshlrev_b32 v248, 2, v8
  buffer_load_dword v250, v248, s[28:31], 0 offen sc1
  buffer_load_dwordx4 a[100:103], v2, s[24:27], s44 offen offset:0 sc1
  buffer_load_dwordx4 a[104:107], v2, s[24:27], s45 offen offset:0 sc1
  buffer_load_dwordx4 a[108:111], v2, s[24:27], s46 offen offset:0 sc1
  buffer_load_dwordx4 a[112:115], v2, s[24:27], s47 offen offset:0 sc1
  buffer_load_dwordx4 a[116:119], v2, s[24:27], s44 offen offset:1024 sc1
  buffer_load_dwordx4 a[120:123], v2, s[24:27], s45 offen offset:1024 sc1
  buffer_load_dwordx4 a[124:127], v2, s[24:27], s46 offen offset:1024 sc1
  buffer_load_dwordx4 a[128:131], v2, s[24:27], s47 offen offset:1024 sc1
  buffer_load_dwordx4 a[132:135], v2, s[24:27], s44 offen offset:2048 sc1
  buffer_load_dwordx4 a[136:139], v2, s[24:27], s45 offen offset:2048 sc1
  buffer_load_dwordx4 a[140:143], v2, s[24:27], s46 offen offset:2048 sc1
  buffer_load_dwordx4 a[144:147], v2, s[24:27], s47 offen offset:2048 sc1
  s_waitcnt vmcnt(37)
  s_lshl_b32 s41, s3, 10
  s_add_u32 s41, s41, 147456
  v_add_u32 v248, s41, v2
  ds_write_b128 v248, v[244:247]
  v_lshlrev_b32 v248, 5, v9
  v_add_u32 v248, s41, v248
  v_lshlrev_b32 v249, 4, v9
  v_add_u32 v249, s41, v249
  s_waitcnt lgkmcnt(0)
  ds_read_b128 v[224:227], v248 offset:0
  ds_read_b128 v[228:231], v248 offset:16
  ds_read_b128 v[232:235], v248 offset:128
  ds_read_b128 v[236:239], v248 offset:144
  ds_read_b128 v[240:243], v249 offset:256
  ds_read_b128 a[164:167], v3 offset:0
  ds_read_b128 a[168:171], v3 offset:1024
  ds_read_b128 a[172:175], v3 offset:2048
  ds_read_b128 a[176:179], v3 offset:3072
  ds_read_b128 a[180:183], v4 offset:4096
  ds_read_b128 a[184:187], v3 offset:4608
  ds_read_b128 a[188:191], v3 offset:5632
  ds_read_b128 a[192:195], v3 offset:6656
  ds_read_b128 a[196:199], v3 offset:7680
  ds_read_b128 a[200:203], v4 offset:8704
  s_waitcnt vmcnt(12)
  s_waitcnt lgkmcnt(10)
  v_pk_mul_f32 v[224:225], v[224:225], v[250:251] op_sel_hi:[1,0]
  v_pk_mul_f32 v[226:227], v[226:227], v[250:251] op_sel_hi:[1,0]
  v_pk_mul_f32 v[228:229], v[228:229], v[250:251] op_sel_hi:[1,0]
  v_pk_mul_f32 v[230:231], v[230:231], v[250:251] op_sel_hi:[1,0]
  v_pk_mul_f32 v[232:233], v[232:233], v[250:251] op_sel_hi:[1,0]
  v_pk_mul_f32 v[234:235], v[234:235], v[250:251] op_sel_hi:[1,0]
  v_pk_mul_f32 v[236:237], v[236:237], v[250:251] op_sel_hi:[1,0]
  v_pk_mul_f32 v[238:239], v[238:239], v[250:251] op_sel_hi:[1,0]
  v_pk_mul_f32 v[240:241], v[240:241], v[250:251] op_sel_hi:[1,0]
  v_pk_mul_f32 v[242:243], v[242:243], v[250:251] op_sel_hi:[1,0]
  s_waitcnt vmcnt(8)
  s_waitcnt lgkmcnt(5)
  v_mfma_f32_16x16x32_bf16 v[64:67], a[164:167], a[100:103], v[64:67]
  ds_read_b128 a[204:207], v3 offset:36864
  v_mfma_f32_16x16x32_bf16 v[84:87], a[164:167], a[104:107], v[84:87]
  ds_read_b128 a[208:211], v3 offset:37888
  v_mfma_f32_16x16x32_bf16 v[104:107], a[164:167], a[108:111], v[104:107]
  ds_read_b128 a[212:215], v3 offset:38912
  v_mfma_f32_16x16x32_bf16 v[124:127], a[164:167], a[112:115], v[124:127]
  ds_read_b128 a[216:219], v3 offset:39936
  v_mfma_f32_16x16x32_bf16 v[68:71], a[168:171], a[100:103], v[68:71]
  ds_read_b128 a[220:223], v4 offset:40960
  v_mfma_f32_16x16x32_bf16 v[88:91], a[168:171], a[104:107], v[88:91]
  buffer_load_dwordx4 a[148:151], v2, s[24:27], s44 offen offset:3072 sc1
  v_mfma_f32_16x16x32_bf16 v[108:111], a[168:171], a[108:111], v[108:111]
  v_mfma_f32_16x16x32_bf16 v[128:131], a[168:171], a[112:115], v[128:131]
  buffer_load_dwordx4 a[152:155], v2, s[24:27], s45 offen offset:3072 sc1
  v_mfma_f32_16x16x32_bf16 v[72:75], a[172:175], a[100:103], v[72:75]
  v_mfma_f32_16x16x32_bf16 v[92:95], a[172:175], a[104:107], v[92:95]
  buffer_load_dwordx4 a[156:159], v2, s[24:27], s46 offen offset:3072 sc1
  v_mfma_f32_16x16x32_bf16 v[112:115], a[172:175], a[108:111], v[112:115]
  v_mfma_f32_16x16x32_bf16 v[132:135], a[172:175], a[112:115], v[132:135]
  buffer_load_dwordx4 a[160:163], v2, s[24:27], s47 offen offset:3072 sc1
  v_mfma_f32_16x16x32_bf16 v[76:79], a[176:179], a[100:103], v[76:79]
  v_mfma_f32_16x16x32_bf16 v[96:99], a[176:179], a[104:107], v[96:99]
  s_add_u32 s51, s50, 73728
  buffer_load_dwordx4 a[60:63], v2, s[52:55], s51 offen
  v_mfma_f32_16x16x32_bf16 v[116:119], a[176:179], a[108:111], v[116:119]
  v_mfma_f32_16x16x32_bf16 v[136:139], a[176:179], a[112:115], v[136:139]
  buffer_load_dwordx4 a[64:67], v2, s[52:55], s51 offen offset:1024
  v_mfma_f32_16x16x32_bf16 v[80:83], a[180:183], a[100:103], v[80:83]
  v_mfma_f32_16x16x32_bf16 v[100:103], a[180:183], a[104:107], v[100:103]
  buffer_load_dwordx4 a[68:71], v2, s[52:55], s51 offen offset:2048
  v_mfma_f32_16x16x32_bf16 v[120:123], a[180:183], a[108:111], v[120:123]
  v_mfma_f32_16x16x32_bf16 v[140:143], a[180:183], a[112:115], v[140:143]
  s_waitcnt vmcnt(11)
  s_waitcnt lgkmcnt(5)
  v_mfma_f32_16x16x32_bf16 v[64:67], a[184:187], a[116:119], v[64:67]
  ds_read_b128 a[164:167], v3 offset:41472
  v_mfma_f32_16x16x32_bf16 v[84:87], a[184:187], a[120:123], v[84:87]
  ds_read_b128 a[168:171], v3 offset:42496
  v_mfma_f32_16x16x32_bf16 v[104:107], a[184:187], a[124:127], v[104:107]
  ds_read_b128 a[172:175], v3 offset:43520
  v_mfma_f32_16x16x32_bf16 v[124:127], a[184:187], a[128:131], v[124:127]
  ds_read_b128 a[176:179], v3 offset:44544
  v_mfma_f32_16x16x32_bf16 v[68:71], a[188:191], a[116:119], v[68:71]
  ds_read_b128 a[180:183], v4 offset:45568
  v_mfma_f32_16x16x32_bf16 v[88:91], a[188:191], a[120:123], v[88:91]
  s_add_u32 s44, s44, 4096
  buffer_load_dwordx2 a[100:101], v19, s[24:27], s44 offen offset:0 sc1
  buffer_load_dwordx2 a[102:103], v19, s[24:27], s44 offen offset:512 sc1
  v_mfma_f32_16x16x32_bf16 v[108:111], a[188:191], a[124:127], v[108:111]
  v_mfma_f32_16x16x32_bf16 v[128:131], a[188:191], a[128:131], v[128:131]
  s_add_u32 s45, s45, 4096
  buffer_load_dwordx2 a[104:105], v19, s[24:27], s45 offen offset:0 sc1
  buffer_load_dwordx2 a[106:107], v19, s[24:27], s45 offen offset:512 sc1
  v_mfma_f32_16x16x32_bf16 v[72:75], a[192:195], a[116:119], v[72:75]
  v_mfma_f32_16x16x32_bf16 v[92:95], a[192:195], a[120:123], v[92:95]
  s_add_u32 s46, s46, 4096
  buffer_load_dwordx2 a[108:109], v19, s[24:27], s46 offen offset:0 sc1
  buffer_load_dwordx2 a[110:111], v19, s[24:27], s46 offen offset:512 sc1
  v_mfma_f32_16x16x32_bf16 v[112:115], a[192:195], a[124:127], v[112:115]
  v_mfma_f32_16x16x32_bf16 v[132:135], a[192:195], a[128:131], v[132:135]
  s_add_u32 s47, s47, 4096
  buffer_load_dwordx2 a[112:113], v19, s[24:27], s47 offen offset:0 sc1
  buffer_load_dwordx2 a[114:115], v19, s[24:27], s47 offen offset:512 sc1
  v_mfma_f32_16x16x32_bf16 v[76:79], a[196:199], a[116:119], v[76:79]
  v_mfma_f32_16x16x32_bf16 v[96:99], a[196:199], a[120:123], v[96:99]
  buffer_load_dwordx4 a[72:75], v2, s[52:55], s51 offen offset:3072
  v_mfma_f32_16x16x32_bf16 v[116:119], a[196:199], a[124:127], v[116:119]
  v_mfma_f32_16x16x32_bf16 v[136:139], a[196:199], a[128:131], v[136:139]
  s_add_u32 s51, s51, 4096
  buffer_load_dwordx4 a[76:79], v5, s[52:55], s51 offen
  v_mfma_f32_16x16x32_bf16 v[80:83], a[200:203], a[116:119], v[80:83]
  v_mfma_f32_16x16x32_bf16 v[100:103], a[200:203], a[120:123], v[100:103]
  s_add_u32 s51, s50, 78336
  buffer_load_dwordx4 a[80:83], v2, s[52:55], s51 offen
  v_mfma_f32_16x16x32_bf16 v[120:123], a[200:203], a[124:127], v[120:123]
  v_mfma_f32_16x16x32_bf16 v[140:143], a[200:203], a[128:131], v[140:143]
  s_waitcnt vmcnt(18)
  s_waitcnt lgkmcnt(5)
  v_mfma_f32_16x16x32_bf16 v[64:67], a[204:207], a[132:135], v[64:67]
  ds_read_b128 a[184:187], v16 offset:0
  v_mfma_f32_16x16x32_bf16 v[84:87], a[204:207], a[136:139], v[84:87]
  ds_read_b128 a[188:191], v16 offset:1024
  v_mfma_f32_16x16x32_bf16 v[104:107], a[204:207], a[140:143], v[104:107]
  ds_read_b128 a[192:195], v16 offset:2048
  v_mfma_f32_16x16x32_bf16 v[124:127], a[204:207], a[144:147], v[124:127]
  ds_read_b128 a[196:199], v16 offset:3072
  v_mfma_f32_16x16x32_bf16 v[68:71], a[208:211], a[132:135], v[68:71]
  ds_read_b128 a[200:203], v17 offset:4096
  v_mfma_f32_16x16x32_bf16 v[88:91], a[208:211], a[136:139], v[88:91]
  buffer_load_dwordx4 a[116:119], v2, s[24:27], s44 offen offset:1024 sc1
  v_mfma_f32_16x16x32_bf16 v[108:111], a[208:211], a[140:143], v[108:111]
  v_mfma_f32_16x16x32_bf16 v[128:131], a[208:211], a[144:147], v[128:131]
  buffer_load_dwordx4 a[120:123], v2, s[24:27], s45 offen offset:1024 sc1
  v_mfma_f32_16x16x32_bf16 v[72:75], a[212:215], a[132:135], v[72:75]
  v_mfma_f32_16x16x32_bf16 v[92:95], a[212:215], a[136:139], v[92:95]
  buffer_load_dwordx4 a[124:127], v2, s[24:27], s46 offen offset:1024 sc1
  v_mfma_f32_16x16x32_bf16 v[112:115], a[212:215], a[140:143], v[112:115]
  v_mfma_f32_16x16x32_bf16 v[132:135], a[212:215], a[144:147], v[132:135]
  buffer_load_dwordx4 a[128:131], v2, s[24:27], s47 offen offset:1024 sc1
  v_mfma_f32_16x16x32_bf16 v[76:79], a[216:219], a[132:135], v[76:79]
  v_mfma_f32_16x16x32_bf16 v[96:99], a[216:219], a[136:139], v[96:99]
  buffer_load_dwordx4 a[84:87], v2, s[52:55], s51 offen offset:1024
  v_mfma_f32_16x16x32_bf16 v[116:119], a[216:219], a[140:143], v[116:119]
  v_mfma_f32_16x16x32_bf16 v[136:139], a[216:219], a[144:147], v[136:139]
  buffer_load_dwordx4 a[88:91], v2, s[52:55], s51 offen offset:2048
  v_mfma_f32_16x16x32_bf16 v[80:83], a[220:223], a[132:135], v[80:83]
  v_mfma_f32_16x16x32_bf16 v[100:103], a[220:223], a[136:139], v[100:103]
  buffer_load_dwordx4 a[92:95], v2, s[52:55], s51 offen offset:3072
  v_mfma_f32_16x16x32_bf16 v[120:123], a[220:223], a[140:143], v[120:123]
  v_mfma_f32_16x16x32_bf16 v[140:143], a[220:223], a[144:147], v[140:143]
  s_waitcnt vmcnt(21)
  s_waitcnt lgkmcnt(5)
  v_mfma_f32_16x16x32_bf16 v[64:67], a[164:167], a[148:151], v[64:67]
  ds_read_b128 a[204:207], v16 offset:4608
  v_mfma_f32_16x16x32_bf16 v[84:87], a[164:167], a[152:155], v[84:87]
  ds_read_b128 a[208:211], v16 offset:5632
  v_mfma_f32_16x16x32_bf16 v[104:107], a[164:167], a[156:159], v[104:107]
  ds_read_b128 a[212:215], v16 offset:6656
  v_mfma_f32_16x16x32_bf16 v[124:127], a[164:167], a[160:163], v[124:127]
  ds_read_b128 a[216:219], v16 offset:7680
  v_mfma_f32_16x16x32_bf16 v[68:71], a[168:171], a[148:151], v[68:71]
  ds_read_b128 a[220:223], v17 offset:8704
  v_mfma_f32_16x16x32_bf16 v[88:91], a[168:171], a[152:155], v[88:91]
  buffer_load_dwordx4 a[132:135], v2, s[24:27], s44 offen offset:2048 sc1
  v_mfma_f32_16x16x32_bf16 v[108:111], a[168:171], a[156:159], v[108:111]
  v_mfma_f32_16x16x32_bf16 v[128:131], a[168:171], a[160:163], v[128:131]
  buffer_load_dwordx4 a[136:139], v2, s[24:27], s45 offen offset:2048 sc1
  v_mfma_f32_16x16x32_bf16 v[72:75], a[172:175], a[148:151], v[72:75]
  v_mfma_f32_16x16x32_bf16 v[92:95], a[172:175], a[152:155], v[92:95]
  buffer_load_dwordx4 a[140:143], v2, s[24:27], s46 offen offset:2048 sc1
  v_mfma_f32_16x16x32_bf16 v[112:115], a[172:175], a[156:159], v[112:115]
  v_mfma_f32_16x16x32_bf16 v[132:135], a[172:175], a[160:163], v[132:135]
  buffer_load_dwordx4 a[144:147], v2, s[24:27], s47 offen offset:2048 sc1
  v_mfma_f32_16x16x32_bf16 v[76:79], a[176:179], a[148:151], v[76:79]
  v_mfma_f32_16x16x32_bf16 v[96:99], a[176:179], a[152:155], v[96:99]
  s_add_u32 s51, s51, 4096
  buffer_load_dwordx4 a[96:99], v5, s[52:55], s51 offen
  v_mfma_f32_16x16x32_bf16 v[116:119], a[176:179], a[156:159], v[116:119]
  v_mfma_f32_16x16x32_bf16 v[136:139], a[176:179], a[160:163], v[136:139]
  v_mfma_f32_16x16x32_bf16 v[80:83], a[180:183], a[148:151], v[80:83]
  v_mfma_f32_16x16x32_bf16 v[100:103], a[180:183], a[152:155], v[100:103]
  v_mfma_f32_16x16x32_bf16 v[120:123], a[180:183], a[156:159], v[120:123]
  v_mfma_f32_16x16x32_bf16 v[140:143], a[180:183], a[160:163], v[140:143]
  s_waitcnt vmcnt(15)
  s_waitcnt lgkmcnt(5)
  v_mfma_f32_16x16x32_bf16 v[64:67], a[184:187], a[100:103], v[64:67]
  ds_read_b128 a[164:167], v16 offset:36864
  v_mfma_f32_16x16x32_bf16 v[84:87], a[184:187], a[104:107], v[84:87]
  ds_read_b128 a[168:171], v16 offset:37888
  v_mfma_f32_16x16x32_bf16 v[104:107], a[184:187], a[108:111], v[104:107]
  ds_read_b128 a[172:175], v16 offset:38912
  v_mfma_f32_16x16x32_bf16 v[124:127], a[184:187], a[112:115], v[124:127]
  ds_read_b128 a[176:179], v16 offset:39936
  v_mfma_f32_16x16x32_bf16 v[68:71], a[188:191], a[100:103], v[68:71]
  ds_read_b128 a[180:183], v17 offset:40960
  v_mfma_f32_16x16x32_bf16 v[88:91], a[188:191], a[104:107], v[88:91]
  buffer_load_dwordx4 a[148:151], v2, s[24:27], s44 offen offset:3072 sc1
  v_mfma_f32_16x16x32_bf16 v[108:111], a[188:191], a[108:111], v[108:111]
  v_mfma_f32_16x16x32_bf16 v[128:131], a[188:191], a[112:115], v[128:131]
  buffer_load_dwordx4 a[152:155], v2, s[24:27], s45 offen offset:3072 sc1
  v_mfma_f32_16x16x32_bf16 v[72:75], a[192:195], a[100:103], v[72:75]
  v_mfma_f32_16x16x32_bf16 v[92:95], a[192:195], a[104:107], v[92:95]
  buffer_load_dwordx4 a[156:159], v2, s[24:27], s46 offen offset:3072 sc1
  v_mfma_f32_16x16x32_bf16 v[112:115], a[192:195], a[108:111], v[112:115]
  v_mfma_f32_16x16x32_bf16 v[132:135], a[192:195], a[112:115], v[132:135]
  buffer_load_dwordx4 a[160:163], v2, s[24:27], s47 offen offset:3072 sc1
  v_mfma_f32_16x16x32_bf16 v[76:79], a[196:199], a[100:103], v[76:79]
  v_mfma_f32_16x16x32_bf16 v[96:99], a[196:199], a[104:107], v[96:99]
  v_mfma_f32_16x16x32_bf16 v[116:119], a[196:199], a[108:111], v[116:119]
  v_mfma_f32_16x16x32_bf16 v[136:139], a[196:199], a[112:115], v[136:139]
  v_mfma_f32_16x16x32_bf16 v[80:83], a[200:203], a[100:103], v[80:83]
  v_mfma_f32_16x16x32_bf16 v[100:103], a[200:203], a[104:107], v[100:103]
  v_mfma_f32_16x16x32_bf16 v[120:123], a[200:203], a[108:111], v[120:123]
  v_mfma_f32_16x16x32_bf16 v[140:143], a[200:203], a[112:115], v[140:143]
  s_waitcnt vmcnt(12)
  s_waitcnt lgkmcnt(5)
  v_mfma_f32_16x16x32_bf16 v[64:67], a[204:207], a[116:119], v[64:67]
  ds_read_b128 a[184:187], v16 offset:41472
  v_mfma_f32_16x16x32_bf16 v[84:87], a[204:207], a[120:123], v[84:87]
  ds_read_b128 a[188:191], v16 offset:42496
  v_mfma_f32_16x16x32_bf16 v[104:107], a[204:207], a[124:127], v[104:107]
  ds_read_b128 a[192:195], v16 offset:43520
  v_mfma_f32_16x16x32_bf16 v[124:127], a[204:207], a[128:131], v[124:127]
  ds_read_b128 a[196:199], v16 offset:44544
  v_mfma_f32_16x16x32_bf16 v[68:71], a[208:211], a[116:119], v[68:71]
  ds_read_b128 a[200:203], v17 offset:45568
  v_mfma_f32_16x16x32_bf16 v[88:91], a[208:211], a[120:123], v[88:91]
  s_add_u32 s44, s44, 4096
  buffer_load_dwordx4 a[100:103], v2, s[24:27], s44 offen offset:0 sc1
  v_mfma_f32_16x16x32_bf16 v[108:111], a[208:211], a[124:127], v[108:111]
  v_mfma_f32_16x16x32_bf16 v[128:131], a[208:211], a[128:131], v[128:131]
  s_add_u32 s45, s45, 4096
  buffer_load_dwordx4 a[104:107], v2, s[24:27], s45 offen offset:0 sc1
  v_mfma_f32_16x16x32_bf16 v[72:75], a[212:215], a[116:119], v[72:75]
  v_mfma_f32_16x16x32_bf16 v[92:95], a[212:215], a[120:123], v[92:95]
  s_add_u32 s46, s46, 4096
  buffer_load_dwordx4 a[108:111], v2, s[24:27], s46 offen offset:0 sc1
  v_mfma_f32_16x16x32_bf16 v[112:115], a[212:215], a[124:127], v[112:115]
  v_mfma_f32_16x16x32_bf16 v[132:135], a[212:215], a[128:131], v[132:135]
  s_add_u32 s47, s47, 4096
  buffer_load_dwordx4 a[112:115], v2, s[24:27], s47 offen offset:0 sc1
  v_mfma_f32_16x16x32_bf16 v[76:79], a[216:219], a[116:119], v[76:79]
  v_mfma_f32_16x16x32_bf16 v[96:99], a[216:219], a[120:123], v[96:99]
  v_mfma_f32_16x16x32_bf16 v[116:119], a[216:219], a[124:127], v[116:119]
  v_mfma_f32_16x16x32_bf16 v[136:139], a[216:219], a[128:131], v[136:139]
  v_mfma_f32_16x16x32_bf16 v[80:83], a[220:223], a[116:119], v[80:83]
  v_mfma_f32_16x16x32_bf16 v[100:103], a[220:223], a[120:123], v[100:103]
  v_mfma_f32_16x16x32_bf16 v[120:123], a[220:223], a[124:127], v[120:123]
  v_mfma_f32_16x16x32_bf16 v[140:143], a[220:223], a[128:131], v[140:143]
  s_waitcnt vmcnt(9)
  s_waitcnt lgkmcnt(5)
  v_mfma_f32_16x16x32_bf16 v[64:67], a[164:167], a[132:135], v[64:67]
  v_mfma_f32_16x16x32_bf16 v[84:87], a[164:167], a[136:139], v[84:87]
  buffer_load_dwordx4 a[116:119], v2, s[24:27], s44 offen offset:1024 sc1
  v_mfma_f32_16x16x32_bf16 v[104:107], a[164:167], a[140:143], v[104:107]
  v_mfma_f32_16x16x32_bf16 v[124:127], a[164:167], a[144:147], v[124:127]
  buffer_load_dwordx4 a[120:123], v2, s[24:27], s45 offen offset:1024 sc1
  v_mfma_f32_16x16x32_bf16 v[68:71], a[168:171], a[132:135], v[68:71]
  v_mfma_f32_16x16x32_bf16 v[88:91], a[168:171], a[136:139], v[88:91]
  buffer_load_dwordx4 a[124:127], v2, s[24:27], s46 offen offset:1024 sc1
  v_mfma_f32_16x16x32_bf16 v[108:111], a[168:171], a[140:143], v[108:111]
  v_mfma_f32_16x16x32_bf16 v[128:131], a[168:171], a[144:147], v[128:131]
  buffer_load_dwordx4 a[128:131], v2, s[24:27], s47 offen offset:1024 sc1
  v_mfma_f32_16x16x32_bf16 v[72:75], a[172:175], a[132:135], v[72:75]
  v_mfma_f32_16x16x32_bf16 v[92:95], a[172:175], a[136:139], v[92:95]
  v_mfma_f32_16x16x32_bf16 v[112:115], a[172:175], a[140:143], v[112:115]
  v_mfma_f32_16x16x32_bf16 v[132:135], a[172:175], a[144:147], v[132:135]
  v_mfma_f32_16x16x32_bf16 v[76:79], a[176:179], a[132:135], v[76:79]
  v_mfma_f32_16x16x32_bf16 v[96:99], a[176:179], a[136:139], v[96:99]
  v_mfma_f32_16x16x32_bf16 v[116:119], a[176:179], a[140:143], v[116:119]
  v_mfma_f32_16x16x32_bf16 v[136:139], a[176:179], a[144:147], v[136:139]
  v_mfma_f32_16x16x32_bf16 v[80:83], a[180:183], a[132:135], v[80:83]
  v_mfma_f32_16x16x32_bf16 v[100:103], a[180:183], a[136:139], v[100:103]
  v_mfma_f32_16x16x32_bf16 v[120:123], a[180:183], a[140:143], v[120:123]
  v_mfma_f32_16x16x32_bf16 v[140:143], a[180:183], a[144:147], v[140:143]
  s_waitcnt vmcnt(8)
  s_waitcnt lgkmcnt(0)
  v_mfma_f32_16x16x32_bf16 v[64:67], a[184:187], a[148:151], v[64:67]
  v_mfma_f32_16x16x32_bf16 v[84:87], a[184:187], a[152:155], v[84:87]
  buffer_load_dwordx4 a[132:135], v2, s[24:27], s44 offen offset:2048 sc1
  v_mfma_f32_16x16x32_bf16 v[104:107], a[184:187], a[156:159], v[104:107]
  v_mfma_f32_16x16x32_bf16 v[124:127], a[184:187], a[160:163], v[124:127]
  buffer_load_dwordx4 a[136:139], v2, s[24:27], s45 offen offset:2048 sc1
  v_mfma_f32_16x16x32_bf16 v[68:71], a[188:191], a[148:151], v[68:71]
  v_mfma_f32_16x16x32_bf16 v[88:91], a[188:191], a[152:155], v[88:91]
  buffer_load_dwordx4 a[140:143], v2, s[24:27], s46 offen offset:2048 sc1
  v_mfma_f32_16x16x32_bf16 v[108:111], a[188:191], a[156:159], v[108:111]
  v_mfma_f32_16x16x32_bf16 v[128:131], a[188:191], a[160:163], v[128:131]
  buffer_load_dwordx4 a[144:147], v2, s[24:27], s47 offen offset:2048 sc1
  v_mfma_f32_16x16x32_bf16 v[72:75], a[192:195], a[148:151], v[72:75]
  v_mfma_f32_16x16x32_bf16 v[92:95], a[192:195], a[152:155], v[92:95]
  v_mfma_f32_16x16x32_bf16 v[112:115], a[192:195], a[156:159], v[112:115]
  v_mfma_f32_16x16x32_bf16 v[132:135], a[192:195], a[160:163], v[132:135]
  v_mfma_f32_16x16x32_bf16 v[76:79], a[196:199], a[148:151], v[76:79]
  v_mfma_f32_16x16x32_bf16 v[96:99], a[196:199], a[152:155], v[96:99]
  v_mfma_f32_16x16x32_bf16 v[116:119], a[196:199], a[156:159], v[116:119]
  v_mfma_f32_16x16x32_bf16 v[136:139], a[196:199], a[160:163], v[136:139]
  v_mfma_f32_16x16x32_bf16 v[80:83], a[200:203], a[148:151], v[80:83]
  v_mfma_f32_16x16x32_bf16 v[100:103], a[200:203], a[152:155], v[100:103]
  v_mfma_f32_16x16x32_bf16 v[120:123], a[200:203], a[156:159], v[120:123]
  v_mfma_f32_16x16x32_bf16 v[140:143], a[200:203], a[160:163], v[140:143]
  s_waitcnt vmcnt(8)
  v_mfma_f32_16x16x32_bf16 v[64:67], v[144:147], a[100:103], v[64:67]
  v_mfma_f32_16x16x32_bf16 v[84:87], v[144:147], a[104:107], v[84:87]
  buffer_load_dwordx4 a[148:151], v2, s[24:27], s44 offen offset:3072 sc1
  v_mfma_f32_16x16x32_bf16 v[104:107], v[144:147], a[108:111], v[104:107]
  v_mfma_f32_16x16x32_bf16 v[124:127], v[144:147], a[112:115], v[124:127]
  buffer_load_dwordx4 a[152:155], v2, s[24:27], s45 offen offset:3072 sc1
  v_mfma_f32_16x16x32_bf16 v[68:71], v[148:151], a[100:103], v[68:71]
  v_mfma_f32_16x16x32_bf16 v[88:91], v[148:151], a[104:107], v[88:91]
  buffer_load_dwordx4 a[156:159], v2, s[24:27], s46 offen offset:3072 sc1
  v_mfma_f32_16x16x32_bf16 v[108:111], v[148:151], a[108:111], v[108:111]
  v_mfma_f32_16x16x32_bf16 v[128:131], v[148:151], a[112:115], v[128:131]
  buffer_load_dwordx4 a[160:163], v2, s[24:27], s47 offen offset:3072 sc1
  v_mfma_f32_16x16x32_bf16 v[72:75], v[152:155], a[100:103], v[72:75]
  v_mfma_f32_16x16x32_bf16 v[92:95], v[152:155], a[104:107], v[92:95]
  v_mfma_f32_16x16x32_bf16 v[112:115], v[152:155], a[108:111], v[112:115]
  v_mfma_f32_16x16x32_bf16 v[132:135], v[152:155], a[112:115], v[132:135]
  v_mfma_f32_16x16x32_bf16 v[76:79], v[156:159], a[100:103], v[76:79]
  v_mfma_f32_16x16x32_bf16 v[96:99], v[156:159], a[104:107], v[96:99]
  v_mfma_f32_16x16x32_bf16 v[116:119], v[156:159], a[108:111], v[116:119]
  v_mfma_f32_16x16x32_bf16 v[136:139], v[156:159], a[112:115], v[136:139]
  v_mfma_f32_16x16x32_bf16 v[80:83], v[160:163], a[100:103], v[80:83]
  v_mfma_f32_16x16x32_bf16 v[100:103], v[160:163], a[104:107], v[100:103]
  v_mfma_f32_16x16x32_bf16 v[120:123], v[160:163], a[108:111], v[120:123]
  v_mfma_f32_16x16x32_bf16 v[140:143], v[160:163], a[112:115], v[140:143]
  s_waitcnt vmcnt(8)
  v_mfma_f32_16x16x32_bf16 v[64:67], v[164:167], a[116:119], v[64:67]
  v_mfma_f32_16x16x32_bf16 v[84:87], v[164:167], a[120:123], v[84:87]
  s_add_u32 s44, s44, 4096
  buffer_load_dwordx4 a[100:103], v2, s[24:27], s44 offen offset:0 sc1
  v_mfma_f32_16x16x32_bf16 v[104:107], v[164:167], a[124:127], v[104:107]
  v_mfma_f32_16x16x32_bf16 v[124:127], v[164:167], a[128:131], v[124:127]
  s_add_u32 s45, s45, 4096
  buffer_load_dwordx4 a[104:107], v2, s[24:27], s45 offen offset:0 sc1
  v_mfma_f32_16x16x32_bf16 v[68:71], v[168:171], a[116:119], v[68:71]
  v_mfma_f32_16x16x32_bf16 v[88:91], v[168:171], a[120:123], v[88:91]
  s_add_u32 s46, s46, 4096
  buffer_load_dwordx4 a[108:111], v2, s[24:27], s46 offen offset:0 sc1
  v_mfma_f32_16x16x32_bf16 v[108:111], v[168:171], a[124:127], v[108:111]
  v_mfma_f32_16x16x32_bf16 v[128:131], v[168:171], a[128:131], v[128:131]
  s_add_u32 s47, s47, 4096
  buffer_load_dwordx4 a[112:115], v2, s[24:27], s47 offen offset:0 sc1
  v_mfma_f32_16x16x32_bf16 v[72:75], v[172:175], a[116:119], v[72:75]
  v_mfma_f32_16x16x32_bf16 v[92:95], v[172:175], a[120:123], v[92:95]
  v_mfma_f32_16x16x32_bf16 v[112:115], v[172:175], a[124:127], v[112:115]
  v_mfma_f32_16x16x32_bf16 v[132:135], v[172:175], a[128:131], v[132:135]
  v_mfma_f32_16x16x32_bf16 v[76:79], v[176:179], a[116:119], v[76:79]
  v_mfma_f32_16x16x32_bf16 v[96:99], v[176:179], a[120:123], v[96:99]
  v_mfma_f32_16x16x32_bf16 v[116:119], v[176:179], a[124:127], v[116:119]
  v_mfma_f32_16x16x32_bf16 v[136:139], v[176:179], a[128:131], v[136:139]
  v_mfma_f32_16x16x32_bf16 v[80:83], v[180:183], a[116:119], v[80:83]
  v_mfma_f32_16x16x32_bf16 v[100:103], v[180:183], a[120:123], v[100:103]
  v_mfma_f32_16x16x32_bf16 v[120:123], v[180:183], a[124:127], v[120:123]
  v_mfma_f32_16x16x32_bf16 v[140:143], v[180:183], a[128:131], v[140:143]
  s_waitcnt vmcnt(8)
  s_barrier
  s_add_u32 s13, s3, 1
  s_and_b32 s13, s13, 3
  s_mul_i32 s13, s13, 15360
  v_add_u32 v16, s13, v2
  s_add_u32 s13, s3, 2
  s_and_b32 s13, s13, 3
  s_mul_i32 s13, s13, 15360
  v_add_u32 v17, s13, v2
  s_add_u32 s13, s3, 3
  s_and_b32 s13, s13, 3
  s_mul_i32 s13, s13, 15360
  v_add_u32 v18, s13, v2
  s_mul_i32 s12, s3, 15360
  v_add_u32 v4, s12, v2
  v_mfma_f32_16x16x32_bf16 v[64:67], v[184:187], a[132:135], v[64:67]
  v_mfma_f32_16x16x32_bf16 v[84:87], v[184:187], a[136:139], v[84:87]
  buffer_load_dwordx2 a[116:117], v19, s[24:27], s44 offen offset:1024 sc1
  buffer_load_dwordx2 a[118:119], v19, s[24:27], s44 offen offset:1536 sc1
  v_mfma_f32_16x16x32_bf16 v[104:107], v[184:187], a[140:143], v[104:107]
  v_mfma_f32_16x16x32_bf16 v[124:127], v[184:187], a[144:147], v[124:127]
  buffer_load_dwordx2 a[120:121], v19, s[24:27], s45 offen offset:1024 sc1
  buffer_load_dwordx2 a[122:123], v19, s[24:27], s45 offen offset:1536 sc1
  v_mfma_f32_16x16x32_bf16 v[68:71], v[188:191], a[132:135], v[68:71]
  v_mfma_f32_16x16x32_bf16 v[88:91], v[188:191], a[136:139], v[88:91]
  buffer_load_dwordx2 a[124:125], v19, s[24:27], s46 offen offset:1024 sc1
  buffer_load_dwordx2 a[126:127], v19, s[24:27], s46 offen offset:1536 sc1
  v_mfma_f32_16x16x32_bf16 v[108:111], v[188:191], a[140:143], v[108:111]
  v_mfma_f32_16x16x32_bf16 v[128:131], v[188:191], a[144:147], v[128:131]
  buffer_load_dwordx2 a[128:129], v19, s[24:27], s47 offen offset:1024 sc1
  buffer_load_dwordx2 a[130:131], v19, s[24:27], s47 offen offset:1536 sc1
  v_mfma_f32_16x16x32_bf16 v[72:75], v[192:195], a[132:135], v[72:75]
  v_mfma_f32_16x16x32_bf16 v[92:95], v[192:195], a[136:139], v[92:95]
  v_mfma_f32_16x16x32_bf16 v[112:115], v[192:195], a[140:143], v[112:115]
  v_mfma_f32_16x16x32_bf16 v[132:135], v[192:195], a[144:147], v[132:135]
  v_mfma_f32_16x16x32_bf16 v[76:79], v[196:199], a[132:135], v[76:79]
  v_mfma_f32_16x16x32_bf16 v[96:99], v[196:199], a[136:139], v[96:99]
  v_mfma_f32_16x16x32_bf16 v[116:119], v[196:199], a[140:143], v[116:119]
  v_mfma_f32_16x16x32_bf16 v[136:139], v[196:199], a[144:147], v[136:139]
  v_mfma_f32_16x16x32_bf16 v[80:83], v[200:203], a[132:135], v[80:83]
  v_mfma_f32_16x16x32_bf16 v[100:103], v[200:203], a[136:139], v[100:103]
  v_mfma_f32_16x16x32_bf16 v[120:123], v[200:203], a[140:143], v[120:123]
  v_mfma_f32_16x16x32_bf16 v[140:143], v[200:203], a[144:147], v[140:143]
  s_waitcnt vmcnt(12)
  v_mfma_f32_16x16x32_bf16 v[64:67], v[20:23], a[148:151], v[64:67]
  v_mfma_f32_16x16x32_bf16 v[84:87], v[20:23], a[152:155], v[84:87]
  buffer_load_dwordx4 a[132:135], v2, s[24:27], s44 offen offset:2048 sc1
  v_mfma_f32_16x16x32_bf16 v[104:107], v[20:23], a[156:159], v[104:107]
  v_mfma_f32_16x16x32_bf16 v[124:127], v[20:23], a[160:163], v[124:127]
  buffer_load_dwordx4 a[136:139], v2, s[24:27], s45 offen offset:2048 sc1
  v_mfma_f32_16x16x32_bf16 v[68:71], v[24:27], a[148:151], v[68:71]
  v_mfma_f32_16x16x32_bf16 v[88:91], v[24:27], a[152:155], v[88:91]
  buffer_load_dwordx4 a[140:143], v2, s[24:27], s46 offen offset:2048 sc1
  v_mfma_f32_16x16x32_bf16 v[108:111], v[24:27], a[156:159], v[108:111]
  v_mfma_f32_16x16x32_bf16 v[128:131], v[24:27], a[160:163], v[128:131]
  buffer_load_dwordx4 a[144:147], v2, s[24:27], s47 offen offset:2048 sc1
  v_mfma_f32_16x16x32_bf16 v[72:75], v[28:31], a[148:151], v[72:75]
  v_mfma_f32_16x16x32_bf16 v[92:95], v[28:31], a[152:155], v[92:95]
  v_mfma_f32_16x16x32_bf16 v[112:115], v[28:31], a[156:159], v[112:115]
  v_mfma_f32_16x16x32_bf16 v[132:135], v[28:31], a[160:163], v[132:135]
  v_mfma_f32_16x16x32_bf16 v[76:79], v[32:35], a[148:151], v[76:79]
  v_mfma_f32_16x16x32_bf16 v[96:99], v[32:35], a[152:155], v[96:99]
  v_mfma_f32_16x16x32_bf16 v[116:119], v[32:35], a[156:159], v[116:119]
  v_mfma_f32_16x16x32_bf16 v[136:139], v[32:35], a[160:163], v[136:139]
  v_mfma_f32_16x16x32_bf16 v[80:83], v[36:39], a[148:151], v[80:83]
  v_mfma_f32_16x16x32_bf16 v[100:103], v[36:39], a[152:155], v[100:103]
  v_mfma_f32_16x16x32_bf16 v[120:123], v[36:39], a[156:159], v[120:123]
  v_mfma_f32_16x16x32_bf16 v[140:143], v[36:39], a[160:163], v[140:143]
  s_waitcnt vmcnt(12)
  v_mfma_f32_16x16x32_bf16 v[64:67], v[40:43], a[100:103], v[64:67]
  v_mfma_f32_16x16x32_bf16 v[84:87], v[40:43], a[104:107], v[84:87]
  buffer_load_dwordx4 a[148:151], v2, s[24:27], s44 offen offset:3072 sc1
  v_mfma_f32_16x16x32_bf16 v[104:107], v[40:43], a[108:111], v[104:107]
  v_mfma_f32_16x16x32_bf16 v[124:127], v[40:43], a[112:115], v[124:127]
  buffer_load_dwordx4 a[152:155], v2, s[24:27], s45 offen offset:3072 sc1
  v_mfma_f32_16x16x32_bf16 v[68:71], v[44:47], a[100:103], v[68:71]
  v_mfma_f32_16x16x32_bf16 v[88:91], v[44:47], a[104:107], v[88:91]
  buffer_load_dwordx4 a[156:159], v2, s[24:27], s46 offen offset:3072 sc1
  v_mfma_f32_16x16x32_bf16 v[108:111], v[44:47], a[108:111], v[108:111]
  v_mfma_f32_16x16x32_bf16 v[128:131], v[44:47], a[112:115], v[128:131]
  buffer_load_dwordx4 a[160:163], v2, s[24:27], s47 offen offset:3072 sc1
  v_mfma_f32_16x16x32_bf16 v[72:75], v[48:51], a[100:103], v[72:75]
  v_mfma_f32_16x16x32_bf16 v[92:95], v[48:51], a[104:107], v[92:95]
  v_mfma_f32_16x16x32_bf16 v[112:115], v[48:51], a[108:111], v[112:115]
  v_mfma_f32_16x16x32_bf16 v[132:135], v[48:51], a[112:115], v[132:135]
  v_mfma_f32_16x16x32_bf16 v[76:79], v[52:55], a[100:103], v[76:79]
  v_mfma_f32_16x16x32_bf16 v[96:99], v[52:55], a[104:107], v[96:99]
  v_mfma_f32_16x16x32_bf16 v[116:119], v[52:55], a[108:111], v[116:119]
  v_mfma_f32_16x16x32_bf16 v[136:139], v[52:55], a[112:115], v[136:139]
  v_mfma_f32_16x16x32_bf16 v[80:83], v[56:59], a[100:103], v[80:83]
  v_mfma_f32_16x16x32_bf16 v[100:103], v[56:59], a[104:107], v[100:103]
  v_mfma_f32_16x16x32_bf16 v[120:123], v[56:59], a[108:111], v[120:123]
  v_mfma_f32_16x16x32_bf16 v[140:143], v[56:59], a[112:115], v[140:143]
  s_waitcnt vmcnt(8)
  v_mfma_f32_16x16x32_bf16 v[64:67], a[0:3], a[116:119], v[64:67]
  v_mfma_f32_16x16x32_bf16 v[84:87], a[0:3], a[120:123], v[84:87]
  s_add_u32 s44, s44, 4096
  buffer_load_dwordx4 a[100:103], v2, s[24:27], s44 offen offset:0 sc1
  v_mfma_f32_16x16x32_bf16 v[104:107], a[0:3], a[124:127], v[104:107]
  v_mfma_f32_16x16x32_bf16 v[124:127], a[0:3], a[128:131], v[124:127]
  s_add_u32 s45, s45, 4096
  buffer_load_dwordx4 a[104:107], v2, s[24:27], s45 offen offset:0 sc1
  v_mfma_f32_16x16x32_bf16 v[68:71], a[4:7], a[116:119], v[68:71]
  v_mfma_f32_16x16x32_bf16 v[88:91], a[4:7], a[120:123], v[88:91]
  s_add_u32 s46, s46, 4096
  buffer_load_dwordx4 a[108:111], v2, s[24:27], s46 offen offset:0 sc1
  v_mfma_f32_16x16x32_bf16 v[108:111], a[4:7], a[124:127], v[108:111]
  v_mfma_f32_16x16x32_bf16 v[128:131], a[4:7], a[128:131], v[128:131]
  s_add_u32 s47, s47, 4096
  buffer_load_dwordx4 a[112:115], v2, s[24:27], s47 offen offset:0 sc1
  v_mfma_f32_16x16x32_bf16 v[72:75], a[8:11], a[116:119], v[72:75]
  v_mfma_f32_16x16x32_bf16 v[92:95], a[8:11], a[120:123], v[92:95]
  v_mfma_f32_16x16x32_bf16 v[112:115], a[8:11], a[124:127], v[112:115]
  v_mfma_f32_16x16x32_bf16 v[132:135], a[8:11], a[128:131], v[132:135]
  v_mfma_f32_16x16x32_bf16 v[76:79], a[12:15], a[116:119], v[76:79]
  v_mfma_f32_16x16x32_bf16 v[96:99], a[12:15], a[120:123], v[96:99]
  v_mfma_f32_16x16x32_bf16 v[116:119], a[12:15], a[124:127], v[116:119]
  v_mfma_f32_16x16x32_bf16 v[136:139], a[12:15], a[128:131], v[136:139]
  v_mfma_f32_16x16x32_bf16 v[80:83], a[16:19], a[116:119], v[80:83]
  v_mfma_f32_16x16x32_bf16 v[100:103], a[16:19], a[120:123], v[100:103]
  v_mfma_f32_16x16x32_bf16 v[120:123], a[16:19], a[124:127], v[120:123]
  v_mfma_f32_16x16x32_bf16 v[140:143], a[16:19], a[128:131], v[140:143]
  s_waitcnt vmcnt(8)
  v_mfma_f32_16x16x32_bf16 v[64:67], a[20:23], a[132:135], v[64:67]
  v_mfma_f32_16x16x32_bf16 v[84:87], a[20:23], a[136:139], v[84:87]
  buffer_load_dwordx4 a[116:119], v2, s[24:27], s44 offen offset:1024 sc1
  v_mfma_f32_16x16x32_bf16 v[104:107], a[20:23], a[140:143], v[104:107]
  v_mfma_f32_16x16x32_bf16 v[124:127], a[20:23], a[144:147], v[124:127]
  buffer_load_dwordx4 a[120:123], v2, s[24:27], s45 offen offset:1024 sc1
  v_mfma_f32_16x16x32_bf16 v[68:71], a[24:27], a[132:135], v[68:71]
  v_mfma_f32_16x16x32_bf16 v[88:91], a[24:27], a[136:139], v[88:91]
  buffer_load_dwordx4 a[124:127], v2, s[24:27], s46 offen offset:1024 sc1
  v_mfma_f32_16x16x32_bf16 v[108:111], a[24:27], a[140:143], v[108:111]
  v_mfma_f32_16x16x32_bf16 v[128:131], a[24:27], a[144:147], v[128:131]
  buffer_load_dwordx4 a[128:131], v2, s[24:27], s47 offen offset:1024 sc1
  v_mfma_f32_16x16x32_bf16 v[72:75], a[28:31], a[132:135], v[72:75]
  v_mfma_f32_16x16x32_bf16 v[92:95], a[28:31], a[136:139], v[92:95]
  v_mfma_f32_16x16x32_bf16 v[112:115], a[28:31], a[140:143], v[112:115]
  v_mfma_f32_16x16x32_bf16 v[132:135], a[28:31], a[144:147], v[132:135]
  v_mfma_f32_16x16x32_bf16 v[76:79], a[32:35], a[132:135], v[76:79]
  v_mfma_f32_16x16x32_bf16 v[96:99], a[32:35], a[136:139], v[96:99]
  v_mfma_f32_16x16x32_bf16 v[116:119], a[32:35], a[140:143], v[116:119]
  v_mfma_f32_16x16x32_bf16 v[136:139], a[32:35], a[144:147], v[136:139]
  v_mfma_f32_16x16x32_bf16 v[80:83], a[36:39], a[132:135], v[80:83]
  v_mfma_f32_16x16x32_bf16 v[100:103], a[36:39], a[136:139], v[100:103]
  v_mfma_f32_16x16x32_bf16 v[120:123], a[36:39], a[140:143], v[120:123]
  v_mfma_f32_16x16x32_bf16 v[140:143], a[36:39], a[144:147], v[140:143]
  s_waitcnt vmcnt(8)
  v_mfma_f32_16x16x32_bf16 v[64:67], a[40:43], a[148:151], v[64:67]
  v_mfma_f32_16x16x32_bf16 v[84:87], a[40:43], a[152:155], v[84:87]
  v_mfma_f32_16x16x32_bf16 v[104:107], a[40:43], a[156:159], v[104:107]
  v_mfma_f32_16x16x32_bf16 v[124:127], a[40:43], a[160:163], v[124:127]
  v_mfma_f32_16x16x32_bf16 v[68:71], a[44:47], a[148:151], v[68:71]
  v_mfma_f32_16x16x32_bf16 v[88:91], a[44:47], a[152:155], v[88:91]
  v_mfma_f32_16x16x32_bf16 v[108:111], a[44:47], a[156:159], v[108:111]
  v_mfma_f32_16x16x32_bf16 v[128:131], a[44:47], a[160:163], v[128:131]
  v_mfma_f32_16x16x32_bf16 v[72:75], a[48:51], a[148:151], v[72:75]
  v_mfma_f32_16x16x32_bf16 v[92:95], a[48:51], a[152:155], v[92:95]
  v_mfma_f32_16x16x32_bf16 v[112:115], a[48:51], a[156:159], v[112:115]
  v_mfma_f32_16x16x32_bf16 v[132:135], a[48:51], a[160:163], v[132:135]
  v_mfma_f32_16x16x32_bf16 v[76:79], a[52:55], a[148:151], v[76:79]
  v_mfma_f32_16x16x32_bf16 v[96:99], a[52:55], a[152:155], v[96:99]
  v_mfma_f32_16x16x32_bf16 v[116:119], a[52:55], a[156:159], v[116:119]
  v_mfma_f32_16x16x32_bf16 v[136:139], a[52:55], a[160:163], v[136:139]
  v_mfma_f32_16x16x32_bf16 v[80:83], a[56:59], a[148:151], v[80:83]
  v_mfma_f32_16x16x32_bf16 v[100:103], a[56:59], a[152:155], v[100:103]
  v_mfma_f32_16x16x32_bf16 v[120:123], a[56:59], a[156:159], v[120:123]
  v_mfma_f32_16x16x32_bf16 v[140:143], a[56:59], a[160:163], v[140:143]
  s_waitcnt vmcnt(4)
  v_mfma_f32_16x16x32_bf16 v[64:67], a[60:63], a[100:103], v[64:67]
  v_mfma_f32_16x16x32_bf16 v[84:87], a[60:63], a[104:107], v[84:87]
  v_mfma_f32_16x16x32_bf16 v[104:107], a[60:63], a[108:111], v[104:107]
  v_mfma_f32_16x16x32_bf16 v[124:127], a[60:63], a[112:115], v[124:127]
  v_mfma_f32_16x16x32_bf16 v[68:71], a[64:67], a[100:103], v[68:71]
  v_mfma_f32_16x16x32_bf16 v[88:91], a[64:67], a[104:107], v[88:91]
  v_mfma_f32_16x16x32_bf16 v[108:111], a[64:67], a[108:111], v[108:111]
  v_mfma_f32_16x16x32_bf16 v[128:131], a[64:67], a[112:115], v[128:131]
  v_mfma_f32_16x16x32_bf16 v[72:75], a[68:71], a[100:103], v[72:75]
  v_mfma_f32_16x16x32_bf16 v[92:95], a[68:71], a[104:107], v[92:95]
  v_mfma_f32_16x16x32_bf16 v[112:115], a[68:71], a[108:111], v[112:115]
  v_mfma_f32_16x16x32_bf16 v[132:135], a[68:71], a[112:115], v[132:135]
  v_mfma_f32_16x16x32_bf16 v[76:79], a[72:75], a[100:103], v[76:79]
  v_mfma_f32_16x16x32_bf16 v[96:99], a[72:75], a[104:107], v[96:99]
  v_mfma_f32_16x16x32_bf16 v[116:119], a[72:75], a[108:111], v[116:119]
  v_mfma_f32_16x16x32_bf16 v[136:139], a[72:75], a[112:115], v[136:139]
  v_mfma_f32_16x16x32_bf16 v[80:83], a[76:79], a[100:103], v[80:83]
  v_mfma_f32_16x16x32_bf16 v[100:103], a[76:79], a[104:107], v[100:103]
  v_mfma_f32_16x16x32_bf16 v[120:123], a[76:79], a[108:111], v[120:123]
  v_mfma_f32_16x16x32_bf16 v[140:143], a[76:79], a[112:115], v[140:143]
  s_waitcnt vmcnt(0)
  v_mfma_f32_16x16x32_bf16 v[84:87], a[80:83], a[120:123], v[84:87]
  v_mfma_f32_16x16x32_bf16 v[88:91], a[84:87], a[120:123], v[88:91]
  v_mfma_f32_16x16x32_bf16 v[92:95], a[88:91], a[120:123], v[92:95]
  v_mfma_f32_16x16x32_bf16 v[96:99], a[92:95], a[120:123], v[96:99]
  v_mfma_f32_16x16x32_bf16 v[100:103], a[96:99], a[120:123], v[100:103]
  v_mfma_f32_16x16x32_bf16 v[104:107], a[80:83], a[124:127], v[104:107]
  v_mfma_f32_16x16x32_bf16 v[108:111], a[84:87], a[124:127], v[108:111]
  v_mfma_f32_16x16x32_bf16 v[112:115], a[88:91], a[124:127], v[112:115]
  v_mfma_f32_16x16x32_bf16 v[116:119], a[92:95], a[124:127], v[116:119]
  v_mfma_f32_16x16x32_bf16 v[120:123], a[96:99], a[124:127], v[120:123]
  ds_write_b128 v16, v[84:87] offset:0
  v_mfma_f32_16x16x32_bf16 v[124:127], a[80:83], a[128:131], v[124:127]
  ds_write_b128 v16, v[88:91] offset:1024
  v_mfma_f32_16x16x32_bf16 v[128:131], a[84:87], a[128:131], v[128:131]
  ds_write_b128 v16, v[92:95] offset:2048
  v_mfma_f32_16x16x32_bf16 v[132:135], a[88:91], a[128:131], v[132:135]
  ds_write_b128 v16, v[96:99] offset:3072
  v_mfma_f32_16x16x32_bf16 v[136:139], a[92:95], a[128:131], v[136:139]
  ds_write_b128 v16, v[100:103] offset:4096
  v_mfma_f32_16x16x32_bf16 v[140:143], a[96:99], a[128:131], v[140:143]
  ds_write_b128 v17, v[104:107] offset:5120
  v_mfma_f32_16x16x32_bf16 v[64:67], a[80:83], a[116:119], v[64:67]
  ds_write_b128 v17, v[108:111] offset:6144
  v_mfma_f32_16x16x32_bf16 v[68:71], a[84:87], a[116:119], v[68:71]
  ds_write_b128 v17, v[112:115] offset:7168
  v_mfma_f32_16x16x32_bf16 v[72:75], a[88:91], a[116:119], v[72:75]
  ds_write_b128 v17, v[116:119] offset:8192
  v_mfma_f32_16x16x32_bf16 v[76:79], a[92:95], a[116:119], v[76:79]
  ds_write_b128 v17, v[120:123] offset:9216
  v_mfma_f32_16x16x32_bf16 v[80:83], a[96:99], a[116:119], v[80:83]
  ds_write_b128 v18, v[124:127] offset:10240
  ds_write_b128 v18, v[128:131] offset:11264
  ds_write_b128 v18, v[132:135] offset:12288
  ds_write_b128 v18, v[136:139] offset:13312
  ds_write_b128 v18, v[140:143] offset:14336
  s_mov_b32 s24, s18
  s_and_b32 s25, s19, 0xffff
  s_mov_b32 s26, 2359296
  s_mov_b32 s27, 0x20000
  v_lshlrev_b32 v20, 16, v204
  v_and_b32 v21, 0xffff0000, v204
  v_lshlrev_b32 v22, 16, v205
  v_and_b32 v23, 0xffff0000, v205
  v_lshlrev_b32 v24, 16, v206
  v_and_b32 v25, 0xffff0000, v206
  v_lshlrev_b32 v26, 16, v207
  v_and_b32 v27, 0xffff0000, v207
  v_lshlrev_b32 v28, 16, v208
  v_and_b32 v29, 0xffff0000, v208
  v_lshlrev_b32 v30, 16, v209
  v_and_b32 v31, 0xffff0000, v209
  v_lshlrev_b32 v32, 16, v210
  v_and_b32 v33, 0xffff0000, v210
  v_lshlrev_b32 v34, 16, v211
  v_and_b32 v35, 0xffff0000, v211
  v_lshlrev_b32 v36, 16, v212
  v_and_b32 v37, 0xffff0000, v212
  v_lshlrev_b32 v38, 16, v213
  v_and_b32 v39, 0xffff0000, v213
  s_waitcnt lgkmcnt(0)
  s_barrier
  ds_read_b128 v[84:87], v4 offset:0
  ds_read_b128 v[88:91], v4 offset:1024
  ds_read_b128 v[92:95], v4 offset:2048
  ds_read_b128 v[96:99], v4 offset:3072
  ds_read_b128 v[100:103], v4 offset:4096
  ds_read_b128 v[104:107], v4 offset:5120
  ds_read_b128 v[108:111], v4 offset:6144
  ds_read_b128 v[112:115], v4 offset:7168
  ds_read_b128 v[116:119], v4 offset:8192
  ds_read_b128 v[120:123], v4 offset:9216
  ds_read_b128 v[124:127], v4 offset:10240
  ds_read_b128 v[128:131], v4 offset:11264
  ds_read_b128 v[132:135], v4 offset:12288
  ds_read_b128 v[136:139], v4 offset:13312
  ds_read_b128 v[140:143], v4 offset:14336
  s_waitcnt lgkmcnt(10)
  v_pk_add_f32 v[64:65], v[64:65], v[84:85]
  v_pk_add_f32 v[66:67], v[66:67], v[86:87]
  v_pk_add_f32 v[68:69], v[68:69], v[88:89]
  v_pk_add_f32 v[70:71], v[70:71], v[90:91]
  v_pk_add_f32 v[72:73], v[72:73], v[92:93]
  v_pk_add_f32 v[74:75], v[74:75], v[94:95]
  v_pk_add_f32 v[76:77], v[76:77], v[96:97]
  v_pk_add_f32 v[78:79], v[78:79], v[98:99]
  v_pk_add_f32 v[80:81], v[80:81], v[100:101]
  v_pk_add_f32 v[82:83], v[82:83], v[102:103]
  s_waitcnt lgkmcnt(5)
  v_pk_add_f32 v[64:65], v[64:65], v[104:105]
  v_pk_add_f32 v[66:67], v[66:67], v[106:107]
  v_pk_add_f32 v[68:69], v[68:69], v[108:109]
  v_pk_add_f32 v[70:71], v[70:71], v[110:111]
  v_pk_add_f32 v[72:73], v[72:73], v[112:113]
  v_pk_add_f32 v[74:75], v[74:75], v[114:115]
  v_pk_add_f32 v[76:77], v[76:77], v[116:117]
  v_pk_add_f32 v[78:79], v[78:79], v[118:119]
  v_pk_add_f32 v[80:81], v[80:81], v[120:121]
  v_pk_add_f32 v[82:83], v[82:83], v[122:123]
  s_waitcnt lgkmcnt(0)
  v_pk_add_f32 v[64:65], v[64:65], v[124:125]
  v_pk_add_f32 v[66:67], v[66:67], v[126:127]
  v_pk_add_f32 v[68:69], v[68:69], v[128:129]
  v_pk_add_f32 v[70:71], v[70:71], v[130:131]
  v_pk_add_f32 v[72:73], v[72:73], v[132:133]
  v_pk_add_f32 v[74:75], v[74:75], v[134:135]
  v_pk_add_f32 v[76:77], v[76:77], v[136:137]
  v_pk_add_f32 v[78:79], v[78:79], v[138:139]
  v_pk_add_f32 v[80:81], v[80:81], v[140:141]
  v_pk_add_f32 v[82:83], v[82:83], v[142:143]
  v_pk_fma_f32 v[20:21], v[64:65], v[224:225], v[20:21]
  v_pk_fma_f32 v[22:23], v[66:67], v[226:227], v[22:23]
  v_pk_fma_f32 v[24:25], v[68:69], v[228:229], v[24:25]
  v_pk_fma_f32 v[26:27], v[70:71], v[230:231], v[26:27]
  v_pk_fma_f32 v[28:29], v[72:73], v[232:233], v[28:29]
  v_pk_fma_f32 v[30:31], v[74:75], v[234:235], v[30:31]
  v_pk_fma_f32 v[32:33], v[76:77], v[236:237], v[32:33]
  v_pk_fma_f32 v[34:35], v[78:79], v[238:239], v[34:35]
  v_pk_fma_f32 v[36:37], v[80:81], v[240:241], v[36:37]
  v_pk_fma_f32 v[38:39], v[82:83], v[242:243], v[38:39]
  v_cvt_pk_bf16_f32 v204, v20, v21
  v_cvt_pk_bf16_f32 v205, v22, v23
  v_cvt_pk_bf16_f32 v206, v24, v25
  v_cvt_pk_bf16_f32 v207, v26, v27
  v_cvt_pk_bf16_f32 v208, v28, v29
  v_cvt_pk_bf16_f32 v209, v30, v31
  v_cvt_pk_bf16_f32 v210, v32, v33
  v_cvt_pk_bf16_f32 v211, v34, v35
  v_cvt_pk_bf16_f32 v212, v36, v37
  v_cvt_pk_bf16_f32 v213, v38, v39
  buffer_store_dwordx4 v[204:207], v10, s[24:27], 0 offen
  buffer_store_dwordx4 v[208:211], v10, s[24:27], 0 offen offset:64
  buffer_store_dwordx2 v[212:213], v11, s[24:27], 0 offen
L_k4_end:
  s_endpgm
L_end_k3_kernel:
.section .rodata,"a"
.p2align 6
.amdhsa_kernel k3_kernel
  .amdhsa_next_free_vgpr 512
  .amdhsa_next_free_sgpr 68
  .amdhsa_accum_offset 256
  .amdhsa_group_segment_fixed_size 0
  .amdhsa_kernarg_size 120
  .amdhsa_user_sgpr_count 2
  .amdhsa_user_sgpr_kernarg_segment_ptr 1
  .amdhsa_system_sgpr_workgroup_id_x 1
  .amdhsa_float_denorm_mode_32 3
.end_amdhsa_kernel
```
